```python
import torch

def _softmax(x, axis=-1):
    return torch.softmax(x, dim=axis)

def _gelu(x):
    return torch.nn.functional.gelu(x, approximate='tanh')

def _silu(x):
    return torch.nn.functional.silu(x)

def _sigmoid(x):
    return torch.sigmoid(x)

def _layernorm(x, axis=-1, eps=1e-05):
    m = x.mean(dim=axis, keepdim=True)
    v = x.var(dim=axis, keepdim=True, unbiased=False)
    return (x - m) / torch.sqrt(v + eps)

def _scatter_add(tgt, idx, src, axis=0):
    return tgt.clone().index_add_(axis, idx, src)

def _segment_sum(src, seg, n):
    out = torch.zeros((n,) + src.shape[1:], dtype=src.dtype)
    return out.index_add_(0, seg, src)

def _pad(x, pw):
    flat = tuple((v for pair in reversed(pw) for v in pair))
    return torch.nn.functional.pad(x, flat)
kernel_name = 'gated_mix__memory_aug_recurrent_mem_tr__memory_aug_recurrent_mem_tr__prompt'

def setup_inputs():

    _w = lambda a: (lambda t: t.to(torch.bfloat16) if t.is_floating_point() else t)(torch.as_tensor(a))

    def _A_setup():
        B, S, Dm = (1, 2048, 512)
        H, Dh = (32, 128)
        M, seg = (8, 32)
        seg = min(seg, S)
        S = S // seg * seg
        return {'x': _w((lambda *s: torch.randn(*s, dtype=torch.bfloat16) * 0.05)(B, S, Dm)), 'mem0': _w((lambda *s: torch.randn(*s, dtype=torch.bfloat16) * 0.4)(B, M, Dm)), 'Wq': _w((lambda *s: torch.randn(*s, dtype=torch.bfloat16) * 6.4)(Dm, H, Dh) * Dm ** (-0.5)), 'Wk': _w((lambda *s: torch.randn(*s, dtype=torch.bfloat16) * 6.4)(Dm, H, Dh) * Dm ** (-0.5)), 'Wv': _w((lambda *s: torch.randn(*s, dtype=torch.bfloat16) * 0.4)(Dm, H, Dh) * Dm ** (-0.5)), 'Wo': _w((lambda *s: torch.randn(*s, dtype=torch.bfloat16) * 0.4)(H, Dh, Dm) * (H * Dh) ** (-0.5)), 'seg_len': seg}
    _A_in = _A_setup()

    def _B_setup():
        B, S, Dm = (1, 2048, 512)
        H, Dh = (32, 128)
        M, seg = (8, 32)
        seg = min(seg, S)
        S = S // seg * seg
        return {'x': _w((lambda *s: torch.randn(*s, dtype=torch.bfloat16) * 0.05)(B, S, Dm)), 'mem0': _w((lambda *s: torch.randn(*s, dtype=torch.bfloat16) * 0.4)(B, M, Dm)), 'Wq': _w((lambda *s: torch.randn(*s, dtype=torch.bfloat16) * 6.4)(Dm, H, Dh) * Dm ** (-0.5)), 'Wk': _w((lambda *s: torch.randn(*s, dtype=torch.bfloat16) * 6.4)(Dm, H, Dh) * Dm ** (-0.5)), 'Wv': _w((lambda *s: torch.randn(*s, dtype=torch.bfloat16) * 0.4)(Dm, H, Dh) * Dm ** (-0.5)), 'Wo': _w((lambda *s: torch.randn(*s, dtype=torch.bfloat16) * 0.4)(H, Dh, Dm) * (H * Dh) ** (-0.5)), 'seg_len': seg}
    _B_in = _B_setup()
    return {'A_x': _A_in['x'], 'A_mem0': _A_in['mem0'], 'A_Wq': _A_in['Wq'], 'A_Wk': _A_in['Wk'], 'A_Wv': _A_in['Wv'], 'A_Wo': _A_in['Wo'], 'A_seg_len': _A_in['seg_len'], 'B_x': _B_in['x'], 'B_mem0': _B_in['mem0'], 'B_Wq': _B_in['Wq'], 'B_Wk': _B_in['Wk'], 'B_Wv': _B_in['Wv'], 'B_Wo': _B_in['Wo'], 'B_seg_len': _B_in['seg_len'], 'gate_w': _w((lambda *s: torch.randn(*s, dtype=torch.bfloat16) * 0.05)(512) * 16.0)}

def reference(A_x, A_mem0, A_Wq, A_Wk, A_Wv, A_Wo, A_seg_len, B_x, B_mem0, B_Wq, B_Wk, B_Wv, B_Wo, B_seg_len, gate_w):

    def _A_ref(x, mem0, Wq, Wk, Wv, Wo, seg_len):
        B, S, Dm = x.shape
        H, Dh = (Wq.shape[1], Wq.shape[2])
        M = mem0.shape[1]
        scale = Dh ** (-0.5)
        n_seg = S // seg_len
        L = M + seg_len
        idx = torch.arange(L)
        mask = (idx[:, None] < M) | (idx[:, None] >= idx[None, :])
        mem = mem0
        outs = []
        for s in range(n_seg):
            xs = x[:, s * seg_len:(s + 1) * seg_len, :].clone()
            h = torch.concatenate([mem, xs], axis=1)
            q = torch.einsum('btd,dhe->bhte', h, Wq)
            k = torch.einsum('btd,dhe->bhte', h, Wk)
            v = torch.einsum('btd,dhe->bhte', h, Wv)
            scores = torch.einsum('bhqe,bhke->bhqk', q, k) * scale
            scores = torch.where(mask[None, None], scores, -1000000000.0)
            p = _softmax(scores, axis=-1)
            o = torch.einsum('bhqk,bhke->bhqe', p, v)
            o = torch.einsum('bhte,hed->btd', o, Wo)
            mem = o[:, :M, :].clone()
            outs.append(o[:, M:, :])
        return torch.concatenate(outs, axis=1)

    def _B_ref(x, mem0, Wq, Wk, Wv, Wo, seg_len):
        B, S, Dm = x.shape
        H, Dh = (Wq.shape[1], Wq.shape[2])
        M = mem0.shape[1]
        scale = Dh ** (-0.5)
        n_seg = S // seg_len
        L = M + seg_len
        idx = torch.arange(L)
        mask = (idx[:, None] < M) | (idx[:, None] >= idx[None, :])
        mem = mem0
        outs = []
        for s in range(n_seg):
            xs = x[:, s * seg_len:(s + 1) * seg_len, :].clone()
            h = torch.concatenate([mem, xs], axis=1)
            q = torch.einsum('btd,dhe->bhte', h, Wq)
            k = torch.einsum('btd,dhe->bhte', h, Wk)
            v = torch.einsum('btd,dhe->bhte', h, Wv)
            scores = torch.einsum('bhqe,bhke->bhqk', q, k) * scale
            scores = torch.where(mask[None, None], scores, -1000000000.0)
            p = _softmax(scores, axis=-1)
            o = torch.einsum('bhqk,bhke->bhqe', p, v)
            o = torch.einsum('bhte,hed->btd', o, Wo)
            mem = o[:, :M, :].clone()
            outs.append(o[:, M:, :])
        return torch.concatenate(outs, axis=1)
    x = A_x
    g = _sigmoid((x * gate_w).sum(-1, keepdims=True))
    a = _A_ref(x, A_mem0, A_Wq, A_Wk, A_Wv, A_Wo, A_seg_len)
    b = _B_ref(x, B_mem0, B_Wq, B_Wk, B_Wv, B_Wo, B_seg_len)
    return g * a + (1 - g) * b
```

```asm
; @launch grid=(256,1,1) block=(256,1,1) lds=163840
.amdgcn_target "amdgcn-amd-amdhsa--gfx950"
.text
.globl gated_mix__memory_aug_recurrent_mem_tr__memory_aug_recurrent_mem_tr__prompt_kernel
.p2align 8
.type gated_mix__memory_aug_recurrent_mem_tr__memory_aug_recurrent_mem_tr__prompt_kernel,@function
gated_mix__memory_aug_recurrent_mem_tr__memory_aug_recurrent_mem_tr__prompt_kernel:
    s_cmp_ge_u32 s2, 256
    s_cbranch_scc1 L_end
    s_and_b32 s4, s2, 7
    s_cmp_ge_u32 s4, 2
    s_cbranch_scc1 L_worker
    s_load_dwordx4 s[8:11], s[0:1], 16
    s_load_dwordx4 s[12:15], s[0:1], 32
    s_load_dwordx2 s[16:17], s[0:1], 8
    s_load_dwordx2 s[18:19], s[0:1], 136
    s_load_dwordx4 s[64:67], s[0:1], 72
    s_load_dwordx4 s[68:71], s[0:1], 88
    s_load_dwordx2 s[72:73], s[0:1], 64
    s_load_dwordx2 s[62:63], s[0:1], 128
    s_and_b32 s4, s2, 7
    s_lshr_b32 s5, s2, 3
    v_lshrrev_b32 v2, 6, v0
    v_and_b32 v1, 63, v0
    s_nop 0
    v_readfirstlane_b32 s6, v2
    s_waitcnt lgkmcnt(0)
    s_cmp_eq_u32 s4, 1
    s_cselect_b32 s8, s64, s8
    s_cselect_b32 s9, s65, s9
    s_cselect_b32 s10, s66, s10
    s_cselect_b32 s11, s67, s11
    s_cselect_b32 s12, s68, s12
    s_cselect_b32 s13, s69, s13
    s_cselect_b32 s14, s70, s14
    s_cselect_b32 s15, s71, s15
    s_cselect_b32 s16, s72, s16
    s_cselect_b32 s17, s73, s17
    v_mov_b32 v126, v1
    v_mov_b32 v127, v1
    v_mov_b32 v0, v1
    v_and_b32 v20, 15, v0
    v_lshrrev_b32 v21, 4, v0
    v_lshlrev_b32 v1, 4, v0
    v_and_b32 v22, 1, v0
    v_mov_b32 v23, 0x4444
    v_mov_b32 v24, 0xeeee
    v_cmp_eq_u32 vcc, 1, v22
    s_nop 1
    v_cndmask_b32 v2, v23, v24, vcc
    v_and_b32 v22, 7, v20
    v_lshrrev_b32 v23, 1, v22
    v_and_b32 v24, 1, v22
    v_mov_b32 v25, 0x3f80
    v_mov_b32 v26, 0x3f800000
    v_cmp_eq_u32 vcc, 1, v24
    s_nop 1
    v_cndmask_b32 v25, v25, v26, vcc
    v_cmp_eq_u32 vcc, 0, v23
    s_nop 1
    v_cndmask_b32 v4, 0, v25, vcc
    v_cmp_eq_u32 vcc, 1, v23
    s_nop 1
    v_cndmask_b32 v5, 0, v25, vcc
    v_cmp_eq_u32 vcc, 2, v23
    s_nop 1
    v_cndmask_b32 v6, 0, v25, vcc
    v_cmp_eq_u32 vcc, 3, v23
    s_nop 1
    v_cndmask_b32 v7, 0, v25, vcc
    s_lshl_b32 s39, s6, 3
    v_add_u32 v22, s39, v21
    v_lshlrev_b32 v22, 13, v22
    s_lshl_b32 s39, s5, 6
    v_lshrrev_b32 v23, 2, v20
    v_lshlrev_b32 v23, 11, v23
    v_add3_u32 v22, v22, v23, s39
    v_and_b32 v23, 3, v20
    v_lshl_add_u32 v8, v23, 4, v22
    v_and_b32 v22, 1, v0
    v_lshlrev_b32 v9, 13, v22
    v_and_b32 v22, 1, v20
    v_lshlrev_b32 v22, 1, v22
    v_and_b32 v23, 7, v20
    v_lshrrev_b32 v23, 2, v23
    v_add_u32 v22, v22, v23
    v_lshlrev_b32 v22, 4, v22
    v_and_b32 v23, 1, v21
    v_lshlrev_b32 v23, 1, v23
    v_lshrrev_b32 v24, 1, v21
    v_add_u32 v23, v23, v24
    v_lshl_add_u32 v22, v23, 2, v22
    s_lshr_b32 s39, s5, 2
    s_lshl_b32 s39, s39, 10
    s_and_b32 s40, s5, 3
    s_lshl_b32 s40, s40, 6
    s_add_u32 s39, s39, s40
    s_lshl_b32 s40, s6, 8
    s_add_u32 s39, s39, s40
    v_add_u32 v10, s39, v22
    v_lshrrev_b32 v22, 3, v20
    v_lshlrev_b32 v22, 15, v22
    v_add_u32 v10, v10, v22
    s_lshl_b32 s39, s6, 10
    s_add_u32 s39, s39, 24576
    v_lshlrev_b32 v22, 5, v20
    v_lshl_add_u32 v22, v21, 3, v22
    v_add_u32 v11, s39, v22
    v_lshrrev_b32 v22, 2, v20
    v_lshl_add_u32 v22, v21, 2, v22
    v_lshlrev_b32 v22, 5, v22
    v_and_b32 v23, 3, v20
    v_lshl_add_u32 v22, v23, 3, v22
    v_add_u32 v12, 24576, v22
    v_lshrrev_b32 v22, 2, v20
    v_lshlrev_b32 v22, 1, v22
    v_and_b32 v23, 1, v20
    v_add_u32 v22, v22, v23
    v_mul_u32_u24 v22, 272, v22
    v_lshl_add_u32 v22, v21, 3, v22
    s_lshl_b32 s39, s6, 6
    s_add_u32 s39, s39, 28672
    v_add_u32 v13, s39, v22
    v_lshrrev_b32 v22, 2, v20
    v_lshlrev_b32 v22, 1, v22
    v_lshrrev_b32 v23, 1, v20
    v_and_b32 v23, 1, v23
    v_add_u32 v22, v22, v23
    v_mul_u32_u24 v22, 272, v22
    v_lshl_add_u32 v22, v21, 5, v22
    v_and_b32 v23, 1, v20
    v_lshl_add_u32 v22, v23, 4, v22
    v_add_u32 v14, 28672, v22
    s_lshl_b32 s39, s6, 14
    s_add_u32 s39, s39, 32768
    v_add_u32 v15, s39, v1
    v_add_u32 v0, 0x10000, v15
    s_mov_b32 s44, 0xcccccccc
    s_mov_b32 s45, 0xcccccccc
    s_mov_b32 s46, 0x00330033
    s_mov_b32 s47, 0x00330033
    s_mov_b32 s50, 0x3e0293ee
    s_mov_b32 s51, 0x3e0293ee
    s_lshl_b32 s39, s4, 19
    s_add_u32 s39, s39, 0x4000000
    s_add_u32 s20, s18, s39
    s_addc_u32 s21, s19, 0
    s_lshl_b32 s39, s4, 16
    s_add_u32 s39, s39, 0x4100000
    s_add_u32 s22, s18, s39
    s_addc_u32 s23, s19, 0
    s_lshl_b32 s39, s5, 13
    s_lshl_b32 s40, s6, 11
    s_add_u32 s39, s39, s40
    s_add_u32 s96, s20, s39
    s_addc_u32 s97, s21, 0
    s_add_u32 s64, s20, s39
    s_addc_u32 s65, s21, 0
    s_add_u32 s100, s40, 16384
    s_mov_b32 s101, s40
    s_lshl_b32 s40, s4, 11
    s_add_u32 s40, s40, s5
    s_lshl_b32 s39, s40, 13
    s_lshl_b32 s41, s6, 11
    s_add_u32 s39, s39, s41
    s_add_u32 s28, s18, s39
    s_addc_u32 s29, s19, 0
    s_add_u32 s39, s39, 0x2000000
    s_add_u32 s30, s18, s39
    s_addc_u32 s31, s19, 0
    s_lshl_b32 s39, s40, 12
    s_lshl_b32 s41, s6, 10
    s_add_u32 s39, s39, s41
    s_add_u32 s39, s39, 0x4200000
    s_add_u32 s32, s18, s39
    s_addc_u32 s33, s19, 0
    s_lshl_b32 s39, s4, 5
    s_add_u32 s39, s39, s5
    s_lshl_b32 s39, s39, 7
    s_add_u32 s41, s39, 0x5200000
    s_add_u32 s34, s18, s41
    s_addc_u32 s35, s19, 0
    s_add_u32 s41, s39, 0x5204000
    s_add_u32 s92, s18, s41
    s_addc_u32 s93, s19, 0
    s_lshl_b32 s39, s4, 19
    s_add_u32 s39, s39, 0xb402000
    s_add_u32 s36, s18, s39
    s_addc_u32 s37, s19, 0
    s_lshl_b32 s49, s6, 11
    s_add_u32 s49, s49, 0
    v_mov_b32 v20, -1
    v_mov_b32 v21, -1
    v_mov_b32 v22, -1
    v_mov_b32 v23, -1
    global_store_dwordx4 v1, v[20:23], s[64:65] sc1
    global_store_dwordx4 v1, v[20:23], s[64:65] offset:1024 sc1
    s_mov_b64 exec, s[46:47]
    v_mov_b32 v24, v10
    global_store_dword v24, v20, s[22:23] sc1
    v_add_u32 v24, 0x2000, v24
    global_store_dword v24, v20, s[22:23] sc1
    v_add_u32 v24, 0x2000, v24
    global_store_dword v24, v20, s[22:23] sc1
    v_add_u32 v24, 0x2000, v24
    global_store_dword v24, v20, s[22:23] sc1
    s_mov_b64 exec, -1
    v_mov_b32 v20, 0
    s_mov_b64 exec, 1
    global_store_dword v20, v20, s[92:93] sc1
    s_getreg_b32 s39, hwreg(HW_REG_XCC_ID)
    s_and_b32 s39, s39, 15
    s_add_u32 s39, s39, 1
    v_mov_b32 v21, s39
    s_add_u32 s42, s92, 24576
    s_addc_u32 s43, s93, 0
    global_store_dword v20, v21, s[42:43] sc1
    s_mov_b64 exec, -1
    v_and_b32 v20, 15, v127
    v_lshrrev_b32 v21, 4, v127
    v_lshrrev_b32 v22, 2, v20
    v_lshlrev_b32 v22, 1, v22
    v_lshrrev_b32 v23, 1, v20
    v_and_b32 v23, 1, v23
    v_add_u32 v22, v22, v23
    v_lshlrev_b32 v22, 10, v22
    v_and_b32 v23, 1, v20
    v_lshl_add_u32 v22, v23, 6, v22
    v_lshl_add_u32 v22, v21, 3, v22
    s_lshl_b32 s39, s6, 8
    v_add_u32 v22, s39, v22
    global_load_ushort v24, v22, s[16:17] offset:0
    global_load_ushort v25, v22, s[16:17] offset:32
    global_load_ushort v26, v22, s[16:17] offset:2
    global_load_ushort v27, v22, s[16:17] offset:34
    global_load_ushort v28, v22, s[16:17] offset:4
    global_load_ushort v29, v22, s[16:17] offset:36
    global_load_ushort v30, v22, s[16:17] offset:6
    global_load_ushort v31, v22, s[16:17] offset:38
    global_load_ushort v32, v22, s[16:17] offset:128
    global_load_ushort v33, v22, s[16:17] offset:160
    global_load_ushort v34, v22, s[16:17] offset:130
    global_load_ushort v35, v22, s[16:17] offset:162
    global_load_ushort v36, v22, s[16:17] offset:132
    global_load_ushort v37, v22, s[16:17] offset:164
    global_load_ushort v38, v22, s[16:17] offset:134
    global_load_ushort v39, v22, s[16:17] offset:166
    v_lshrrev_b32 v104, 4, v126
    v_and_b32 v105, 15, v126
    v_lshrrev_b32 v105, 2, v105
    v_and_b32 v106, 3, v126
    v_and_b32 v107, 15, v126
    v_lshrrev_b32 v110, 5, v126
    v_lshlrev_b32 v110, 2, v110
    s_lshl_b32 s39, s6, 1
    s_and_b32 s40, s39, 3
    v_add_u32 v111, s40, v110
    s_add_u32 s40, s39, 1
    s_and_b32 s40, s40, 3
    v_add_u32 v112, s40, v110
    v_lshlrev_b32 v111, 1, v111
    v_lshlrev_b32 v112, 1, v112
    v_xor_b32 v111, v107, v111
    v_xor_b32 v112, v107, v112
    v_lshlrev_b32 v111, 4, v111
    v_lshlrev_b32 v112, 4, v112
    s_lshl_b32 s39, s6, 5
    v_add_u32 v113, s39, v104
    v_lshlrev_b32 v113, 13, v113
    s_lshl_b32 s39, s5, 8
    v_add3_u32 v108, v113, v111, s39
    v_add3_u32 v109, v113, v112, s39
    v_and_b32 v110, 1, v104
    v_lshlrev_b32 v110, 2, v110
    v_add_u32 v110, v110, v105
    s_lshl_b32 s39, s6, 1
    v_xor_b32 v111, s39, v110
    s_add_u32 s39, s39, 1
    v_xor_b32 v112, s39, v110
    v_lshlrev_b32 v111, 5, v111
    v_lshlrev_b32 v112, 5, v112
    v_lshlrev_b32 v113, 4, v105
    v_lshl_add_u32 v113, v104, 1, v113
    v_lshlrev_b32 v113, 8, v113
    v_lshl_add_u32 v113, v106, 3, v113
    v_add_u32 v113, 32768, v113
    v_add_u32 v114, v113, v111
    v_add_u32 v115, v113, v112
    v_add_u32 v116, 0x10000, v114
    v_add_u32 v117, 0x10000, v115
    v_lshlrev_b32 v118, 4, v126
    v_add_u32 v122, -32768, v114
    v_add_u32 v123, -32768, v115
    s_add_u32 s42, s10, 0x0
    s_addc_u32 s43, s11, 0
    s_lshl_b32 s39, s6, 13
    s_add_u32 m0, s39, 131072
    s_nop 0
    global_load_lds_dwordx4 v108, s[42:43]
    s_add_u32 s42, s10, 0x8000
    s_addc_u32 s43, s11, 0
    s_lshl_b32 s39, s6, 13
    s_add_u32 m0, s39, 132096
    s_nop 0
    global_load_lds_dwordx4 v108, s[42:43]
    s_add_u32 s42, s10, 0x10000
    s_addc_u32 s43, s11, 0
    s_lshl_b32 s39, s6, 13
    s_add_u32 m0, s39, 133120
    s_nop 0
    global_load_lds_dwordx4 v108, s[42:43]
    s_add_u32 s42, s10, 0x18000
    s_addc_u32 s43, s11, 0
    s_lshl_b32 s39, s6, 13
    s_add_u32 m0, s39, 134144
    s_nop 0
    global_load_lds_dwordx4 v108, s[42:43]
    s_add_u32 s42, s10, 0x20000
    s_addc_u32 s43, s11, 0
    s_lshl_b32 s39, s6, 13
    s_add_u32 m0, s39, 135168
    s_nop 0
    global_load_lds_dwordx4 v109, s[42:43]
    s_add_u32 s42, s10, 0x28000
    s_addc_u32 s43, s11, 0
    s_lshl_b32 s39, s6, 13
    s_add_u32 m0, s39, 136192
    s_nop 0
    global_load_lds_dwordx4 v109, s[42:43]
    s_add_u32 s42, s10, 0x30000
    s_addc_u32 s43, s11, 0
    s_lshl_b32 s39, s6, 13
    s_add_u32 m0, s39, 137216
    s_nop 0
    global_load_lds_dwordx4 v109, s[42:43]
    s_add_u32 s42, s10, 0x38000
    s_addc_u32 s43, s11, 0
    s_lshl_b32 s39, s6, 13
    s_add_u32 m0, s39, 138240
    s_nop 0
    global_load_lds_dwordx4 v109, s[42:43]
    s_add_u32 s42, s10, 0x100000
    s_addc_u32 s43, s11, 0
    s_lshl_b32 s39, s6, 13
    s_add_u32 m0, s39, 0
    s_nop 0
    global_load_lds_dwordx4 v108, s[42:43]
    s_add_u32 s42, s10, 0x108000
    s_addc_u32 s43, s11, 0
    s_lshl_b32 s39, s6, 13
    s_add_u32 m0, s39, 1024
    s_nop 0
    global_load_lds_dwordx4 v108, s[42:43]
    s_add_u32 s42, s10, 0x110000
    s_addc_u32 s43, s11, 0
    s_lshl_b32 s39, s6, 13
    s_add_u32 m0, s39, 2048
    s_nop 0
    global_load_lds_dwordx4 v108, s[42:43]
    s_add_u32 s42, s10, 0x118000
    s_addc_u32 s43, s11, 0
    s_lshl_b32 s39, s6, 13
    s_add_u32 m0, s39, 3072
    s_nop 0
    global_load_lds_dwordx4 v108, s[42:43]
    s_add_u32 s42, s10, 0x120000
    s_addc_u32 s43, s11, 0
    s_lshl_b32 s39, s6, 13
    s_add_u32 m0, s39, 4096
    s_nop 0
    global_load_lds_dwordx4 v109, s[42:43]
    s_add_u32 s42, s10, 0x128000
    s_addc_u32 s43, s11, 0
    s_lshl_b32 s39, s6, 13
    s_add_u32 m0, s39, 5120
    s_nop 0
    global_load_lds_dwordx4 v109, s[42:43]
    s_add_u32 s42, s10, 0x130000
    s_addc_u32 s43, s11, 0
    s_lshl_b32 s39, s6, 13
    s_add_u32 m0, s39, 6144
    s_nop 0
    global_load_lds_dwordx4 v109, s[42:43]
    s_add_u32 s42, s10, 0x138000
    s_addc_u32 s43, s11, 0
    s_lshl_b32 s39, s6, 13
    s_add_u32 m0, s39, 7168
    s_nop 0
    global_load_lds_dwordx4 v109, s[42:43]
    s_add_u32 s42, s10, 0x200000
    s_addc_u32 s43, s11, 0
    s_lshl_b32 s39, s6, 13
    s_add_u32 m0, s39, 32768
    s_nop 0
    global_load_lds_dwordx4 v108, s[42:43]
    s_add_u32 s42, s10, 0x208000
    s_addc_u32 s43, s11, 0
    s_lshl_b32 s39, s6, 13
    s_add_u32 m0, s39, 33792
    s_nop 0
    global_load_lds_dwordx4 v108, s[42:43]
    s_add_u32 s42, s10, 0x210000
    s_addc_u32 s43, s11, 0
    s_lshl_b32 s39, s6, 13
    s_add_u32 m0, s39, 34816
    s_nop 0
    global_load_lds_dwordx4 v108, s[42:43]
    s_add_u32 s42, s10, 0x218000
    s_addc_u32 s43, s11, 0
    s_lshl_b32 s39, s6, 13
    s_add_u32 m0, s39, 35840
    s_nop 0
    global_load_lds_dwordx4 v108, s[42:43]
    s_add_u32 s42, s10, 0x220000
    s_addc_u32 s43, s11, 0
    s_lshl_b32 s39, s6, 13
    s_add_u32 m0, s39, 36864
    s_nop 0
    global_load_lds_dwordx4 v109, s[42:43]
    s_add_u32 s42, s10, 0x228000
    s_addc_u32 s43, s11, 0
    s_lshl_b32 s39, s6, 13
    s_add_u32 m0, s39, 37888
    s_nop 0
    global_load_lds_dwordx4 v109, s[42:43]
    s_add_u32 s42, s10, 0x230000
    s_addc_u32 s43, s11, 0
    s_lshl_b32 s39, s6, 13
    s_add_u32 m0, s39, 38912
    s_nop 0
    global_load_lds_dwordx4 v109, s[42:43]
    s_add_u32 s42, s10, 0x238000
    s_addc_u32 s43, s11, 0
    s_lshl_b32 s39, s6, 13
    s_add_u32 m0, s39, 39936
    s_nop 0
    global_load_lds_dwordx4 v109, s[42:43]
    s_add_u32 s42, s10, 0x300000
    s_addc_u32 s43, s11, 0
    s_lshl_b32 s39, s6, 13
    s_add_u32 m0, s39, 65536
    s_nop 0
    global_load_lds_dwordx4 v108, s[42:43]
    s_add_u32 s42, s10, 0x308000
    s_addc_u32 s43, s11, 0
    s_lshl_b32 s39, s6, 13
    s_add_u32 m0, s39, 66560
    s_nop 0
    global_load_lds_dwordx4 v108, s[42:43]
    s_add_u32 s42, s10, 0x310000
    s_addc_u32 s43, s11, 0
    s_lshl_b32 s39, s6, 13
    s_add_u32 m0, s39, 67584
    s_nop 0
    global_load_lds_dwordx4 v108, s[42:43]
    s_add_u32 s42, s10, 0x318000
    s_addc_u32 s43, s11, 0
    s_lshl_b32 s39, s6, 13
    s_add_u32 m0, s39, 68608
    s_nop 0
    global_load_lds_dwordx4 v108, s[42:43]
    s_add_u32 s42, s10, 0x320000
    s_addc_u32 s43, s11, 0
    s_lshl_b32 s39, s6, 13
    s_add_u32 m0, s39, 69632
    s_nop 0
    global_load_lds_dwordx4 v109, s[42:43]
    s_add_u32 s42, s10, 0x328000
    s_addc_u32 s43, s11, 0
    s_lshl_b32 s39, s6, 13
    s_add_u32 m0, s39, 70656
    s_nop 0
    global_load_lds_dwordx4 v109, s[42:43]
    s_add_u32 s42, s10, 0x330000
    s_addc_u32 s43, s11, 0
    s_lshl_b32 s39, s6, 13
    s_add_u32 m0, s39, 71680
    s_nop 0
    global_load_lds_dwordx4 v109, s[42:43]
    s_add_u32 s42, s10, 0x338000
    s_addc_u32 s43, s11, 0
    s_lshl_b32 s39, s6, 13
    s_add_u32 m0, s39, 72704
    s_nop 0
    global_load_lds_dwordx4 v109, s[42:43]
    s_waitcnt vmcnt(24)
    s_barrier
    s_cmp_eq_u32 s6, 0
    s_cbranch_scc0 LARR_1
    v_mov_b32 v20, 0
    v_mov_b32 v21, 1
    s_mov_b64 exec, 1
    global_atomic_add v20, v21, s[62:63]
    s_mov_b64 exec, -1
LARR_1:
    s_add_u32 s42, s12, 0x0
    s_addc_u32 s43, s13, 0
    s_lshl_b32 s39, s6, 13
    s_add_u32 m0, s39, 98304
    s_nop 0
    global_load_lds_dwordx4 v108, s[42:43]
    s_add_u32 s42, s12, 0x8000
    s_addc_u32 s43, s13, 0
    s_lshl_b32 s39, s6, 13
    s_add_u32 m0, s39, 99328
    s_nop 0
    global_load_lds_dwordx4 v108, s[42:43]
    s_add_u32 s42, s12, 0x10000
    s_addc_u32 s43, s13, 0
    s_lshl_b32 s39, s6, 13
    s_add_u32 m0, s39, 100352
    s_nop 0
    global_load_lds_dwordx4 v108, s[42:43]
    s_add_u32 s42, s12, 0x18000
    s_addc_u32 s43, s13, 0
    s_lshl_b32 s39, s6, 13
    s_add_u32 m0, s39, 101376
    s_nop 0
    global_load_lds_dwordx4 v108, s[42:43]
    s_add_u32 s42, s12, 0x20000
    s_addc_u32 s43, s13, 0
    s_lshl_b32 s39, s6, 13
    s_add_u32 m0, s39, 102400
    s_nop 0
    global_load_lds_dwordx4 v109, s[42:43]
    s_add_u32 s42, s12, 0x28000
    s_addc_u32 s43, s13, 0
    s_lshl_b32 s39, s6, 13
    s_add_u32 m0, s39, 103424
    s_nop 0
    global_load_lds_dwordx4 v109, s[42:43]
    s_add_u32 s42, s12, 0x30000
    s_addc_u32 s43, s13, 0
    s_lshl_b32 s39, s6, 13
    s_add_u32 m0, s39, 104448
    s_nop 0
    global_load_lds_dwordx4 v109, s[42:43]
    s_add_u32 s42, s12, 0x38000
    s_addc_u32 s43, s13, 0
    s_lshl_b32 s39, s6, 13
    s_add_u32 m0, s39, 105472
    s_nop 0
    global_load_lds_dwordx4 v109, s[42:43]
    ds_read_b64_tr_b16 a[128:129], v116 offset:32768
    ds_read_b64_tr_b16 a[130:131], v116 offset:33024
    ds_read_b64_tr_b16 a[132:133], v116 offset:34816
    ds_read_b64_tr_b16 a[134:135], v116 offset:35072
    ds_read_b64_tr_b16 a[136:137], v116 offset:49152
    ds_read_b64_tr_b16 a[138:139], v116 offset:49408
    ds_read_b64_tr_b16 a[140:141], v116 offset:51200
    ds_read_b64_tr_b16 a[142:143], v116 offset:51456
    ds_read_b64_tr_b16 a[192:193], v117 offset:32768
    ds_read_b64_tr_b16 a[194:195], v117 offset:33024
    ds_read_b64_tr_b16 a[196:197], v117 offset:34816
    ds_read_b64_tr_b16 a[198:199], v117 offset:35072
    ds_read_b64_tr_b16 a[200:201], v117 offset:49152
    ds_read_b64_tr_b16 a[202:203], v117 offset:49408
    ds_read_b64_tr_b16 a[204:205], v117 offset:51200
    ds_read_b64_tr_b16 a[206:207], v117 offset:51456
    s_waitcnt lgkmcnt(0)
    s_waitcnt vmcnt(24)
    s_barrier
    s_add_u32 s42, s12, 0x100000
    s_addc_u32 s43, s13, 0
    s_lshl_b32 s39, s6, 13
    s_add_u32 m0, s39, 131072
    s_nop 0
    global_load_lds_dwordx4 v108, s[42:43]
    s_add_u32 s42, s12, 0x108000
    s_addc_u32 s43, s13, 0
    s_lshl_b32 s39, s6, 13
    s_add_u32 m0, s39, 132096
    s_nop 0
    global_load_lds_dwordx4 v108, s[42:43]
    s_add_u32 s42, s12, 0x110000
    s_addc_u32 s43, s13, 0
    s_lshl_b32 s39, s6, 13
    s_add_u32 m0, s39, 133120
    s_nop 0
    global_load_lds_dwordx4 v108, s[42:43]
    s_add_u32 s42, s12, 0x118000
    s_addc_u32 s43, s13, 0
    s_lshl_b32 s39, s6, 13
    s_add_u32 m0, s39, 134144
    s_nop 0
    global_load_lds_dwordx4 v108, s[42:43]
    s_add_u32 s42, s12, 0x120000
    s_addc_u32 s43, s13, 0
    s_lshl_b32 s39, s6, 13
    s_add_u32 m0, s39, 135168
    s_nop 0
    global_load_lds_dwordx4 v109, s[42:43]
    s_add_u32 s42, s12, 0x128000
    s_addc_u32 s43, s13, 0
    s_lshl_b32 s39, s6, 13
    s_add_u32 m0, s39, 136192
    s_nop 0
    global_load_lds_dwordx4 v109, s[42:43]
    s_add_u32 s42, s12, 0x130000
    s_addc_u32 s43, s13, 0
    s_lshl_b32 s39, s6, 13
    s_add_u32 m0, s39, 137216
    s_nop 0
    global_load_lds_dwordx4 v109, s[42:43]
    s_add_u32 s42, s12, 0x138000
    s_addc_u32 s43, s13, 0
    s_lshl_b32 s39, s6, 13
    s_add_u32 m0, s39, 138240
    s_nop 0
    global_load_lds_dwordx4 v109, s[42:43]
    ds_read_b64_tr_b16 a[144:145], v122 offset:0
    ds_read_b64_tr_b16 a[146:147], v122 offset:256
    ds_read_b64_tr_b16 a[148:149], v122 offset:2048
    ds_read_b64_tr_b16 a[150:151], v122 offset:2304
    ds_read_b64_tr_b16 a[152:153], v122 offset:16384
    ds_read_b64_tr_b16 a[154:155], v122 offset:16640
    ds_read_b64_tr_b16 a[156:157], v122 offset:18432
    ds_read_b64_tr_b16 a[158:159], v122 offset:18688
    ds_read_b64_tr_b16 a[208:209], v123 offset:0
    ds_read_b64_tr_b16 a[210:211], v123 offset:256
    ds_read_b64_tr_b16 a[212:213], v123 offset:2048
    ds_read_b64_tr_b16 a[214:215], v123 offset:2304
    ds_read_b64_tr_b16 a[216:217], v123 offset:16384
    ds_read_b64_tr_b16 a[218:219], v123 offset:16640
    ds_read_b64_tr_b16 a[220:221], v123 offset:18432
    ds_read_b64_tr_b16 a[222:223], v123 offset:18688
    s_waitcnt lgkmcnt(0)
    s_waitcnt vmcnt(24)
    s_barrier
    s_add_u32 s42, s12, 0x200000
    s_addc_u32 s43, s13, 0
    s_lshl_b32 s39, s6, 13
    s_add_u32 m0, s39, 0
    s_nop 0
    global_load_lds_dwordx4 v108, s[42:43]
    s_add_u32 s42, s12, 0x208000
    s_addc_u32 s43, s13, 0
    s_lshl_b32 s39, s6, 13
    s_add_u32 m0, s39, 1024
    s_nop 0
    global_load_lds_dwordx4 v108, s[42:43]
    s_add_u32 s42, s12, 0x210000
    s_addc_u32 s43, s13, 0
    s_lshl_b32 s39, s6, 13
    s_add_u32 m0, s39, 2048
    s_nop 0
    global_load_lds_dwordx4 v108, s[42:43]
    s_add_u32 s42, s12, 0x218000
    s_addc_u32 s43, s13, 0
    s_lshl_b32 s39, s6, 13
    s_add_u32 m0, s39, 3072
    s_nop 0
    global_load_lds_dwordx4 v108, s[42:43]
    s_add_u32 s42, s12, 0x220000
    s_addc_u32 s43, s13, 0
    s_lshl_b32 s39, s6, 13
    s_add_u32 m0, s39, 4096
    s_nop 0
    global_load_lds_dwordx4 v109, s[42:43]
    s_add_u32 s42, s12, 0x228000
    s_addc_u32 s43, s13, 0
    s_lshl_b32 s39, s6, 13
    s_add_u32 m0, s39, 5120
    s_nop 0
    global_load_lds_dwordx4 v109, s[42:43]
    s_add_u32 s42, s12, 0x230000
    s_addc_u32 s43, s13, 0
    s_lshl_b32 s39, s6, 13
    s_add_u32 m0, s39, 6144
    s_nop 0
    global_load_lds_dwordx4 v109, s[42:43]
    s_add_u32 s42, s12, 0x238000
    s_addc_u32 s43, s13, 0
    s_lshl_b32 s39, s6, 13
    s_add_u32 m0, s39, 7168
    s_nop 0
    global_load_lds_dwordx4 v109, s[42:43]
    ds_read_b64_tr_b16 a[160:161], v114 offset:0
    ds_read_b64_tr_b16 a[162:163], v114 offset:256
    ds_read_b64_tr_b16 a[164:165], v114 offset:2048
    ds_read_b64_tr_b16 a[166:167], v114 offset:2304
    ds_read_b64_tr_b16 a[168:169], v114 offset:16384
    ds_read_b64_tr_b16 a[170:171], v114 offset:16640
    ds_read_b64_tr_b16 a[172:173], v114 offset:18432
    ds_read_b64_tr_b16 a[174:175], v114 offset:18688
    ds_read_b64_tr_b16 a[224:225], v115 offset:0
    ds_read_b64_tr_b16 a[226:227], v115 offset:256
    ds_read_b64_tr_b16 a[228:229], v115 offset:2048
    ds_read_b64_tr_b16 a[230:231], v115 offset:2304
    ds_read_b64_tr_b16 a[232:233], v115 offset:16384
    ds_read_b64_tr_b16 a[234:235], v115 offset:16640
    ds_read_b64_tr_b16 a[236:237], v115 offset:18432
    ds_read_b64_tr_b16 a[238:239], v115 offset:18688
    s_waitcnt lgkmcnt(0)
    s_waitcnt vmcnt(24)
    s_barrier
    s_add_u32 s42, s12, 0x300000
    s_addc_u32 s43, s13, 0
    s_lshl_b32 s39, s6, 13
    s_add_u32 m0, s39, 32768
    s_nop 0
    global_load_lds_dwordx4 v108, s[42:43]
    s_add_u32 s42, s12, 0x308000
    s_addc_u32 s43, s13, 0
    s_lshl_b32 s39, s6, 13
    s_add_u32 m0, s39, 33792
    s_nop 0
    global_load_lds_dwordx4 v108, s[42:43]
    s_add_u32 s42, s12, 0x310000
    s_addc_u32 s43, s13, 0
    s_lshl_b32 s39, s6, 13
    s_add_u32 m0, s39, 34816
    s_nop 0
    global_load_lds_dwordx4 v108, s[42:43]
    s_add_u32 s42, s12, 0x318000
    s_addc_u32 s43, s13, 0
    s_lshl_b32 s39, s6, 13
    s_add_u32 m0, s39, 35840
    s_nop 0
    global_load_lds_dwordx4 v108, s[42:43]
    s_add_u32 s42, s12, 0x320000
    s_addc_u32 s43, s13, 0
    s_lshl_b32 s39, s6, 13
    s_add_u32 m0, s39, 36864
    s_nop 0
    global_load_lds_dwordx4 v109, s[42:43]
    s_add_u32 s42, s12, 0x328000
    s_addc_u32 s43, s13, 0
    s_lshl_b32 s39, s6, 13
    s_add_u32 m0, s39, 37888
    s_nop 0
    global_load_lds_dwordx4 v109, s[42:43]
    s_add_u32 s42, s12, 0x330000
    s_addc_u32 s43, s13, 0
    s_lshl_b32 s39, s6, 13
    s_add_u32 m0, s39, 38912
    s_nop 0
    global_load_lds_dwordx4 v109, s[42:43]
    s_add_u32 s42, s12, 0x338000
    s_addc_u32 s43, s13, 0
    s_lshl_b32 s39, s6, 13
    s_add_u32 m0, s39, 39936
    s_nop 0
    global_load_lds_dwordx4 v109, s[42:43]
    ds_read_b64_tr_b16 a[176:177], v114 offset:32768
    ds_read_b64_tr_b16 a[178:179], v114 offset:33024
    ds_read_b64_tr_b16 a[180:181], v114 offset:34816
    ds_read_b64_tr_b16 a[182:183], v114 offset:35072
    ds_read_b64_tr_b16 a[184:185], v114 offset:49152
    ds_read_b64_tr_b16 a[186:187], v114 offset:49408
    ds_read_b64_tr_b16 a[188:189], v114 offset:51200
    ds_read_b64_tr_b16 a[190:191], v114 offset:51456
    ds_read_b64_tr_b16 a[240:241], v115 offset:32768
    ds_read_b64_tr_b16 a[242:243], v115 offset:33024
    ds_read_b64_tr_b16 a[244:245], v115 offset:34816
    ds_read_b64_tr_b16 a[246:247], v115 offset:35072
    ds_read_b64_tr_b16 a[248:249], v115 offset:49152
    ds_read_b64_tr_b16 a[250:251], v115 offset:49408
    ds_read_b64_tr_b16 a[252:253], v115 offset:51200
    ds_read_b64_tr_b16 a[254:255], v115 offset:51456
    s_waitcnt lgkmcnt(0)
    s_waitcnt vmcnt(24)
    s_barrier
    v_mov_b32 v20, 0
    global_load_dword v124, v20, s[62:63] sc1
    s_add_u32 s42, s8, 0x0
    s_addc_u32 s43, s9, 0
    s_lshl_b32 s39, s6, 13
    s_add_u32 m0, s39, 65536
    s_nop 0
    global_load_lds_dwordx4 v108, s[42:43]
    s_add_u32 s42, s8, 0x8000
    s_addc_u32 s43, s9, 0
    s_lshl_b32 s39, s6, 13
    s_add_u32 m0, s39, 66560
    s_nop 0
    global_load_lds_dwordx4 v108, s[42:43]
    s_add_u32 s42, s8, 0x10000
    s_addc_u32 s43, s9, 0
    s_lshl_b32 s39, s6, 13
    s_add_u32 m0, s39, 67584
    s_nop 0
    global_load_lds_dwordx4 v108, s[42:43]
    s_add_u32 s42, s8, 0x18000
    s_addc_u32 s43, s9, 0
    s_lshl_b32 s39, s6, 13
    s_add_u32 m0, s39, 68608
    s_nop 0
    global_load_lds_dwordx4 v108, s[42:43]
    s_add_u32 s42, s8, 0x20000
    s_addc_u32 s43, s9, 0
    s_lshl_b32 s39, s6, 13
    s_add_u32 m0, s39, 69632
    s_nop 0
    global_load_lds_dwordx4 v109, s[42:43]
    s_add_u32 s42, s8, 0x28000
    s_addc_u32 s43, s9, 0
    s_lshl_b32 s39, s6, 13
    s_add_u32 m0, s39, 70656
    s_nop 0
    global_load_lds_dwordx4 v109, s[42:43]
    s_add_u32 s42, s8, 0x30000
    s_addc_u32 s43, s9, 0
    s_lshl_b32 s39, s6, 13
    s_add_u32 m0, s39, 71680
    s_nop 0
    global_load_lds_dwordx4 v109, s[42:43]
    s_add_u32 s42, s8, 0x38000
    s_addc_u32 s43, s9, 0
    s_lshl_b32 s39, s6, 13
    s_add_u32 m0, s39, 72704
    s_nop 0
    global_load_lds_dwordx4 v109, s[42:43]
    ds_read_b64_tr_b16 v[128:129], v116 offset:0
    ds_read_b64_tr_b16 v[130:131], v116 offset:256
    ds_read_b64_tr_b16 v[132:133], v116 offset:2048
    ds_read_b64_tr_b16 v[134:135], v116 offset:2304
    ds_read_b64_tr_b16 v[136:137], v116 offset:16384
    ds_read_b64_tr_b16 v[138:139], v116 offset:16640
    ds_read_b64_tr_b16 v[140:141], v116 offset:18432
    ds_read_b64_tr_b16 v[142:143], v116 offset:18688
    ds_read_b64_tr_b16 v[192:193], v117 offset:0
    ds_read_b64_tr_b16 v[194:195], v117 offset:256
    ds_read_b64_tr_b16 v[196:197], v117 offset:2048
    ds_read_b64_tr_b16 v[198:199], v117 offset:2304
    ds_read_b64_tr_b16 v[200:201], v117 offset:16384
    ds_read_b64_tr_b16 v[202:203], v117 offset:16640
    ds_read_b64_tr_b16 v[204:205], v117 offset:18432
    ds_read_b64_tr_b16 v[206:207], v117 offset:18688
    s_waitcnt lgkmcnt(0)
    s_waitcnt vmcnt(24)
    s_barrier
    s_add_u32 s42, s8, 0x100000
    s_addc_u32 s43, s9, 0
    s_lshl_b32 s39, s6, 13
    s_add_u32 m0, s39, 98304
    s_nop 0
    global_load_lds_dwordx4 v108, s[42:43]
    s_add_u32 s42, s8, 0x108000
    s_addc_u32 s43, s9, 0
    s_lshl_b32 s39, s6, 13
    s_add_u32 m0, s39, 99328
    s_nop 0
    global_load_lds_dwordx4 v108, s[42:43]
    s_add_u32 s42, s8, 0x110000
    s_addc_u32 s43, s9, 0
    s_lshl_b32 s39, s6, 13
    s_add_u32 m0, s39, 100352
    s_nop 0
    global_load_lds_dwordx4 v108, s[42:43]
    s_add_u32 s42, s8, 0x118000
    s_addc_u32 s43, s9, 0
    s_lshl_b32 s39, s6, 13
    s_add_u32 m0, s39, 101376
    s_nop 0
    global_load_lds_dwordx4 v108, s[42:43]
    s_add_u32 s42, s8, 0x120000
    s_addc_u32 s43, s9, 0
    s_lshl_b32 s39, s6, 13
    s_add_u32 m0, s39, 102400
    s_nop 0
    global_load_lds_dwordx4 v109, s[42:43]
    s_add_u32 s42, s8, 0x128000
    s_addc_u32 s43, s9, 0
    s_lshl_b32 s39, s6, 13
    s_add_u32 m0, s39, 103424
    s_nop 0
    global_load_lds_dwordx4 v109, s[42:43]
    s_add_u32 s42, s8, 0x130000
    s_addc_u32 s43, s9, 0
    s_lshl_b32 s39, s6, 13
    s_add_u32 m0, s39, 104448
    s_nop 0
    global_load_lds_dwordx4 v109, s[42:43]
    s_add_u32 s42, s8, 0x138000
    s_addc_u32 s43, s9, 0
    s_lshl_b32 s39, s6, 13
    s_add_u32 m0, s39, 105472
    s_nop 0
    global_load_lds_dwordx4 v109, s[42:43]
    ds_read_b64_tr_b16 v[144:145], v116 offset:32768
    ds_read_b64_tr_b16 v[146:147], v116 offset:33024
    ds_read_b64_tr_b16 v[148:149], v116 offset:34816
    ds_read_b64_tr_b16 v[150:151], v116 offset:35072
    ds_read_b64_tr_b16 v[152:153], v116 offset:49152
    ds_read_b64_tr_b16 v[154:155], v116 offset:49408
    ds_read_b64_tr_b16 v[156:157], v116 offset:51200
    ds_read_b64_tr_b16 v[158:159], v116 offset:51456
    ds_read_b64_tr_b16 v[208:209], v117 offset:32768
    ds_read_b64_tr_b16 v[210:211], v117 offset:33024
    ds_read_b64_tr_b16 v[212:213], v117 offset:34816
    ds_read_b64_tr_b16 v[214:215], v117 offset:35072
    ds_read_b64_tr_b16 v[216:217], v117 offset:49152
    ds_read_b64_tr_b16 v[218:219], v117 offset:49408
    ds_read_b64_tr_b16 v[220:221], v117 offset:51200
    ds_read_b64_tr_b16 v[222:223], v117 offset:51456
    s_waitcnt lgkmcnt(0)
    s_waitcnt vmcnt(24)
    s_barrier
    s_add_u32 s42, s8, 0x200000
    s_addc_u32 s43, s9, 0
    s_lshl_b32 s39, s6, 13
    s_add_u32 m0, s39, 131072
    s_nop 0
    global_load_lds_dwordx4 v108, s[42:43]
    s_add_u32 s42, s8, 0x208000
    s_addc_u32 s43, s9, 0
    s_lshl_b32 s39, s6, 13
    s_add_u32 m0, s39, 132096
    s_nop 0
    global_load_lds_dwordx4 v108, s[42:43]
    s_add_u32 s42, s8, 0x210000
    s_addc_u32 s43, s9, 0
    s_lshl_b32 s39, s6, 13
    s_add_u32 m0, s39, 133120
    s_nop 0
    global_load_lds_dwordx4 v108, s[42:43]
    s_add_u32 s42, s8, 0x218000
    s_addc_u32 s43, s9, 0
    s_lshl_b32 s39, s6, 13
    s_add_u32 m0, s39, 134144
    s_nop 0
    global_load_lds_dwordx4 v108, s[42:43]
    s_add_u32 s42, s8, 0x220000
    s_addc_u32 s43, s9, 0
    s_lshl_b32 s39, s6, 13
    s_add_u32 m0, s39, 135168
    s_nop 0
    global_load_lds_dwordx4 v109, s[42:43]
    s_add_u32 s42, s8, 0x228000
    s_addc_u32 s43, s9, 0
    s_lshl_b32 s39, s6, 13
    s_add_u32 m0, s39, 136192
    s_nop 0
    global_load_lds_dwordx4 v109, s[42:43]
    s_add_u32 s42, s8, 0x230000
    s_addc_u32 s43, s9, 0
    s_lshl_b32 s39, s6, 13
    s_add_u32 m0, s39, 137216
    s_nop 0
    global_load_lds_dwordx4 v109, s[42:43]
    s_add_u32 s42, s8, 0x238000
    s_addc_u32 s43, s9, 0
    s_lshl_b32 s39, s6, 13
    s_add_u32 m0, s39, 138240
    s_nop 0
    global_load_lds_dwordx4 v109, s[42:43]
    ds_read_b64_tr_b16 v[160:161], v122 offset:0
    ds_read_b64_tr_b16 v[162:163], v122 offset:256
    ds_read_b64_tr_b16 v[164:165], v122 offset:2048
    ds_read_b64_tr_b16 v[166:167], v122 offset:2304
    ds_read_b64_tr_b16 v[168:169], v122 offset:16384
    ds_read_b64_tr_b16 v[170:171], v122 offset:16640
    ds_read_b64_tr_b16 v[172:173], v122 offset:18432
    ds_read_b64_tr_b16 v[174:175], v122 offset:18688
    ds_read_b64_tr_b16 v[224:225], v123 offset:0
    ds_read_b64_tr_b16 v[226:227], v123 offset:256
    ds_read_b64_tr_b16 v[228:229], v123 offset:2048
    ds_read_b64_tr_b16 v[230:231], v123 offset:2304
    ds_read_b64_tr_b16 v[232:233], v123 offset:16384
    ds_read_b64_tr_b16 v[234:235], v123 offset:16640
    ds_read_b64_tr_b16 v[236:237], v123 offset:18432
    ds_read_b64_tr_b16 v[238:239], v123 offset:18688
    s_waitcnt lgkmcnt(0)
    s_waitcnt vmcnt(24)
    s_barrier
    s_add_u32 s42, s8, 0x300000
    s_addc_u32 s43, s9, 0
    s_lshl_b32 s39, s6, 13
    s_add_u32 m0, s39, 0
    s_nop 0
    global_load_lds_dwordx4 v108, s[42:43]
    s_add_u32 s42, s8, 0x308000
    s_addc_u32 s43, s9, 0
    s_lshl_b32 s39, s6, 13
    s_add_u32 m0, s39, 1024
    s_nop 0
    global_load_lds_dwordx4 v108, s[42:43]
    s_add_u32 s42, s8, 0x310000
    s_addc_u32 s43, s9, 0
    s_lshl_b32 s39, s6, 13
    s_add_u32 m0, s39, 2048
    s_nop 0
    global_load_lds_dwordx4 v108, s[42:43]
    s_add_u32 s42, s8, 0x318000
    s_addc_u32 s43, s9, 0
    s_lshl_b32 s39, s6, 13
    s_add_u32 m0, s39, 3072
    s_nop 0
    global_load_lds_dwordx4 v108, s[42:43]
    s_add_u32 s42, s8, 0x320000
    s_addc_u32 s43, s9, 0
    s_lshl_b32 s39, s6, 13
    s_add_u32 m0, s39, 4096
    s_nop 0
    global_load_lds_dwordx4 v109, s[42:43]
    s_add_u32 s42, s8, 0x328000
    s_addc_u32 s43, s9, 0
    s_lshl_b32 s39, s6, 13
    s_add_u32 m0, s39, 5120
    s_nop 0
    global_load_lds_dwordx4 v109, s[42:43]
    s_add_u32 s42, s8, 0x330000
    s_addc_u32 s43, s9, 0
    s_lshl_b32 s39, s6, 13
    s_add_u32 m0, s39, 6144
    s_nop 0
    global_load_lds_dwordx4 v109, s[42:43]
    s_add_u32 s42, s8, 0x338000
    s_addc_u32 s43, s9, 0
    s_lshl_b32 s39, s6, 13
    s_add_u32 m0, s39, 7168
    s_nop 0
    global_load_lds_dwordx4 v109, s[42:43]
    ds_read_b64_tr_b16 v[176:177], v114 offset:0
    ds_read_b64_tr_b16 v[178:179], v114 offset:256
    ds_read_b64_tr_b16 v[180:181], v114 offset:2048
    ds_read_b64_tr_b16 v[182:183], v114 offset:2304
    ds_read_b64_tr_b16 v[184:185], v114 offset:16384
    ds_read_b64_tr_b16 v[186:187], v114 offset:16640
    ds_read_b64_tr_b16 v[188:189], v114 offset:18432
    ds_read_b64_tr_b16 v[190:191], v114 offset:18688
    ds_read_b64_tr_b16 v[240:241], v115 offset:0
    ds_read_b64_tr_b16 v[242:243], v115 offset:256
    ds_read_b64_tr_b16 v[244:245], v115 offset:2048
    ds_read_b64_tr_b16 v[246:247], v115 offset:2304
    ds_read_b64_tr_b16 v[248:249], v115 offset:16384
    ds_read_b64_tr_b16 v[250:251], v115 offset:16640
    ds_read_b64_tr_b16 v[252:253], v115 offset:18432
    ds_read_b64_tr_b16 v[254:255], v115 offset:18688
    s_waitcnt lgkmcnt(0)
    s_waitcnt vmcnt(24)
    s_barrier
    v_readfirstlane_b32 s75, v124
    s_lshl_b32 s39, s4, 12
    s_add_u32 s39, s39, 0x520a000
    s_add_u32 s42, s18, s39
    s_addc_u32 s43, s19, 0
    v_and_b32 v20, 31, v127
    v_lshlrev_b32 v20, 7, v20
    global_load_dword v125, v20, s[42:43] sc1
    global_load_dword v3, v9, s[34:35] sc1
    s_and_b32 s39, s6, 1
    s_lshl_b32 s39, s39, 7
    s_or_b32 s39, s39, 0
    v_xor_b32 v119, s39, v118
    s_lshl_b32 s40, s5, 7
    s_lshl_b32 s41, s6, 3
    s_add_u32 s40, s40, s41
    s_add_u32 s40, s40, 0
    s_lshl_b32 s40, s40, 10
    s_add_u32 s42, s14, s40
    s_addc_u32 s43, s15, 0
    s_lshl_b32 s39, s6, 13
    s_add_u32 m0, s39, 32768
    s_nop 0
    global_load_lds_dwordx4 v119, s[42:43]
    s_and_b32 s39, s6, 1
    s_lshl_b32 s39, s39, 7
    s_or_b32 s39, s39, 32
    v_xor_b32 v119, s39, v118
    s_lshl_b32 s40, s5, 7
    s_lshl_b32 s41, s6, 3
    s_add_u32 s40, s40, s41
    s_add_u32 s40, s40, 1
    s_lshl_b32 s40, s40, 10
    s_add_u32 s42, s14, s40
    s_addc_u32 s43, s15, 0
    s_lshl_b32 s39, s6, 13
    s_add_u32 m0, s39, 33792
    s_nop 0
    global_load_lds_dwordx4 v119, s[42:43]
    s_and_b32 s39, s6, 1
    s_lshl_b32 s39, s39, 7
    s_or_b32 s39, s39, 0
    v_xor_b32 v119, s39, v118
    s_lshl_b32 s40, s5, 7
    s_lshl_b32 s41, s6, 3
    s_add_u32 s40, s40, s41
    s_add_u32 s40, s40, 2
    s_lshl_b32 s40, s40, 10
    s_add_u32 s42, s14, s40
    s_addc_u32 s43, s15, 0
    s_lshl_b32 s39, s6, 13
    s_add_u32 m0, s39, 34816
    s_nop 0
    global_load_lds_dwordx4 v119, s[42:43]
    s_and_b32 s39, s6, 1
    s_lshl_b32 s39, s39, 7
    s_or_b32 s39, s39, 32
    v_xor_b32 v119, s39, v118
    s_lshl_b32 s40, s5, 7
    s_lshl_b32 s41, s6, 3
    s_add_u32 s40, s40, s41
    s_add_u32 s40, s40, 3
    s_lshl_b32 s40, s40, 10
    s_add_u32 s42, s14, s40
    s_addc_u32 s43, s15, 0
    s_lshl_b32 s39, s6, 13
    s_add_u32 m0, s39, 35840
    s_nop 0
    global_load_lds_dwordx4 v119, s[42:43]
    s_and_b32 s39, s6, 1
    s_lshl_b32 s39, s39, 7
    s_or_b32 s39, s39, 64
    v_xor_b32 v119, s39, v118
    s_lshl_b32 s40, s5, 7
    s_lshl_b32 s41, s6, 3
    s_add_u32 s40, s40, s41
    s_add_u32 s40, s40, 4
    s_lshl_b32 s40, s40, 10
    s_add_u32 s42, s14, s40
    s_addc_u32 s43, s15, 0
    s_lshl_b32 s39, s6, 13
    s_add_u32 m0, s39, 36864
    s_nop 0
    global_load_lds_dwordx4 v119, s[42:43]
    s_and_b32 s39, s6, 1
    s_lshl_b32 s39, s39, 7
    s_or_b32 s39, s39, 96
    v_xor_b32 v119, s39, v118
    s_lshl_b32 s40, s5, 7
    s_lshl_b32 s41, s6, 3
    s_add_u32 s40, s40, s41
    s_add_u32 s40, s40, 5
    s_lshl_b32 s40, s40, 10
    s_add_u32 s42, s14, s40
    s_addc_u32 s43, s15, 0
    s_lshl_b32 s39, s6, 13
    s_add_u32 m0, s39, 37888
    s_nop 0
    global_load_lds_dwordx4 v119, s[42:43]
    s_and_b32 s39, s6, 1
    s_lshl_b32 s39, s39, 7
    s_or_b32 s39, s39, 64
    v_xor_b32 v119, s39, v118
    s_lshl_b32 s40, s5, 7
    s_lshl_b32 s41, s6, 3
    s_add_u32 s40, s40, s41
    s_add_u32 s40, s40, 6
    s_lshl_b32 s40, s40, 10
    s_add_u32 s42, s14, s40
    s_addc_u32 s43, s15, 0
    s_lshl_b32 s39, s6, 13
    s_add_u32 m0, s39, 38912
    s_nop 0
    global_load_lds_dwordx4 v119, s[42:43]
    s_and_b32 s39, s6, 1
    s_lshl_b32 s39, s39, 7
    s_or_b32 s39, s39, 96
    v_xor_b32 v119, s39, v118
    s_lshl_b32 s40, s5, 7
    s_lshl_b32 s41, s6, 3
    s_add_u32 s40, s40, s41
    s_add_u32 s40, s40, 7
    s_lshl_b32 s40, s40, 10
    s_add_u32 s42, s14, s40
    s_addc_u32 s43, s15, 0
    s_lshl_b32 s39, s6, 13
    s_add_u32 m0, s39, 39936
    s_nop 0
    global_load_lds_dwordx4 v119, s[42:43]
    ds_read_b64_tr_b16 a[0:1], v114 offset:32768
    ds_read_b64_tr_b16 a[2:3], v114 offset:33024
    ds_read_b64_tr_b16 a[4:5], v114 offset:34816
    ds_read_b64_tr_b16 a[6:7], v114 offset:35072
    ds_read_b64_tr_b16 a[8:9], v114 offset:49152
    ds_read_b64_tr_b16 a[10:11], v114 offset:49408
    ds_read_b64_tr_b16 a[12:13], v114 offset:51200
    ds_read_b64_tr_b16 a[14:15], v114 offset:51456
    ds_read_b64_tr_b16 a[64:65], v115 offset:32768
    ds_read_b64_tr_b16 a[66:67], v115 offset:33024
    ds_read_b64_tr_b16 a[68:69], v115 offset:34816
    ds_read_b64_tr_b16 a[70:71], v115 offset:35072
    ds_read_b64_tr_b16 a[72:73], v115 offset:49152
    ds_read_b64_tr_b16 a[74:75], v115 offset:49408
    ds_read_b64_tr_b16 a[76:77], v115 offset:51200
    ds_read_b64_tr_b16 a[78:79], v115 offset:51456
    s_waitcnt lgkmcnt(0)
    s_waitcnt vmcnt(24)
    s_barrier
    s_and_b32 s39, s6, 1
    s_lshl_b32 s39, s39, 7
    s_or_b32 s39, s39, 0
    v_xor_b32 v119, s39, v118
    s_lshl_b32 s40, s5, 7
    s_lshl_b32 s41, s6, 3
    s_add_u32 s40, s40, s41
    s_add_u32 s40, s40, 32
    s_lshl_b32 s40, s40, 10
    s_add_u32 s42, s14, s40
    s_addc_u32 s43, s15, 0
    s_lshl_b32 s39, s6, 13
    s_add_u32 m0, s39, 65536
    s_nop 0
    global_load_lds_dwordx4 v119, s[42:43]
    s_and_b32 s39, s6, 1
    s_lshl_b32 s39, s39, 7
    s_or_b32 s39, s39, 32
    v_xor_b32 v119, s39, v118
    s_lshl_b32 s40, s5, 7
    s_lshl_b32 s41, s6, 3
    s_add_u32 s40, s40, s41
    s_add_u32 s40, s40, 33
    s_lshl_b32 s40, s40, 10
    s_add_u32 s42, s14, s40
    s_addc_u32 s43, s15, 0
    s_lshl_b32 s39, s6, 13
    s_add_u32 m0, s39, 66560
    s_nop 0
    global_load_lds_dwordx4 v119, s[42:43]
    s_and_b32 s39, s6, 1
    s_lshl_b32 s39, s39, 7
    s_or_b32 s39, s39, 0
    v_xor_b32 v119, s39, v118
    s_lshl_b32 s40, s5, 7
    s_lshl_b32 s41, s6, 3
    s_add_u32 s40, s40, s41
    s_add_u32 s40, s40, 34
    s_lshl_b32 s40, s40, 10
    s_add_u32 s42, s14, s40
    s_addc_u32 s43, s15, 0
    s_lshl_b32 s39, s6, 13
    s_add_u32 m0, s39, 67584
    s_nop 0
    global_load_lds_dwordx4 v119, s[42:43]
    s_and_b32 s39, s6, 1
    s_lshl_b32 s39, s39, 7
    s_or_b32 s39, s39, 32
    v_xor_b32 v119, s39, v118
    s_lshl_b32 s40, s5, 7
    s_lshl_b32 s41, s6, 3
    s_add_u32 s40, s40, s41
    s_add_u32 s40, s40, 35
    s_lshl_b32 s40, s40, 10
    s_add_u32 s42, s14, s40
    s_addc_u32 s43, s15, 0
    s_lshl_b32 s39, s6, 13
    s_add_u32 m0, s39, 68608
    s_nop 0
    global_load_lds_dwordx4 v119, s[42:43]
    s_and_b32 s39, s6, 1
    s_lshl_b32 s39, s39, 7
    s_or_b32 s39, s39, 64
    v_xor_b32 v119, s39, v118
    s_lshl_b32 s40, s5, 7
    s_lshl_b32 s41, s6, 3
    s_add_u32 s40, s40, s41
    s_add_u32 s40, s40, 36
    s_lshl_b32 s40, s40, 10
    s_add_u32 s42, s14, s40
    s_addc_u32 s43, s15, 0
    s_lshl_b32 s39, s6, 13
    s_add_u32 m0, s39, 69632
    s_nop 0
    global_load_lds_dwordx4 v119, s[42:43]
    s_and_b32 s39, s6, 1
    s_lshl_b32 s39, s39, 7
    s_or_b32 s39, s39, 96
    v_xor_b32 v119, s39, v118
    s_lshl_b32 s40, s5, 7
    s_lshl_b32 s41, s6, 3
    s_add_u32 s40, s40, s41
    s_add_u32 s40, s40, 37
    s_lshl_b32 s40, s40, 10
    s_add_u32 s42, s14, s40
    s_addc_u32 s43, s15, 0
    s_lshl_b32 s39, s6, 13
    s_add_u32 m0, s39, 70656
    s_nop 0
    global_load_lds_dwordx4 v119, s[42:43]
    s_and_b32 s39, s6, 1
    s_lshl_b32 s39, s39, 7
    s_or_b32 s39, s39, 64
    v_xor_b32 v119, s39, v118
    s_lshl_b32 s40, s5, 7
    s_lshl_b32 s41, s6, 3
    s_add_u32 s40, s40, s41
    s_add_u32 s40, s40, 38
    s_lshl_b32 s40, s40, 10
    s_add_u32 s42, s14, s40
    s_addc_u32 s43, s15, 0
    s_lshl_b32 s39, s6, 13
    s_add_u32 m0, s39, 71680
    s_nop 0
    global_load_lds_dwordx4 v119, s[42:43]
    s_and_b32 s39, s6, 1
    s_lshl_b32 s39, s39, 7
    s_or_b32 s39, s39, 96
    v_xor_b32 v119, s39, v118
    s_lshl_b32 s40, s5, 7
    s_lshl_b32 s41, s6, 3
    s_add_u32 s40, s40, s41
    s_add_u32 s40, s40, 39
    s_lshl_b32 s40, s40, 10
    s_add_u32 s42, s14, s40
    s_addc_u32 s43, s15, 0
    s_lshl_b32 s39, s6, 13
    s_add_u32 m0, s39, 72704
    s_nop 0
    global_load_lds_dwordx4 v119, s[42:43]
    ds_read_b64_tr_b16 a[16:17], v116 offset:0
    ds_read_b64_tr_b16 a[18:19], v116 offset:256
    ds_read_b64_tr_b16 a[20:21], v116 offset:2048
    ds_read_b64_tr_b16 a[22:23], v116 offset:2304
    ds_read_b64_tr_b16 a[24:25], v116 offset:16384
    ds_read_b64_tr_b16 a[26:27], v116 offset:16640
    ds_read_b64_tr_b16 a[28:29], v116 offset:18432
    ds_read_b64_tr_b16 a[30:31], v116 offset:18688
    ds_read_b64_tr_b16 a[80:81], v117 offset:0
    ds_read_b64_tr_b16 a[82:83], v117 offset:256
    ds_read_b64_tr_b16 a[84:85], v117 offset:2048
    ds_read_b64_tr_b16 a[86:87], v117 offset:2304
    ds_read_b64_tr_b16 a[88:89], v117 offset:16384
    ds_read_b64_tr_b16 a[90:91], v117 offset:16640
    ds_read_b64_tr_b16 a[92:93], v117 offset:18432
    ds_read_b64_tr_b16 a[94:95], v117 offset:18688
    s_waitcnt lgkmcnt(0)
    s_waitcnt vmcnt(24)
    s_barrier
    s_and_b32 s39, s6, 1
    s_lshl_b32 s39, s39, 7
    s_or_b32 s39, s39, 0
    v_xor_b32 v119, s39, v118
    s_lshl_b32 s40, s5, 7
    s_lshl_b32 s41, s6, 3
    s_add_u32 s40, s40, s41
    s_add_u32 s40, s40, 64
    s_lshl_b32 s40, s40, 10
    s_add_u32 s42, s14, s40
    s_addc_u32 s43, s15, 0
    s_lshl_b32 s39, s6, 13
    s_add_u32 m0, s39, 98304
    s_nop 0
    global_load_lds_dwordx4 v119, s[42:43]
    s_and_b32 s39, s6, 1
    s_lshl_b32 s39, s39, 7
    s_or_b32 s39, s39, 32
    v_xor_b32 v119, s39, v118
    s_lshl_b32 s40, s5, 7
    s_lshl_b32 s41, s6, 3
    s_add_u32 s40, s40, s41
    s_add_u32 s40, s40, 65
    s_lshl_b32 s40, s40, 10
    s_add_u32 s42, s14, s40
    s_addc_u32 s43, s15, 0
    s_lshl_b32 s39, s6, 13
    s_add_u32 m0, s39, 99328
    s_nop 0
    global_load_lds_dwordx4 v119, s[42:43]
    s_and_b32 s39, s6, 1
    s_lshl_b32 s39, s39, 7
    s_or_b32 s39, s39, 0
    v_xor_b32 v119, s39, v118
    s_lshl_b32 s40, s5, 7
    s_lshl_b32 s41, s6, 3
    s_add_u32 s40, s40, s41
    s_add_u32 s40, s40, 66
    s_lshl_b32 s40, s40, 10
    s_add_u32 s42, s14, s40
    s_addc_u32 s43, s15, 0
    s_lshl_b32 s39, s6, 13
    s_add_u32 m0, s39, 100352
    s_nop 0
    global_load_lds_dwordx4 v119, s[42:43]
    s_and_b32 s39, s6, 1
    s_lshl_b32 s39, s39, 7
    s_or_b32 s39, s39, 32
    v_xor_b32 v119, s39, v118
    s_lshl_b32 s40, s5, 7
    s_lshl_b32 s41, s6, 3
    s_add_u32 s40, s40, s41
    s_add_u32 s40, s40, 67
    s_lshl_b32 s40, s40, 10
    s_add_u32 s42, s14, s40
    s_addc_u32 s43, s15, 0
    s_lshl_b32 s39, s6, 13
    s_add_u32 m0, s39, 101376
    s_nop 0
    global_load_lds_dwordx4 v119, s[42:43]
    s_and_b32 s39, s6, 1
    s_lshl_b32 s39, s39, 7
    s_or_b32 s39, s39, 64
    v_xor_b32 v119, s39, v118
    s_lshl_b32 s40, s5, 7
    s_lshl_b32 s41, s6, 3
    s_add_u32 s40, s40, s41
    s_add_u32 s40, s40, 68
    s_lshl_b32 s40, s40, 10
    s_add_u32 s42, s14, s40
    s_addc_u32 s43, s15, 0
    s_lshl_b32 s39, s6, 13
    s_add_u32 m0, s39, 102400
    s_nop 0
    global_load_lds_dwordx4 v119, s[42:43]
    s_and_b32 s39, s6, 1
    s_lshl_b32 s39, s39, 7
    s_or_b32 s39, s39, 96
    v_xor_b32 v119, s39, v118
    s_lshl_b32 s40, s5, 7
    s_lshl_b32 s41, s6, 3
    s_add_u32 s40, s40, s41
    s_add_u32 s40, s40, 69
    s_lshl_b32 s40, s40, 10
    s_add_u32 s42, s14, s40
    s_addc_u32 s43, s15, 0
    s_lshl_b32 s39, s6, 13
    s_add_u32 m0, s39, 103424
    s_nop 0
    global_load_lds_dwordx4 v119, s[42:43]
    s_and_b32 s39, s6, 1
    s_lshl_b32 s39, s39, 7
    s_or_b32 s39, s39, 64
    v_xor_b32 v119, s39, v118
    s_lshl_b32 s40, s5, 7
    s_lshl_b32 s41, s6, 3
    s_add_u32 s40, s40, s41
    s_add_u32 s40, s40, 70
    s_lshl_b32 s40, s40, 10
    s_add_u32 s42, s14, s40
    s_addc_u32 s43, s15, 0
    s_lshl_b32 s39, s6, 13
    s_add_u32 m0, s39, 104448
    s_nop 0
    global_load_lds_dwordx4 v119, s[42:43]
    s_and_b32 s39, s6, 1
    s_lshl_b32 s39, s39, 7
    s_or_b32 s39, s39, 96
    v_xor_b32 v119, s39, v118
    s_lshl_b32 s40, s5, 7
    s_lshl_b32 s41, s6, 3
    s_add_u32 s40, s40, s41
    s_add_u32 s40, s40, 71
    s_lshl_b32 s40, s40, 10
    s_add_u32 s42, s14, s40
    s_addc_u32 s43, s15, 0
    s_lshl_b32 s39, s6, 13
    s_add_u32 m0, s39, 105472
    s_nop 0
    global_load_lds_dwordx4 v119, s[42:43]
    ds_read_b64_tr_b16 a[32:33], v116 offset:32768
    ds_read_b64_tr_b16 a[34:35], v116 offset:33024
    ds_read_b64_tr_b16 a[36:37], v116 offset:34816
    ds_read_b64_tr_b16 a[38:39], v116 offset:35072
    ds_read_b64_tr_b16 a[40:41], v116 offset:49152
    ds_read_b64_tr_b16 a[42:43], v116 offset:49408
    ds_read_b64_tr_b16 a[44:45], v116 offset:51200
    ds_read_b64_tr_b16 a[46:47], v116 offset:51456
    ds_read_b64_tr_b16 a[96:97], v117 offset:32768
    ds_read_b64_tr_b16 a[98:99], v117 offset:33024
    ds_read_b64_tr_b16 a[100:101], v117 offset:34816
    ds_read_b64_tr_b16 a[102:103], v117 offset:35072
    ds_read_b64_tr_b16 a[104:105], v117 offset:49152
    ds_read_b64_tr_b16 a[106:107], v117 offset:49408
    ds_read_b64_tr_b16 a[108:109], v117 offset:51200
    ds_read_b64_tr_b16 a[110:111], v117 offset:51456
    s_waitcnt lgkmcnt(0)
    s_waitcnt vmcnt(24)
    s_barrier
    s_and_b32 s39, s6, 1
    s_lshl_b32 s39, s39, 7
    s_or_b32 s39, s39, 0
    v_xor_b32 v119, s39, v118
    s_lshl_b32 s40, s5, 7
    s_lshl_b32 s41, s6, 3
    s_add_u32 s40, s40, s41
    s_add_u32 s40, s40, 96
    s_lshl_b32 s40, s40, 10
    s_add_u32 s42, s14, s40
    s_addc_u32 s43, s15, 0
    s_lshl_b32 s39, s6, 13
    s_add_u32 m0, s39, 131072
    s_nop 0
    global_load_lds_dwordx4 v119, s[42:43]
    s_and_b32 s39, s6, 1
    s_lshl_b32 s39, s39, 7
    s_or_b32 s39, s39, 32
    v_xor_b32 v119, s39, v118
    s_lshl_b32 s40, s5, 7
    s_lshl_b32 s41, s6, 3
    s_add_u32 s40, s40, s41
    s_add_u32 s40, s40, 97
    s_lshl_b32 s40, s40, 10
    s_add_u32 s42, s14, s40
    s_addc_u32 s43, s15, 0
    s_lshl_b32 s39, s6, 13
    s_add_u32 m0, s39, 132096
    s_nop 0
    global_load_lds_dwordx4 v119, s[42:43]
    s_and_b32 s39, s6, 1
    s_lshl_b32 s39, s39, 7
    s_or_b32 s39, s39, 0
    v_xor_b32 v119, s39, v118
    s_lshl_b32 s40, s5, 7
    s_lshl_b32 s41, s6, 3
    s_add_u32 s40, s40, s41
    s_add_u32 s40, s40, 98
    s_lshl_b32 s40, s40, 10
    s_add_u32 s42, s14, s40
    s_addc_u32 s43, s15, 0
    s_lshl_b32 s39, s6, 13
    s_add_u32 m0, s39, 133120
    s_nop 0
    global_load_lds_dwordx4 v119, s[42:43]
    s_and_b32 s39, s6, 1
    s_lshl_b32 s39, s39, 7
    s_or_b32 s39, s39, 32
    v_xor_b32 v119, s39, v118
    s_lshl_b32 s40, s5, 7
    s_lshl_b32 s41, s6, 3
    s_add_u32 s40, s40, s41
    s_add_u32 s40, s40, 99
    s_lshl_b32 s40, s40, 10
    s_add_u32 s42, s14, s40
    s_addc_u32 s43, s15, 0
    s_lshl_b32 s39, s6, 13
    s_add_u32 m0, s39, 134144
    s_nop 0
    global_load_lds_dwordx4 v119, s[42:43]
    s_and_b32 s39, s6, 1
    s_lshl_b32 s39, s39, 7
    s_or_b32 s39, s39, 64
    v_xor_b32 v119, s39, v118
    s_lshl_b32 s40, s5, 7
    s_lshl_b32 s41, s6, 3
    s_add_u32 s40, s40, s41
    s_add_u32 s40, s40, 100
    s_lshl_b32 s40, s40, 10
    s_add_u32 s42, s14, s40
    s_addc_u32 s43, s15, 0
    s_lshl_b32 s39, s6, 13
    s_add_u32 m0, s39, 135168
    s_nop 0
    global_load_lds_dwordx4 v119, s[42:43]
    s_and_b32 s39, s6, 1
    s_lshl_b32 s39, s39, 7
    s_or_b32 s39, s39, 96
    v_xor_b32 v119, s39, v118
    s_lshl_b32 s40, s5, 7
    s_lshl_b32 s41, s6, 3
    s_add_u32 s40, s40, s41
    s_add_u32 s40, s40, 101
    s_lshl_b32 s40, s40, 10
    s_add_u32 s42, s14, s40
    s_addc_u32 s43, s15, 0
    s_lshl_b32 s39, s6, 13
    s_add_u32 m0, s39, 136192
    s_nop 0
    global_load_lds_dwordx4 v119, s[42:43]
    s_and_b32 s39, s6, 1
    s_lshl_b32 s39, s39, 7
    s_or_b32 s39, s39, 64
    v_xor_b32 v119, s39, v118
    s_lshl_b32 s40, s5, 7
    s_lshl_b32 s41, s6, 3
    s_add_u32 s40, s40, s41
    s_add_u32 s40, s40, 102
    s_lshl_b32 s40, s40, 10
    s_add_u32 s42, s14, s40
    s_addc_u32 s43, s15, 0
    s_lshl_b32 s39, s6, 13
    s_add_u32 m0, s39, 137216
    s_nop 0
    global_load_lds_dwordx4 v119, s[42:43]
    s_and_b32 s39, s6, 1
    s_lshl_b32 s39, s39, 7
    s_or_b32 s39, s39, 96
    v_xor_b32 v119, s39, v118
    s_lshl_b32 s40, s5, 7
    s_lshl_b32 s41, s6, 3
    s_add_u32 s40, s40, s41
    s_add_u32 s40, s40, 103
    s_lshl_b32 s40, s40, 10
    s_add_u32 s42, s14, s40
    s_addc_u32 s43, s15, 0
    s_lshl_b32 s39, s6, 13
    s_add_u32 m0, s39, 138240
    s_nop 0
    global_load_lds_dwordx4 v119, s[42:43]
    ds_read_b64_tr_b16 a[48:49], v122 offset:0
    ds_read_b64_tr_b16 a[50:51], v122 offset:256
    ds_read_b64_tr_b16 a[52:53], v122 offset:2048
    ds_read_b64_tr_b16 a[54:55], v122 offset:2304
    ds_read_b64_tr_b16 a[56:57], v122 offset:16384
    ds_read_b64_tr_b16 a[58:59], v122 offset:16640
    ds_read_b64_tr_b16 a[60:61], v122 offset:18432
    ds_read_b64_tr_b16 a[62:63], v122 offset:18688
    ds_read_b64_tr_b16 a[112:113], v123 offset:0
    ds_read_b64_tr_b16 a[114:115], v123 offset:256
    ds_read_b64_tr_b16 a[116:117], v123 offset:2048
    ds_read_b64_tr_b16 a[118:119], v123 offset:2304
    ds_read_b64_tr_b16 a[120:121], v123 offset:16384
    ds_read_b64_tr_b16 a[122:123], v123 offset:16640
    ds_read_b64_tr_b16 a[124:125], v123 offset:18432
    ds_read_b64_tr_b16 a[126:127], v123 offset:18688
    s_waitcnt lgkmcnt(0)
    v_lshrrev_b32 v110, 1, v104
    v_lshlrev_b32 v110, 4, v110
    v_lshrrev_b32 v111, 1, v105
    v_lshl_add_u32 v110, v111, 3, v110
    v_and_b32 v112, 1, v104
    v_lshl_add_u32 v110, v112, 2, v110
    v_and_b32 v113, 1, v105
    v_add_u32 v110, v110, v113
    v_lshlrev_b32 v110, 10, v110
    v_lshl_add_u32 v110, v106, 3, v110
    s_lshl_b32 s39, s6, 8
    s_add_u32 s39, s39, 32768
    v_add_u32 v110, s39, v110
    v_lshlrev_b32 v111, 2, v111
    v_lshl_add_u32 v111, v112, 1, v111
    v_add_u32 v111, v111, v113
    s_lshl_b32 s39, s6, 14
    s_add_u32 s39, s39, 32768
    v_add_u32 v120, s39, v118
    s_waitcnt vmcnt(16)
    s_barrier
    v_xor_b32 v112, 0, v111
    v_lshl_add_u32 v112, v112, 5, v110
    ds_read_b64_tr_b16 v[40:41], v112 offset:0
    ds_read_b64_tr_b16 v[42:43], v112 offset:2048
    ds_read_b64_tr_b16 v[44:45], v112 offset:32768
    ds_read_b64_tr_b16 v[46:47], v112 offset:34816
    v_xor_b32 v112, 1, v111
    v_lshl_add_u32 v112, v112, 5, v110
    ds_read_b64_tr_b16 v[48:49], v112 offset:0
    ds_read_b64_tr_b16 v[50:51], v112 offset:2048
    ds_read_b64_tr_b16 v[52:53], v112 offset:32768
    ds_read_b64_tr_b16 v[54:55], v112 offset:34816
    v_xor_b32 v112, 2, v111
    v_lshl_add_u32 v112, v112, 5, v110
    ds_read_b64_tr_b16 v[56:57], v112 offset:0
    ds_read_b64_tr_b16 v[58:59], v112 offset:2048
    ds_read_b64_tr_b16 v[60:61], v112 offset:32768
    ds_read_b64_tr_b16 v[62:63], v112 offset:34816
    v_xor_b32 v112, 3, v111
    v_lshl_add_u32 v112, v112, 5, v110
    ds_read_b64_tr_b16 v[64:65], v112 offset:0
    ds_read_b64_tr_b16 v[66:67], v112 offset:2048
    ds_read_b64_tr_b16 v[68:69], v112 offset:32768
    ds_read_b64_tr_b16 v[70:71], v112 offset:34816
    v_xor_b32 v112, 4, v111
    v_lshl_add_u32 v112, v112, 5, v110
    ds_read_b64_tr_b16 v[72:73], v112 offset:0
    ds_read_b64_tr_b16 v[74:75], v112 offset:2048
    ds_read_b64_tr_b16 v[76:77], v112 offset:32768
    ds_read_b64_tr_b16 v[78:79], v112 offset:34816
    v_xor_b32 v112, 5, v111
    v_lshl_add_u32 v112, v112, 5, v110
    ds_read_b64_tr_b16 v[80:81], v112 offset:0
    ds_read_b64_tr_b16 v[82:83], v112 offset:2048
    ds_read_b64_tr_b16 v[84:85], v112 offset:32768
    ds_read_b64_tr_b16 v[86:87], v112 offset:34816
    v_xor_b32 v112, 6, v111
    v_lshl_add_u32 v112, v112, 5, v110
    ds_read_b64_tr_b16 v[88:89], v112 offset:0
    ds_read_b64_tr_b16 v[90:91], v112 offset:2048
    ds_read_b64_tr_b16 v[92:93], v112 offset:32768
    ds_read_b64_tr_b16 v[94:95], v112 offset:34816
    v_xor_b32 v112, 7, v111
    v_lshl_add_u32 v112, v112, 5, v110
    ds_read_b64_tr_b16 v[96:97], v112 offset:0
    ds_read_b64_tr_b16 v[98:99], v112 offset:2048
    ds_read_b64_tr_b16 v[100:101], v112 offset:32768
    ds_read_b64_tr_b16 v[102:103], v112 offset:34816
    s_waitcnt lgkmcnt(0)
    s_barrier
    ds_write_b128 v120, v[40:43] offset:0
    ds_write_b128 v120, v[44:47] offset:1024
    ds_write_b128 v120, v[48:51] offset:2048
    ds_write_b128 v120, v[52:55] offset:3072
    ds_write_b128 v120, v[56:59] offset:4096
    ds_write_b128 v120, v[60:63] offset:5120
    ds_write_b128 v120, v[64:67] offset:6144
    ds_write_b128 v120, v[68:71] offset:7168
    ds_write_b128 v120, v[72:75] offset:8192
    ds_write_b128 v120, v[76:79] offset:9216
    ds_write_b128 v120, v[80:83] offset:10240
    ds_write_b128 v120, v[84:87] offset:11264
    ds_write_b128 v120, v[88:91] offset:12288
    ds_write_b128 v120, v[92:95] offset:13312
    ds_write_b128 v120, v[96:99] offset:14336
    ds_write_b128 v120, v[100:103] offset:15360
    s_waitcnt lgkmcnt(0)
    s_waitcnt vmcnt(0)
    s_barrier
    s_cmp_ge_u32 s75, 256
    s_cbranch_scc1 L_arr_ok
    v_mov_b32 v20, 0
    s_mov_b32 s48, 0
LWA_2:
    global_load_dword v21, v20, s[62:63] sc1
    s_waitcnt vmcnt(0)
    v_readfirstlane_b32 s39, v21
    s_cmp_ge_u32 s39, 256
    s_cbranch_scc1 LWAOK_3
    s_sleep 4
    s_add_u32 s48, s48, 1
    s_cmp_lt_u32 s48, 0x40000
    s_cbranch_scc1 LWA_2
    s_branch L_fail
LWAOK_3:
    s_lshl_b32 s39, s4, 12
    s_add_u32 s39, s39, 0x520a000
    s_add_u32 s42, s18, s39
    s_addc_u32 s43, s19, 0
    v_and_b32 v20, 31, v127
    v_lshlrev_b32 v20, 7, v20
    global_load_dword v125, v20, s[42:43] sc1
    global_load_dword v3, v9, s[34:35] sc1
    s_waitcnt vmcnt(0)
L_arr_ok:
    v_readfirstlane_b32 s39, v125
    s_nop 1
    v_cmp_ne_u32 vcc, s39, v125
    s_nop 1
    s_mov_b64 s[76:77], vcc
    s_mov_b32 s48, 0
L_kv0:
    v_readlane_b32 s95, v3, 0
    v_readlane_b32 s39, v3, 1
    s_nop 0
    s_min_u32 s95, s95, s39
    s_cmp_ge_u32 s95, 1
    s_cbranch_scc1 L_kv0ok
    s_sleep 4
    global_load_dword v3, v9, s[34:35] sc1
    s_waitcnt vmcnt(0)
    s_add_u32 s48, s48, 1
    s_cmp_lt_u32 s48, 0x40000
    s_cbranch_scc1 L_kv0
    s_branch L_fail
L_kv0ok:
    s_add_u32 m0, s49, 0
    global_load_dwordx4 v[16:19], v1, s[30:31]
    global_load_lds_dwordx4 v1, s[28:29]
    global_load_dwordx4 v[20:23], v1, s[30:31] offset:1024
    global_load_lds_dwordx4 v1, s[28:29] offset:1024
    s_add_u32 s28, s28, 0x40000
    s_addc_u32 s29, s29, 0
    s_add_u32 s30, s30, 0x40000
    s_addc_u32 s31, s31, 0
    v_xor_b32 v112, 0, v111
    v_lshl_add_u32 v112, v112, 5, v110
    v_add_u32 v112, 0x10000, v112
    ds_read_b64_tr_b16 v[40:41], v112 offset:0
    ds_read_b64_tr_b16 v[42:43], v112 offset:2048
    ds_read_b64_tr_b16 v[44:45], v112 offset:32768
    ds_read_b64_tr_b16 v[46:47], v112 offset:34816
    v_xor_b32 v112, 1, v111
    v_lshl_add_u32 v112, v112, 5, v110
    v_add_u32 v112, 0x10000, v112
    ds_read_b64_tr_b16 v[48:49], v112 offset:0
    ds_read_b64_tr_b16 v[50:51], v112 offset:2048
    ds_read_b64_tr_b16 v[52:53], v112 offset:32768
    ds_read_b64_tr_b16 v[54:55], v112 offset:34816
    v_xor_b32 v112, 2, v111
    v_lshl_add_u32 v112, v112, 5, v110
    v_add_u32 v112, 0x10000, v112
    ds_read_b64_tr_b16 v[56:57], v112 offset:0
    ds_read_b64_tr_b16 v[58:59], v112 offset:2048
    ds_read_b64_tr_b16 v[60:61], v112 offset:32768
    ds_read_b64_tr_b16 v[62:63], v112 offset:34816
    v_xor_b32 v112, 3, v111
    v_lshl_add_u32 v112, v112, 5, v110
    v_add_u32 v112, 0x10000, v112
    ds_read_b64_tr_b16 v[64:65], v112 offset:0
    ds_read_b64_tr_b16 v[66:67], v112 offset:2048
    ds_read_b64_tr_b16 v[68:69], v112 offset:32768
    ds_read_b64_tr_b16 v[70:71], v112 offset:34816
    v_xor_b32 v112, 4, v111
    v_lshl_add_u32 v112, v112, 5, v110
    v_add_u32 v112, 0x10000, v112
    ds_read_b64_tr_b16 v[72:73], v112 offset:0
    ds_read_b64_tr_b16 v[74:75], v112 offset:2048
    ds_read_b64_tr_b16 v[76:77], v112 offset:32768
    ds_read_b64_tr_b16 v[78:79], v112 offset:34816
    v_xor_b32 v112, 5, v111
    v_lshl_add_u32 v112, v112, 5, v110
    v_add_u32 v112, 0x10000, v112
    ds_read_b64_tr_b16 v[80:81], v112 offset:0
    ds_read_b64_tr_b16 v[82:83], v112 offset:2048
    ds_read_b64_tr_b16 v[84:85], v112 offset:32768
    ds_read_b64_tr_b16 v[86:87], v112 offset:34816
    v_xor_b32 v112, 6, v111
    v_lshl_add_u32 v112, v112, 5, v110
    v_add_u32 v112, 0x10000, v112
    ds_read_b64_tr_b16 v[88:89], v112 offset:0
    ds_read_b64_tr_b16 v[90:91], v112 offset:2048
    ds_read_b64_tr_b16 v[92:93], v112 offset:32768
    ds_read_b64_tr_b16 v[94:95], v112 offset:34816
    v_xor_b32 v112, 7, v111
    v_lshl_add_u32 v112, v112, 5, v110
    v_add_u32 v112, 0x10000, v112
    ds_read_b64_tr_b16 v[96:97], v112 offset:0
    ds_read_b64_tr_b16 v[98:99], v112 offset:2048
    ds_read_b64_tr_b16 v[100:101], v112 offset:32768
    ds_read_b64_tr_b16 v[102:103], v112 offset:34816
    s_waitcnt lgkmcnt(0)
    s_barrier
    v_add_u32 v120, 0x10000, v120
    ds_write_b128 v120, v[40:43] offset:0
    ds_write_b128 v120, v[44:47] offset:1024
    ds_write_b128 v120, v[48:51] offset:2048
    ds_write_b128 v120, v[52:55] offset:3072
    ds_write_b128 v120, v[56:59] offset:4096
    ds_write_b128 v120, v[60:63] offset:5120
    ds_write_b128 v120, v[64:67] offset:6144
    ds_write_b128 v120, v[68:71] offset:7168
    ds_write_b128 v120, v[72:75] offset:8192
    ds_write_b128 v120, v[76:79] offset:9216
    ds_write_b128 v120, v[80:83] offset:10240
    ds_write_b128 v120, v[84:87] offset:11264
    ds_write_b128 v120, v[88:91] offset:12288
    ds_write_b128 v120, v[92:95] offset:13312
    ds_write_b128 v120, v[96:99] offset:14336
    ds_write_b128 v120, v[100:103] offset:15360
    s_waitcnt lgkmcnt(0)
    s_barrier
    v_add_u32 v121, 0xffff0000, v120
    ds_read_b128 v[40:43], v121 offset:12288
    ds_read_b128 v[44:47], v121 offset:13312
    ds_read_b128 v[48:51], v120 offset:12288
    ds_read_b128 v[52:55], v120 offset:13312
    ds_read_b128 v[56:59], v121 offset:14336
    ds_read_b128 v[60:63], v121 offset:15360
    ds_read_b128 v[64:67], v120 offset:14336
    ds_read_b128 v[68:71], v120 offset:15360
    s_waitcnt lgkmcnt(0)
    ds_write_b128 v121, a[0:3] offset:12288
    ds_write_b128 v121, a[4:7] offset:13312
    ds_write_b128 v120, a[8:11] offset:12288
    ds_write_b128 v120, a[12:15] offset:13312
    ds_write_b128 v121, a[16:19] offset:14336
    ds_write_b128 v121, a[20:23] offset:15360
    ds_write_b128 v120, a[24:27] offset:14336
    ds_write_b128 v120, a[28:31] offset:15360
    s_waitcnt lgkmcnt(0)
    v_accvgpr_write_b32 a0, v40
    v_accvgpr_write_b32 a1, v41
    v_accvgpr_write_b32 a2, v42
    v_accvgpr_write_b32 a3, v43
    v_accvgpr_write_b32 a4, v44
    v_accvgpr_write_b32 a5, v45
    v_accvgpr_write_b32 a6, v46
    v_accvgpr_write_b32 a7, v47
    v_accvgpr_write_b32 a8, v48
    v_accvgpr_write_b32 a9, v49
    v_accvgpr_write_b32 a10, v50
    v_accvgpr_write_b32 a11, v51
    v_accvgpr_write_b32 a12, v52
    v_accvgpr_write_b32 a13, v53
    v_accvgpr_write_b32 a14, v54
    v_accvgpr_write_b32 a15, v55
    v_accvgpr_write_b32 a16, v56
    v_accvgpr_write_b32 a17, v57
    v_accvgpr_write_b32 a18, v58
    v_accvgpr_write_b32 a19, v59
    v_accvgpr_write_b32 a20, v60
    v_accvgpr_write_b32 a21, v61
    v_accvgpr_write_b32 a22, v62
    v_accvgpr_write_b32 a23, v63
    v_accvgpr_write_b32 a24, v64
    v_accvgpr_write_b32 a25, v65
    v_accvgpr_write_b32 a26, v66
    v_accvgpr_write_b32 a27, v67
    v_accvgpr_write_b32 a28, v68
    v_accvgpr_write_b32 a29, v69
    v_accvgpr_write_b32 a30, v70
    v_accvgpr_write_b32 a31, v71
    v_lshl_or_b32 v112, v25, 16, v24
    v_lshl_or_b32 v113, v27, 16, v26
    v_lshl_or_b32 v114, v29, 16, v28
    v_lshl_or_b32 v115, v31, 16, v30
    v_lshl_or_b32 v116, v33, 16, v32
    v_lshl_or_b32 v117, v35, 16, v34
    v_lshl_or_b32 v118, v37, 16, v36
    v_lshl_or_b32 v119, v39, 16, v38
    v_add_u32 v120, s100, v1
    ds_write_b128 v120, v[112:115]
    ds_write_b128 v120, v[116:119] offset:1024
    s_waitcnt lgkmcnt(0)
    v_mov_b64 v[64:65], 0
    v_mov_b64 v[66:67], 0
    v_mov_b64 v[68:69], 0
    v_mov_b64 v[70:71], 0
    v_mov_b64 v[72:73], 0
    v_mov_b64 v[74:75], 0
    v_mov_b64 v[76:77], 0
    v_mov_b64 v[78:79], 0
    v_mov_b64 v[80:81], 0
    v_mov_b64 v[82:83], 0
    v_mov_b64 v[84:85], 0
    v_mov_b64 v[86:87], 0
    ds_read_b128 v[88:91], v15 offset:12288
    ds_read_b128 v[92:95], v15 offset:13312
    ds_read_b128 v[96:99], v0 offset:12288
    ds_read_b128 v[100:103], v0 offset:13312
    ds_read_b128 v[104:107], v15 offset:14336
    ds_read_b128 v[108:111], v15 offset:15360
    ds_read_b128 v[112:115], v0 offset:14336
    ds_read_b128 v[116:119], v0 offset:15360
    s_waitcnt lgkmcnt(0)
    s_mov_b32 s38, 0
    s_mov_b32 s48, 0
    s_mov_b32 s61, 0
    s_mov_b32 s8, 0x3f803f80
    s_mov_b32 s9, 0x3f803f80
    s_add_u32 s24, s22, 0x2000
    s_addc_u32 s25, s23, 0
    s_add_u32 s26, s22, 0x4000
    s_addc_u32 s27, s23, 0
    s_waitcnt vmcnt(0)
    s_barrier
    s_cmp_eq_u64 s[76:77], 0
    s_cbranch_scc0 L_chain_slow
L_loopF:
    ds_read_b128 v[32:35], v1 offset:16384
    ds_read_b128 v[36:39], v1 offset:17408
    ds_read_b128 v[40:43], v1 offset:18432
    s_waitcnt lgkmcnt(2)
    v_smfmac_f32_16x16x64_bf16 v[64:67], v[32:35], v[88:95], v2
    ds_read_b128 v[44:47], v1 offset:19456
    s_waitcnt lgkmcnt(2)
    v_smfmac_f32_16x16x64_bf16 v[64:67], v[36:39], v[96:103], v2
    ds_read_b128 v[48:51], v1 offset:20480
    s_waitcnt lgkmcnt(2)
    v_smfmac_f32_16x16x64_bf16 v[64:67], v[40:43], v[104:111], v2
    ds_read_b128 v[52:55], v1 offset:21504
    s_waitcnt lgkmcnt(2)
    v_smfmac_f32_16x16x64_bf16 v[64:67], v[44:47], v[112:119], v2
    ds_read_b128 v[56:59], v1 offset:22528
    s_waitcnt lgkmcnt(2)
    v_smfmac_f32_16x16x64_bf16 v[64:67], v[48:51], a[32:39], v2
    ds_read_b128 v[60:63], v1 offset:23552
    s_waitcnt lgkmcnt(2)
    v_smfmac_f32_16x16x64_bf16 v[64:67], v[52:55], a[40:47], v2
    s_waitcnt lgkmcnt(1)
    v_smfmac_f32_16x16x64_bf16 v[64:67], v[56:59], a[48:55], v2
    s_waitcnt lgkmcnt(0)
    v_smfmac_f32_16x16x64_bf16 v[64:67], v[60:63], a[56:63], v2
    v_smfmac_f32_16x16x64_bf16 v[68:71], v[32:35], a[64:71], v2
    ds_read_b128 v[104:107], v1 offset:0
    v_smfmac_f32_16x16x64_bf16 v[68:71], v[36:39], a[72:79], v2
    ds_read_b128 v[108:111], v1 offset:1024
    v_smfmac_f32_16x16x64_bf16 v[68:71], v[40:43], a[80:87], v2
    ds_read_b128 v[112:115], v1 offset:2048
    v_add_f32 v64, v64, v65
    v_smfmac_f32_16x16x64_bf16 v[68:71], v[44:47], a[88:95], v2
    ds_read_b128 v[116:119], v1 offset:3072
    v_add_f32 v66, v66, v67
    v_smfmac_f32_16x16x64_bf16 v[68:71], v[48:51], a[96:103], v2
    global_load_dword v3, v9, s[34:35] sc1
    v_cvt_pk_bf16_f32 v65, v64, v66
    v_smfmac_f32_16x16x64_bf16 v[68:71], v[52:55], a[104:111], v2
    s_add_u32 m0, s49, 8192
    v_mov_b32 v88, -1
    v_smfmac_f32_16x16x64_bf16 v[68:71], v[56:59], a[112:119], v2
    global_load_dwordx4 v[24:27], v1, s[30:31]
    v_mov_b32 v89, s38
    v_smfmac_f32_16x16x64_bf16 v[68:71], v[60:63], a[120:127], v2
    v_mov_b32 v90, 0
    v_smfmac_f32_16x16x64_bf16 v[72:75], v[32:35], a[128:135], v2
    global_load_lds_dwordx4 v1, s[28:29]
    v_smfmac_f32_16x16x64_bf16 v[72:75], v[36:39], a[136:143], v2
    v_smfmac_f32_16x16x64_bf16 v[72:75], v[40:43], a[144:151], v2
    global_load_dwordx4 v[28:31], v1, s[30:31] offset:1024
    v_add_f32 v68, v68, v69
    v_smfmac_f32_16x16x64_bf16 v[72:75], v[44:47], a[152:159], v2
    v_add_f32 v70, v70, v71
    v_smfmac_f32_16x16x64_bf16 v[72:75], v[48:51], a[160:167], v2
    global_load_lds_dwordx4 v1, s[28:29] offset:1024
    v_cvt_pk_bf16_f32 v69, v68, v70
    v_smfmac_f32_16x16x64_bf16 v[72:75], v[52:55], a[168:175], v2
    s_add_u32 s28, s28, 0x40000
    s_addc_u32 s29, s29, 0
    v_smfmac_f32_16x16x64_bf16 v[72:75], v[56:59], a[176:183], v2
    s_add_u32 s30, s30, 0x40000
    s_addc_u32 s31, s31, 0
    v_smfmac_f32_16x16x64_bf16 v[72:75], v[60:63], a[184:191], v2
    v_smfmac_f32_16x16x64_bf16 v[76:79], v[32:35], a[192:199], v2
    s_mov_b64 exec, s[46:47]
    global_store_dword v10, v88, s[26:27]
    global_store_dword v90, v89, s[92:93] sc1
    v_smfmac_f32_16x16x64_bf16 v[76:79], v[36:39], a[200:207], v2
    s_mov_b64 exec, -1
    v_smfmac_f32_16x16x64_bf16 v[76:79], v[40:43], a[208:215], v2
    v_add_f32 v72, v72, v73
    v_smfmac_f32_16x16x64_bf16 v[76:79], v[44:47], a[216:223], v2
    s_waitcnt vmcnt(7)
    v_add_f32 v74, v74, v75
    v_smfmac_f32_16x16x64_bf16 v[76:79], v[48:51], a[224:231], v2
    v_cvt_pk_bf16_f32 v120, v72, v74
    v_smfmac_f32_16x16x64_bf16 v[76:79], v[52:55], a[232:239], v2
    ds_write2_b32 v11, v120, v65 offset0:0 offset1:1
    v_smfmac_f32_16x16x64_bf16 v[76:79], v[56:59], a[240:247], v2
    v_smfmac_f32_16x16x64_bf16 v[76:79], v[60:63], a[248:255], v2
    v_smfmac_f32_16x16x64_bf16 v[80:83], v[32:35], v[128:135], v2
    v_smfmac_f32_16x16x64_bf16 v[80:83], v[36:39], v[136:143], v2
    v_add_f32 v76, v76, v77
    v_add_f32 v78, v78, v79
    v_smfmac_f32_16x16x64_bf16 v[80:83], v[40:43], v[144:151], v2
    v_cvt_pk_bf16_f32 v121, v76, v78
    v_smfmac_f32_16x16x64_bf16 v[80:83], v[44:47], v[152:159], v2
    ds_write2_b32 v11, v121, v69 offset0:128 offset1:129
    v_smfmac_f32_16x16x64_bf16 v[80:83], v[48:51], v[160:167], v2
    v_smfmac_f32_16x16x64_bf16 v[80:83], v[52:55], v[168:175], v2
    v_smfmac_f32_16x16x64_bf16 v[80:83], v[56:59], v[176:183], v2
    v_smfmac_f32_16x16x64_bf16 v[80:83], v[60:63], v[184:191], v2
    s_waitcnt lgkmcnt(0)
    s_barrier
    v_smfmac_f32_16x16x64_bf16 v[84:87], v[32:35], v[192:199], v2
    ds_read_b64_tr_b16 v[88:89], v12 offset:0
    v_smfmac_f32_16x16x64_bf16 v[84:87], v[36:39], v[200:207], v2
    ds_read_b64_tr_b16 v[90:91], v12 offset:512
    v_smfmac_f32_16x16x64_bf16 v[84:87], v[40:43], v[208:215], v2
    ds_read_b64_tr_b16 v[92:93], v12 offset:1024
    v_add_f32 v80, v80, v81
    v_smfmac_f32_16x16x64_bf16 v[84:87], v[44:47], v[216:223], v2
    ds_read_b64_tr_b16 v[94:95], v12 offset:1536
    v_add_f32 v82, v82, v83
    v_smfmac_f32_16x16x64_bf16 v[84:87], v[48:51], v[224:231], v2
    ds_read_b64_tr_b16 v[96:97], v12 offset:2048
    v_cvt_pk_bf16_f32 v122, v80, v82
    v_smfmac_f32_16x16x64_bf16 v[84:87], v[52:55], v[232:239], v2
    ds_read_b64_tr_b16 v[98:99], v12 offset:2560
    v_mov_b32 v80, v122
    v_smfmac_f32_16x16x64_bf16 v[84:87], v[56:59], v[240:247], v2
    ds_read_b64_tr_b16 v[100:101], v12 offset:3072
    v_smfmac_f32_16x16x64_bf16 v[84:87], v[60:63], v[248:255], v2
    ds_read_b64_tr_b16 v[102:103], v12 offset:3584
    s_waitcnt lgkmcnt(6)
    v_mfma_f32_16x16x32_bf16 v[64:67], v[104:107], v[88:91], 0
    ds_read_b128 v[32:35], v1 offset:4096
    s_nop 2
    v_add_f32 v84, v84, v85
    s_waitcnt lgkmcnt(5)
    v_mfma_f32_16x16x32_bf16 v[64:67], v[108:111], v[92:95], v[64:67]
    ds_read_b128 v[36:39], v1 offset:5120
    v_add_f32 v86, v86, v87
    s_waitcnt lgkmcnt(4)
    v_mfma_f32_16x16x32_bf16 v[64:67], v[112:115], v[96:99], v[64:67]
    ds_read_b128 v[40:43], v1 offset:6144
    v_cvt_pk_bf16_f32 v123, v84, v86
    s_waitcnt lgkmcnt(3)
    v_mfma_f32_16x16x32_bf16 v[64:67], v[116:119], v[100:103], v[64:67]
    ds_read_b128 v[44:47], v1 offset:7168
    v_mov_b32 v81, v123
    v_mfma_f32_16x16x32_bf16 v[76:79], v[88:91], v[88:91], 0
    ds_read_b128 v[48:51], v15 offset:2048
    v_mov_b32 v84, v123
    v_mov_b32 v85, 0
    v_mfma_f32_16x16x32_bf16 v[76:79], v[92:95], v[92:95], v[76:79]
    ds_read_b128 v[52:55], v15 offset:3072
    global_store_dwordx4 v1, v[120:123], s[32:33] sc1
    v_mfma_f32_16x16x32_bf16 v[76:79], v[96:99], v[96:99], v[76:79]
    ds_read_b128 v[56:59], v0 offset:2048
    v_mfma_f32_16x16x32_bf16 v[76:79], v[100:103], v[100:103], v[76:79]
    ds_read_b128 v[60:63], v0 offset:3072
    s_waitcnt lgkmcnt(4)
    v_mfma_f32_16x16x32_bf16 v[68:71], v[32:35], v[88:91], 0
    ds_read_b128 v[104:107], v15 offset:6144
    v_mfma_f32_16x16x32_bf16 v[68:71], v[36:39], v[92:95], v[68:71]
    ds_read_b128 v[108:111], v15 offset:7168
    v_max3_f32 v126, v64, v65, v66
    v_mfma_f32_16x16x32_bf16 v[68:71], v[40:43], v[96:99], v[68:71]
    ds_read_b128 v[112:115], v0 offset:6144
    v_max3_f32 v127, v67, v76, v77
    v_mfma_f32_16x16x32_bf16 v[68:71], v[44:47], v[100:103], v[68:71]
    ds_read_b128 v[116:119], v0 offset:7168
    v_max_f32 v126, v126, v127
    s_add_u32 s32, s32, 0x20000
    s_addc_u32 s33, s33, 0
    ds_read_b128 v[32:35], v15 offset:0
    ds_read_b128 v[36:39], v15 offset:1024
    ds_read_b128 v[88:91], v15 offset:4096
    s_nop 0
    v_max3_f32 v127, v68, v69, v70
    v_max3_f32 v126, v126, v127, v71
    v_mov_b32 v127, v126
    ds_read_b128 v[92:95], v15 offset:5120
    s_nop 0
    v_permlane16_swap_b32 v126, v127
    v_max_f32 v126, v126, v127
    v_mov_b32 v127, v126
    ds_read_b128 v[40:43], v0 offset:0
    s_nop 0
    v_permlane32_swap_b32 v126, v127
    v_max_f32 v126, v126, v127
    v_mul_f32 v126, s50, v126
    v_fma_f32 v64, v64, s50, -v126
    v_fma_f32 v65, v65, s50, -v126
    v_fma_f32 v66, v66, s50, -v126
    v_fma_f32 v67, v67, s50, -v126
    v_fma_f32 v68, v68, s50, -v126
    v_fma_f32 v69, v69, s50, -v126
    v_fma_f32 v70, v70, s50, -v126
    v_fma_f32 v71, v71, s50, -v126
    v_fma_f32 v76, v76, s50, -v126
    v_fma_f32 v77, v77, s50, -v126
    v_exp_f32 v64, v64
    v_exp_f32 v65, v65
    v_exp_f32 v66, v66
    v_exp_f32 v67, v67
    v_exp_f32 v68, v68
    v_exp_f32 v69, v69
    v_exp_f32 v70, v70
    v_exp_f32 v71, v71
    v_exp_f32 v76, v76
    v_exp_f32 v77, v77
    v_cvt_pk_bf16_f32 v72, v64, v65
    v_cvt_pk_bf16_f32 v73, v66, v67
    v_mov_b64 v[64:65], s[8:9]
    v_mov_b64 v[66:67], s[8:9]
    v_cvt_pk_bf16_f32 v74, v68, v69
    v_cvt_pk_bf16_f32 v75, v70, v71
    v_cvt_pk_bf16_f32 v78, v76, v77
    v_mov_b32 v79, 0
    v_mfma_f32_16x16x32_bf16 v[68:71], v[64:67], v[72:75], 0
    ds_read_b128 v[44:47], v0 offset:1024
    v_mfma_f32_16x16x32_bf16 v[120:123], v[16:19], v[72:75], 0
    ds_read_b128 v[96:99], v0 offset:4096
    v_mfma_f32_16x16x32_bf16 v[124:127], v[20:23], v[72:75], 0
    ds_read_b128 v[100:103], v0 offset:5120
    v_mfma_f32_16x16x16_bf16 v[68:71], v[64:65], v[78:79], v[68:71]
    v_mfma_f32_16x16x16_bf16 v[120:123], v[80:81], v[78:79], v[120:123]
    v_mfma_f32_16x16x16_bf16 v[124:127], v[84:85], v[78:79], v[124:127]
    v_rcp_f32 v68, v68
    s_nop 2
    v_pk_mul_f32 v[120:121], v[120:121], v[68:69] op_sel_hi:[1,0]
    v_pk_mul_f32 v[122:123], v[122:123], v[68:69] op_sel_hi:[1,0]
    v_cvt_pk_bf16_f32 v120, v120, v121
    v_cvt_pk_bf16_f32 v121, v122, v123
    s_mov_b64 exec, s[44:45]
    ds_write_b64 v13, v[120:121]
    v_pk_mul_f32 v[124:125], v[124:125], v[68:69] op_sel_hi:[1,0]
    v_pk_mul_f32 v[126:127], v[126:127], v[68:69] op_sel_hi:[1,0]
    v_cvt_pk_bf16_f32 v122, v124, v125
    v_cvt_pk_bf16_f32 v123, v126, v127
    ds_write_b64 v13, v[122:123] offset:32
    s_mov_b64 exec, -1
    v_mov_b64 v[64:65], 0
    v_mov_b64 v[66:67], 0
    v_mov_b64 v[68:69], 0
    v_mov_b64 v[70:71], 0
    v_mov_b64 v[72:73], 0
    v_mov_b64 v[74:75], 0
    v_mov_b64 v[76:77], 0
    v_mov_b64 v[78:79], 0
    v_mov_b64 v[80:81], 0
    v_mov_b64 v[82:83], 0
    v_mov_b64 v[84:85], 0
    v_mov_b64 v[86:87], 0
    v_mov_b64 v[120:121], 0
    v_mov_b64 v[122:123], 0
    v_mov_b64 v[124:125], 0
    v_mov_b64 v[126:127], 0
    s_waitcnt lgkmcnt(0)
    s_barrier
    ds_read_b128 v[16:19], v14
    ds_read_b128 v[20:23], v14 offset:128
    s_waitcnt lgkmcnt(1)
    v_smfmac_f32_16x16x64_bf16 v[64:67], v[16:19], v[32:39], v2
    ds_read_b128 v[32:35], v15 offset:8192
    s_waitcnt lgkmcnt(1)
    v_smfmac_f32_16x16x64_bf16 v[64:67], v[20:23], v[40:47], v2
    ds_read_b128 v[36:39], v15 offset:9216
    v_smfmac_f32_16x16x64_bf16 v[68:71], v[16:19], v[48:55], v2
    ds_read_b128 v[40:43], v0 offset:8192
    v_smfmac_f32_16x16x64_bf16 v[68:71], v[20:23], v[56:63], v2
    ds_read_b128 v[44:47], v0 offset:9216
    v_add_f32 v64, v64, v65
    v_smfmac_f32_16x16x64_bf16 v[72:75], v[16:19], v[88:95], v2
    ds_read_b128 v[48:51], v15 offset:10240
    v_add_f32 v66, v66, v67
    v_smfmac_f32_16x16x64_bf16 v[72:75], v[20:23], v[96:103], v2
    ds_read_b128 v[52:55], v15 offset:11264
    v_cvt_pk_bf16_f32 v64, v64, v66
    v_add_f32 v68, v68, v69
    v_smfmac_f32_16x16x64_bf16 v[76:79], v[16:19], v[104:111], v2
    ds_read_b128 v[56:59], v0 offset:10240
    v_add_f32 v70, v70, v71
    v_smfmac_f32_16x16x64_bf16 v[76:79], v[20:23], v[112:119], v2
    ds_read_b128 v[60:63], v0 offset:11264
    v_cvt_pk_bf16_f32 v65, v68, v70
    v_add_f32 v72, v72, v73
    v_smfmac_f32_16x16x64_bf16 v[80:83], v[16:19], a[0:7], v2
    v_add_f32 v74, v74, v75
    v_smfmac_f32_16x16x64_bf16 v[80:83], v[20:23], a[8:15], v2
    v_cvt_pk_bf16_f32 v66, v72, v74
    v_add_f32 v76, v76, v77
    v_smfmac_f32_16x16x64_bf16 v[84:87], v[16:19], a[16:23], v2
    v_add_f32 v78, v78, v79
    v_smfmac_f32_16x16x64_bf16 v[84:87], v[20:23], a[24:31], v2
    v_cvt_pk_bf16_f32 v67, v76, v78
    v_add_f32 v80, v80, v81
    v_and_b32 v64, -2, v64
    s_waitcnt lgkmcnt(4)
    v_smfmac_f32_16x16x64_bf16 v[120:123], v[16:19], v[32:39], v2
    global_store_dwordx4 v8, v[64:67], s[20:21]
    v_add_f32 v82, v82, v83
    v_add_u32 v72, 0x8000, v8
    s_waitcnt lgkmcnt(3)
    v_smfmac_f32_16x16x64_bf16 v[120:123], v[20:23], v[40:47], v2
    v_cvt_pk_bf16_f32 v82, v80, v82
    v_add_f32 v84, v84, v85
    s_waitcnt lgkmcnt(2)
    v_smfmac_f32_16x16x64_bf16 v[124:127], v[16:19], v[48:55], v2
    v_add_f32 v86, v86, v87
    s_waitcnt lgkmcnt(0)
    v_smfmac_f32_16x16x64_bf16 v[124:127], v[20:23], v[56:63], v2
    v_cvt_pk_bf16_f32 v83, v84, v86
    v_add_f32 v120, v120, v121
    v_add_f32 v122, v122, v123
    v_cvt_pk_bf16_f32 v80, v120, v122
    s_nop 3
    v_add_f32 v124, v124, v125
    v_add_f32 v126, v126, v127
    v_cvt_pk_bf16_f32 v81, v124, v126
    v_and_b32 v80, -2, v80
    global_store_dwordx4 v72, v[80:83], s[20:21]
    v_mov_b64 v[64:65], 0
    v_mov_b64 v[66:67], 0
    v_mov_b64 v[68:69], 0
    v_mov_b64 v[70:71], 0
    v_mov_b64 v[72:73], 0
    v_mov_b64 v[74:75], 0
    v_mov_b64 v[76:77], 0
    v_mov_b64 v[78:79], 0
    v_mov_b64 v[80:81], 0
    v_mov_b64 v[82:83], 0
    v_mov_b64 v[84:85], 0
    v_mov_b64 v[86:87], 0
    ds_read_b128 v[88:91], v15 offset:12288
    ds_read_b128 v[92:95], v15 offset:13312
    ds_read_b128 v[96:99], v0 offset:12288
    ds_read_b128 v[100:103], v0 offset:13312
    ds_read_b128 v[104:107], v15 offset:14336
    ds_read_b128 v[108:111], v15 offset:15360
    ds_read_b128 v[112:115], v0 offset:14336
    ds_read_b128 v[116:119], v0 offset:15360
    s_waitcnt vmcnt(2)
    v_readlane_b32 s95, v3, 0
    v_readlane_b32 s39, v3, 1
    s_add_u32 s94, s38, 2
    s_lshr_b32 s94, s94, 1
    s_add_u32 s94, s94, 1
    s_min_u32 s94, s94, 32
    s_min_u32 s95, s95, s39
    s_cmp_lt_u32 s95, s94
    s_cbranch_scc1 LKV_0F
LKVB_0F:
    s_waitcnt vmcnt(0)
    global_load_dwordx4 v[32:35], v1, s[96:97] sc1
    global_load_dwordx4 v[36:39], v1, s[96:97] offset:1024 sc1
    s_waitcnt vmcnt(0)
    v_mfma_f32_16x16x32_bf16 v[48:51], v[32:35], v[4:7], 0
    v_bitop3_b32 v52, v32, v36, 1 bitop3:0xa8
    v_cmp_ne_u32 vcc, 0, v52
    v_mfma_f32_16x16x32_bf16 v[48:51], v[36:39], v[4:7], v[48:51]
    s_cbranch_vccnz LPR_0F
LPB_0F:
    s_nop 6
    v_permlane32_swap_b32 v48, v49
    v_permlane32_swap_b32 v50, v51
    v_add_f32 v48, v48, v49
    v_add_f32 v50, v50, v51
    s_nop 1
    v_permlane16_swap_b32 v48, v50
    v_add_f32 v48, v48, v50
    s_nop 1
    v_mov_b32_dpp v49, v48 quad_perm:[2,3,2,3] row_mask:0xf bank_mask:0xf
    v_cvt_pk_bf16_f32 v48, v48, v49
    s_mov_b64 exec, s[46:47]
    global_store_dword v10, v48, s[24:25]
    s_mov_b64 exec, -1
    s_add_u32 s98, s24, s101
    s_addc_u32 s99, s25, 0
    v_add_u32 v40, s100, v1
    s_add_u32 s38, s38, 1
    s_add_u32 s39, s38, 1
    s_and_b32 s39, s39, 3
    s_lshl_b32 s40, s39, 13
    s_add_u32 s39, s38, 2
    s_and_b32 s39, s39, 3
    s_lshl_b32 s39, s39, 13
    s_add_u32 s26, s22, s39
    s_addc_u32 s27, s23, 0
    s_waitcnt vmcnt(0)
    global_load_dwordx4 v[120:123], v1, s[98:99] sc1
    global_load_dwordx4 v[124:127], v1, s[98:99] offset:1024 sc1
    s_waitcnt vmcnt(0)
    ds_write_b128 v40, v[120:123]
    ds_write_b128 v40, v[124:127] offset:1024
    v_max3_u32 v42, v120, v121, v122
    v_max3_u32 v43, v124, v125, v126
    v_max3_u32 v42, v42, v123, v127
    v_max_u32 v42, v42, v43
    v_cmp_eq_u32 vcc, -1, v42
    s_cbranch_vccnz LMR_0F
LMB_0F:
    s_add_u32 s24, s22, s40
    s_addc_u32 s25, s23, 0
    s_waitcnt lgkmcnt(0)
    s_barrier
    s_cmp_ge_u32 s38, 63
    s_cbranch_scc1 L_last1F
    ds_read_b128 v[32:35], v1 offset:16384
    ds_read_b128 v[36:39], v1 offset:17408
    ds_read_b128 v[40:43], v1 offset:18432
    s_waitcnt lgkmcnt(2)
    v_smfmac_f32_16x16x64_bf16 v[64:67], v[32:35], v[88:95], v2
    ds_read_b128 v[44:47], v1 offset:19456
    s_waitcnt lgkmcnt(2)
    v_smfmac_f32_16x16x64_bf16 v[64:67], v[36:39], v[96:103], v2
    ds_read_b128 v[48:51], v1 offset:20480
    s_waitcnt lgkmcnt(2)
    v_smfmac_f32_16x16x64_bf16 v[64:67], v[40:43], v[104:111], v2
    ds_read_b128 v[52:55], v1 offset:21504
    s_waitcnt lgkmcnt(2)
    v_smfmac_f32_16x16x64_bf16 v[64:67], v[44:47], v[112:119], v2
    ds_read_b128 v[56:59], v1 offset:22528
    s_waitcnt lgkmcnt(2)
    v_smfmac_f32_16x16x64_bf16 v[64:67], v[48:51], a[32:39], v2
    ds_read_b128 v[60:63], v1 offset:23552
    s_waitcnt lgkmcnt(2)
    v_smfmac_f32_16x16x64_bf16 v[64:67], v[52:55], a[40:47], v2
    s_waitcnt lgkmcnt(1)
    v_smfmac_f32_16x16x64_bf16 v[64:67], v[56:59], a[48:55], v2
    s_waitcnt lgkmcnt(0)
    v_smfmac_f32_16x16x64_bf16 v[64:67], v[60:63], a[56:63], v2
    v_smfmac_f32_16x16x64_bf16 v[68:71], v[32:35], a[64:71], v2
    ds_read_b128 v[104:107], v1 offset:8192
    v_smfmac_f32_16x16x64_bf16 v[68:71], v[36:39], a[72:79], v2
    ds_read_b128 v[108:111], v1 offset:9216
    v_smfmac_f32_16x16x64_bf16 v[68:71], v[40:43], a[80:87], v2
    ds_read_b128 v[112:115], v1 offset:10240
    v_add_f32 v64, v64, v65
    v_smfmac_f32_16x16x64_bf16 v[68:71], v[44:47], a[88:95], v2
    ds_read_b128 v[116:119], v1 offset:11264
    v_add_f32 v66, v66, v67
    v_smfmac_f32_16x16x64_bf16 v[68:71], v[48:51], a[96:103], v2
    global_load_dword v3, v9, s[34:35] sc1
    v_cvt_pk_bf16_f32 v65, v64, v66
    v_smfmac_f32_16x16x64_bf16 v[68:71], v[52:55], a[104:111], v2
    s_add_u32 m0, s49, 0
    v_mov_b32 v88, -1
    v_smfmac_f32_16x16x64_bf16 v[68:71], v[56:59], a[112:119], v2
    global_load_dwordx4 v[16:19], v1, s[30:31]
    v_smfmac_f32_16x16x64_bf16 v[68:71], v[60:63], a[120:127], v2
    v_smfmac_f32_16x16x64_bf16 v[72:75], v[32:35], a[128:135], v2
    global_load_lds_dwordx4 v1, s[28:29]
    v_smfmac_f32_16x16x64_bf16 v[72:75], v[36:39], a[136:143], v2
    v_smfmac_f32_16x16x64_bf16 v[72:75], v[40:43], a[144:151], v2
    global_load_dwordx4 v[20:23], v1, s[30:31] offset:1024
    v_add_f32 v68, v68, v69
    v_smfmac_f32_16x16x64_bf16 v[72:75], v[44:47], a[152:159], v2
    v_add_f32 v70, v70, v71
    v_smfmac_f32_16x16x64_bf16 v[72:75], v[48:51], a[160:167], v2
    global_load_lds_dwordx4 v1, s[28:29] offset:1024
    v_cvt_pk_bf16_f32 v69, v68, v70
    v_smfmac_f32_16x16x64_bf16 v[72:75], v[52:55], a[168:175], v2
    s_add_u32 s28, s28, 0x40000
    s_addc_u32 s29, s29, 0
    v_smfmac_f32_16x16x64_bf16 v[72:75], v[56:59], a[176:183], v2
    s_add_u32 s30, s30, 0x40000
    s_addc_u32 s31, s31, 0
    v_smfmac_f32_16x16x64_bf16 v[72:75], v[60:63], a[184:191], v2
    v_smfmac_f32_16x16x64_bf16 v[76:79], v[32:35], a[192:199], v2
    s_mov_b64 exec, s[46:47]
    global_store_dword v10, v88, s[26:27]
    v_smfmac_f32_16x16x64_bf16 v[76:79], v[36:39], a[200:207], v2
    s_mov_b64 exec, -1
    v_smfmac_f32_16x16x64_bf16 v[76:79], v[40:43], a[208:215], v2
    v_add_f32 v72, v72, v73
    v_smfmac_f32_16x16x64_bf16 v[76:79], v[44:47], a[216:223], v2
    s_waitcnt vmcnt(6)
    v_add_f32 v74, v74, v75
    v_smfmac_f32_16x16x64_bf16 v[76:79], v[48:51], a[224:231], v2
    v_cvt_pk_bf16_f32 v120, v72, v74
    v_smfmac_f32_16x16x64_bf16 v[76:79], v[52:55], a[232:239], v2
    ds_write2_b32 v11, v120, v65 offset0:0 offset1:1
    v_smfmac_f32_16x16x64_bf16 v[76:79], v[56:59], a[240:247], v2
    v_smfmac_f32_16x16x64_bf16 v[76:79], v[60:63], a[248:255], v2
    v_smfmac_f32_16x16x64_bf16 v[80:83], v[32:35], v[128:135], v2
    v_smfmac_f32_16x16x64_bf16 v[80:83], v[36:39], v[136:143], v2
    v_add_f32 v76, v76, v77
    v_add_f32 v78, v78, v79
    v_smfmac_f32_16x16x64_bf16 v[80:83], v[40:43], v[144:151], v2
    v_cvt_pk_bf16_f32 v121, v76, v78
    v_smfmac_f32_16x16x64_bf16 v[80:83], v[44:47], v[152:159], v2
    ds_write2_b32 v11, v121, v69 offset0:128 offset1:129
    v_smfmac_f32_16x16x64_bf16 v[80:83], v[48:51], v[160:167], v2
    v_smfmac_f32_16x16x64_bf16 v[80:83], v[52:55], v[168:175], v2
    v_smfmac_f32_16x16x64_bf16 v[80:83], v[56:59], v[176:183], v2
    v_smfmac_f32_16x16x64_bf16 v[80:83], v[60:63], v[184:191], v2
    s_waitcnt lgkmcnt(0)
    s_barrier
    v_smfmac_f32_16x16x64_bf16 v[84:87], v[32:35], v[192:199], v2
    ds_read_b64_tr_b16 v[88:89], v12 offset:0
    v_smfmac_f32_16x16x64_bf16 v[84:87], v[36:39], v[200:207], v2
    ds_read_b64_tr_b16 v[90:91], v12 offset:512
    v_smfmac_f32_16x16x64_bf16 v[84:87], v[40:43], v[208:215], v2
    ds_read_b64_tr_b16 v[92:93], v12 offset:1024
    v_add_f32 v80, v80, v81
    v_smfmac_f32_16x16x64_bf16 v[84:87], v[44:47], v[216:223], v2
    ds_read_b64_tr_b16 v[94:95], v12 offset:1536
    v_add_f32 v82, v82, v83
    v_smfmac_f32_16x16x64_bf16 v[84:87], v[48:51], v[224:231], v2
    ds_read_b64_tr_b16 v[96:97], v12 offset:2048
    v_cvt_pk_bf16_f32 v122, v80, v82
    v_smfmac_f32_16x16x64_bf16 v[84:87], v[52:55], v[232:239], v2
    ds_read_b64_tr_b16 v[98:99], v12 offset:2560
    v_mov_b32 v80, v122
    v_smfmac_f32_16x16x64_bf16 v[84:87], v[56:59], v[240:247], v2
    ds_read_b64_tr_b16 v[100:101], v12 offset:3072
    v_smfmac_f32_16x16x64_bf16 v[84:87], v[60:63], v[248:255], v2
    ds_read_b64_tr_b16 v[102:103], v12 offset:3584
    s_waitcnt lgkmcnt(6)
    v_mfma_f32_16x16x32_bf16 v[64:67], v[104:107], v[88:91], 0
    ds_read_b128 v[32:35], v1 offset:12288
    s_nop 2
    v_add_f32 v84, v84, v85
    s_waitcnt lgkmcnt(5)
    v_mfma_f32_16x16x32_bf16 v[64:67], v[108:111], v[92:95], v[64:67]
    ds_read_b128 v[36:39], v1 offset:13312
    v_add_f32 v86, v86, v87
    s_waitcnt lgkmcnt(4)
    v_mfma_f32_16x16x32_bf16 v[64:67], v[112:115], v[96:99], v[64:67]
    ds_read_b128 v[40:43], v1 offset:14336
    v_cvt_pk_bf16_f32 v123, v84, v86
    s_waitcnt lgkmcnt(3)
    v_mfma_f32_16x16x32_bf16 v[64:67], v[116:119], v[100:103], v[64:67]
    ds_read_b128 v[44:47], v1 offset:15360
    v_mov_b32 v81, v123
    v_mfma_f32_16x16x32_bf16 v[76:79], v[88:91], v[88:91], 0
    ds_read_b128 v[48:51], v15 offset:2048
    v_mov_b32 v84, v123
    v_mov_b32 v85, 0
    v_mfma_f32_16x16x32_bf16 v[76:79], v[92:95], v[92:95], v[76:79]
    ds_read_b128 v[52:55], v15 offset:3072
    global_store_dwordx4 v1, v[120:123], s[32:33] sc1
    v_mfma_f32_16x16x32_bf16 v[76:79], v[96:99], v[96:99], v[76:79]
    ds_read_b128 v[56:59], v0 offset:2048
    v_mfma_f32_16x16x32_bf16 v[76:79], v[100:103], v[100:103], v[76:79]
    ds_read_b128 v[60:63], v0 offset:3072
    s_waitcnt lgkmcnt(4)
    v_mfma_f32_16x16x32_bf16 v[68:71], v[32:35], v[88:91], 0
    ds_read_b128 v[104:107], v15 offset:6144
    v_mfma_f32_16x16x32_bf16 v[68:71], v[36:39], v[92:95], v[68:71]
    ds_read_b128 v[108:111], v15 offset:7168
    v_max3_f32 v126, v64, v65, v66
    v_mfma_f32_16x16x32_bf16 v[68:71], v[40:43], v[96:99], v[68:71]
    ds_read_b128 v[112:115], v0 offset:6144
    v_max3_f32 v127, v67, v76, v77
    v_mfma_f32_16x16x32_bf16 v[68:71], v[44:47], v[100:103], v[68:71]
    ds_read_b128 v[116:119], v0 offset:7168
    v_max_f32 v126, v126, v127
    s_add_u32 s32, s32, 0x20000
    s_addc_u32 s33, s33, 0
    ds_read_b128 v[32:35], v15 offset:0
    ds_read_b128 v[36:39], v15 offset:1024
    ds_read_b128 v[88:91], v15 offset:4096
    s_nop 0
    v_max3_f32 v127, v68, v69, v70
    v_max3_f32 v126, v126, v127, v71
    v_mov_b32 v127, v126
    ds_read_b128 v[92:95], v15 offset:5120
    s_nop 0
    v_permlane16_swap_b32 v126, v127
    v_max_f32 v126, v126, v127
    v_mov_b32 v127, v126
    ds_read_b128 v[40:43], v0 offset:0
    s_nop 0
    v_permlane32_swap_b32 v126, v127
    v_max_f32 v126, v126, v127
    v_mul_f32 v126, s50, v126
    v_fma_f32 v64, v64, s50, -v126
    v_fma_f32 v65, v65, s50, -v126
    v_fma_f32 v66, v66, s50, -v126
    v_fma_f32 v67, v67, s50, -v126
    v_fma_f32 v68, v68, s50, -v126
    v_fma_f32 v69, v69, s50, -v126
    v_fma_f32 v70, v70, s50, -v126
    v_fma_f32 v71, v71, s50, -v126
    v_fma_f32 v76, v76, s50, -v126
    v_fma_f32 v77, v77, s50, -v126
    v_exp_f32 v64, v64
    v_exp_f32 v65, v65
    v_exp_f32 v66, v66
    v_exp_f32 v67, v67
    v_exp_f32 v68, v68
    v_exp_f32 v69, v69
    v_exp_f32 v70, v70
    v_exp_f32 v71, v71
    v_exp_f32 v76, v76
    v_exp_f32 v77, v77
    v_cvt_pk_bf16_f32 v72, v64, v65
    v_cvt_pk_bf16_f32 v73, v66, v67
    v_mov_b64 v[64:65], s[8:9]
    v_mov_b64 v[66:67], s[8:9]
    v_cvt_pk_bf16_f32 v74, v68, v69
    v_cvt_pk_bf16_f32 v75, v70, v71
    v_cvt_pk_bf16_f32 v78, v76, v77
    v_mov_b32 v79, 0
    v_mfma_f32_16x16x32_bf16 v[68:71], v[64:67], v[72:75], 0
    ds_read_b128 v[44:47], v0 offset:1024
    v_mfma_f32_16x16x32_bf16 v[120:123], v[24:27], v[72:75], 0
    ds_read_b128 v[96:99], v0 offset:4096
    v_mfma_f32_16x16x32_bf16 v[124:127], v[28:31], v[72:75], 0
    ds_read_b128 v[100:103], v0 offset:5120
    v_mfma_f32_16x16x16_bf16 v[68:71], v[64:65], v[78:79], v[68:71]
    v_mfma_f32_16x16x16_bf16 v[120:123], v[80:81], v[78:79], v[120:123]
    v_mfma_f32_16x16x16_bf16 v[124:127], v[84:85], v[78:79], v[124:127]
    v_rcp_f32 v68, v68
    s_nop 2
    v_pk_mul_f32 v[120:121], v[120:121], v[68:69] op_sel_hi:[1,0]
    v_pk_mul_f32 v[122:123], v[122:123], v[68:69] op_sel_hi:[1,0]
    v_cvt_pk_bf16_f32 v120, v120, v121
    v_cvt_pk_bf16_f32 v121, v122, v123
    s_mov_b64 exec, s[44:45]
    ds_write_b64 v13, v[120:121]
    v_pk_mul_f32 v[124:125], v[124:125], v[68:69] op_sel_hi:[1,0]
    v_pk_mul_f32 v[126:127], v[126:127], v[68:69] op_sel_hi:[1,0]
    v_cvt_pk_bf16_f32 v122, v124, v125
    v_cvt_pk_bf16_f32 v123, v126, v127
    ds_write_b64 v13, v[122:123] offset:32
    s_mov_b64 exec, -1
    v_mov_b64 v[64:65], 0
    v_mov_b64 v[66:67], 0
    v_mov_b64 v[68:69], 0
    v_mov_b64 v[70:71], 0
    v_mov_b64 v[72:73], 0
    v_mov_b64 v[74:75], 0
    v_mov_b64 v[76:77], 0
    v_mov_b64 v[78:79], 0
    v_mov_b64 v[80:81], 0
    v_mov_b64 v[82:83], 0
    v_mov_b64 v[84:85], 0
    v_mov_b64 v[86:87], 0
    v_mov_b64 v[120:121], 0
    v_mov_b64 v[122:123], 0
    v_mov_b64 v[124:125], 0
    v_mov_b64 v[126:127], 0
    s_waitcnt lgkmcnt(0)
    s_barrier
    ds_read_b128 v[24:27], v14
    ds_read_b128 v[28:31], v14 offset:128
    s_waitcnt lgkmcnt(1)
    v_smfmac_f32_16x16x64_bf16 v[64:67], v[24:27], v[32:39], v2
    ds_read_b128 v[32:35], v15 offset:8192
    s_waitcnt lgkmcnt(1)
    v_smfmac_f32_16x16x64_bf16 v[64:67], v[28:31], v[40:47], v2
    ds_read_b128 v[36:39], v15 offset:9216
    v_smfmac_f32_16x16x64_bf16 v[68:71], v[24:27], v[48:55], v2
    ds_read_b128 v[40:43], v0 offset:8192
    v_smfmac_f32_16x16x64_bf16 v[68:71], v[28:31], v[56:63], v2
    ds_read_b128 v[44:47], v0 offset:9216
    v_add_f32 v64, v64, v65
    v_smfmac_f32_16x16x64_bf16 v[72:75], v[24:27], v[88:95], v2
    ds_read_b128 v[48:51], v15 offset:10240
    v_add_f32 v66, v66, v67
    v_smfmac_f32_16x16x64_bf16 v[72:75], v[28:31], v[96:103], v2
    ds_read_b128 v[52:55], v15 offset:11264
    v_cvt_pk_bf16_f32 v64, v64, v66
    v_add_f32 v68, v68, v69
    v_smfmac_f32_16x16x64_bf16 v[76:79], v[24:27], v[104:111], v2
    ds_read_b128 v[56:59], v0 offset:10240
    v_add_f32 v70, v70, v71
    v_smfmac_f32_16x16x64_bf16 v[76:79], v[28:31], v[112:119], v2
    ds_read_b128 v[60:63], v0 offset:11264
    v_cvt_pk_bf16_f32 v65, v68, v70
    v_add_f32 v72, v72, v73
    v_smfmac_f32_16x16x64_bf16 v[80:83], v[24:27], a[0:7], v2
    v_add_f32 v74, v74, v75
    v_smfmac_f32_16x16x64_bf16 v[80:83], v[28:31], a[8:15], v2
    v_cvt_pk_bf16_f32 v66, v72, v74
    v_add_f32 v76, v76, v77
    v_smfmac_f32_16x16x64_bf16 v[84:87], v[24:27], a[16:23], v2
    v_add_f32 v78, v78, v79
    v_smfmac_f32_16x16x64_bf16 v[84:87], v[28:31], a[24:31], v2
    v_cvt_pk_bf16_f32 v67, v76, v78
    v_add_f32 v80, v80, v81
    v_or_b32 v64, 1, v64
    s_waitcnt lgkmcnt(4)
    v_smfmac_f32_16x16x64_bf16 v[120:123], v[24:27], v[32:39], v2
    global_store_dwordx4 v8, v[64:67], s[20:21]
    v_add_f32 v82, v82, v83
    v_add_u32 v72, 0x8000, v8
    s_waitcnt lgkmcnt(3)
    v_smfmac_f32_16x16x64_bf16 v[120:123], v[28:31], v[40:47], v2
    v_cvt_pk_bf16_f32 v82, v80, v82
    v_add_f32 v84, v84, v85
    s_waitcnt lgkmcnt(2)
    v_smfmac_f32_16x16x64_bf16 v[124:127], v[24:27], v[48:55], v2
    v_add_f32 v86, v86, v87
    s_waitcnt lgkmcnt(0)
    v_smfmac_f32_16x16x64_bf16 v[124:127], v[28:31], v[56:63], v2
    v_cvt_pk_bf16_f32 v83, v84, v86
    v_add_f32 v120, v120, v121
    v_add_f32 v122, v122, v123
    v_cvt_pk_bf16_f32 v80, v120, v122
    s_nop 3
    v_add_f32 v124, v124, v125
    v_add_f32 v126, v126, v127
    v_cvt_pk_bf16_f32 v81, v124, v126
    v_or_b32 v80, 1, v80
    global_store_dwordx4 v72, v[80:83], s[20:21]
    v_mov_b64 v[64:65], 0
    v_mov_b64 v[66:67], 0
    v_mov_b64 v[68:69], 0
    v_mov_b64 v[70:71], 0
    v_mov_b64 v[72:73], 0
    v_mov_b64 v[74:75], 0
    v_mov_b64 v[76:77], 0
    v_mov_b64 v[78:79], 0
    v_mov_b64 v[80:81], 0
    v_mov_b64 v[82:83], 0
    v_mov_b64 v[84:85], 0
    v_mov_b64 v[86:87], 0
    ds_read_b128 v[88:91], v15 offset:12288
    ds_read_b128 v[92:95], v15 offset:13312
    ds_read_b128 v[96:99], v0 offset:12288
    ds_read_b128 v[100:103], v0 offset:13312
    ds_read_b128 v[104:107], v15 offset:14336
    ds_read_b128 v[108:111], v15 offset:15360
    ds_read_b128 v[112:115], v0 offset:14336
    ds_read_b128 v[116:119], v0 offset:15360
    s_waitcnt vmcnt(2)
    v_readlane_b32 s95, v3, 0
    v_readlane_b32 s39, v3, 1
    s_add_u32 s94, s38, 2
    s_lshr_b32 s94, s94, 1
    s_add_u32 s94, s94, 1
    s_min_u32 s94, s94, 32
    s_min_u32 s95, s95, s39
    s_cmp_lt_u32 s95, s94
    s_cbranch_scc1 LKV_1F
LKVB_1F:
    s_waitcnt vmcnt(0)
    global_load_dwordx4 v[32:35], v1, s[96:97] sc1
    global_load_dwordx4 v[36:39], v1, s[96:97] offset:1024 sc1
    s_waitcnt vmcnt(0)
    v_mfma_f32_16x16x32_bf16 v[48:51], v[32:35], v[4:7], 0
    v_bitop3_b32 v52, v32, v36, 1 bitop3:0x2a
    v_cmp_ne_u32 vcc, 0, v52
    v_mfma_f32_16x16x32_bf16 v[48:51], v[36:39], v[4:7], v[48:51]
    s_cbranch_vccnz LPR_1F
LPB_1F:
    s_nop 6
    v_permlane32_swap_b32 v48, v49
    v_permlane32_swap_b32 v50, v51
    v_add_f32 v48, v48, v49
    v_add_f32 v50, v50, v51
    s_nop 1
    v_permlane16_swap_b32 v48, v50
    v_add_f32 v48, v48, v50
    s_nop 1
    v_mov_b32_dpp v49, v48 quad_perm:[2,3,2,3] row_mask:0xf bank_mask:0xf
    v_cvt_pk_bf16_f32 v48, v48, v49
    s_mov_b64 exec, s[46:47]
    global_store_dword v10, v48, s[24:25]
    s_mov_b64 exec, -1
    s_add_u32 s98, s24, s101
    s_addc_u32 s99, s25, 0
    v_add_u32 v40, s100, v1
    s_add_u32 s38, s38, 1
    s_add_u32 s39, s38, 1
    s_and_b32 s39, s39, 3
    s_lshl_b32 s40, s39, 13
    s_add_u32 s39, s38, 2
    s_and_b32 s39, s39, 3
    s_lshl_b32 s39, s39, 13
    s_add_u32 s26, s22, s39
    s_addc_u32 s27, s23, 0
    s_waitcnt vmcnt(0)
    global_load_dwordx4 v[120:123], v1, s[98:99] sc1
    global_load_dwordx4 v[124:127], v1, s[98:99] offset:1024 sc1
    s_waitcnt vmcnt(0)
    ds_write_b128 v40, v[120:123]
    ds_write_b128 v40, v[124:127] offset:1024
    v_max3_u32 v42, v120, v121, v122
    v_max3_u32 v43, v124, v125, v126
    v_max3_u32 v42, v42, v123, v127
    v_max_u32 v42, v42, v43
    v_cmp_eq_u32 vcc, -1, v42
    s_cbranch_vccnz LMR_1F
LMB_1F:
    s_add_u32 s24, s22, s40
    s_addc_u32 s25, s23, 0
    s_waitcnt lgkmcnt(0)
    s_barrier
    s_cmp_lt_u32 s38, 63
    s_cbranch_scc1 L_loopF
    ds_read_b128 v[32:35], v1 offset:16384
    ds_read_b128 v[36:39], v1 offset:17408
    ds_read_b128 v[40:43], v1 offset:18432
    s_waitcnt lgkmcnt(2)
    v_smfmac_f32_16x16x64_bf16 v[64:67], v[32:35], v[88:95], v2
    ds_read_b128 v[44:47], v1 offset:19456
    s_waitcnt lgkmcnt(2)
    v_smfmac_f32_16x16x64_bf16 v[64:67], v[36:39], v[96:103], v2
    ds_read_b128 v[48:51], v1 offset:20480
    s_waitcnt lgkmcnt(2)
    v_smfmac_f32_16x16x64_bf16 v[64:67], v[40:43], v[104:111], v2
    ds_read_b128 v[52:55], v1 offset:21504
    s_waitcnt lgkmcnt(2)
    v_smfmac_f32_16x16x64_bf16 v[64:67], v[44:47], v[112:119], v2
    ds_read_b128 v[56:59], v1 offset:22528
    s_waitcnt lgkmcnt(2)
    v_smfmac_f32_16x16x64_bf16 v[64:67], v[48:51], a[32:39], v2
    ds_read_b128 v[60:63], v1 offset:23552
    s_waitcnt lgkmcnt(2)
    v_smfmac_f32_16x16x64_bf16 v[64:67], v[52:55], a[40:47], v2
    s_waitcnt lgkmcnt(1)
    v_smfmac_f32_16x16x64_bf16 v[64:67], v[56:59], a[48:55], v2
    s_waitcnt lgkmcnt(0)
    v_smfmac_f32_16x16x64_bf16 v[64:67], v[60:63], a[56:63], v2
    v_smfmac_f32_16x16x64_bf16 v[68:71], v[32:35], a[64:71], v2
    v_smfmac_f32_16x16x64_bf16 v[68:71], v[36:39], a[72:79], v2
    v_smfmac_f32_16x16x64_bf16 v[68:71], v[40:43], a[80:87], v2
    v_add_f32 v64, v64, v65
    v_smfmac_f32_16x16x64_bf16 v[68:71], v[44:47], a[88:95], v2
    v_add_f32 v66, v66, v67
    v_smfmac_f32_16x16x64_bf16 v[68:71], v[48:51], a[96:103], v2
    v_cvt_pk_bf16_f32 v65, v64, v66
    v_smfmac_f32_16x16x64_bf16 v[68:71], v[52:55], a[104:111], v2
    v_smfmac_f32_16x16x64_bf16 v[68:71], v[56:59], a[112:119], v2
    v_mov_b32 v89, s38
    v_smfmac_f32_16x16x64_bf16 v[68:71], v[60:63], a[120:127], v2
    v_mov_b32 v90, 0
    v_smfmac_f32_16x16x64_bf16 v[72:75], v[32:35], a[128:135], v2
    v_smfmac_f32_16x16x64_bf16 v[72:75], v[36:39], a[136:143], v2
    v_smfmac_f32_16x16x64_bf16 v[72:75], v[40:43], a[144:151], v2
    v_add_f32 v68, v68, v69
    v_smfmac_f32_16x16x64_bf16 v[72:75], v[44:47], a[152:159], v2
    v_add_f32 v70, v70, v71
    v_smfmac_f32_16x16x64_bf16 v[72:75], v[48:51], a[160:167], v2
    v_cvt_pk_bf16_f32 v69, v68, v70
    v_smfmac_f32_16x16x64_bf16 v[72:75], v[52:55], a[168:175], v2
    v_smfmac_f32_16x16x64_bf16 v[72:75], v[56:59], a[176:183], v2
    v_smfmac_f32_16x16x64_bf16 v[72:75], v[60:63], a[184:191], v2
    v_smfmac_f32_16x16x64_bf16 v[76:79], v[32:35], a[192:199], v2
    s_mov_b64 exec, s[46:47]
    global_store_dword v90, v89, s[92:93] sc1
    v_smfmac_f32_16x16x64_bf16 v[76:79], v[36:39], a[200:207], v2
    s_mov_b64 exec, -1
    v_smfmac_f32_16x16x64_bf16 v[76:79], v[40:43], a[208:215], v2
    v_add_f32 v72, v72, v73
    v_smfmac_f32_16x16x64_bf16 v[76:79], v[44:47], a[216:223], v2
    s_waitcnt vmcnt(1)
    v_add_f32 v74, v74, v75
    v_smfmac_f32_16x16x64_bf16 v[76:79], v[48:51], a[224:231], v2
    v_cvt_pk_bf16_f32 v120, v72, v74
    v_smfmac_f32_16x16x64_bf16 v[76:79], v[52:55], a[232:239], v2
    ds_write2_b32 v11, v120, v65 offset0:0 offset1:1
    v_smfmac_f32_16x16x64_bf16 v[76:79], v[56:59], a[240:247], v2
    v_smfmac_f32_16x16x64_bf16 v[76:79], v[60:63], a[248:255], v2
    v_smfmac_f32_16x16x64_bf16 v[80:83], v[32:35], v[128:135], v2
    v_smfmac_f32_16x16x64_bf16 v[80:83], v[36:39], v[136:143], v2
    v_add_f32 v76, v76, v77
    v_add_f32 v78, v78, v79
    v_smfmac_f32_16x16x64_bf16 v[80:83], v[40:43], v[144:151], v2
    v_cvt_pk_bf16_f32 v121, v76, v78
    v_smfmac_f32_16x16x64_bf16 v[80:83], v[44:47], v[152:159], v2
    ds_write2_b32 v11, v121, v69 offset0:128 offset1:129
    v_smfmac_f32_16x16x64_bf16 v[80:83], v[48:51], v[160:167], v2
    v_smfmac_f32_16x16x64_bf16 v[80:83], v[52:55], v[168:175], v2
    v_smfmac_f32_16x16x64_bf16 v[80:83], v[56:59], v[176:183], v2
    v_smfmac_f32_16x16x64_bf16 v[80:83], v[60:63], v[184:191], v2
    v_smfmac_f32_16x16x64_bf16 v[84:87], v[32:35], v[192:199], v2
    v_smfmac_f32_16x16x64_bf16 v[84:87], v[36:39], v[200:207], v2
    v_smfmac_f32_16x16x64_bf16 v[84:87], v[40:43], v[208:215], v2
    v_add_f32 v80, v80, v81
    v_smfmac_f32_16x16x64_bf16 v[84:87], v[44:47], v[216:223], v2
    v_add_f32 v82, v82, v83
    v_smfmac_f32_16x16x64_bf16 v[84:87], v[48:51], v[224:231], v2
    v_cvt_pk_bf16_f32 v122, v80, v82
    v_smfmac_f32_16x16x64_bf16 v[84:87], v[52:55], v[232:239], v2
    v_mov_b32 v80, v122
    v_smfmac_f32_16x16x64_bf16 v[84:87], v[56:59], v[240:247], v2
    v_smfmac_f32_16x16x64_bf16 v[84:87], v[60:63], v[248:255], v2
    s_nop 7
    v_add_f32 v84, v84, v85
    v_add_f32 v86, v86, v87
    v_cvt_pk_bf16_f32 v123, v84, v86
    global_store_dwordx4 v1, v[120:123], s[32:33] sc1
    s_waitcnt vmcnt(0)
    s_barrier
    v_mov_b32 v89, 64
    s_mov_b64 exec, 1
    global_store_dword v90, v89, s[92:93] sc1
    s_mov_b64 exec, -1
    s_waitcnt vmcnt(0)
    s_branch L_chain_done
L_last1F:
    ds_read_b128 v[32:35], v1 offset:16384
    ds_read_b128 v[36:39], v1 offset:17408
    ds_read_b128 v[40:43], v1 offset:18432
    s_waitcnt lgkmcnt(2)
    v_smfmac_f32_16x16x64_bf16 v[64:67], v[32:35], v[88:95], v2
    ds_read_b128 v[44:47], v1 offset:19456
    s_waitcnt lgkmcnt(2)
    v_smfmac_f32_16x16x64_bf16 v[64:67], v[36:39], v[96:103], v2
    ds_read_b128 v[48:51], v1 offset:20480
    s_waitcnt lgkmcnt(2)
    v_smfmac_f32_16x16x64_bf16 v[64:67], v[40:43], v[104:111], v2
    ds_read_b128 v[52:55], v1 offset:21504
    s_waitcnt lgkmcnt(2)
    v_smfmac_f32_16x16x64_bf16 v[64:67], v[44:47], v[112:119], v2
    ds_read_b128 v[56:59], v1 offset:22528
    s_waitcnt lgkmcnt(2)
    v_smfmac_f32_16x16x64_bf16 v[64:67], v[48:51], a[32:39], v2
    ds_read_b128 v[60:63], v1 offset:23552
    s_waitcnt lgkmcnt(2)
    v_smfmac_f32_16x16x64_bf16 v[64:67], v[52:55], a[40:47], v2
    s_waitcnt lgkmcnt(1)
    v_smfmac_f32_16x16x64_bf16 v[64:67], v[56:59], a[48:55], v2
    s_waitcnt lgkmcnt(0)
    v_smfmac_f32_16x16x64_bf16 v[64:67], v[60:63], a[56:63], v2
    v_smfmac_f32_16x16x64_bf16 v[68:71], v[32:35], a[64:71], v2
    v_smfmac_f32_16x16x64_bf16 v[68:71], v[36:39], a[72:79], v2
    v_smfmac_f32_16x16x64_bf16 v[68:71], v[40:43], a[80:87], v2
    v_add_f32 v64, v64, v65
    v_smfmac_f32_16x16x64_bf16 v[68:71], v[44:47], a[88:95], v2
    v_add_f32 v66, v66, v67
    v_smfmac_f32_16x16x64_bf16 v[68:71], v[48:51], a[96:103], v2
    v_cvt_pk_bf16_f32 v65, v64, v66
    v_smfmac_f32_16x16x64_bf16 v[68:71], v[52:55], a[104:111], v2
    v_smfmac_f32_16x16x64_bf16 v[68:71], v[56:59], a[112:119], v2
    v_mov_b32 v89, s38
    v_smfmac_f32_16x16x64_bf16 v[68:71], v[60:63], a[120:127], v2
    v_mov_b32 v90, 0
    v_smfmac_f32_16x16x64_bf16 v[72:75], v[32:35], a[128:135], v2
    v_smfmac_f32_16x16x64_bf16 v[72:75], v[36:39], a[136:143], v2
    v_smfmac_f32_16x16x64_bf16 v[72:75], v[40:43], a[144:151], v2
    v_add_f32 v68, v68, v69
    v_smfmac_f32_16x16x64_bf16 v[72:75], v[44:47], a[152:159], v2
    v_add_f32 v70, v70, v71
    v_smfmac_f32_16x16x64_bf16 v[72:75], v[48:51], a[160:167], v2
    v_cvt_pk_bf16_f32 v69, v68, v70
    v_smfmac_f32_16x16x64_bf16 v[72:75], v[52:55], a[168:175], v2
    v_smfmac_f32_16x16x64_bf16 v[72:75], v[56:59], a[176:183], v2
    v_smfmac_f32_16x16x64_bf16 v[72:75], v[60:63], a[184:191], v2
    v_smfmac_f32_16x16x64_bf16 v[76:79], v[32:35], a[192:199], v2
    s_mov_b64 exec, s[46:47]
    global_store_dword v90, v89, s[92:93] sc1
    v_smfmac_f32_16x16x64_bf16 v[76:79], v[36:39], a[200:207], v2
    s_mov_b64 exec, -1
    v_smfmac_f32_16x16x64_bf16 v[76:79], v[40:43], a[208:215], v2
    v_add_f32 v72, v72, v73
    v_smfmac_f32_16x16x64_bf16 v[76:79], v[44:47], a[216:223], v2
    s_waitcnt vmcnt(1)
    v_add_f32 v74, v74, v75
    v_smfmac_f32_16x16x64_bf16 v[76:79], v[48:51], a[224:231], v2
    v_cvt_pk_bf16_f32 v120, v72, v74
    v_smfmac_f32_16x16x64_bf16 v[76:79], v[52:55], a[232:239], v2
    ds_write2_b32 v11, v120, v65 offset0:0 offset1:1
    v_smfmac_f32_16x16x64_bf16 v[76:79], v[56:59], a[240:247], v2
    v_smfmac_f32_16x16x64_bf16 v[76:79], v[60:63], a[248:255], v2
    v_smfmac_f32_16x16x64_bf16 v[80:83], v[32:35], v[128:135], v2
    v_smfmac_f32_16x16x64_bf16 v[80:83], v[36:39], v[136:143], v2
    v_add_f32 v76, v76, v77
    v_add_f32 v78, v78, v79
    v_smfmac_f32_16x16x64_bf16 v[80:83], v[40:43], v[144:151], v2
    v_cvt_pk_bf16_f32 v121, v76, v78
    v_smfmac_f32_16x16x64_bf16 v[80:83], v[44:47], v[152:159], v2
    ds_write2_b32 v11, v121, v69 offset0:128 offset1:129
    v_smfmac_f32_16x16x64_bf16 v[80:83], v[48:51], v[160:167], v2
    v_smfmac_f32_16x16x64_bf16 v[80:83], v[52:55], v[168:175], v2
    v_smfmac_f32_16x16x64_bf16 v[80:83], v[56:59], v[176:183], v2
    v_smfmac_f32_16x16x64_bf16 v[80:83], v[60:63], v[184:191], v2
    v_smfmac_f32_16x16x64_bf16 v[84:87], v[32:35], v[192:199], v2
    v_smfmac_f32_16x16x64_bf16 v[84:87], v[36:39], v[200:207], v2
    v_smfmac_f32_16x16x64_bf16 v[84:87], v[40:43], v[208:215], v2
    v_add_f32 v80, v80, v81
    v_smfmac_f32_16x16x64_bf16 v[84:87], v[44:47], v[216:223], v2
    v_add_f32 v82, v82, v83
    v_smfmac_f32_16x16x64_bf16 v[84:87], v[48:51], v[224:231], v2
    v_cvt_pk_bf16_f32 v122, v80, v82
    v_smfmac_f32_16x16x64_bf16 v[84:87], v[52:55], v[232:239], v2
    v_mov_b32 v80, v122
    v_smfmac_f32_16x16x64_bf16 v[84:87], v[56:59], v[240:247], v2
    v_smfmac_f32_16x16x64_bf16 v[84:87], v[60:63], v[248:255], v2
    s_nop 7
    v_add_f32 v84, v84, v85
    v_add_f32 v86, v86, v87
    v_cvt_pk_bf16_f32 v123, v84, v86
    global_store_dwordx4 v1, v[120:123], s[32:33] sc1
    s_waitcnt vmcnt(0)
    s_barrier
    v_mov_b32 v89, 64
    s_mov_b64 exec, 1
    global_store_dword v90, v89, s[92:93] sc1
    s_mov_b64 exec, -1
    s_waitcnt vmcnt(0)
    s_branch L_chain_done
LKV_0F:
    global_load_dword v3, v9, s[34:35] sc1
    s_waitcnt vmcnt(0)
    v_readlane_b32 s95, v3, 0
    v_readlane_b32 s39, v3, 1
    s_nop 0
    s_min_u32 s95, s95, s39
    s_cmp_ge_u32 s95, s94
    s_cbranch_scc1 LKVB_0F
    s_sleep 2
    s_add_u32 s48, s48, 1
    s_cmp_lt_u32 s48, 0x40000
    s_cbranch_scc1 LKV_0F
    s_branch L_fail
LPR_0F:
    s_mov_b64 exec, vcc
    global_load_dwordx4 v[32:35], v1, s[96:97] sc1
    global_load_dwordx4 v[36:39], v1, s[96:97] offset:1024 sc1
    s_nop 15
LPL_0F:
    global_load_dwordx4 v[32:35], v1, s[96:97] sc1
    global_load_dwordx4 v[36:39], v1, s[96:97] offset:1024 sc1
    s_waitcnt vmcnt(2)
    v_bitop3_b32 v52, v32, v36, 1 bitop3:0xa8
    v_cmp_ne_u32 vcc, 0, v52
    s_add_u32 s48, s48, 1
    s_cbranch_vccz LPD_0F
    s_mov_b64 exec, vcc
    s_cmp_lt_u32 s48, 0x100000
    s_cbranch_scc1 LPL_0F
    s_branch L_fail
LPD_0F:
    s_mov_b64 exec, -1
    s_nop 3
    v_mfma_f32_16x16x32_bf16 v[48:51], v[32:35], v[4:7], 0
    v_mfma_f32_16x16x32_bf16 v[48:51], v[36:39], v[4:7], v[48:51]
    s_nop 7
    s_branch LPB_0F
LMR_0F:
    s_mov_b64 exec, vcc
    global_load_dwordx4 v[120:123], v1, s[98:99] sc1
    global_load_dwordx4 v[124:127], v1, s[98:99] offset:1024 sc1
    s_nop 15
LML_0F:
    global_load_dwordx4 v[120:123], v1, s[98:99] sc1
    global_load_dwordx4 v[124:127], v1, s[98:99] offset:1024 sc1
    s_waitcnt vmcnt(2)
    v_max3_u32 v42, v120, v121, v122
    v_max3_u32 v43, v124, v125, v126
    v_max3_u32 v42, v42, v123, v127
    v_max_u32 v42, v42, v43
    v_cmp_eq_u32 vcc, -1, v42
    s_add_u32 s61, s61, 1
    s_add_u32 s48, s48, 1
    s_cbranch_vccz LMD_0F
    s_mov_b64 exec, vcc
    s_cmp_lt_u32 s48, 0x100000
    s_cbranch_scc1 LML_0F
    s_branch L_fail
LMD_0F:
    s_mov_b64 exec, -1
    ds_write_b128 v40, v[120:123]
    ds_write_b128 v40, v[124:127] offset:1024
    s_branch LMB_0F
LKV_1F:
    global_load_dword v3, v9, s[34:35] sc1
    s_waitcnt vmcnt(0)
    v_readlane_b32 s95, v3, 0
    v_readlane_b32 s39, v3, 1
    s_nop 0
    s_min_u32 s95, s95, s39
    s_cmp_ge_u32 s95, s94
    s_cbranch_scc1 LKVB_1F
    s_sleep 2
    s_add_u32 s48, s48, 1
    s_cmp_lt_u32 s48, 0x40000
    s_cbranch_scc1 LKV_1F
    s_branch L_fail
LPR_1F:
    s_mov_b64 exec, vcc
    global_load_dwordx4 v[32:35], v1, s[96:97] sc1
    global_load_dwordx4 v[36:39], v1, s[96:97] offset:1024 sc1
    s_nop 15
LPL_1F:
    global_load_dwordx4 v[32:35], v1, s[96:97] sc1
    global_load_dwordx4 v[36:39], v1, s[96:97] offset:1024 sc1
    s_waitcnt vmcnt(2)
    v_bitop3_b32 v52, v32, v36, 1 bitop3:0x2a
    v_cmp_ne_u32 vcc, 0, v52
    s_add_u32 s48, s48, 1
    s_cbranch_vccz LPD_1F
    s_mov_b64 exec, vcc
    s_cmp_lt_u32 s48, 0x100000
    s_cbranch_scc1 LPL_1F
    s_branch L_fail
LPD_1F:
    s_mov_b64 exec, -1
    s_nop 3
    v_mfma_f32_16x16x32_bf16 v[48:51], v[32:35], v[4:7], 0
    v_mfma_f32_16x16x32_bf16 v[48:51], v[36:39], v[4:7], v[48:51]
    s_nop 7
    s_branch LPB_1F
LMR_1F:
    s_mov_b64 exec, vcc
    global_load_dwordx4 v[120:123], v1, s[98:99] sc1
    global_load_dwordx4 v[124:127], v1, s[98:99] offset:1024 sc1
    s_nop 15
LML_1F:
    global_load_dwordx4 v[120:123], v1, s[98:99] sc1
    global_load_dwordx4 v[124:127], v1, s[98:99] offset:1024 sc1
    s_waitcnt vmcnt(2)
    v_max3_u32 v42, v120, v121, v122
    v_max3_u32 v43, v124, v125, v126
    v_max3_u32 v42, v42, v123, v127
    v_max_u32 v42, v42, v43
    v_cmp_eq_u32 vcc, -1, v42
    s_add_u32 s61, s61, 1
    s_add_u32 s48, s48, 1
    s_cbranch_vccz LMD_1F
    s_mov_b64 exec, vcc
    s_cmp_lt_u32 s48, 0x100000
    s_cbranch_scc1 LML_1F
    s_branch L_fail
LMD_1F:
    s_mov_b64 exec, -1
    ds_write_b128 v40, v[120:123]
    ds_write_b128 v40, v[124:127] offset:1024
    s_branch LMB_1F
L_chain_slow:
L_loopS:
    ds_read_b128 v[32:35], v1 offset:16384
    ds_read_b128 v[36:39], v1 offset:17408
    ds_read_b128 v[40:43], v1 offset:18432
    s_waitcnt lgkmcnt(2)
    v_smfmac_f32_16x16x64_bf16 v[64:67], v[32:35], v[88:95], v2
    ds_read_b128 v[44:47], v1 offset:19456
    s_waitcnt lgkmcnt(2)
    v_smfmac_f32_16x16x64_bf16 v[64:67], v[36:39], v[96:103], v2
    ds_read_b128 v[48:51], v1 offset:20480
    s_waitcnt lgkmcnt(2)
    v_smfmac_f32_16x16x64_bf16 v[64:67], v[40:43], v[104:111], v2
    ds_read_b128 v[52:55], v1 offset:21504
    s_waitcnt lgkmcnt(2)
    v_smfmac_f32_16x16x64_bf16 v[64:67], v[44:47], v[112:119], v2
    ds_read_b128 v[56:59], v1 offset:22528
    s_waitcnt lgkmcnt(2)
    v_smfmac_f32_16x16x64_bf16 v[64:67], v[48:51], a[32:39], v2
    ds_read_b128 v[60:63], v1 offset:23552
    s_waitcnt lgkmcnt(2)
    v_smfmac_f32_16x16x64_bf16 v[64:67], v[52:55], a[40:47], v2
    s_waitcnt lgkmcnt(1)
    v_smfmac_f32_16x16x64_bf16 v[64:67], v[56:59], a[48:55], v2
    s_waitcnt lgkmcnt(0)
    v_smfmac_f32_16x16x64_bf16 v[64:67], v[60:63], a[56:63], v2
    v_smfmac_f32_16x16x64_bf16 v[68:71], v[32:35], a[64:71], v2
    ds_read_b128 v[104:107], v1 offset:0
    v_smfmac_f32_16x16x64_bf16 v[68:71], v[36:39], a[72:79], v2
    ds_read_b128 v[108:111], v1 offset:1024
    v_smfmac_f32_16x16x64_bf16 v[68:71], v[40:43], a[80:87], v2
    ds_read_b128 v[112:115], v1 offset:2048
    v_add_f32 v64, v64, v65
    v_smfmac_f32_16x16x64_bf16 v[68:71], v[44:47], a[88:95], v2
    ds_read_b128 v[116:119], v1 offset:3072
    v_add_f32 v66, v66, v67
    v_smfmac_f32_16x16x64_bf16 v[68:71], v[48:51], a[96:103], v2
    global_load_dword v3, v9, s[34:35] sc1
    v_cvt_pk_bf16_f32 v65, v64, v66
    v_smfmac_f32_16x16x64_bf16 v[68:71], v[52:55], a[104:111], v2
    s_add_u32 m0, s49, 8192
    v_mov_b32 v88, -1
    v_smfmac_f32_16x16x64_bf16 v[68:71], v[56:59], a[112:119], v2
    global_load_dwordx4 v[24:27], v1, s[30:31]
    v_mov_b32 v89, s38
    v_smfmac_f32_16x16x64_bf16 v[68:71], v[60:63], a[120:127], v2
    v_mov_b32 v90, 0
    v_smfmac_f32_16x16x64_bf16 v[72:75], v[32:35], a[128:135], v2
    global_load_lds_dwordx4 v1, s[28:29]
    v_smfmac_f32_16x16x64_bf16 v[72:75], v[36:39], a[136:143], v2
    v_smfmac_f32_16x16x64_bf16 v[72:75], v[40:43], a[144:151], v2
    global_load_dwordx4 v[28:31], v1, s[30:31] offset:1024
    v_add_f32 v68, v68, v69
    v_smfmac_f32_16x16x64_bf16 v[72:75], v[44:47], a[152:159], v2
    v_add_f32 v70, v70, v71
    v_smfmac_f32_16x16x64_bf16 v[72:75], v[48:51], a[160:167], v2
    global_load_lds_dwordx4 v1, s[28:29] offset:1024
    v_cvt_pk_bf16_f32 v69, v68, v70
    v_smfmac_f32_16x16x64_bf16 v[72:75], v[52:55], a[168:175], v2
    s_add_u32 s28, s28, 0x40000
    s_addc_u32 s29, s29, 0
    v_smfmac_f32_16x16x64_bf16 v[72:75], v[56:59], a[176:183], v2
    s_add_u32 s30, s30, 0x40000
    s_addc_u32 s31, s31, 0
    v_smfmac_f32_16x16x64_bf16 v[72:75], v[60:63], a[184:191], v2
    v_smfmac_f32_16x16x64_bf16 v[76:79], v[32:35], a[192:199], v2
    s_mov_b64 exec, s[46:47]
    global_store_dword v10, v88, s[26:27] sc1
    global_store_dword v90, v89, s[92:93] sc1
    v_smfmac_f32_16x16x64_bf16 v[76:79], v[36:39], a[200:207], v2
    s_mov_b64 exec, -1
    v_smfmac_f32_16x16x64_bf16 v[76:79], v[40:43], a[208:215], v2
    v_add_f32 v72, v72, v73
    v_smfmac_f32_16x16x64_bf16 v[76:79], v[44:47], a[216:223], v2
    s_waitcnt vmcnt(7)
    v_add_f32 v74, v74, v75
    v_smfmac_f32_16x16x64_bf16 v[76:79], v[48:51], a[224:231], v2
    v_cvt_pk_bf16_f32 v120, v72, v74
    v_smfmac_f32_16x16x64_bf16 v[76:79], v[52:55], a[232:239], v2
    ds_write2_b32 v11, v120, v65 offset0:0 offset1:1
    v_smfmac_f32_16x16x64_bf16 v[76:79], v[56:59], a[240:247], v2
    v_smfmac_f32_16x16x64_bf16 v[76:79], v[60:63], a[248:255], v2
    v_smfmac_f32_16x16x64_bf16 v[80:83], v[32:35], v[128:135], v2
    v_smfmac_f32_16x16x64_bf16 v[80:83], v[36:39], v[136:143], v2
    v_add_f32 v76, v76, v77
    v_add_f32 v78, v78, v79
    v_smfmac_f32_16x16x64_bf16 v[80:83], v[40:43], v[144:151], v2
    v_cvt_pk_bf16_f32 v121, v76, v78
    v_smfmac_f32_16x16x64_bf16 v[80:83], v[44:47], v[152:159], v2
    ds_write2_b32 v11, v121, v69 offset0:128 offset1:129
    v_smfmac_f32_16x16x64_bf16 v[80:83], v[48:51], v[160:167], v2
    v_smfmac_f32_16x16x64_bf16 v[80:83], v[52:55], v[168:175], v2
    v_smfmac_f32_16x16x64_bf16 v[80:83], v[56:59], v[176:183], v2
    v_smfmac_f32_16x16x64_bf16 v[80:83], v[60:63], v[184:191], v2
    s_waitcnt lgkmcnt(0)
    s_barrier
    v_smfmac_f32_16x16x64_bf16 v[84:87], v[32:35], v[192:199], v2
    ds_read_b64_tr_b16 v[88:89], v12 offset:0
    v_smfmac_f32_16x16x64_bf16 v[84:87], v[36:39], v[200:207], v2
    ds_read_b64_tr_b16 v[90:91], v12 offset:512
    v_smfmac_f32_16x16x64_bf16 v[84:87], v[40:43], v[208:215], v2
    ds_read_b64_tr_b16 v[92:93], v12 offset:1024
    v_add_f32 v80, v80, v81
    v_smfmac_f32_16x16x64_bf16 v[84:87], v[44:47], v[216:223], v2
    ds_read_b64_tr_b16 v[94:95], v12 offset:1536
    v_add_f32 v82, v82, v83
    v_smfmac_f32_16x16x64_bf16 v[84:87], v[48:51], v[224:231], v2
    ds_read_b64_tr_b16 v[96:97], v12 offset:2048
    v_cvt_pk_bf16_f32 v122, v80, v82
    v_smfmac_f32_16x16x64_bf16 v[84:87], v[52:55], v[232:239], v2
    ds_read_b64_tr_b16 v[98:99], v12 offset:2560
    v_mov_b32 v80, v122
    v_smfmac_f32_16x16x64_bf16 v[84:87], v[56:59], v[240:247], v2
    ds_read_b64_tr_b16 v[100:101], v12 offset:3072
    v_smfmac_f32_16x16x64_bf16 v[84:87], v[60:63], v[248:255], v2
    ds_read_b64_tr_b16 v[102:103], v12 offset:3584
    s_waitcnt lgkmcnt(6)
    v_mfma_f32_16x16x32_bf16 v[64:67], v[104:107], v[88:91], 0
    ds_read_b128 v[32:35], v1 offset:4096
    s_nop 2
    v_add_f32 v84, v84, v85
    s_waitcnt lgkmcnt(5)
    v_mfma_f32_16x16x32_bf16 v[64:67], v[108:111], v[92:95], v[64:67]
    ds_read_b128 v[36:39], v1 offset:5120
    v_add_f32 v86, v86, v87
    s_waitcnt lgkmcnt(4)
    v_mfma_f32_16x16x32_bf16 v[64:67], v[112:115], v[96:99], v[64:67]
    ds_read_b128 v[40:43], v1 offset:6144
    v_cvt_pk_bf16_f32 v123, v84, v86
    s_waitcnt lgkmcnt(3)
    v_mfma_f32_16x16x32_bf16 v[64:67], v[116:119], v[100:103], v[64:67]
    ds_read_b128 v[44:47], v1 offset:7168
    v_mov_b32 v81, v123
    v_mfma_f32_16x16x32_bf16 v[76:79], v[88:91], v[88:91], 0
    ds_read_b128 v[48:51], v15 offset:2048
    v_mov_b32 v84, v123
    v_mov_b32 v85, 0
    v_mfma_f32_16x16x32_bf16 v[76:79], v[92:95], v[92:95], v[76:79]
    ds_read_b128 v[52:55], v15 offset:3072
    global_store_dwordx4 v1, v[120:123], s[32:33] sc1
    v_mfma_f32_16x16x32_bf16 v[76:79], v[96:99], v[96:99], v[76:79]
    ds_read_b128 v[56:59], v0 offset:2048
    v_mfma_f32_16x16x32_bf16 v[76:79], v[100:103], v[100:103], v[76:79]
    ds_read_b128 v[60:63], v0 offset:3072
    s_waitcnt lgkmcnt(4)
    v_mfma_f32_16x16x32_bf16 v[68:71], v[32:35], v[88:91], 0
    ds_read_b128 v[104:107], v15 offset:6144
    v_mfma_f32_16x16x32_bf16 v[68:71], v[36:39], v[92:95], v[68:71]
    ds_read_b128 v[108:111], v15 offset:7168
    v_max3_f32 v126, v64, v65, v66
    v_mfma_f32_16x16x32_bf16 v[68:71], v[40:43], v[96:99], v[68:71]
    ds_read_b128 v[112:115], v0 offset:6144
    v_max3_f32 v127, v67, v76, v77
    v_mfma_f32_16x16x32_bf16 v[68:71], v[44:47], v[100:103], v[68:71]
    ds_read_b128 v[116:119], v0 offset:7168
    v_max_f32 v126, v126, v127
    s_add_u32 s32, s32, 0x20000
    s_addc_u32 s33, s33, 0
    ds_read_b128 v[32:35], v15 offset:0
    ds_read_b128 v[36:39], v15 offset:1024
    ds_read_b128 v[88:91], v15 offset:4096
    s_nop 0
    v_max3_f32 v127, v68, v69, v70
    v_max3_f32 v126, v126, v127, v71
    v_mov_b32 v127, v126
    ds_read_b128 v[92:95], v15 offset:5120
    s_nop 0
    v_permlane16_swap_b32 v126, v127
    v_max_f32 v126, v126, v127
    v_mov_b32 v127, v126
    ds_read_b128 v[40:43], v0 offset:0
    s_nop 0
    v_permlane32_swap_b32 v126, v127
    v_max_f32 v126, v126, v127
    v_mul_f32 v126, s50, v126
    v_fma_f32 v64, v64, s50, -v126
    v_fma_f32 v65, v65, s50, -v126
    v_fma_f32 v66, v66, s50, -v126
    v_fma_f32 v67, v67, s50, -v126
    v_fma_f32 v68, v68, s50, -v126
    v_fma_f32 v69, v69, s50, -v126
    v_fma_f32 v70, v70, s50, -v126
    v_fma_f32 v71, v71, s50, -v126
    v_fma_f32 v76, v76, s50, -v126
    v_fma_f32 v77, v77, s50, -v126
    v_exp_f32 v64, v64
    v_exp_f32 v65, v65
    v_exp_f32 v66, v66
    v_exp_f32 v67, v67
    v_exp_f32 v68, v68
    v_exp_f32 v69, v69
    v_exp_f32 v70, v70
    v_exp_f32 v71, v71
    v_exp_f32 v76, v76
    v_exp_f32 v77, v77
    v_cvt_pk_bf16_f32 v72, v64, v65
    v_cvt_pk_bf16_f32 v73, v66, v67
    v_mov_b64 v[64:65], s[8:9]
    v_mov_b64 v[66:67], s[8:9]
    v_cvt_pk_bf16_f32 v74, v68, v69
    v_cvt_pk_bf16_f32 v75, v70, v71
    v_cvt_pk_bf16_f32 v78, v76, v77
    v_mov_b32 v79, 0
    v_mfma_f32_16x16x32_bf16 v[68:71], v[64:67], v[72:75], 0
    ds_read_b128 v[44:47], v0 offset:1024
    v_mfma_f32_16x16x32_bf16 v[120:123], v[16:19], v[72:75], 0
    ds_read_b128 v[96:99], v0 offset:4096
    v_mfma_f32_16x16x32_bf16 v[124:127], v[20:23], v[72:75], 0
    ds_read_b128 v[100:103], v0 offset:5120
    v_mfma_f32_16x16x16_bf16 v[68:71], v[64:65], v[78:79], v[68:71]
    v_mfma_f32_16x16x16_bf16 v[120:123], v[80:81], v[78:79], v[120:123]
    v_mfma_f32_16x16x16_bf16 v[124:127], v[84:85], v[78:79], v[124:127]
    v_rcp_f32 v68, v68
    s_nop 2
    v_pk_mul_f32 v[120:121], v[120:121], v[68:69] op_sel_hi:[1,0]
    v_pk_mul_f32 v[122:123], v[122:123], v[68:69] op_sel_hi:[1,0]
    v_cvt_pk_bf16_f32 v120, v120, v121
    v_cvt_pk_bf16_f32 v121, v122, v123
    s_mov_b64 exec, s[44:45]
    ds_write_b64 v13, v[120:121]
    v_pk_mul_f32 v[124:125], v[124:125], v[68:69] op_sel_hi:[1,0]
    v_pk_mul_f32 v[126:127], v[126:127], v[68:69] op_sel_hi:[1,0]
    v_cvt_pk_bf16_f32 v122, v124, v125
    v_cvt_pk_bf16_f32 v123, v126, v127
    ds_write_b64 v13, v[122:123] offset:32
    s_mov_b64 exec, -1
    v_mov_b64 v[64:65], 0
    v_mov_b64 v[66:67], 0
    v_mov_b64 v[68:69], 0
    v_mov_b64 v[70:71], 0
    v_mov_b64 v[72:73], 0
    v_mov_b64 v[74:75], 0
    v_mov_b64 v[76:77], 0
    v_mov_b64 v[78:79], 0
    v_mov_b64 v[80:81], 0
    v_mov_b64 v[82:83], 0
    v_mov_b64 v[84:85], 0
    v_mov_b64 v[86:87], 0
    v_mov_b64 v[120:121], 0
    v_mov_b64 v[122:123], 0
    v_mov_b64 v[124:125], 0
    v_mov_b64 v[126:127], 0
    s_waitcnt lgkmcnt(0)
    s_barrier
    ds_read_b128 v[16:19], v14
    ds_read_b128 v[20:23], v14 offset:128
    s_waitcnt lgkmcnt(1)
    v_smfmac_f32_16x16x64_bf16 v[64:67], v[16:19], v[32:39], v2
    ds_read_b128 v[32:35], v15 offset:8192
    s_waitcnt lgkmcnt(1)
    v_smfmac_f32_16x16x64_bf16 v[64:67], v[20:23], v[40:47], v2
    ds_read_b128 v[36:39], v15 offset:9216
    v_smfmac_f32_16x16x64_bf16 v[68:71], v[16:19], v[48:55], v2
    ds_read_b128 v[40:43], v0 offset:8192
    v_smfmac_f32_16x16x64_bf16 v[68:71], v[20:23], v[56:63], v2
    ds_read_b128 v[44:47], v0 offset:9216
    v_add_f32 v64, v64, v65
    v_smfmac_f32_16x16x64_bf16 v[72:75], v[16:19], v[88:95], v2
    ds_read_b128 v[48:51], v15 offset:10240
    v_add_f32 v66, v66, v67
    v_smfmac_f32_16x16x64_bf16 v[72:75], v[20:23], v[96:103], v2
    ds_read_b128 v[52:55], v15 offset:11264
    v_cvt_pk_bf16_f32 v64, v64, v66
    v_add_f32 v68, v68, v69
    v_smfmac_f32_16x16x64_bf16 v[76:79], v[16:19], v[104:111], v2
    ds_read_b128 v[56:59], v0 offset:10240
    v_add_f32 v70, v70, v71
    v_smfmac_f32_16x16x64_bf16 v[76:79], v[20:23], v[112:119], v2
    ds_read_b128 v[60:63], v0 offset:11264
    v_cvt_pk_bf16_f32 v65, v68, v70
    v_add_f32 v72, v72, v73
    v_smfmac_f32_16x16x64_bf16 v[80:83], v[16:19], a[0:7], v2
    v_add_f32 v74, v74, v75
    v_smfmac_f32_16x16x64_bf16 v[80:83], v[20:23], a[8:15], v2
    v_cvt_pk_bf16_f32 v66, v72, v74
    v_add_f32 v76, v76, v77
    v_smfmac_f32_16x16x64_bf16 v[84:87], v[16:19], a[16:23], v2
    v_add_f32 v78, v78, v79
    v_smfmac_f32_16x16x64_bf16 v[84:87], v[20:23], a[24:31], v2
    v_cvt_pk_bf16_f32 v67, v76, v78
    v_add_f32 v80, v80, v81
    v_and_b32 v64, -2, v64
    s_waitcnt lgkmcnt(4)
    v_smfmac_f32_16x16x64_bf16 v[120:123], v[16:19], v[32:39], v2
    global_store_dwordx4 v8, v[64:67], s[20:21] sc1
    v_add_f32 v82, v82, v83
    v_add_u32 v72, 0x8000, v8
    s_waitcnt lgkmcnt(3)
    v_smfmac_f32_16x16x64_bf16 v[120:123], v[20:23], v[40:47], v2
    v_cvt_pk_bf16_f32 v82, v80, v82
    v_add_f32 v84, v84, v85
    s_waitcnt lgkmcnt(2)
    v_smfmac_f32_16x16x64_bf16 v[124:127], v[16:19], v[48:55], v2
    v_add_f32 v86, v86, v87
    s_waitcnt lgkmcnt(0)
    v_smfmac_f32_16x16x64_bf16 v[124:127], v[20:23], v[56:63], v2
    v_cvt_pk_bf16_f32 v83, v84, v86
    v_add_f32 v120, v120, v121
    v_add_f32 v122, v122, v123
    v_cvt_pk_bf16_f32 v80, v120, v122
    s_nop 3
    v_add_f32 v124, v124, v125
    v_add_f32 v126, v126, v127
    v_cvt_pk_bf16_f32 v81, v124, v126
    v_and_b32 v80, -2, v80
    global_store_dwordx4 v72, v[80:83], s[20:21] sc1
    v_mov_b64 v[64:65], 0
    v_mov_b64 v[66:67], 0
    v_mov_b64 v[68:69], 0
    v_mov_b64 v[70:71], 0
    v_mov_b64 v[72:73], 0
    v_mov_b64 v[74:75], 0
    v_mov_b64 v[76:77], 0
    v_mov_b64 v[78:79], 0
    v_mov_b64 v[80:81], 0
    v_mov_b64 v[82:83], 0
    v_mov_b64 v[84:85], 0
    v_mov_b64 v[86:87], 0
    ds_read_b128 v[88:91], v15 offset:12288
    ds_read_b128 v[92:95], v15 offset:13312
    ds_read_b128 v[96:99], v0 offset:12288
    ds_read_b128 v[100:103], v0 offset:13312
    ds_read_b128 v[104:107], v15 offset:14336
    ds_read_b128 v[108:111], v15 offset:15360
    ds_read_b128 v[112:115], v0 offset:14336
    ds_read_b128 v[116:119], v0 offset:15360
    s_waitcnt vmcnt(2)
    v_readlane_b32 s95, v3, 0
    v_readlane_b32 s39, v3, 1
    s_add_u32 s94, s38, 2
    s_lshr_b32 s94, s94, 1
    s_add_u32 s94, s94, 1
    s_min_u32 s94, s94, 32
    s_min_u32 s95, s95, s39
    s_cmp_lt_u32 s95, s94
    s_cbranch_scc1 LKV_0S
LKVB_0S:
    s_waitcnt vmcnt(0)
    global_load_dwordx4 v[32:35], v1, s[96:97] sc1
    global_load_dwordx4 v[36:39], v1, s[96:97] offset:1024 sc1
    s_waitcnt vmcnt(0)
    v_mfma_f32_16x16x32_bf16 v[48:51], v[32:35], v[4:7], 0
    v_bitop3_b32 v52, v32, v36, 1 bitop3:0xa8
    v_cmp_ne_u32 vcc, 0, v52
    v_mfma_f32_16x16x32_bf16 v[48:51], v[36:39], v[4:7], v[48:51]
    s_cbranch_vccnz LPR_0S
LPB_0S:
    s_nop 6
    v_permlane32_swap_b32 v48, v49
    v_permlane32_swap_b32 v50, v51
    v_add_f32 v48, v48, v49
    v_add_f32 v50, v50, v51
    s_nop 1
    v_permlane16_swap_b32 v48, v50
    v_add_f32 v48, v48, v50
    s_nop 1
    v_mov_b32_dpp v49, v48 quad_perm:[2,3,2,3] row_mask:0xf bank_mask:0xf
    v_cvt_pk_bf16_f32 v48, v48, v49
    s_mov_b64 exec, s[46:47]
    global_store_dword v10, v48, s[24:25] sc1
    s_mov_b64 exec, -1
    s_add_u32 s98, s24, s101
    s_addc_u32 s99, s25, 0
    v_add_u32 v40, s100, v1
    s_add_u32 s38, s38, 1
    s_add_u32 s39, s38, 1
    s_and_b32 s39, s39, 3
    s_lshl_b32 s40, s39, 13
    s_add_u32 s39, s38, 2
    s_and_b32 s39, s39, 3
    s_lshl_b32 s39, s39, 13
    s_add_u32 s26, s22, s39
    s_addc_u32 s27, s23, 0
    s_waitcnt vmcnt(0)
    global_load_dwordx4 v[120:123], v1, s[98:99] sc1
    global_load_dwordx4 v[124:127], v1, s[98:99] offset:1024 sc1
    s_waitcnt vmcnt(0)
    ds_write_b128 v40, v[120:123]
    ds_write_b128 v40, v[124:127] offset:1024
    v_max3_u32 v42, v120, v121, v122
    v_max3_u32 v43, v124, v125, v126
    v_max3_u32 v42, v42, v123, v127
    v_max_u32 v42, v42, v43
    v_cmp_eq_u32 vcc, -1, v42
    s_cbranch_vccnz LMR_0S
LMB_0S:
    s_add_u32 s24, s22, s40
    s_addc_u32 s25, s23, 0
    s_waitcnt lgkmcnt(0)
    s_barrier
    s_cmp_ge_u32 s38, 63
    s_cbranch_scc1 L_last1S
    ds_read_b128 v[32:35], v1 offset:16384
    ds_read_b128 v[36:39], v1 offset:17408
    ds_read_b128 v[40:43], v1 offset:18432
    s_waitcnt lgkmcnt(2)
    v_smfmac_f32_16x16x64_bf16 v[64:67], v[32:35], v[88:95], v2
    ds_read_b128 v[44:47], v1 offset:19456
    s_waitcnt lgkmcnt(2)
    v_smfmac_f32_16x16x64_bf16 v[64:67], v[36:39], v[96:103], v2
    ds_read_b128 v[48:51], v1 offset:20480
    s_waitcnt lgkmcnt(2)
    v_smfmac_f32_16x16x64_bf16 v[64:67], v[40:43], v[104:111], v2
    ds_read_b128 v[52:55], v1 offset:21504
    s_waitcnt lgkmcnt(2)
    v_smfmac_f32_16x16x64_bf16 v[64:67], v[44:47], v[112:119], v2
    ds_read_b128 v[56:59], v1 offset:22528
    s_waitcnt lgkmcnt(2)
    v_smfmac_f32_16x16x64_bf16 v[64:67], v[48:51], a[32:39], v2
    ds_read_b128 v[60:63], v1 offset:23552
    s_waitcnt lgkmcnt(2)
    v_smfmac_f32_16x16x64_bf16 v[64:67], v[52:55], a[40:47], v2
    s_waitcnt lgkmcnt(1)
    v_smfmac_f32_16x16x64_bf16 v[64:67], v[56:59], a[48:55], v2
    s_waitcnt lgkmcnt(0)
    v_smfmac_f32_16x16x64_bf16 v[64:67], v[60:63], a[56:63], v2
    v_smfmac_f32_16x16x64_bf16 v[68:71], v[32:35], a[64:71], v2
    ds_read_b128 v[104:107], v1 offset:8192
    v_smfmac_f32_16x16x64_bf16 v[68:71], v[36:39], a[72:79], v2
    ds_read_b128 v[108:111], v1 offset:9216
    v_smfmac_f32_16x16x64_bf16 v[68:71], v[40:43], a[80:87], v2
    ds_read_b128 v[112:115], v1 offset:10240
    v_add_f32 v64, v64, v65
    v_smfmac_f32_16x16x64_bf16 v[68:71], v[44:47], a[88:95], v2
    ds_read_b128 v[116:119], v1 offset:11264
    v_add_f32 v66, v66, v67
    v_smfmac_f32_16x16x64_bf16 v[68:71], v[48:51], a[96:103], v2
    global_load_dword v3, v9, s[34:35] sc1
    v_cvt_pk_bf16_f32 v65, v64, v66
    v_smfmac_f32_16x16x64_bf16 v[68:71], v[52:55], a[104:111], v2
    s_add_u32 m0, s49, 0
    v_mov_b32 v88, -1
    v_smfmac_f32_16x16x64_bf16 v[68:71], v[56:59], a[112:119], v2
    global_load_dwordx4 v[16:19], v1, s[30:31]
    v_smfmac_f32_16x16x64_bf16 v[68:71], v[60:63], a[120:127], v2
    v_smfmac_f32_16x16x64_bf16 v[72:75], v[32:35], a[128:135], v2
    global_load_lds_dwordx4 v1, s[28:29]
    v_smfmac_f32_16x16x64_bf16 v[72:75], v[36:39], a[136:143], v2
    v_smfmac_f32_16x16x64_bf16 v[72:75], v[40:43], a[144:151], v2
    global_load_dwordx4 v[20:23], v1, s[30:31] offset:1024
    v_add_f32 v68, v68, v69
    v_smfmac_f32_16x16x64_bf16 v[72:75], v[44:47], a[152:159], v2
    v_add_f32 v70, v70, v71
    v_smfmac_f32_16x16x64_bf16 v[72:75], v[48:51], a[160:167], v2
    global_load_lds_dwordx4 v1, s[28:29] offset:1024
    v_cvt_pk_bf16_f32 v69, v68, v70
    v_smfmac_f32_16x16x64_bf16 v[72:75], v[52:55], a[168:175], v2
    s_add_u32 s28, s28, 0x40000
    s_addc_u32 s29, s29, 0
    v_smfmac_f32_16x16x64_bf16 v[72:75], v[56:59], a[176:183], v2
    s_add_u32 s30, s30, 0x40000
    s_addc_u32 s31, s31, 0
    v_smfmac_f32_16x16x64_bf16 v[72:75], v[60:63], a[184:191], v2
    v_smfmac_f32_16x16x64_bf16 v[76:79], v[32:35], a[192:199], v2
    s_mov_b64 exec, s[46:47]
    global_store_dword v10, v88, s[26:27] sc1
    v_smfmac_f32_16x16x64_bf16 v[76:79], v[36:39], a[200:207], v2
    s_mov_b64 exec, -1
    v_smfmac_f32_16x16x64_bf16 v[76:79], v[40:43], a[208:215], v2
    v_add_f32 v72, v72, v73
    v_smfmac_f32_16x16x64_bf16 v[76:79], v[44:47], a[216:223], v2
    s_waitcnt vmcnt(6)
    v_add_f32 v74, v74, v75
    v_smfmac_f32_16x16x64_bf16 v[76:79], v[48:51], a[224:231], v2
    v_cvt_pk_bf16_f32 v120, v72, v74
    v_smfmac_f32_16x16x64_bf16 v[76:79], v[52:55], a[232:239], v2
    ds_write2_b32 v11, v120, v65 offset0:0 offset1:1
    v_smfmac_f32_16x16x64_bf16 v[76:79], v[56:59], a[240:247], v2
    v_smfmac_f32_16x16x64_bf16 v[76:79], v[60:63], a[248:255], v2
    v_smfmac_f32_16x16x64_bf16 v[80:83], v[32:35], v[128:135], v2
    v_smfmac_f32_16x16x64_bf16 v[80:83], v[36:39], v[136:143], v2
    v_add_f32 v76, v76, v77
    v_add_f32 v78, v78, v79
    v_smfmac_f32_16x16x64_bf16 v[80:83], v[40:43], v[144:151], v2
    v_cvt_pk_bf16_f32 v121, v76, v78
    v_smfmac_f32_16x16x64_bf16 v[80:83], v[44:47], v[152:159], v2
    ds_write2_b32 v11, v121, v69 offset0:128 offset1:129
    v_smfmac_f32_16x16x64_bf16 v[80:83], v[48:51], v[160:167], v2
    v_smfmac_f32_16x16x64_bf16 v[80:83], v[52:55], v[168:175], v2
    v_smfmac_f32_16x16x64_bf16 v[80:83], v[56:59], v[176:183], v2
    v_smfmac_f32_16x16x64_bf16 v[80:83], v[60:63], v[184:191], v2
    s_waitcnt lgkmcnt(0)
    s_barrier
    v_smfmac_f32_16x16x64_bf16 v[84:87], v[32:35], v[192:199], v2
    ds_read_b64_tr_b16 v[88:89], v12 offset:0
    v_smfmac_f32_16x16x64_bf16 v[84:87], v[36:39], v[200:207], v2
    ds_read_b64_tr_b16 v[90:91], v12 offset:512
    v_smfmac_f32_16x16x64_bf16 v[84:87], v[40:43], v[208:215], v2
    ds_read_b64_tr_b16 v[92:93], v12 offset:1024
    v_add_f32 v80, v80, v81
    v_smfmac_f32_16x16x64_bf16 v[84:87], v[44:47], v[216:223], v2
    ds_read_b64_tr_b16 v[94:95], v12 offset:1536
    v_add_f32 v82, v82, v83
    v_smfmac_f32_16x16x64_bf16 v[84:87], v[48:51], v[224:231], v2
    ds_read_b64_tr_b16 v[96:97], v12 offset:2048
    v_cvt_pk_bf16_f32 v122, v80, v82
    v_smfmac_f32_16x16x64_bf16 v[84:87], v[52:55], v[232:239], v2
    ds_read_b64_tr_b16 v[98:99], v12 offset:2560
    v_mov_b32 v80, v122
    v_smfmac_f32_16x16x64_bf16 v[84:87], v[56:59], v[240:247], v2
    ds_read_b64_tr_b16 v[100:101], v12 offset:3072
    v_smfmac_f32_16x16x64_bf16 v[84:87], v[60:63], v[248:255], v2
    ds_read_b64_tr_b16 v[102:103], v12 offset:3584
    s_waitcnt lgkmcnt(6)
    v_mfma_f32_16x16x32_bf16 v[64:67], v[104:107], v[88:91], 0
    ds_read_b128 v[32:35], v1 offset:12288
    s_nop 2
    v_add_f32 v84, v84, v85
    s_waitcnt lgkmcnt(5)
    v_mfma_f32_16x16x32_bf16 v[64:67], v[108:111], v[92:95], v[64:67]
    ds_read_b128 v[36:39], v1 offset:13312
    v_add_f32 v86, v86, v87
    s_waitcnt lgkmcnt(4)
    v_mfma_f32_16x16x32_bf16 v[64:67], v[112:115], v[96:99], v[64:67]
    ds_read_b128 v[40:43], v1 offset:14336
    v_cvt_pk_bf16_f32 v123, v84, v86
    s_waitcnt lgkmcnt(3)
    v_mfma_f32_16x16x32_bf16 v[64:67], v[116:119], v[100:103], v[64:67]
    ds_read_b128 v[44:47], v1 offset:15360
    v_mov_b32 v81, v123
    v_mfma_f32_16x16x32_bf16 v[76:79], v[88:91], v[88:91], 0
    ds_read_b128 v[48:51], v15 offset:2048
    v_mov_b32 v84, v123
    v_mov_b32 v85, 0
    v_mfma_f32_16x16x32_bf16 v[76:79], v[92:95], v[92:95], v[76:79]
    ds_read_b128 v[52:55], v15 offset:3072
    global_store_dwordx4 v1, v[120:123], s[32:33] sc1
    v_mfma_f32_16x16x32_bf16 v[76:79], v[96:99], v[96:99], v[76:79]
    ds_read_b128 v[56:59], v0 offset:2048
    v_mfma_f32_16x16x32_bf16 v[76:79], v[100:103], v[100:103], v[76:79]
    ds_read_b128 v[60:63], v0 offset:3072
    s_waitcnt lgkmcnt(4)
    v_mfma_f32_16x16x32_bf16 v[68:71], v[32:35], v[88:91], 0
    ds_read_b128 v[104:107], v15 offset:6144
    v_mfma_f32_16x16x32_bf16 v[68:71], v[36:39], v[92:95], v[68:71]
    ds_read_b128 v[108:111], v15 offset:7168
    v_max3_f32 v126, v64, v65, v66
    v_mfma_f32_16x16x32_bf16 v[68:71], v[40:43], v[96:99], v[68:71]
    ds_read_b128 v[112:115], v0 offset:6144
    v_max3_f32 v127, v67, v76, v77
    v_mfma_f32_16x16x32_bf16 v[68:71], v[44:47], v[100:103], v[68:71]
    ds_read_b128 v[116:119], v0 offset:7168
    v_max_f32 v126, v126, v127
    s_add_u32 s32, s32, 0x20000
    s_addc_u32 s33, s33, 0
    ds_read_b128 v[32:35], v15 offset:0
    ds_read_b128 v[36:39], v15 offset:1024
    ds_read_b128 v[88:91], v15 offset:4096
    s_nop 0
    v_max3_f32 v127, v68, v69, v70
    v_max3_f32 v126, v126, v127, v71
    v_mov_b32 v127, v126
    ds_read_b128 v[92:95], v15 offset:5120
    s_nop 0
    v_permlane16_swap_b32 v126, v127
    v_max_f32 v126, v126, v127
    v_mov_b32 v127, v126
    ds_read_b128 v[40:43], v0 offset:0
    s_nop 0
    v_permlane32_swap_b32 v126, v127
    v_max_f32 v126, v126, v127
    v_mul_f32 v126, s50, v126
    v_fma_f32 v64, v64, s50, -v126
    v_fma_f32 v65, v65, s50, -v126
    v_fma_f32 v66, v66, s50, -v126
    v_fma_f32 v67, v67, s50, -v126
    v_fma_f32 v68, v68, s50, -v126
    v_fma_f32 v69, v69, s50, -v126
    v_fma_f32 v70, v70, s50, -v126
    v_fma_f32 v71, v71, s50, -v126
    v_fma_f32 v76, v76, s50, -v126
    v_fma_f32 v77, v77, s50, -v126
    v_exp_f32 v64, v64
    v_exp_f32 v65, v65
    v_exp_f32 v66, v66
    v_exp_f32 v67, v67
    v_exp_f32 v68, v68
    v_exp_f32 v69, v69
    v_exp_f32 v70, v70
    v_exp_f32 v71, v71
    v_exp_f32 v76, v76
    v_exp_f32 v77, v77
    v_cvt_pk_bf16_f32 v72, v64, v65
    v_cvt_pk_bf16_f32 v73, v66, v67
    v_mov_b64 v[64:65], s[8:9]
    v_mov_b64 v[66:67], s[8:9]
    v_cvt_pk_bf16_f32 v74, v68, v69
    v_cvt_pk_bf16_f32 v75, v70, v71
    v_cvt_pk_bf16_f32 v78, v76, v77
    v_mov_b32 v79, 0
    v_mfma_f32_16x16x32_bf16 v[68:71], v[64:67], v[72:75], 0
    ds_read_b128 v[44:47], v0 offset:1024
    v_mfma_f32_16x16x32_bf16 v[120:123], v[24:27], v[72:75], 0
    ds_read_b128 v[96:99], v0 offset:4096
    v_mfma_f32_16x16x32_bf16 v[124:127], v[28:31], v[72:75], 0
    ds_read_b128 v[100:103], v0 offset:5120
    v_mfma_f32_16x16x16_bf16 v[68:71], v[64:65], v[78:79], v[68:71]
    v_mfma_f32_16x16x16_bf16 v[120:123], v[80:81], v[78:79], v[120:123]
    v_mfma_f32_16x16x16_bf16 v[124:127], v[84:85], v[78:79], v[124:127]
    v_rcp_f32 v68, v68
    s_nop 2
    v_pk_mul_f32 v[120:121], v[120:121], v[68:69] op_sel_hi:[1,0]
    v_pk_mul_f32 v[122:123], v[122:123], v[68:69] op_sel_hi:[1,0]
    v_cvt_pk_bf16_f32 v120, v120, v121
    v_cvt_pk_bf16_f32 v121, v122, v123
    s_mov_b64 exec, s[44:45]
    ds_write_b64 v13, v[120:121]
    v_pk_mul_f32 v[124:125], v[124:125], v[68:69] op_sel_hi:[1,0]
    v_pk_mul_f32 v[126:127], v[126:127], v[68:69] op_sel_hi:[1,0]
    v_cvt_pk_bf16_f32 v122, v124, v125
    v_cvt_pk_bf16_f32 v123, v126, v127
    ds_write_b64 v13, v[122:123] offset:32
    s_mov_b64 exec, -1
    v_mov_b64 v[64:65], 0
    v_mov_b64 v[66:67], 0
    v_mov_b64 v[68:69], 0
    v_mov_b64 v[70:71], 0
    v_mov_b64 v[72:73], 0
    v_mov_b64 v[74:75], 0
    v_mov_b64 v[76:77], 0
    v_mov_b64 v[78:79], 0
    v_mov_b64 v[80:81], 0
    v_mov_b64 v[82:83], 0
    v_mov_b64 v[84:85], 0
    v_mov_b64 v[86:87], 0
    v_mov_b64 v[120:121], 0
    v_mov_b64 v[122:123], 0
    v_mov_b64 v[124:125], 0
    v_mov_b64 v[126:127], 0
    s_waitcnt lgkmcnt(0)
    s_barrier
    ds_read_b128 v[24:27], v14
    ds_read_b128 v[28:31], v14 offset:128
    s_waitcnt lgkmcnt(1)
    v_smfmac_f32_16x16x64_bf16 v[64:67], v[24:27], v[32:39], v2
    ds_read_b128 v[32:35], v15 offset:8192
    s_waitcnt lgkmcnt(1)
    v_smfmac_f32_16x16x64_bf16 v[64:67], v[28:31], v[40:47], v2
    ds_read_b128 v[36:39], v15 offset:9216
    v_smfmac_f32_16x16x64_bf16 v[68:71], v[24:27], v[48:55], v2
    ds_read_b128 v[40:43], v0 offset:8192
    v_smfmac_f32_16x16x64_bf16 v[68:71], v[28:31], v[56:63], v2
    ds_read_b128 v[44:47], v0 offset:9216
    v_add_f32 v64, v64, v65
    v_smfmac_f32_16x16x64_bf16 v[72:75], v[24:27], v[88:95], v2
    ds_read_b128 v[48:51], v15 offset:10240
    v_add_f32 v66, v66, v67
    v_smfmac_f32_16x16x64_bf16 v[72:75], v[28:31], v[96:103], v2
    ds_read_b128 v[52:55], v15 offset:11264
    v_cvt_pk_bf16_f32 v64, v64, v66
    v_add_f32 v68, v68, v69
    v_smfmac_f32_16x16x64_bf16 v[76:79], v[24:27], v[104:111], v2
    ds_read_b128 v[56:59], v0 offset:10240
    v_add_f32 v70, v70, v71
    v_smfmac_f32_16x16x64_bf16 v[76:79], v[28:31], v[112:119], v2
    ds_read_b128 v[60:63], v0 offset:11264
    v_cvt_pk_bf16_f32 v65, v68, v70
    v_add_f32 v72, v72, v73
    v_smfmac_f32_16x16x64_bf16 v[80:83], v[24:27], a[0:7], v2
    v_add_f32 v74, v74, v75
    v_smfmac_f32_16x16x64_bf16 v[80:83], v[28:31], a[8:15], v2
    v_cvt_pk_bf16_f32 v66, v72, v74
    v_add_f32 v76, v76, v77
    v_smfmac_f32_16x16x64_bf16 v[84:87], v[24:27], a[16:23], v2
    v_add_f32 v78, v78, v79
    v_smfmac_f32_16x16x64_bf16 v[84:87], v[28:31], a[24:31], v2
    v_cvt_pk_bf16_f32 v67, v76, v78
    v_add_f32 v80, v80, v81
    v_or_b32 v64, 1, v64
    s_waitcnt lgkmcnt(4)
    v_smfmac_f32_16x16x64_bf16 v[120:123], v[24:27], v[32:39], v2
    global_store_dwordx4 v8, v[64:67], s[20:21] sc1
    v_add_f32 v82, v82, v83
    v_add_u32 v72, 0x8000, v8
    s_waitcnt lgkmcnt(3)
    v_smfmac_f32_16x16x64_bf16 v[120:123], v[28:31], v[40:47], v2
    v_cvt_pk_bf16_f32 v82, v80, v82
    v_add_f32 v84, v84, v85
    s_waitcnt lgkmcnt(2)
    v_smfmac_f32_16x16x64_bf16 v[124:127], v[24:27], v[48:55], v2
    v_add_f32 v86, v86, v87
    s_waitcnt lgkmcnt(0)
    v_smfmac_f32_16x16x64_bf16 v[124:127], v[28:31], v[56:63], v2
    v_cvt_pk_bf16_f32 v83, v84, v86
    v_add_f32 v120, v120, v121
    v_add_f32 v122, v122, v123
    v_cvt_pk_bf16_f32 v80, v120, v122
    s_nop 3
    v_add_f32 v124, v124, v125
    v_add_f32 v126, v126, v127
    v_cvt_pk_bf16_f32 v81, v124, v126
    v_or_b32 v80, 1, v80
    global_store_dwordx4 v72, v[80:83], s[20:21] sc1
    v_mov_b64 v[64:65], 0
    v_mov_b64 v[66:67], 0
    v_mov_b64 v[68:69], 0
    v_mov_b64 v[70:71], 0
    v_mov_b64 v[72:73], 0
    v_mov_b64 v[74:75], 0
    v_mov_b64 v[76:77], 0
    v_mov_b64 v[78:79], 0
    v_mov_b64 v[80:81], 0
    v_mov_b64 v[82:83], 0
    v_mov_b64 v[84:85], 0
    v_mov_b64 v[86:87], 0
    ds_read_b128 v[88:91], v15 offset:12288
    ds_read_b128 v[92:95], v15 offset:13312
    ds_read_b128 v[96:99], v0 offset:12288
    ds_read_b128 v[100:103], v0 offset:13312
    ds_read_b128 v[104:107], v15 offset:14336
    ds_read_b128 v[108:111], v15 offset:15360
    ds_read_b128 v[112:115], v0 offset:14336
    ds_read_b128 v[116:119], v0 offset:15360
    s_waitcnt vmcnt(2)
    v_readlane_b32 s95, v3, 0
    v_readlane_b32 s39, v3, 1
    s_add_u32 s94, s38, 2
    s_lshr_b32 s94, s94, 1
    s_add_u32 s94, s94, 1
    s_min_u32 s94, s94, 32
    s_min_u32 s95, s95, s39
    s_cmp_lt_u32 s95, s94
    s_cbranch_scc1 LKV_1S
LKVB_1S:
    s_waitcnt vmcnt(0)
    global_load_dwordx4 v[32:35], v1, s[96:97] sc1
    global_load_dwordx4 v[36:39], v1, s[96:97] offset:1024 sc1
    s_waitcnt vmcnt(0)
    v_mfma_f32_16x16x32_bf16 v[48:51], v[32:35], v[4:7], 0
    v_bitop3_b32 v52, v32, v36, 1 bitop3:0x2a
    v_cmp_ne_u32 vcc, 0, v52
    v_mfma_f32_16x16x32_bf16 v[48:51], v[36:39], v[4:7], v[48:51]
    s_cbranch_vccnz LPR_1S
LPB_1S:
    s_nop 6
    v_permlane32_swap_b32 v48, v49
    v_permlane32_swap_b32 v50, v51
    v_add_f32 v48, v48, v49
    v_add_f32 v50, v50, v51
    s_nop 1
    v_permlane16_swap_b32 v48, v50
    v_add_f32 v48, v48, v50
    s_nop 1
    v_mov_b32_dpp v49, v48 quad_perm:[2,3,2,3] row_mask:0xf bank_mask:0xf
    v_cvt_pk_bf16_f32 v48, v48, v49
    s_mov_b64 exec, s[46:47]
    global_store_dword v10, v48, s[24:25] sc1
    s_mov_b64 exec, -1
    s_add_u32 s98, s24, s101
    s_addc_u32 s99, s25, 0
    v_add_u32 v40, s100, v1
    s_add_u32 s38, s38, 1
    s_add_u32 s39, s38, 1
    s_and_b32 s39, s39, 3
    s_lshl_b32 s40, s39, 13
    s_add_u32 s39, s38, 2
    s_and_b32 s39, s39, 3
    s_lshl_b32 s39, s39, 13
    s_add_u32 s26, s22, s39
    s_addc_u32 s27, s23, 0
    s_waitcnt vmcnt(0)
    global_load_dwordx4 v[120:123], v1, s[98:99] sc1
    global_load_dwordx4 v[124:127], v1, s[98:99] offset:1024 sc1
    s_waitcnt vmcnt(0)
    ds_write_b128 v40, v[120:123]
    ds_write_b128 v40, v[124:127] offset:1024
    v_max3_u32 v42, v120, v121, v122
    v_max3_u32 v43, v124, v125, v126
    v_max3_u32 v42, v42, v123, v127
    v_max_u32 v42, v42, v43
    v_cmp_eq_u32 vcc, -1, v42
    s_cbranch_vccnz LMR_1S
LMB_1S:
    s_add_u32 s24, s22, s40
    s_addc_u32 s25, s23, 0
    s_waitcnt lgkmcnt(0)
    s_barrier
    s_cmp_lt_u32 s38, 63
    s_cbranch_scc1 L_loopS
    ds_read_b128 v[32:35], v1 offset:16384
    ds_read_b128 v[36:39], v1 offset:17408
    ds_read_b128 v[40:43], v1 offset:18432
    s_waitcnt lgkmcnt(2)
    v_smfmac_f32_16x16x64_bf16 v[64:67], v[32:35], v[88:95], v2
    ds_read_b128 v[44:47], v1 offset:19456
    s_waitcnt lgkmcnt(2)
    v_smfmac_f32_16x16x64_bf16 v[64:67], v[36:39], v[96:103], v2
    ds_read_b128 v[48:51], v1 offset:20480
    s_waitcnt lgkmcnt(2)
    v_smfmac_f32_16x16x64_bf16 v[64:67], v[40:43], v[104:111], v2
    ds_read_b128 v[52:55], v1 offset:21504
    s_waitcnt lgkmcnt(2)
    v_smfmac_f32_16x16x64_bf16 v[64:67], v[44:47], v[112:119], v2
    ds_read_b128 v[56:59], v1 offset:22528
    s_waitcnt lgkmcnt(2)
    v_smfmac_f32_16x16x64_bf16 v[64:67], v[48:51], a[32:39], v2
    ds_read_b128 v[60:63], v1 offset:23552
    s_waitcnt lgkmcnt(2)
    v_smfmac_f32_16x16x64_bf16 v[64:67], v[52:55], a[40:47], v2
    s_waitcnt lgkmcnt(1)
    v_smfmac_f32_16x16x64_bf16 v[64:67], v[56:59], a[48:55], v2
    s_waitcnt lgkmcnt(0)
    v_smfmac_f32_16x16x64_bf16 v[64:67], v[60:63], a[56:63], v2
    v_smfmac_f32_16x16x64_bf16 v[68:71], v[32:35], a[64:71], v2
    v_smfmac_f32_16x16x64_bf16 v[68:71], v[36:39], a[72:79], v2
    v_smfmac_f32_16x16x64_bf16 v[68:71], v[40:43], a[80:87], v2
    v_add_f32 v64, v64, v65
    v_smfmac_f32_16x16x64_bf16 v[68:71], v[44:47], a[88:95], v2
    v_add_f32 v66, v66, v67
    v_smfmac_f32_16x16x64_bf16 v[68:71], v[48:51], a[96:103], v2
    v_cvt_pk_bf16_f32 v65, v64, v66
    v_smfmac_f32_16x16x64_bf16 v[68:71], v[52:55], a[104:111], v2
    v_smfmac_f32_16x16x64_bf16 v[68:71], v[56:59], a[112:119], v2
    v_mov_b32 v89, s38
    v_smfmac_f32_16x16x64_bf16 v[68:71], v[60:63], a[120:127], v2
    v_mov_b32 v90, 0
    v_smfmac_f32_16x16x64_bf16 v[72:75], v[32:35], a[128:135], v2
    v_smfmac_f32_16x16x64_bf16 v[72:75], v[36:39], a[136:143], v2
    v_smfmac_f32_16x16x64_bf16 v[72:75], v[40:43], a[144:151], v2
    v_add_f32 v68, v68, v69
    v_smfmac_f32_16x16x64_bf16 v[72:75], v[44:47], a[152:159], v2
    v_add_f32 v70, v70, v71
    v_smfmac_f32_16x16x64_bf16 v[72:75], v[48:51], a[160:167], v2
    v_cvt_pk_bf16_f32 v69, v68, v70
    v_smfmac_f32_16x16x64_bf16 v[72:75], v[52:55], a[168:175], v2
    v_smfmac_f32_16x16x64_bf16 v[72:75], v[56:59], a[176:183], v2
    v_smfmac_f32_16x16x64_bf16 v[72:75], v[60:63], a[184:191], v2
    v_smfmac_f32_16x16x64_bf16 v[76:79], v[32:35], a[192:199], v2
    s_mov_b64 exec, s[46:47]
    global_store_dword v90, v89, s[92:93] sc1
    v_smfmac_f32_16x16x64_bf16 v[76:79], v[36:39], a[200:207], v2
    s_mov_b64 exec, -1
    v_smfmac_f32_16x16x64_bf16 v[76:79], v[40:43], a[208:215], v2
    v_add_f32 v72, v72, v73
    v_smfmac_f32_16x16x64_bf16 v[76:79], v[44:47], a[216:223], v2
    s_waitcnt vmcnt(1)
    v_add_f32 v74, v74, v75
    v_smfmac_f32_16x16x64_bf16 v[76:79], v[48:51], a[224:231], v2
    v_cvt_pk_bf16_f32 v120, v72, v74
    v_smfmac_f32_16x16x64_bf16 v[76:79], v[52:55], a[232:239], v2
    ds_write2_b32 v11, v120, v65 offset0:0 offset1:1
    v_smfmac_f32_16x16x64_bf16 v[76:79], v[56:59], a[240:247], v2
    v_smfmac_f32_16x16x64_bf16 v[76:79], v[60:63], a[248:255], v2
    v_smfmac_f32_16x16x64_bf16 v[80:83], v[32:35], v[128:135], v2
    v_smfmac_f32_16x16x64_bf16 v[80:83], v[36:39], v[136:143], v2
    v_add_f32 v76, v76, v77
    v_add_f32 v78, v78, v79
    v_smfmac_f32_16x16x64_bf16 v[80:83], v[40:43], v[144:151], v2
    v_cvt_pk_bf16_f32 v121, v76, v78
    v_smfmac_f32_16x16x64_bf16 v[80:83], v[44:47], v[152:159], v2
    ds_write2_b32 v11, v121, v69 offset0:128 offset1:129
    v_smfmac_f32_16x16x64_bf16 v[80:83], v[48:51], v[160:167], v2
    v_smfmac_f32_16x16x64_bf16 v[80:83], v[52:55], v[168:175], v2
    v_smfmac_f32_16x16x64_bf16 v[80:83], v[56:59], v[176:183], v2
    v_smfmac_f32_16x16x64_bf16 v[80:83], v[60:63], v[184:191], v2
    v_smfmac_f32_16x16x64_bf16 v[84:87], v[32:35], v[192:199], v2
    v_smfmac_f32_16x16x64_bf16 v[84:87], v[36:39], v[200:207], v2
    v_smfmac_f32_16x16x64_bf16 v[84:87], v[40:43], v[208:215], v2
    v_add_f32 v80, v80, v81
    v_smfmac_f32_16x16x64_bf16 v[84:87], v[44:47], v[216:223], v2
    v_add_f32 v82, v82, v83
    v_smfmac_f32_16x16x64_bf16 v[84:87], v[48:51], v[224:231], v2
    v_cvt_pk_bf16_f32 v122, v80, v82
    v_smfmac_f32_16x16x64_bf16 v[84:87], v[52:55], v[232:239], v2
    v_mov_b32 v80, v122
    v_smfmac_f32_16x16x64_bf16 v[84:87], v[56:59], v[240:247], v2
    v_smfmac_f32_16x16x64_bf16 v[84:87], v[60:63], v[248:255], v2
    s_nop 7
    v_add_f32 v84, v84, v85
    v_add_f32 v86, v86, v87
    v_cvt_pk_bf16_f32 v123, v84, v86
    global_store_dwordx4 v1, v[120:123], s[32:33] sc1
    s_waitcnt vmcnt(0)
    s_barrier
    v_mov_b32 v89, 64
    s_mov_b64 exec, 1
    global_store_dword v90, v89, s[92:93] sc1
    s_mov_b64 exec, -1
    s_waitcnt vmcnt(0)
    s_branch L_chain_done
L_last1S:
    ds_read_b128 v[32:35], v1 offset:16384
    ds_read_b128 v[36:39], v1 offset:17408
    ds_read_b128 v[40:43], v1 offset:18432
    s_waitcnt lgkmcnt(2)
    v_smfmac_f32_16x16x64_bf16 v[64:67], v[32:35], v[88:95], v2
    ds_read_b128 v[44:47], v1 offset:19456
    s_waitcnt lgkmcnt(2)
    v_smfmac_f32_16x16x64_bf16 v[64:67], v[36:39], v[96:103], v2
    ds_read_b128 v[48:51], v1 offset:20480
    s_waitcnt lgkmcnt(2)
    v_smfmac_f32_16x16x64_bf16 v[64:67], v[40:43], v[104:111], v2
    ds_read_b128 v[52:55], v1 offset:21504
    s_waitcnt lgkmcnt(2)
    v_smfmac_f32_16x16x64_bf16 v[64:67], v[44:47], v[112:119], v2
    ds_read_b128 v[56:59], v1 offset:22528
    s_waitcnt lgkmcnt(2)
    v_smfmac_f32_16x16x64_bf16 v[64:67], v[48:51], a[32:39], v2
    ds_read_b128 v[60:63], v1 offset:23552
    s_waitcnt lgkmcnt(2)
    v_smfmac_f32_16x16x64_bf16 v[64:67], v[52:55], a[40:47], v2
    s_waitcnt lgkmcnt(1)
    v_smfmac_f32_16x16x64_bf16 v[64:67], v[56:59], a[48:55], v2
    s_waitcnt lgkmcnt(0)
    v_smfmac_f32_16x16x64_bf16 v[64:67], v[60:63], a[56:63], v2
    v_smfmac_f32_16x16x64_bf16 v[68:71], v[32:35], a[64:71], v2
    v_smfmac_f32_16x16x64_bf16 v[68:71], v[36:39], a[72:79], v2
    v_smfmac_f32_16x16x64_bf16 v[68:71], v[40:43], a[80:87], v2
    v_add_f32 v64, v64, v65
    v_smfmac_f32_16x16x64_bf16 v[68:71], v[44:47], a[88:95], v2
    v_add_f32 v66, v66, v67
    v_smfmac_f32_16x16x64_bf16 v[68:71], v[48:51], a[96:103], v2
    v_cvt_pk_bf16_f32 v65, v64, v66
    v_smfmac_f32_16x16x64_bf16 v[68:71], v[52:55], a[104:111], v2
    v_smfmac_f32_16x16x64_bf16 v[68:71], v[56:59], a[112:119], v2
    v_mov_b32 v89, s38
    v_smfmac_f32_16x16x64_bf16 v[68:71], v[60:63], a[120:127], v2
    v_mov_b32 v90, 0
    v_smfmac_f32_16x16x64_bf16 v[72:75], v[32:35], a[128:135], v2
    v_smfmac_f32_16x16x64_bf16 v[72:75], v[36:39], a[136:143], v2
    v_smfmac_f32_16x16x64_bf16 v[72:75], v[40:43], a[144:151], v2
    v_add_f32 v68, v68, v69
    v_smfmac_f32_16x16x64_bf16 v[72:75], v[44:47], a[152:159], v2
    v_add_f32 v70, v70, v71
    v_smfmac_f32_16x16x64_bf16 v[72:75], v[48:51], a[160:167], v2
    v_cvt_pk_bf16_f32 v69, v68, v70
    v_smfmac_f32_16x16x64_bf16 v[72:75], v[52:55], a[168:175], v2
    v_smfmac_f32_16x16x64_bf16 v[72:75], v[56:59], a[176:183], v2
    v_smfmac_f32_16x16x64_bf16 v[72:75], v[60:63], a[184:191], v2
    v_smfmac_f32_16x16x64_bf16 v[76:79], v[32:35], a[192:199], v2
    s_mov_b64 exec, s[46:47]
    global_store_dword v90, v89, s[92:93] sc1
    v_smfmac_f32_16x16x64_bf16 v[76:79], v[36:39], a[200:207], v2
    s_mov_b64 exec, -1
    v_smfmac_f32_16x16x64_bf16 v[76:79], v[40:43], a[208:215], v2
    v_add_f32 v72, v72, v73
    v_smfmac_f32_16x16x64_bf16 v[76:79], v[44:47], a[216:223], v2
    s_waitcnt vmcnt(1)
    v_add_f32 v74, v74, v75
    v_smfmac_f32_16x16x64_bf16 v[76:79], v[48:51], a[224:231], v2
    v_cvt_pk_bf16_f32 v120, v72, v74
    v_smfmac_f32_16x16x64_bf16 v[76:79], v[52:55], a[232:239], v2
    ds_write2_b32 v11, v120, v65 offset0:0 offset1:1
    v_smfmac_f32_16x16x64_bf16 v[76:79], v[56:59], a[240:247], v2
    v_smfmac_f32_16x16x64_bf16 v[76:79], v[60:63], a[248:255], v2
    v_smfmac_f32_16x16x64_bf16 v[80:83], v[32:35], v[128:135], v2
    v_smfmac_f32_16x16x64_bf16 v[80:83], v[36:39], v[136:143], v2
    v_add_f32 v76, v76, v77
    v_add_f32 v78, v78, v79
    v_smfmac_f32_16x16x64_bf16 v[80:83], v[40:43], v[144:151], v2
    v_cvt_pk_bf16_f32 v121, v76, v78
    v_smfmac_f32_16x16x64_bf16 v[80:83], v[44:47], v[152:159], v2
    ds_write2_b32 v11, v121, v69 offset0:128 offset1:129
    v_smfmac_f32_16x16x64_bf16 v[80:83], v[48:51], v[160:167], v2
    v_smfmac_f32_16x16x64_bf16 v[80:83], v[52:55], v[168:175], v2
    v_smfmac_f32_16x16x64_bf16 v[80:83], v[56:59], v[176:183], v2
    v_smfmac_f32_16x16x64_bf16 v[80:83], v[60:63], v[184:191], v2
    v_smfmac_f32_16x16x64_bf16 v[84:87], v[32:35], v[192:199], v2
    v_smfmac_f32_16x16x64_bf16 v[84:87], v[36:39], v[200:207], v2
    v_smfmac_f32_16x16x64_bf16 v[84:87], v[40:43], v[208:215], v2
    v_add_f32 v80, v80, v81
    v_smfmac_f32_16x16x64_bf16 v[84:87], v[44:47], v[216:223], v2
    v_add_f32 v82, v82, v83
    v_smfmac_f32_16x16x64_bf16 v[84:87], v[48:51], v[224:231], v2
    v_cvt_pk_bf16_f32 v122, v80, v82
    v_smfmac_f32_16x16x64_bf16 v[84:87], v[52:55], v[232:239], v2
    v_mov_b32 v80, v122
    v_smfmac_f32_16x16x64_bf16 v[84:87], v[56:59], v[240:247], v2
    v_smfmac_f32_16x16x64_bf16 v[84:87], v[60:63], v[248:255], v2
    s_nop 7
    v_add_f32 v84, v84, v85
    v_add_f32 v86, v86, v87
    v_cvt_pk_bf16_f32 v123, v84, v86
    global_store_dwordx4 v1, v[120:123], s[32:33] sc1
    s_waitcnt vmcnt(0)
    s_barrier
    v_mov_b32 v89, 64
    s_mov_b64 exec, 1
    global_store_dword v90, v89, s[92:93] sc1
    s_mov_b64 exec, -1
    s_waitcnt vmcnt(0)
    s_branch L_chain_done
LKV_0S:
    global_load_dword v3, v9, s[34:35] sc1
    s_waitcnt vmcnt(0)
    v_readlane_b32 s95, v3, 0
    v_readlane_b32 s39, v3, 1
    s_nop 0
    s_min_u32 s95, s95, s39
    s_cmp_ge_u32 s95, s94
    s_cbranch_scc1 LKVB_0S
    s_sleep 2
    s_add_u32 s48, s48, 1
    s_cmp_lt_u32 s48, 0x40000
    s_cbranch_scc1 LKV_0S
    s_branch L_fail
LPR_0S:
    s_mov_b64 exec, vcc
    global_load_dwordx4 v[32:35], v1, s[96:97] sc1
    global_load_dwordx4 v[36:39], v1, s[96:97] offset:1024 sc1
    s_nop 15
LPL_0S:
    global_load_dwordx4 v[32:35], v1, s[96:97] sc1
    global_load_dwordx4 v[36:39], v1, s[96:97] offset:1024 sc1
    s_waitcnt vmcnt(2)
    v_bitop3_b32 v52, v32, v36, 1 bitop3:0xa8
    v_cmp_ne_u32 vcc, 0, v52
    s_add_u32 s48, s48, 1
    s_cbranch_vccz LPD_0S
    s_mov_b64 exec, vcc
    s_cmp_lt_u32 s48, 0x100000
    s_cbranch_scc1 LPL_0S
    s_branch L_fail
LPD_0S:
    s_mov_b64 exec, -1
    s_nop 3
    v_mfma_f32_16x16x32_bf16 v[48:51], v[32:35], v[4:7], 0
    v_mfma_f32_16x16x32_bf16 v[48:51], v[36:39], v[4:7], v[48:51]
    s_nop 7
    s_branch LPB_0S
LMR_0S:
    s_mov_b64 exec, vcc
    global_load_dwordx4 v[120:123], v1, s[98:99] sc1
    global_load_dwordx4 v[124:127], v1, s[98:99] offset:1024 sc1
    s_nop 15
LML_0S:
    global_load_dwordx4 v[120:123], v1, s[98:99] sc1
    global_load_dwordx4 v[124:127], v1, s[98:99] offset:1024 sc1
    s_waitcnt vmcnt(2)
    v_max3_u32 v42, v120, v121, v122
    v_max3_u32 v43, v124, v125, v126
    v_max3_u32 v42, v42, v123, v127
    v_max_u32 v42, v42, v43
    v_cmp_eq_u32 vcc, -1, v42
    s_add_u32 s61, s61, 1
    s_add_u32 s48, s48, 1
    s_cbranch_vccz LMD_0S
    s_mov_b64 exec, vcc
    s_cmp_lt_u32 s48, 0x100000
    s_cbranch_scc1 LML_0S
    s_branch L_fail
LMD_0S:
    s_mov_b64 exec, -1
    ds_write_b128 v40, v[120:123]
    ds_write_b128 v40, v[124:127] offset:1024
    s_branch LMB_0S
LKV_1S:
    global_load_dword v3, v9, s[34:35] sc1
    s_waitcnt vmcnt(0)
    v_readlane_b32 s95, v3, 0
    v_readlane_b32 s39, v3, 1
    s_nop 0
    s_min_u32 s95, s95, s39
    s_cmp_ge_u32 s95, s94
    s_cbranch_scc1 LKVB_1S
    s_sleep 2
    s_add_u32 s48, s48, 1
    s_cmp_lt_u32 s48, 0x40000
    s_cbranch_scc1 LKV_1S
    s_branch L_fail
LPR_1S:
    s_mov_b64 exec, vcc
    global_load_dwordx4 v[32:35], v1, s[96:97] sc1
    global_load_dwordx4 v[36:39], v1, s[96:97] offset:1024 sc1
    s_nop 15
LPL_1S:
    global_load_dwordx4 v[32:35], v1, s[96:97] sc1
    global_load_dwordx4 v[36:39], v1, s[96:97] offset:1024 sc1
    s_waitcnt vmcnt(2)
    v_bitop3_b32 v52, v32, v36, 1 bitop3:0x2a
    v_cmp_ne_u32 vcc, 0, v52
    s_add_u32 s48, s48, 1
    s_cbranch_vccz LPD_1S
    s_mov_b64 exec, vcc
    s_cmp_lt_u32 s48, 0x100000
    s_cbranch_scc1 LPL_1S
    s_branch L_fail
LPD_1S:
    s_mov_b64 exec, -1
    s_nop 3
    v_mfma_f32_16x16x32_bf16 v[48:51], v[32:35], v[4:7], 0
    v_mfma_f32_16x16x32_bf16 v[48:51], v[36:39], v[4:7], v[48:51]
    s_nop 7
    s_branch LPB_1S
LMR_1S:
    s_mov_b64 exec, vcc
    global_load_dwordx4 v[120:123], v1, s[98:99] sc1
    global_load_dwordx4 v[124:127], v1, s[98:99] offset:1024 sc1
    s_nop 15
LML_1S:
    global_load_dwordx4 v[120:123], v1, s[98:99] sc1
    global_load_dwordx4 v[124:127], v1, s[98:99] offset:1024 sc1
    s_waitcnt vmcnt(2)
    v_max3_u32 v42, v120, v121, v122
    v_max3_u32 v43, v124, v125, v126
    v_max3_u32 v42, v42, v123, v127
    v_max_u32 v42, v42, v43
    v_cmp_eq_u32 vcc, -1, v42
    s_add_u32 s61, s61, 1
    s_add_u32 s48, s48, 1
    s_cbranch_vccz LMD_1S
    s_mov_b64 exec, vcc
    s_cmp_lt_u32 s48, 0x100000
    s_cbranch_scc1 LML_1S
    s_branch L_fail
LMD_1S:
    s_mov_b64 exec, -1
    ds_write_b128 v40, v[120:123]
    ds_write_b128 v40, v[124:127] offset:1024
    s_branch LMB_1S
L_chain_done:
    s_branch L_end
L_worker:
    s_load_dwordx2 s[34:35], s[0:1], 0
    s_load_dwordx2 s[18:19], s[0:1], 136
    s_load_dwordx2 s[38:39], s[0:1], 128
    s_load_dwordx2 s[36:37], s[0:1], 120
    s_load_dwordx2 s[32:33], s[0:1], 112
    s_load_dwordx4 s[72:75], s[0:1], 16
    s_load_dwordx4 s[76:79], s[0:1], 32
    s_load_dwordx4 s[80:83], s[0:1], 72
    s_load_dwordx4 s[84:87], s[0:1], 88
    s_sub_u32 s21, s4, 2
    s_lshl_b32 s21, s21, 5
    s_lshr_b32 s22, s2, 3
    s_add_u32 s31, s21, s22
    v_lshrrev_b32 v2, 6, v0
    v_and_b32 v0, 63, v0
    s_nop 0
    v_readfirstlane_b32 s6, v2
    s_lshr_b32 s4, s31, 5
    s_and_b32 s4, s4, 1
    s_and_b32 s5, s31, 31
    s_and_b32 s7, s6, 1
    s_lshr_b32 s3, s6, 1
    s_waitcnt lgkmcnt(0)
    s_lshr_b32 s22, s31, 6
    s_cmp_eq_u32 s22, 1
    s_cbranch_scc1 L_roleV
    s_cmp_eq_u32 s22, 2
    s_cbranch_scc1 L_roleQ
    s_cmp_eq_u32 s4, 0
    s_cselect_b32 s8, s74, s82
    s_cselect_b32 s9, s75, s83
    s_lshl_b32 s21, s5, 8
    s_add_u32 s8, s8, s21
    s_addc_u32 s9, s9, 0
    v_lshrrev_b32 v20, 4, v0
    v_and_b32 v23, 15, v0
    v_lshrrev_b32 v21, 2, v23
    v_and_b32 v22, 3, v0
    v_and_b32 v24, 15, v0
    v_lshrrev_b32 v25, 4, v0
    v_lshlrev_b32 v26, 1, v25
    v_xor_b32 v27, v24, v26
    v_xor_b32 v28, 8, v27
    v_lshlrev_b32 v27, 4, v27
    v_lshlrev_b32 v28, 4, v28
    v_lshlrev_b32 v29, 13, v25
    v_add_u32 v27, v27, v29
    v_add_u32 v28, v28, v29
    s_lshl_b32 s21, s6, 20
    s_add_u32 s24, s8, s21
    s_addc_u32 s25, s9, 0
    s_lshl_b32 s30, s6, 15
    s_mov_b32 m0, s30
    s_add_u32 s30, s30, 1024
    global_load_lds_dwordx4 v27, s[24:25]
    s_add_u32 s24, s24, 0x8000
    s_addc_u32 s25, s25, 0
    s_mov_b32 m0, s30
    s_add_u32 s30, s30, 1024
    global_load_lds_dwordx4 v27, s[24:25]
    s_add_u32 s24, s24, 0x8000
    s_addc_u32 s25, s25, 0
    s_mov_b32 m0, s30
    s_add_u32 s30, s30, 1024
    global_load_lds_dwordx4 v28, s[24:25]
    s_add_u32 s24, s24, 0x8000
    s_addc_u32 s25, s25, 0
    s_mov_b32 m0, s30
    s_add_u32 s30, s30, 1024
    global_load_lds_dwordx4 v28, s[24:25]
    s_add_u32 s24, s24, 0x8000
    s_addc_u32 s25, s25, 0
    s_mov_b32 m0, s30
    s_add_u32 s30, s30, 1024
    global_load_lds_dwordx4 v27, s[24:25]
    s_add_u32 s24, s24, 0x8000
    s_addc_u32 s25, s25, 0
    s_mov_b32 m0, s30
    s_add_u32 s30, s30, 1024
    global_load_lds_dwordx4 v27, s[24:25]
    s_add_u32 s24, s24, 0x8000
    s_addc_u32 s25, s25, 0
    s_mov_b32 m0, s30
    s_add_u32 s30, s30, 1024
    global_load_lds_dwordx4 v28, s[24:25]
    s_add_u32 s24, s24, 0x8000
    s_addc_u32 s25, s25, 0
    s_mov_b32 m0, s30
    s_add_u32 s30, s30, 1024
    global_load_lds_dwordx4 v28, s[24:25]
    s_add_u32 s24, s24, 0x8000
    s_addc_u32 s25, s25, 0
    s_mov_b32 m0, s30
    s_add_u32 s30, s30, 1024
    global_load_lds_dwordx4 v27, s[24:25]
    s_add_u32 s24, s24, 0x8000
    s_addc_u32 s25, s25, 0
    s_mov_b32 m0, s30
    s_add_u32 s30, s30, 1024
    global_load_lds_dwordx4 v27, s[24:25]
    s_add_u32 s24, s24, 0x8000
    s_addc_u32 s25, s25, 0
    s_mov_b32 m0, s30
    s_add_u32 s30, s30, 1024
    global_load_lds_dwordx4 v28, s[24:25]
    s_add_u32 s24, s24, 0x8000
    s_addc_u32 s25, s25, 0
    s_mov_b32 m0, s30
    s_add_u32 s30, s30, 1024
    global_load_lds_dwordx4 v28, s[24:25]
    s_add_u32 s24, s24, 0x8000
    s_addc_u32 s25, s25, 0
    s_waitcnt vmcnt(8)
    s_mov_b32 m0, s30
    s_add_u32 s30, s30, 1024
    global_load_lds_dwordx4 v27, s[24:25]
    s_add_u32 s24, s24, 0x8000
    s_addc_u32 s25, s25, 0
    s_mov_b32 m0, s30
    s_add_u32 s30, s30, 1024
    global_load_lds_dwordx4 v27, s[24:25]
    s_add_u32 s24, s24, 0x8000
    s_addc_u32 s25, s25, 0
    s_mov_b32 m0, s30
    s_add_u32 s30, s30, 1024
    global_load_lds_dwordx4 v28, s[24:25]
    s_add_u32 s24, s24, 0x8000
    s_addc_u32 s25, s25, 0
    s_mov_b32 m0, s30
    s_add_u32 s30, s30, 1024
    global_load_lds_dwordx4 v28, s[24:25]
    s_add_u32 s24, s24, 0x8000
    s_addc_u32 s25, s25, 0
    s_waitcnt vmcnt(8)
    s_mov_b32 m0, s30
    s_add_u32 s30, s30, 1024
    global_load_lds_dwordx4 v27, s[24:25]
    s_add_u32 s24, s24, 0x8000
    s_addc_u32 s25, s25, 0
    s_mov_b32 m0, s30
    s_add_u32 s30, s30, 1024
    global_load_lds_dwordx4 v27, s[24:25]
    s_add_u32 s24, s24, 0x8000
    s_addc_u32 s25, s25, 0
    s_mov_b32 m0, s30
    s_add_u32 s30, s30, 1024
    global_load_lds_dwordx4 v28, s[24:25]
    s_add_u32 s24, s24, 0x8000
    s_addc_u32 s25, s25, 0
    s_mov_b32 m0, s30
    s_add_u32 s30, s30, 1024
    global_load_lds_dwordx4 v28, s[24:25]
    s_add_u32 s24, s24, 0x8000
    s_addc_u32 s25, s25, 0
    s_waitcnt vmcnt(8)
    s_mov_b32 m0, s30
    s_add_u32 s30, s30, 1024
    global_load_lds_dwordx4 v27, s[24:25]
    s_add_u32 s24, s24, 0x8000
    s_addc_u32 s25, s25, 0
    s_mov_b32 m0, s30
    s_add_u32 s30, s30, 1024
    global_load_lds_dwordx4 v27, s[24:25]
    s_add_u32 s24, s24, 0x8000
    s_addc_u32 s25, s25, 0
    s_mov_b32 m0, s30
    s_add_u32 s30, s30, 1024
    global_load_lds_dwordx4 v28, s[24:25]
    s_add_u32 s24, s24, 0x8000
    s_addc_u32 s25, s25, 0
    s_mov_b32 m0, s30
    s_add_u32 s30, s30, 1024
    global_load_lds_dwordx4 v28, s[24:25]
    s_add_u32 s24, s24, 0x8000
    s_addc_u32 s25, s25, 0
    s_waitcnt vmcnt(8)
    s_mov_b32 m0, s30
    s_add_u32 s30, s30, 1024
    global_load_lds_dwordx4 v27, s[24:25]
    s_add_u32 s24, s24, 0x8000
    s_addc_u32 s25, s25, 0
    s_mov_b32 m0, s30
    s_add_u32 s30, s30, 1024
    global_load_lds_dwordx4 v27, s[24:25]
    s_add_u32 s24, s24, 0x8000
    s_addc_u32 s25, s25, 0
    s_mov_b32 m0, s30
    s_add_u32 s30, s30, 1024
    global_load_lds_dwordx4 v28, s[24:25]
    s_add_u32 s24, s24, 0x8000
    s_addc_u32 s25, s25, 0
    s_mov_b32 m0, s30
    s_add_u32 s30, s30, 1024
    global_load_lds_dwordx4 v28, s[24:25]
    s_add_u32 s24, s24, 0x8000
    s_addc_u32 s25, s25, 0
    s_waitcnt vmcnt(8)
    s_mov_b32 m0, s30
    s_add_u32 s30, s30, 1024
    global_load_lds_dwordx4 v27, s[24:25]
    s_add_u32 s24, s24, 0x8000
    s_addc_u32 s25, s25, 0
    s_mov_b32 m0, s30
    s_add_u32 s30, s30, 1024
    global_load_lds_dwordx4 v27, s[24:25]
    s_add_u32 s24, s24, 0x8000
    s_addc_u32 s25, s25, 0
    s_mov_b32 m0, s30
    s_add_u32 s30, s30, 1024
    global_load_lds_dwordx4 v28, s[24:25]
    s_add_u32 s24, s24, 0x8000
    s_addc_u32 s25, s25, 0
    s_mov_b32 m0, s30
    s_add_u32 s30, s30, 1024
    global_load_lds_dwordx4 v28, s[24:25]
    s_add_u32 s24, s24, 0x8000
    s_addc_u32 s25, s25, 0
    v_lshl_add_u32 v24, v20, 3, v21
    v_and_b32 v25, 1, v20
    v_lshl_add_u32 v25, v25, 2, v21
    v_lshlrev_b32 v24, 8, v24
    v_lshl_add_u32 v24, v22, 3, v24
    s_lshl_b32 s21, s7, 2
    s_add_u32 s22, s21, 0
    v_xor_b32 v26, s22, v25
    v_lshl_add_u32 v8, v26, 5, v24
    v_add_u32 v12, 0x10000, v8
    s_add_u32 s22, s21, 1
    v_xor_b32 v26, s22, v25
    v_lshl_add_u32 v9, v26, 5, v24
    v_add_u32 v13, 0x10000, v9
    s_add_u32 s22, s21, 2
    v_xor_b32 v26, s22, v25
    v_lshl_add_u32 v10, v26, 5, v24
    v_add_u32 v14, 0x10000, v10
    s_add_u32 s22, s21, 3
    v_xor_b32 v26, s22, v25
    v_lshl_add_u32 v11, v26, 5, v24
    v_add_u32 v15, 0x10000, v11
    s_and_b32 s23, s31, 63
    s_lshl_b32 s23, s23, 7
    s_lshr_b32 s22, s31, 6
    s_mov_b32 s21, 0x5202000
    s_cmp_eq_u32 s22, 0
    s_cselect_b32 s21, 0x5200000, s21
    s_cmp_eq_u32 s22, 2
    s_cselect_b32 s21, 0x5206000, s21
    s_add_u32 s21, s21, s23
    s_add_u32 s58, s18, s21
    s_addc_u32 s59, s19, 0
    v_mov_b32 v20, 0
    s_mov_b64 exec, 1
    global_store_dword v20, v20, s[58:59] sc1
    s_mov_b64 exec, -1
    s_add_u32 s21, s23, 0x5208000
    s_cmp_eq_u32 s22, 0
    s_cbranch_scc0 LNK_4
    s_add_u32 s58, s18, s21
    s_addc_u32 s59, s19, 0
    v_mov_b32 v20, 0
    s_mov_b64 exec, 1
    global_store_dword v20, v20, s[58:59] sc1
    s_mov_b64 exec, -1
LNK_4:
    s_waitcnt vmcnt(0)
    s_barrier
    s_cmp_eq_u32 s6, 0
    s_cbranch_scc0 LARR_5
    v_mov_b32 v30, 0
    v_mov_b32 v31, 1
    s_mov_b64 exec, 1
    global_atomic_add v30, v31, s[38:39]
    s_mov_b64 exec, -1
LARR_5:
    ds_read_b64_tr_b16 a[0:1], v8 offset:0
    ds_read_b64_tr_b16 a[2:3], v8 offset:1024
    ds_read_b64_tr_b16 a[4:5], v8 offset:8192
    ds_read_b64_tr_b16 a[6:7], v8 offset:9216
    ds_read_b64_tr_b16 a[8:9], v8 offset:16384
    ds_read_b64_tr_b16 a[10:11], v8 offset:17408
    ds_read_b64_tr_b16 a[12:13], v8 offset:24576
    ds_read_b64_tr_b16 a[14:15], v8 offset:25600
    ds_read_b64_tr_b16 a[16:17], v8 offset:32768
    ds_read_b64_tr_b16 a[18:19], v8 offset:33792
    ds_read_b64_tr_b16 a[20:21], v8 offset:40960
    ds_read_b64_tr_b16 a[22:23], v8 offset:41984
    s_waitcnt lgkmcnt(4)
    ds_read_b64_tr_b16 a[24:25], v8 offset:49152
    ds_read_b64_tr_b16 a[26:27], v8 offset:50176
    ds_read_b64_tr_b16 a[28:29], v8 offset:57344
    ds_read_b64_tr_b16 a[30:31], v8 offset:58368
    ds_read_b64_tr_b16 a[32:33], v12 offset:0
    ds_read_b64_tr_b16 a[34:35], v12 offset:1024
    ds_read_b64_tr_b16 a[36:37], v12 offset:8192
    ds_read_b64_tr_b16 a[38:39], v12 offset:9216
    ds_read_b64_tr_b16 a[40:41], v12 offset:16384
    ds_read_b64_tr_b16 a[42:43], v12 offset:17408
    ds_read_b64_tr_b16 a[44:45], v12 offset:24576
    ds_read_b64_tr_b16 a[46:47], v12 offset:25600
    s_waitcnt lgkmcnt(4)
    ds_read_b64_tr_b16 a[48:49], v12 offset:32768
    ds_read_b64_tr_b16 a[50:51], v12 offset:33792
    ds_read_b64_tr_b16 a[52:53], v12 offset:40960
    ds_read_b64_tr_b16 a[54:55], v12 offset:41984
    ds_read_b64_tr_b16 a[56:57], v12 offset:49152
    ds_read_b64_tr_b16 a[58:59], v12 offset:50176
    ds_read_b64_tr_b16 a[60:61], v12 offset:57344
    ds_read_b64_tr_b16 a[62:63], v12 offset:58368
    s_waitcnt lgkmcnt(0)
    ds_read_b64_tr_b16 a[64:65], v9 offset:0
    ds_read_b64_tr_b16 a[66:67], v9 offset:1024
    ds_read_b64_tr_b16 a[68:69], v9 offset:8192
    ds_read_b64_tr_b16 a[70:71], v9 offset:9216
    ds_read_b64_tr_b16 a[72:73], v9 offset:16384
    ds_read_b64_tr_b16 a[74:75], v9 offset:17408
    ds_read_b64_tr_b16 a[76:77], v9 offset:24576
    ds_read_b64_tr_b16 a[78:79], v9 offset:25600
    ds_read_b64_tr_b16 a[80:81], v9 offset:32768
    ds_read_b64_tr_b16 a[82:83], v9 offset:33792
    ds_read_b64_tr_b16 a[84:85], v9 offset:40960
    ds_read_b64_tr_b16 a[86:87], v9 offset:41984
    s_waitcnt lgkmcnt(4)
    ds_read_b64_tr_b16 a[88:89], v9 offset:49152
    ds_read_b64_tr_b16 a[90:91], v9 offset:50176
    ds_read_b64_tr_b16 a[92:93], v9 offset:57344
    ds_read_b64_tr_b16 a[94:95], v9 offset:58368
    ds_read_b64_tr_b16 a[96:97], v13 offset:0
    ds_read_b64_tr_b16 a[98:99], v13 offset:1024
    ds_read_b64_tr_b16 a[100:101], v13 offset:8192
    ds_read_b64_tr_b16 a[102:103], v13 offset:9216
    ds_read_b64_tr_b16 a[104:105], v13 offset:16384
    ds_read_b64_tr_b16 a[106:107], v13 offset:17408
    ds_read_b64_tr_b16 a[108:109], v13 offset:24576
    ds_read_b64_tr_b16 a[110:111], v13 offset:25600
    s_waitcnt lgkmcnt(4)
    ds_read_b64_tr_b16 a[112:113], v13 offset:32768
    ds_read_b64_tr_b16 a[114:115], v13 offset:33792
    ds_read_b64_tr_b16 a[116:117], v13 offset:40960
    ds_read_b64_tr_b16 a[118:119], v13 offset:41984
    ds_read_b64_tr_b16 a[120:121], v13 offset:49152
    ds_read_b64_tr_b16 a[122:123], v13 offset:50176
    ds_read_b64_tr_b16 a[124:125], v13 offset:57344
    ds_read_b64_tr_b16 a[126:127], v13 offset:58368
    s_waitcnt lgkmcnt(0)
    ds_read_b64_tr_b16 a[128:129], v10 offset:0
    ds_read_b64_tr_b16 a[130:131], v10 offset:1024
    ds_read_b64_tr_b16 a[132:133], v10 offset:8192
    ds_read_b64_tr_b16 a[134:135], v10 offset:9216
    ds_read_b64_tr_b16 a[136:137], v10 offset:16384
    ds_read_b64_tr_b16 a[138:139], v10 offset:17408
    ds_read_b64_tr_b16 a[140:141], v10 offset:24576
    ds_read_b64_tr_b16 a[142:143], v10 offset:25600
    ds_read_b64_tr_b16 a[144:145], v10 offset:32768
    ds_read_b64_tr_b16 a[146:147], v10 offset:33792
    ds_read_b64_tr_b16 a[148:149], v10 offset:40960
    ds_read_b64_tr_b16 a[150:151], v10 offset:41984
    s_waitcnt lgkmcnt(4)
    ds_read_b64_tr_b16 a[152:153], v10 offset:49152
    ds_read_b64_tr_b16 a[154:155], v10 offset:50176
    ds_read_b64_tr_b16 a[156:157], v10 offset:57344
    ds_read_b64_tr_b16 a[158:159], v10 offset:58368
    ds_read_b64_tr_b16 a[160:161], v14 offset:0
    ds_read_b64_tr_b16 a[162:163], v14 offset:1024
    ds_read_b64_tr_b16 a[164:165], v14 offset:8192
    ds_read_b64_tr_b16 a[166:167], v14 offset:9216
    ds_read_b64_tr_b16 a[168:169], v14 offset:16384
    ds_read_b64_tr_b16 a[170:171], v14 offset:17408
    ds_read_b64_tr_b16 a[172:173], v14 offset:24576
    ds_read_b64_tr_b16 a[174:175], v14 offset:25600
    s_waitcnt lgkmcnt(4)
    ds_read_b64_tr_b16 a[176:177], v14 offset:32768
    ds_read_b64_tr_b16 a[178:179], v14 offset:33792
    ds_read_b64_tr_b16 a[180:181], v14 offset:40960
    ds_read_b64_tr_b16 a[182:183], v14 offset:41984
    ds_read_b64_tr_b16 a[184:185], v14 offset:49152
    ds_read_b64_tr_b16 a[186:187], v14 offset:50176
    ds_read_b64_tr_b16 a[188:189], v14 offset:57344
    ds_read_b64_tr_b16 a[190:191], v14 offset:58368
    s_waitcnt lgkmcnt(0)
    ds_read_b64_tr_b16 a[192:193], v11 offset:0
    ds_read_b64_tr_b16 a[194:195], v11 offset:1024
    ds_read_b64_tr_b16 a[196:197], v11 offset:8192
    ds_read_b64_tr_b16 a[198:199], v11 offset:9216
    ds_read_b64_tr_b16 a[200:201], v11 offset:16384
    ds_read_b64_tr_b16 a[202:203], v11 offset:17408
    ds_read_b64_tr_b16 a[204:205], v11 offset:24576
    ds_read_b64_tr_b16 a[206:207], v11 offset:25600
    ds_read_b64_tr_b16 a[208:209], v11 offset:32768
    ds_read_b64_tr_b16 a[210:211], v11 offset:33792
    ds_read_b64_tr_b16 a[212:213], v11 offset:40960
    ds_read_b64_tr_b16 a[214:215], v11 offset:41984
    s_waitcnt lgkmcnt(4)
    ds_read_b64_tr_b16 a[216:217], v11 offset:49152
    ds_read_b64_tr_b16 a[218:219], v11 offset:50176
    ds_read_b64_tr_b16 a[220:221], v11 offset:57344
    ds_read_b64_tr_b16 a[222:223], v11 offset:58368
    ds_read_b64_tr_b16 a[224:225], v15 offset:0
    ds_read_b64_tr_b16 a[226:227], v15 offset:1024
    ds_read_b64_tr_b16 a[228:229], v15 offset:8192
    ds_read_b64_tr_b16 a[230:231], v15 offset:9216
    ds_read_b64_tr_b16 a[232:233], v15 offset:16384
    ds_read_b64_tr_b16 a[234:235], v15 offset:17408
    ds_read_b64_tr_b16 a[236:237], v15 offset:24576
    ds_read_b64_tr_b16 a[238:239], v15 offset:25600
    s_waitcnt lgkmcnt(4)
    ds_read_b64_tr_b16 a[240:241], v15 offset:32768
    ds_read_b64_tr_b16 a[242:243], v15 offset:33792
    ds_read_b64_tr_b16 a[244:245], v15 offset:40960
    ds_read_b64_tr_b16 a[246:247], v15 offset:41984
    ds_read_b64_tr_b16 a[248:249], v15 offset:49152
    ds_read_b64_tr_b16 a[250:251], v15 offset:50176
    ds_read_b64_tr_b16 a[252:253], v15 offset:57344
    ds_read_b64_tr_b16 a[254:255], v15 offset:58368
    s_waitcnt lgkmcnt(0)
    s_barrier
    v_lshlrev_b32 v1, 4, v0
    v_lshrrev_b32 v20, 3, v0
    v_and_b32 v21, 7, v0
    v_and_b32 v22, 6, v20
    v_xor_b32 v21, v21, v22
    v_lshlrev_b32 v21, 4, v21
    v_lshl_add_u32 v2, v20, 10, v21
    v_and_b32 v20, 15, v0
    v_lshrrev_b32 v21, 3, v20
    v_lshlrev_b32 v21, 13, v21
    v_and_b32 v22, 7, v20
    v_and_b32 v23, 6, v22
    v_lshrrev_b32 v24, 4, v0
    v_xor_b32 v23, v24, v23
    v_lshl_add_u32 v23, v22, 3, v23
    v_lshl_add_u32 v21, v23, 4, v21
    s_lshl_b32 s21, s3, 15
    v_add_u32 v4, s21, v21
    v_xor_b32 v5, 64, v4
    v_add_u32 v6, 0x10000, v4
    v_add_u32 v7, 0x10000, v5
    s_mov_b32 s26, s34
    s_mov_b32 s27, s35
    s_lshl_b32 s21, s4, 6
    s_add_u32 s21, s21, s3
    s_lshl_b32 s21, s21, 5
    s_add_u32 s21, s21, s5
    s_lshl_b32 s21, s21, 13
    s_add_u32 s21, s21, 0x0
    s_add_u32 s12, s18, s21
    s_addc_u32 s13, s19, 0
    s_lshl_b32 s21, s7, 11
    v_add_u32 v16, s21, v1
    v_add_u32 v17, 0x1000, v16
    s_lshl_b32 s21, s4, 5
    s_add_u32 s21, s21, s5
    s_lshl_b32 s21, s21, 7
    s_add_u32 s21, s21, 0x5200000
    s_add_u32 s14, s18, s21
    s_addc_u32 s15, s19, 0
    s_mov_b32 s20, 0
    s_lshl_b32 s21, s6, 14
    s_add_u32 s21, s21, 0
    s_add_u32 s24, s26, s21
    s_addc_u32 s25, s27, 0
    s_add_u32 s30, s21, 0
    s_add_u32 m0, s30, 0
    s_nop 0
    global_load_lds_dwordx4 v2, s[24:25] offset:0
    s_add_u32 m0, s30, 896
    s_nop 0
    global_load_lds_dwordx4 v2, s[24:25] offset:128
    s_add_u32 m0, s30, 1792
    s_nop 0
    global_load_lds_dwordx4 v2, s[24:25] offset:256
    s_add_u32 m0, s30, 2688
    s_nop 0
    global_load_lds_dwordx4 v2, s[24:25] offset:384
    s_add_u32 m0, s30, 3584
    s_nop 0
    global_load_lds_dwordx4 v2, s[24:25] offset:512
    s_add_u32 m0, s30, 4480
    s_nop 0
    global_load_lds_dwordx4 v2, s[24:25] offset:640
    s_add_u32 m0, s30, 5376
    s_nop 0
    global_load_lds_dwordx4 v2, s[24:25] offset:768
    s_add_u32 m0, s30, 6272
    s_nop 0
    global_load_lds_dwordx4 v2, s[24:25] offset:896
    s_lshl_b32 s21, s6, 14
    s_add_u32 s21, s21, 8192
    s_add_u32 s24, s26, s21
    s_addc_u32 s25, s27, 0
    s_add_u32 s30, s21, 0
    s_add_u32 m0, s30, 0
    s_nop 0
    global_load_lds_dwordx4 v2, s[24:25] offset:0
    s_add_u32 m0, s30, 896
    s_nop 0
    global_load_lds_dwordx4 v2, s[24:25] offset:128
    s_add_u32 m0, s30, 1792
    s_nop 0
    global_load_lds_dwordx4 v2, s[24:25] offset:256
    s_add_u32 m0, s30, 2688
    s_nop 0
    global_load_lds_dwordx4 v2, s[24:25] offset:384
    s_add_u32 m0, s30, 3584
    s_nop 0
    global_load_lds_dwordx4 v2, s[24:25] offset:512
    s_add_u32 m0, s30, 4480
    s_nop 0
    global_load_lds_dwordx4 v2, s[24:25] offset:640
    s_add_u32 m0, s30, 5376
    s_nop 0
    global_load_lds_dwordx4 v2, s[24:25] offset:768
    s_add_u32 m0, s30, 6272
    s_nop 0
    global_load_lds_dwordx4 v2, s[24:25] offset:896
    s_waitcnt vmcnt(0)
L_K_loop:
    s_waitcnt vmcnt(4)
    s_barrier
    s_sub_u32 s23, s20, 1
    s_cmp_ge_i32 s23, 4
    s_cbranch_scc0 LNP_6
    s_cmp_eq_u32 s6, 0
    s_cbranch_scc0 LPUB_7
    v_mov_b32 v8, s23
    v_mov_b32 v9, 0
    s_mov_b64 exec, 1
    global_store_dword v9, v8, s[14:15] sc1
    s_mov_b64 exec, -1
LPUB_7:
LNP_6:
    s_add_u32 s26, s26, 0x10000
    s_addc_u32 s27, s27, 0
    s_add_u32 s23, s20, 1
    s_cmp_lt_u32 s23, 32
    s_cbranch_scc0 LND_8
    ds_read_b128 v[96:99], v4 offset:0
    ds_read_b128 v[100:103], v4 offset:16384
    ds_read_b128 v[104:107], v5 offset:0
    ds_read_b128 v[108:111], v5 offset:16384
    s_waitcnt lgkmcnt(2)
    v_mfma_f32_16x16x32_bf16 v[128:131], a[0:3], v[96:99], 0
    v_mfma_f32_16x16x32_bf16 v[136:139], a[64:67], v[96:99], 0
    s_lshl_b32 s21, s6, 14
    s_add_u32 s21, s21, 0
    s_add_u32 s24, s26, s21
    s_addc_u32 s25, s27, 0
    s_add_u32 s30, s21, 65536
    s_add_u32 m0, s30, 0
    s_nop 0
    global_load_lds_dwordx4 v2, s[24:25] offset:0
    v_mfma_f32_16x16x32_bf16 v[144:147], a[128:131], v[96:99], 0
    v_mfma_f32_16x16x32_bf16 v[152:155], a[192:195], v[96:99], 0
    v_mfma_f32_16x16x32_bf16 v[132:135], a[0:3], v[100:103], 0
    v_mfma_f32_16x16x32_bf16 v[140:143], a[64:67], v[100:103], 0
    v_mfma_f32_16x16x32_bf16 v[148:151], a[128:131], v[100:103], 0
    v_mfma_f32_16x16x32_bf16 v[156:159], a[192:195], v[100:103], 0
    ds_read_b128 v[96:99], v4 offset:1024
    ds_read_b128 v[100:103], v4 offset:17408
    s_waitcnt lgkmcnt(2)
    v_mfma_f32_16x16x32_bf16 v[128:131], a[4:7], v[104:107], v[128:131]
    v_mfma_f32_16x16x32_bf16 v[136:139], a[68:71], v[104:107], v[136:139]
    s_add_u32 m0, s30, 896
    s_nop 0
    global_load_lds_dwordx4 v2, s[24:25] offset:128
    v_mfma_f32_16x16x32_bf16 v[144:147], a[132:135], v[104:107], v[144:147]
    v_mfma_f32_16x16x32_bf16 v[152:155], a[196:199], v[104:107], v[152:155]
    v_mfma_f32_16x16x32_bf16 v[132:135], a[4:7], v[108:111], v[132:135]
    v_mfma_f32_16x16x32_bf16 v[140:143], a[68:71], v[108:111], v[140:143]
    v_mfma_f32_16x16x32_bf16 v[148:151], a[132:135], v[108:111], v[148:151]
    v_mfma_f32_16x16x32_bf16 v[156:159], a[196:199], v[108:111], v[156:159]
    ds_read_b128 v[104:107], v5 offset:1024
    ds_read_b128 v[108:111], v5 offset:17408
    s_waitcnt lgkmcnt(2)
    v_mfma_f32_16x16x32_bf16 v[128:131], a[8:11], v[96:99], v[128:131]
    v_mfma_f32_16x16x32_bf16 v[136:139], a[72:75], v[96:99], v[136:139]
    s_add_u32 m0, s30, 1792
    s_nop 0
    global_load_lds_dwordx4 v2, s[24:25] offset:256
    v_mfma_f32_16x16x32_bf16 v[144:147], a[136:139], v[96:99], v[144:147]
    v_mfma_f32_16x16x32_bf16 v[152:155], a[200:203], v[96:99], v[152:155]
    v_mfma_f32_16x16x32_bf16 v[132:135], a[8:11], v[100:103], v[132:135]
    v_mfma_f32_16x16x32_bf16 v[140:143], a[72:75], v[100:103], v[140:143]
    v_mfma_f32_16x16x32_bf16 v[148:151], a[136:139], v[100:103], v[148:151]
    v_mfma_f32_16x16x32_bf16 v[156:159], a[200:203], v[100:103], v[156:159]
    ds_read_b128 v[96:99], v4 offset:2048
    ds_read_b128 v[100:103], v4 offset:18432
    s_waitcnt lgkmcnt(2)
    v_mfma_f32_16x16x32_bf16 v[128:131], a[12:15], v[104:107], v[128:131]
    v_mfma_f32_16x16x32_bf16 v[136:139], a[76:79], v[104:107], v[136:139]
    s_add_u32 m0, s30, 2688
    s_nop 0
    global_load_lds_dwordx4 v2, s[24:25] offset:384
    v_mfma_f32_16x16x32_bf16 v[144:147], a[140:143], v[104:107], v[144:147]
    v_mfma_f32_16x16x32_bf16 v[152:155], a[204:207], v[104:107], v[152:155]
    v_mfma_f32_16x16x32_bf16 v[132:135], a[12:15], v[108:111], v[132:135]
    v_mfma_f32_16x16x32_bf16 v[140:143], a[76:79], v[108:111], v[140:143]
    v_mfma_f32_16x16x32_bf16 v[148:151], a[140:143], v[108:111], v[148:151]
    v_mfma_f32_16x16x32_bf16 v[156:159], a[204:207], v[108:111], v[156:159]
    ds_read_b128 v[104:107], v5 offset:2048
    ds_read_b128 v[108:111], v5 offset:18432
    s_waitcnt lgkmcnt(2)
    v_mfma_f32_16x16x32_bf16 v[128:131], a[16:19], v[96:99], v[128:131]
    v_mfma_f32_16x16x32_bf16 v[136:139], a[80:83], v[96:99], v[136:139]
    s_add_u32 m0, s30, 3584
    s_nop 0
    global_load_lds_dwordx4 v2, s[24:25] offset:512
    v_mfma_f32_16x16x32_bf16 v[144:147], a[144:147], v[96:99], v[144:147]
    v_mfma_f32_16x16x32_bf16 v[152:155], a[208:211], v[96:99], v[152:155]
    v_mfma_f32_16x16x32_bf16 v[132:135], a[16:19], v[100:103], v[132:135]
    v_mfma_f32_16x16x32_bf16 v[140:143], a[80:83], v[100:103], v[140:143]
    v_mfma_f32_16x16x32_bf16 v[148:151], a[144:147], v[100:103], v[148:151]
    v_mfma_f32_16x16x32_bf16 v[156:159], a[208:211], v[100:103], v[156:159]
    ds_read_b128 v[96:99], v4 offset:3072
    ds_read_b128 v[100:103], v4 offset:19456
    s_waitcnt lgkmcnt(2)
    v_mfma_f32_16x16x32_bf16 v[128:131], a[20:23], v[104:107], v[128:131]
    v_mfma_f32_16x16x32_bf16 v[136:139], a[84:87], v[104:107], v[136:139]
    s_add_u32 m0, s30, 4480
    s_nop 0
    global_load_lds_dwordx4 v2, s[24:25] offset:640
    v_mfma_f32_16x16x32_bf16 v[144:147], a[148:151], v[104:107], v[144:147]
    v_mfma_f32_16x16x32_bf16 v[152:155], a[212:215], v[104:107], v[152:155]
    v_mfma_f32_16x16x32_bf16 v[132:135], a[20:23], v[108:111], v[132:135]
    v_mfma_f32_16x16x32_bf16 v[140:143], a[84:87], v[108:111], v[140:143]
    v_mfma_f32_16x16x32_bf16 v[148:151], a[148:151], v[108:111], v[148:151]
    v_mfma_f32_16x16x32_bf16 v[156:159], a[212:215], v[108:111], v[156:159]
    ds_read_b128 v[104:107], v5 offset:3072
    ds_read_b128 v[108:111], v5 offset:19456
    s_waitcnt lgkmcnt(2)
    v_mfma_f32_16x16x32_bf16 v[128:131], a[24:27], v[96:99], v[128:131]
    v_mfma_f32_16x16x32_bf16 v[136:139], a[88:91], v[96:99], v[136:139]
    s_add_u32 m0, s30, 5376
    s_nop 0
    global_load_lds_dwordx4 v2, s[24:25] offset:768
    v_mfma_f32_16x16x32_bf16 v[144:147], a[152:155], v[96:99], v[144:147]
    v_mfma_f32_16x16x32_bf16 v[152:155], a[216:219], v[96:99], v[152:155]
    v_mfma_f32_16x16x32_bf16 v[132:135], a[24:27], v[100:103], v[132:135]
    v_mfma_f32_16x16x32_bf16 v[140:143], a[88:91], v[100:103], v[140:143]
    v_mfma_f32_16x16x32_bf16 v[148:151], a[152:155], v[100:103], v[148:151]
    v_mfma_f32_16x16x32_bf16 v[156:159], a[216:219], v[100:103], v[156:159]
    ds_read_b128 v[96:99], v4 offset:4096
    ds_read_b128 v[100:103], v4 offset:20480
    s_waitcnt lgkmcnt(2)
    v_mfma_f32_16x16x32_bf16 v[128:131], a[28:31], v[104:107], v[128:131]
    v_mfma_f32_16x16x32_bf16 v[136:139], a[92:95], v[104:107], v[136:139]
    s_add_u32 m0, s30, 6272
    s_nop 0
    global_load_lds_dwordx4 v2, s[24:25] offset:896
    v_mfma_f32_16x16x32_bf16 v[144:147], a[156:159], v[104:107], v[144:147]
    v_mfma_f32_16x16x32_bf16 v[152:155], a[220:223], v[104:107], v[152:155]
    v_mfma_f32_16x16x32_bf16 v[132:135], a[28:31], v[108:111], v[132:135]
    v_mfma_f32_16x16x32_bf16 v[140:143], a[92:95], v[108:111], v[140:143]
    v_mfma_f32_16x16x32_bf16 v[148:151], a[156:159], v[108:111], v[148:151]
    v_mfma_f32_16x16x32_bf16 v[156:159], a[220:223], v[108:111], v[156:159]
    ds_read_b128 v[104:107], v5 offset:4096
    ds_read_b128 v[108:111], v5 offset:20480
    s_waitcnt lgkmcnt(2)
    v_mfma_f32_16x16x32_bf16 v[128:131], a[32:35], v[96:99], v[128:131]
    v_mfma_f32_16x16x32_bf16 v[136:139], a[96:99], v[96:99], v[136:139]
    s_lshl_b32 s21, s6, 14
    s_add_u32 s21, s21, 8192
    s_add_u32 s24, s26, s21
    s_addc_u32 s25, s27, 0
    s_add_u32 s30, s21, 65536
    s_add_u32 m0, s30, 0
    s_nop 0
    global_load_lds_dwordx4 v2, s[24:25] offset:0
    v_mfma_f32_16x16x32_bf16 v[144:147], a[160:163], v[96:99], v[144:147]
    v_mfma_f32_16x16x32_bf16 v[152:155], a[224:227], v[96:99], v[152:155]
    v_mfma_f32_16x16x32_bf16 v[132:135], a[32:35], v[100:103], v[132:135]
    v_mfma_f32_16x16x32_bf16 v[140:143], a[96:99], v[100:103], v[140:143]
    v_mfma_f32_16x16x32_bf16 v[148:151], a[160:163], v[100:103], v[148:151]
    v_mfma_f32_16x16x32_bf16 v[156:159], a[224:227], v[100:103], v[156:159]
    ds_read_b128 v[96:99], v4 offset:5120
    ds_read_b128 v[100:103], v4 offset:21504
    s_waitcnt lgkmcnt(2)
    v_mfma_f32_16x16x32_bf16 v[128:131], a[36:39], v[104:107], v[128:131]
    v_mfma_f32_16x16x32_bf16 v[136:139], a[100:103], v[104:107], v[136:139]
    s_add_u32 m0, s30, 896
    s_nop 0
    global_load_lds_dwordx4 v2, s[24:25] offset:128
    v_mfma_f32_16x16x32_bf16 v[144:147], a[164:167], v[104:107], v[144:147]
    v_mfma_f32_16x16x32_bf16 v[152:155], a[228:231], v[104:107], v[152:155]
    v_mfma_f32_16x16x32_bf16 v[132:135], a[36:39], v[108:111], v[132:135]
    v_mfma_f32_16x16x32_bf16 v[140:143], a[100:103], v[108:111], v[140:143]
    v_mfma_f32_16x16x32_bf16 v[148:151], a[164:167], v[108:111], v[148:151]
    v_mfma_f32_16x16x32_bf16 v[156:159], a[228:231], v[108:111], v[156:159]
    ds_read_b128 v[104:107], v5 offset:5120
    ds_read_b128 v[108:111], v5 offset:21504
    s_waitcnt lgkmcnt(2)
    v_mfma_f32_16x16x32_bf16 v[128:131], a[40:43], v[96:99], v[128:131]
    v_mfma_f32_16x16x32_bf16 v[136:139], a[104:107], v[96:99], v[136:139]
    s_add_u32 m0, s30, 1792
    s_nop 0
    global_load_lds_dwordx4 v2, s[24:25] offset:256
    v_mfma_f32_16x16x32_bf16 v[144:147], a[168:171], v[96:99], v[144:147]
    v_mfma_f32_16x16x32_bf16 v[152:155], a[232:235], v[96:99], v[152:155]
    v_mfma_f32_16x16x32_bf16 v[132:135], a[40:43], v[100:103], v[132:135]
    v_mfma_f32_16x16x32_bf16 v[140:143], a[104:107], v[100:103], v[140:143]
    v_mfma_f32_16x16x32_bf16 v[148:151], a[168:171], v[100:103], v[148:151]
    v_mfma_f32_16x16x32_bf16 v[156:159], a[232:235], v[100:103], v[156:159]
    ds_read_b128 v[96:99], v4 offset:6144
    ds_read_b128 v[100:103], v4 offset:22528
    s_waitcnt lgkmcnt(2)
    v_mfma_f32_16x16x32_bf16 v[128:131], a[44:47], v[104:107], v[128:131]
    v_mfma_f32_16x16x32_bf16 v[136:139], a[108:111], v[104:107], v[136:139]
    s_add_u32 m0, s30, 2688
    s_nop 0
    global_load_lds_dwordx4 v2, s[24:25] offset:384
    v_mfma_f32_16x16x32_bf16 v[144:147], a[172:175], v[104:107], v[144:147]
    v_mfma_f32_16x16x32_bf16 v[152:155], a[236:239], v[104:107], v[152:155]
    v_mfma_f32_16x16x32_bf16 v[132:135], a[44:47], v[108:111], v[132:135]
    v_mfma_f32_16x16x32_bf16 v[140:143], a[108:111], v[108:111], v[140:143]
    v_mfma_f32_16x16x32_bf16 v[148:151], a[172:175], v[108:111], v[148:151]
    v_mfma_f32_16x16x32_bf16 v[156:159], a[236:239], v[108:111], v[156:159]
    ds_read_b128 v[104:107], v5 offset:6144
    ds_read_b128 v[108:111], v5 offset:22528
    s_waitcnt lgkmcnt(2)
    v_mfma_f32_16x16x32_bf16 v[128:131], a[48:51], v[96:99], v[128:131]
    v_mfma_f32_16x16x32_bf16 v[136:139], a[112:115], v[96:99], v[136:139]
    s_add_u32 m0, s30, 3584
    s_nop 0
    global_load_lds_dwordx4 v2, s[24:25] offset:512
    v_mfma_f32_16x16x32_bf16 v[144:147], a[176:179], v[96:99], v[144:147]
    v_mfma_f32_16x16x32_bf16 v[152:155], a[240:243], v[96:99], v[152:155]
    v_mfma_f32_16x16x32_bf16 v[132:135], a[48:51], v[100:103], v[132:135]
    v_mfma_f32_16x16x32_bf16 v[140:143], a[112:115], v[100:103], v[140:143]
    v_mfma_f32_16x16x32_bf16 v[148:151], a[176:179], v[100:103], v[148:151]
    v_mfma_f32_16x16x32_bf16 v[156:159], a[240:243], v[100:103], v[156:159]
    ds_read_b128 v[96:99], v4 offset:7168
    ds_read_b128 v[100:103], v4 offset:23552
    s_waitcnt lgkmcnt(2)
    v_mfma_f32_16x16x32_bf16 v[128:131], a[52:55], v[104:107], v[128:131]
    v_mfma_f32_16x16x32_bf16 v[136:139], a[116:119], v[104:107], v[136:139]
    s_add_u32 m0, s30, 4480
    s_nop 0
    global_load_lds_dwordx4 v2, s[24:25] offset:640
    v_mfma_f32_16x16x32_bf16 v[144:147], a[180:183], v[104:107], v[144:147]
    v_mfma_f32_16x16x32_bf16 v[152:155], a[244:247], v[104:107], v[152:155]
    v_mfma_f32_16x16x32_bf16 v[132:135], a[52:55], v[108:111], v[132:135]
    v_mfma_f32_16x16x32_bf16 v[140:143], a[116:119], v[108:111], v[140:143]
    v_mfma_f32_16x16x32_bf16 v[148:151], a[180:183], v[108:111], v[148:151]
    v_mfma_f32_16x16x32_bf16 v[156:159], a[244:247], v[108:111], v[156:159]
    ds_read_b128 v[104:107], v5 offset:7168
    ds_read_b128 v[108:111], v5 offset:23552
    s_waitcnt lgkmcnt(2)
    v_mfma_f32_16x16x32_bf16 v[128:131], a[56:59], v[96:99], v[128:131]
    v_mfma_f32_16x16x32_bf16 v[136:139], a[120:123], v[96:99], v[136:139]
    s_add_u32 m0, s30, 5376
    s_nop 0
    global_load_lds_dwordx4 v2, s[24:25] offset:768
    v_mfma_f32_16x16x32_bf16 v[144:147], a[184:187], v[96:99], v[144:147]
    v_mfma_f32_16x16x32_bf16 v[152:155], a[248:251], v[96:99], v[152:155]
    v_mfma_f32_16x16x32_bf16 v[132:135], a[56:59], v[100:103], v[132:135]
    v_mfma_f32_16x16x32_bf16 v[140:143], a[120:123], v[100:103], v[140:143]
    v_mfma_f32_16x16x32_bf16 v[148:151], a[184:187], v[100:103], v[148:151]
    v_mfma_f32_16x16x32_bf16 v[156:159], a[248:251], v[100:103], v[156:159]
    s_waitcnt lgkmcnt(0)
    v_mfma_f32_16x16x32_bf16 v[128:131], a[60:63], v[104:107], v[128:131]
    v_mfma_f32_16x16x32_bf16 v[136:139], a[124:127], v[104:107], v[136:139]
    s_add_u32 m0, s30, 6272
    s_nop 0
    global_load_lds_dwordx4 v2, s[24:25] offset:896
    v_mfma_f32_16x16x32_bf16 v[144:147], a[188:191], v[104:107], v[144:147]
    v_mfma_f32_16x16x32_bf16 v[152:155], a[252:255], v[104:107], v[152:155]
    v_mfma_f32_16x16x32_bf16 v[132:135], a[60:63], v[108:111], v[132:135]
    v_mfma_f32_16x16x32_bf16 v[140:143], a[124:127], v[108:111], v[140:143]
    v_mfma_f32_16x16x32_bf16 v[148:151], a[188:191], v[108:111], v[148:151]
    v_mfma_f32_16x16x32_bf16 v[156:159], a[252:255], v[108:111], v[156:159]
    s_branch LJ_9
LND_8:
    ds_read_b128 v[96:99], v4 offset:0
    ds_read_b128 v[100:103], v4 offset:16384
    ds_read_b128 v[104:107], v5 offset:0
    ds_read_b128 v[108:111], v5 offset:16384
    s_waitcnt lgkmcnt(2)
    v_mfma_f32_16x16x32_bf16 v[128:131], a[0:3], v[96:99], 0
    v_mfma_f32_16x16x32_bf16 v[136:139], a[64:67], v[96:99], 0
    v_mfma_f32_16x16x32_bf16 v[144:147], a[128:131], v[96:99], 0
    v_mfma_f32_16x16x32_bf16 v[152:155], a[192:195], v[96:99], 0
    v_mfma_f32_16x16x32_bf16 v[132:135], a[0:3], v[100:103], 0
    v_mfma_f32_16x16x32_bf16 v[140:143], a[64:67], v[100:103], 0
    v_mfma_f32_16x16x32_bf16 v[148:151], a[128:131], v[100:103], 0
    v_mfma_f32_16x16x32_bf16 v[156:159], a[192:195], v[100:103], 0
    ds_read_b128 v[96:99], v4 offset:1024
    ds_read_b128 v[100:103], v4 offset:17408
    s_waitcnt lgkmcnt(2)
    v_mfma_f32_16x16x32_bf16 v[128:131], a[4:7], v[104:107], v[128:131]
    v_mfma_f32_16x16x32_bf16 v[136:139], a[68:71], v[104:107], v[136:139]
    v_mfma_f32_16x16x32_bf16 v[144:147], a[132:135], v[104:107], v[144:147]
    v_mfma_f32_16x16x32_bf16 v[152:155], a[196:199], v[104:107], v[152:155]
    v_mfma_f32_16x16x32_bf16 v[132:135], a[4:7], v[108:111], v[132:135]
    v_mfma_f32_16x16x32_bf16 v[140:143], a[68:71], v[108:111], v[140:143]
    v_mfma_f32_16x16x32_bf16 v[148:151], a[132:135], v[108:111], v[148:151]
    v_mfma_f32_16x16x32_bf16 v[156:159], a[196:199], v[108:111], v[156:159]
    ds_read_b128 v[104:107], v5 offset:1024
    ds_read_b128 v[108:111], v5 offset:17408
    s_waitcnt lgkmcnt(2)
    v_mfma_f32_16x16x32_bf16 v[128:131], a[8:11], v[96:99], v[128:131]
    v_mfma_f32_16x16x32_bf16 v[136:139], a[72:75], v[96:99], v[136:139]
    v_mfma_f32_16x16x32_bf16 v[144:147], a[136:139], v[96:99], v[144:147]
    v_mfma_f32_16x16x32_bf16 v[152:155], a[200:203], v[96:99], v[152:155]
    v_mfma_f32_16x16x32_bf16 v[132:135], a[8:11], v[100:103], v[132:135]
    v_mfma_f32_16x16x32_bf16 v[140:143], a[72:75], v[100:103], v[140:143]
    v_mfma_f32_16x16x32_bf16 v[148:151], a[136:139], v[100:103], v[148:151]
    v_mfma_f32_16x16x32_bf16 v[156:159], a[200:203], v[100:103], v[156:159]
    ds_read_b128 v[96:99], v4 offset:2048
    ds_read_b128 v[100:103], v4 offset:18432
    s_waitcnt lgkmcnt(2)
    v_mfma_f32_16x16x32_bf16 v[128:131], a[12:15], v[104:107], v[128:131]
    v_mfma_f32_16x16x32_bf16 v[136:139], a[76:79], v[104:107], v[136:139]
    v_mfma_f32_16x16x32_bf16 v[144:147], a[140:143], v[104:107], v[144:147]
    v_mfma_f32_16x16x32_bf16 v[152:155], a[204:207], v[104:107], v[152:155]
    v_mfma_f32_16x16x32_bf16 v[132:135], a[12:15], v[108:111], v[132:135]
    v_mfma_f32_16x16x32_bf16 v[140:143], a[76:79], v[108:111], v[140:143]
    v_mfma_f32_16x16x32_bf16 v[148:151], a[140:143], v[108:111], v[148:151]
    v_mfma_f32_16x16x32_bf16 v[156:159], a[204:207], v[108:111], v[156:159]
    ds_read_b128 v[104:107], v5 offset:2048
    ds_read_b128 v[108:111], v5 offset:18432
    s_waitcnt lgkmcnt(2)
    v_mfma_f32_16x16x32_bf16 v[128:131], a[16:19], v[96:99], v[128:131]
    v_mfma_f32_16x16x32_bf16 v[136:139], a[80:83], v[96:99], v[136:139]
    v_mfma_f32_16x16x32_bf16 v[144:147], a[144:147], v[96:99], v[144:147]
    v_mfma_f32_16x16x32_bf16 v[152:155], a[208:211], v[96:99], v[152:155]
    v_mfma_f32_16x16x32_bf16 v[132:135], a[16:19], v[100:103], v[132:135]
    v_mfma_f32_16x16x32_bf16 v[140:143], a[80:83], v[100:103], v[140:143]
    v_mfma_f32_16x16x32_bf16 v[148:151], a[144:147], v[100:103], v[148:151]
    v_mfma_f32_16x16x32_bf16 v[156:159], a[208:211], v[100:103], v[156:159]
    ds_read_b128 v[96:99], v4 offset:3072
    ds_read_b128 v[100:103], v4 offset:19456
    s_waitcnt lgkmcnt(2)
    v_mfma_f32_16x16x32_bf16 v[128:131], a[20:23], v[104:107], v[128:131]
    v_mfma_f32_16x16x32_bf16 v[136:139], a[84:87], v[104:107], v[136:139]
    v_mfma_f32_16x16x32_bf16 v[144:147], a[148:151], v[104:107], v[144:147]
    v_mfma_f32_16x16x32_bf16 v[152:155], a[212:215], v[104:107], v[152:155]
    v_mfma_f32_16x16x32_bf16 v[132:135], a[20:23], v[108:111], v[132:135]
    v_mfma_f32_16x16x32_bf16 v[140:143], a[84:87], v[108:111], v[140:143]
    v_mfma_f32_16x16x32_bf16 v[148:151], a[148:151], v[108:111], v[148:151]
    v_mfma_f32_16x16x32_bf16 v[156:159], a[212:215], v[108:111], v[156:159]
    ds_read_b128 v[104:107], v5 offset:3072
    ds_read_b128 v[108:111], v5 offset:19456
    s_waitcnt lgkmcnt(2)
    v_mfma_f32_16x16x32_bf16 v[128:131], a[24:27], v[96:99], v[128:131]
    v_mfma_f32_16x16x32_bf16 v[136:139], a[88:91], v[96:99], v[136:139]
    v_mfma_f32_16x16x32_bf16 v[144:147], a[152:155], v[96:99], v[144:147]
    v_mfma_f32_16x16x32_bf16 v[152:155], a[216:219], v[96:99], v[152:155]
    v_mfma_f32_16x16x32_bf16 v[132:135], a[24:27], v[100:103], v[132:135]
    v_mfma_f32_16x16x32_bf16 v[140:143], a[88:91], v[100:103], v[140:143]
    v_mfma_f32_16x16x32_bf16 v[148:151], a[152:155], v[100:103], v[148:151]
    v_mfma_f32_16x16x32_bf16 v[156:159], a[216:219], v[100:103], v[156:159]
    ds_read_b128 v[96:99], v4 offset:4096
    ds_read_b128 v[100:103], v4 offset:20480
    s_waitcnt lgkmcnt(2)
    v_mfma_f32_16x16x32_bf16 v[128:131], a[28:31], v[104:107], v[128:131]
    v_mfma_f32_16x16x32_bf16 v[136:139], a[92:95], v[104:107], v[136:139]
    v_mfma_f32_16x16x32_bf16 v[144:147], a[156:159], v[104:107], v[144:147]
    v_mfma_f32_16x16x32_bf16 v[152:155], a[220:223], v[104:107], v[152:155]
    v_mfma_f32_16x16x32_bf16 v[132:135], a[28:31], v[108:111], v[132:135]
    v_mfma_f32_16x16x32_bf16 v[140:143], a[92:95], v[108:111], v[140:143]
    v_mfma_f32_16x16x32_bf16 v[148:151], a[156:159], v[108:111], v[148:151]
    v_mfma_f32_16x16x32_bf16 v[156:159], a[220:223], v[108:111], v[156:159]
    ds_read_b128 v[104:107], v5 offset:4096
    ds_read_b128 v[108:111], v5 offset:20480
    s_waitcnt lgkmcnt(2)
    v_mfma_f32_16x16x32_bf16 v[128:131], a[32:35], v[96:99], v[128:131]
    v_mfma_f32_16x16x32_bf16 v[136:139], a[96:99], v[96:99], v[136:139]
    v_mfma_f32_16x16x32_bf16 v[144:147], a[160:163], v[96:99], v[144:147]
    v_mfma_f32_16x16x32_bf16 v[152:155], a[224:227], v[96:99], v[152:155]
    v_mfma_f32_16x16x32_bf16 v[132:135], a[32:35], v[100:103], v[132:135]
    v_mfma_f32_16x16x32_bf16 v[140:143], a[96:99], v[100:103], v[140:143]
    v_mfma_f32_16x16x32_bf16 v[148:151], a[160:163], v[100:103], v[148:151]
    v_mfma_f32_16x16x32_bf16 v[156:159], a[224:227], v[100:103], v[156:159]
    ds_read_b128 v[96:99], v4 offset:5120
    ds_read_b128 v[100:103], v4 offset:21504
    s_waitcnt lgkmcnt(2)
    v_mfma_f32_16x16x32_bf16 v[128:131], a[36:39], v[104:107], v[128:131]
    v_mfma_f32_16x16x32_bf16 v[136:139], a[100:103], v[104:107], v[136:139]
    v_mfma_f32_16x16x32_bf16 v[144:147], a[164:167], v[104:107], v[144:147]
    v_mfma_f32_16x16x32_bf16 v[152:155], a[228:231], v[104:107], v[152:155]
    v_mfma_f32_16x16x32_bf16 v[132:135], a[36:39], v[108:111], v[132:135]
    v_mfma_f32_16x16x32_bf16 v[140:143], a[100:103], v[108:111], v[140:143]
    v_mfma_f32_16x16x32_bf16 v[148:151], a[164:167], v[108:111], v[148:151]
    v_mfma_f32_16x16x32_bf16 v[156:159], a[228:231], v[108:111], v[156:159]
    ds_read_b128 v[104:107], v5 offset:5120
    ds_read_b128 v[108:111], v5 offset:21504
    s_waitcnt lgkmcnt(2)
    v_mfma_f32_16x16x32_bf16 v[128:131], a[40:43], v[96:99], v[128:131]
    v_mfma_f32_16x16x32_bf16 v[136:139], a[104:107], v[96:99], v[136:139]
    v_mfma_f32_16x16x32_bf16 v[144:147], a[168:171], v[96:99], v[144:147]
    v_mfma_f32_16x16x32_bf16 v[152:155], a[232:235], v[96:99], v[152:155]
    v_mfma_f32_16x16x32_bf16 v[132:135], a[40:43], v[100:103], v[132:135]
    v_mfma_f32_16x16x32_bf16 v[140:143], a[104:107], v[100:103], v[140:143]
    v_mfma_f32_16x16x32_bf16 v[148:151], a[168:171], v[100:103], v[148:151]
    v_mfma_f32_16x16x32_bf16 v[156:159], a[232:235], v[100:103], v[156:159]
    ds_read_b128 v[96:99], v4 offset:6144
    ds_read_b128 v[100:103], v4 offset:22528
    s_waitcnt lgkmcnt(2)
    v_mfma_f32_16x16x32_bf16 v[128:131], a[44:47], v[104:107], v[128:131]
    v_mfma_f32_16x16x32_bf16 v[136:139], a[108:111], v[104:107], v[136:139]
    v_mfma_f32_16x16x32_bf16 v[144:147], a[172:175], v[104:107], v[144:147]
    v_mfma_f32_16x16x32_bf16 v[152:155], a[236:239], v[104:107], v[152:155]
    v_mfma_f32_16x16x32_bf16 v[132:135], a[44:47], v[108:111], v[132:135]
    v_mfma_f32_16x16x32_bf16 v[140:143], a[108:111], v[108:111], v[140:143]
    v_mfma_f32_16x16x32_bf16 v[148:151], a[172:175], v[108:111], v[148:151]
    v_mfma_f32_16x16x32_bf16 v[156:159], a[236:239], v[108:111], v[156:159]
    ds_read_b128 v[104:107], v5 offset:6144
    ds_read_b128 v[108:111], v5 offset:22528
    s_waitcnt lgkmcnt(2)
    v_mfma_f32_16x16x32_bf16 v[128:131], a[48:51], v[96:99], v[128:131]
    v_mfma_f32_16x16x32_bf16 v[136:139], a[112:115], v[96:99], v[136:139]
    v_mfma_f32_16x16x32_bf16 v[144:147], a[176:179], v[96:99], v[144:147]
    v_mfma_f32_16x16x32_bf16 v[152:155], a[240:243], v[96:99], v[152:155]
    v_mfma_f32_16x16x32_bf16 v[132:135], a[48:51], v[100:103], v[132:135]
    v_mfma_f32_16x16x32_bf16 v[140:143], a[112:115], v[100:103], v[140:143]
    v_mfma_f32_16x16x32_bf16 v[148:151], a[176:179], v[100:103], v[148:151]
    v_mfma_f32_16x16x32_bf16 v[156:159], a[240:243], v[100:103], v[156:159]
    ds_read_b128 v[96:99], v4 offset:7168
    ds_read_b128 v[100:103], v4 offset:23552
    s_waitcnt lgkmcnt(2)
    v_mfma_f32_16x16x32_bf16 v[128:131], a[52:55], v[104:107], v[128:131]
    v_mfma_f32_16x16x32_bf16 v[136:139], a[116:119], v[104:107], v[136:139]
    v_mfma_f32_16x16x32_bf16 v[144:147], a[180:183], v[104:107], v[144:147]
    v_mfma_f32_16x16x32_bf16 v[152:155], a[244:247], v[104:107], v[152:155]
    v_mfma_f32_16x16x32_bf16 v[132:135], a[52:55], v[108:111], v[132:135]
    v_mfma_f32_16x16x32_bf16 v[140:143], a[116:119], v[108:111], v[140:143]
    v_mfma_f32_16x16x32_bf16 v[148:151], a[180:183], v[108:111], v[148:151]
    v_mfma_f32_16x16x32_bf16 v[156:159], a[244:247], v[108:111], v[156:159]
    ds_read_b128 v[104:107], v5 offset:7168
    ds_read_b128 v[108:111], v5 offset:23552
    s_waitcnt lgkmcnt(2)
    v_mfma_f32_16x16x32_bf16 v[128:131], a[56:59], v[96:99], v[128:131]
    v_mfma_f32_16x16x32_bf16 v[136:139], a[120:123], v[96:99], v[136:139]
    v_mfma_f32_16x16x32_bf16 v[144:147], a[184:187], v[96:99], v[144:147]
    v_mfma_f32_16x16x32_bf16 v[152:155], a[248:251], v[96:99], v[152:155]
    v_mfma_f32_16x16x32_bf16 v[132:135], a[56:59], v[100:103], v[132:135]
    v_mfma_f32_16x16x32_bf16 v[140:143], a[120:123], v[100:103], v[140:143]
    v_mfma_f32_16x16x32_bf16 v[148:151], a[184:187], v[100:103], v[148:151]
    v_mfma_f32_16x16x32_bf16 v[156:159], a[248:251], v[100:103], v[156:159]
    s_waitcnt lgkmcnt(0)
    v_mfma_f32_16x16x32_bf16 v[128:131], a[60:63], v[104:107], v[128:131]
    v_mfma_f32_16x16x32_bf16 v[136:139], a[124:127], v[104:107], v[136:139]
    v_mfma_f32_16x16x32_bf16 v[144:147], a[188:191], v[104:107], v[144:147]
    v_mfma_f32_16x16x32_bf16 v[152:155], a[252:255], v[104:107], v[152:155]
    v_mfma_f32_16x16x32_bf16 v[132:135], a[60:63], v[108:111], v[132:135]
    v_mfma_f32_16x16x32_bf16 v[140:143], a[124:127], v[108:111], v[140:143]
    v_mfma_f32_16x16x32_bf16 v[148:151], a[188:191], v[108:111], v[148:151]
    v_mfma_f32_16x16x32_bf16 v[156:159], a[252:255], v[108:111], v[156:159]
LJ_9:
    s_nop 7
    v_cvt_pk_bf16_f32 v112, v128, v129
    v_cvt_pk_bf16_f32 v113, v130, v131
    v_cvt_pk_bf16_f32 v114, v136, v137
    v_cvt_pk_bf16_f32 v115, v138, v139
    global_store_dwordx4 v16, v[112:115], s[12:13] offset:0 sc1
    v_cvt_pk_bf16_f32 v116, v144, v145
    v_cvt_pk_bf16_f32 v117, v146, v147
    v_cvt_pk_bf16_f32 v118, v152, v153
    v_cvt_pk_bf16_f32 v119, v154, v155
    global_store_dwordx4 v16, v[116:119], s[12:13] offset:1024 sc1
    v_cvt_pk_bf16_f32 v120, v132, v133
    v_cvt_pk_bf16_f32 v121, v134, v135
    v_cvt_pk_bf16_f32 v122, v140, v141
    v_cvt_pk_bf16_f32 v123, v142, v143
    global_store_dwordx4 v17, v[120:123], s[12:13] offset:0 sc1
    v_cvt_pk_bf16_f32 v124, v148, v149
    v_cvt_pk_bf16_f32 v125, v150, v151
    v_cvt_pk_bf16_f32 v126, v156, v157
    v_cvt_pk_bf16_f32 v127, v158, v159
    global_store_dwordx4 v17, v[124:127], s[12:13] offset:1024 sc1
    s_add_u32 s12, s12, 0x80000
    s_addc_u32 s13, s13, 0
    s_add_u32 s20, s20, 1
    s_cmp_le_u32 s20, 3
    s_cbranch_scc0 LEF_10
    s_waitcnt vmcnt(0)
    s_barrier
    s_cmp_eq_u32 s6, 0
    s_cbranch_scc0 LPUB_11
    v_mov_b32 v8, s20
    v_mov_b32 v9, 0
    s_mov_b64 exec, 1
    global_store_dword v9, v8, s[14:15] sc1
    s_mov_b64 exec, -1
LPUB_11:
    s_cmp_eq_u32 s20, 3
    s_cbranch_scc0 LEF_10
LEF_10:
    s_waitcnt vmcnt(4)
    s_barrier
    s_sub_u32 s23, s20, 1
    s_cmp_ge_i32 s23, 4
    s_cbranch_scc0 LNP_12
    s_cmp_eq_u32 s6, 0
    s_cbranch_scc0 LPUB_13
    v_mov_b32 v8, s23
    v_mov_b32 v9, 0
    s_mov_b64 exec, 1
    global_store_dword v9, v8, s[14:15] sc1
    s_mov_b64 exec, -1
LPUB_13:
LNP_12:
    s_add_u32 s26, s26, 0x10000
    s_addc_u32 s27, s27, 0
    s_add_u32 s23, s20, 1
    s_cmp_lt_u32 s23, 32
    s_cbranch_scc0 LND_14
    ds_read_b128 v[96:99], v6 offset:0
    ds_read_b128 v[100:103], v6 offset:16384
    ds_read_b128 v[104:107], v7 offset:0
    ds_read_b128 v[108:111], v7 offset:16384
    s_waitcnt lgkmcnt(2)
    v_mfma_f32_16x16x32_bf16 v[128:131], a[0:3], v[96:99], 0
    v_mfma_f32_16x16x32_bf16 v[136:139], a[64:67], v[96:99], 0
    s_lshl_b32 s21, s6, 14
    s_add_u32 s21, s21, 0
    s_add_u32 s24, s26, s21
    s_addc_u32 s25, s27, 0
    s_add_u32 s30, s21, 0
    s_add_u32 m0, s30, 0
    s_nop 0
    global_load_lds_dwordx4 v2, s[24:25] offset:0
    v_mfma_f32_16x16x32_bf16 v[144:147], a[128:131], v[96:99], 0
    v_mfma_f32_16x16x32_bf16 v[152:155], a[192:195], v[96:99], 0
    v_mfma_f32_16x16x32_bf16 v[132:135], a[0:3], v[100:103], 0
    v_mfma_f32_16x16x32_bf16 v[140:143], a[64:67], v[100:103], 0
    v_mfma_f32_16x16x32_bf16 v[148:151], a[128:131], v[100:103], 0
    v_mfma_f32_16x16x32_bf16 v[156:159], a[192:195], v[100:103], 0
    ds_read_b128 v[96:99], v6 offset:1024
    ds_read_b128 v[100:103], v6 offset:17408
    s_waitcnt lgkmcnt(2)
    v_mfma_f32_16x16x32_bf16 v[128:131], a[4:7], v[104:107], v[128:131]
    v_mfma_f32_16x16x32_bf16 v[136:139], a[68:71], v[104:107], v[136:139]
    s_add_u32 m0, s30, 896
    s_nop 0
    global_load_lds_dwordx4 v2, s[24:25] offset:128
    v_mfma_f32_16x16x32_bf16 v[144:147], a[132:135], v[104:107], v[144:147]
    v_mfma_f32_16x16x32_bf16 v[152:155], a[196:199], v[104:107], v[152:155]
    v_mfma_f32_16x16x32_bf16 v[132:135], a[4:7], v[108:111], v[132:135]
    v_mfma_f32_16x16x32_bf16 v[140:143], a[68:71], v[108:111], v[140:143]
    v_mfma_f32_16x16x32_bf16 v[148:151], a[132:135], v[108:111], v[148:151]
    v_mfma_f32_16x16x32_bf16 v[156:159], a[196:199], v[108:111], v[156:159]
    ds_read_b128 v[104:107], v7 offset:1024
    ds_read_b128 v[108:111], v7 offset:17408
    s_waitcnt lgkmcnt(2)
    v_mfma_f32_16x16x32_bf16 v[128:131], a[8:11], v[96:99], v[128:131]
    v_mfma_f32_16x16x32_bf16 v[136:139], a[72:75], v[96:99], v[136:139]
    s_add_u32 m0, s30, 1792
    s_nop 0
    global_load_lds_dwordx4 v2, s[24:25] offset:256
    v_mfma_f32_16x16x32_bf16 v[144:147], a[136:139], v[96:99], v[144:147]
    v_mfma_f32_16x16x32_bf16 v[152:155], a[200:203], v[96:99], v[152:155]
    v_mfma_f32_16x16x32_bf16 v[132:135], a[8:11], v[100:103], v[132:135]
    v_mfma_f32_16x16x32_bf16 v[140:143], a[72:75], v[100:103], v[140:143]
    v_mfma_f32_16x16x32_bf16 v[148:151], a[136:139], v[100:103], v[148:151]
    v_mfma_f32_16x16x32_bf16 v[156:159], a[200:203], v[100:103], v[156:159]
    ds_read_b128 v[96:99], v6 offset:2048
    ds_read_b128 v[100:103], v6 offset:18432
    s_waitcnt lgkmcnt(2)
    v_mfma_f32_16x16x32_bf16 v[128:131], a[12:15], v[104:107], v[128:131]
    v_mfma_f32_16x16x32_bf16 v[136:139], a[76:79], v[104:107], v[136:139]
    s_add_u32 m0, s30, 2688
    s_nop 0
    global_load_lds_dwordx4 v2, s[24:25] offset:384
    v_mfma_f32_16x16x32_bf16 v[144:147], a[140:143], v[104:107], v[144:147]
    v_mfma_f32_16x16x32_bf16 v[152:155], a[204:207], v[104:107], v[152:155]
    v_mfma_f32_16x16x32_bf16 v[132:135], a[12:15], v[108:111], v[132:135]
    v_mfma_f32_16x16x32_bf16 v[140:143], a[76:79], v[108:111], v[140:143]
    v_mfma_f32_16x16x32_bf16 v[148:151], a[140:143], v[108:111], v[148:151]
    v_mfma_f32_16x16x32_bf16 v[156:159], a[204:207], v[108:111], v[156:159]
    ds_read_b128 v[104:107], v7 offset:2048
    ds_read_b128 v[108:111], v7 offset:18432
    s_waitcnt lgkmcnt(2)
    v_mfma_f32_16x16x32_bf16 v[128:131], a[16:19], v[96:99], v[128:131]
    v_mfma_f32_16x16x32_bf16 v[136:139], a[80:83], v[96:99], v[136:139]
    s_add_u32 m0, s30, 3584
    s_nop 0
    global_load_lds_dwordx4 v2, s[24:25] offset:512
    v_mfma_f32_16x16x32_bf16 v[144:147], a[144:147], v[96:99], v[144:147]
    v_mfma_f32_16x16x32_bf16 v[152:155], a[208:211], v[96:99], v[152:155]
    v_mfma_f32_16x16x32_bf16 v[132:135], a[16:19], v[100:103], v[132:135]
    v_mfma_f32_16x16x32_bf16 v[140:143], a[80:83], v[100:103], v[140:143]
    v_mfma_f32_16x16x32_bf16 v[148:151], a[144:147], v[100:103], v[148:151]
    v_mfma_f32_16x16x32_bf16 v[156:159], a[208:211], v[100:103], v[156:159]
    ds_read_b128 v[96:99], v6 offset:3072
    ds_read_b128 v[100:103], v6 offset:19456
    s_waitcnt lgkmcnt(2)
    v_mfma_f32_16x16x32_bf16 v[128:131], a[20:23], v[104:107], v[128:131]
    v_mfma_f32_16x16x32_bf16 v[136:139], a[84:87], v[104:107], v[136:139]
    s_add_u32 m0, s30, 4480
    s_nop 0
    global_load_lds_dwordx4 v2, s[24:25] offset:640
    v_mfma_f32_16x16x32_bf16 v[144:147], a[148:151], v[104:107], v[144:147]
    v_mfma_f32_16x16x32_bf16 v[152:155], a[212:215], v[104:107], v[152:155]
    v_mfma_f32_16x16x32_bf16 v[132:135], a[20:23], v[108:111], v[132:135]
    v_mfma_f32_16x16x32_bf16 v[140:143], a[84:87], v[108:111], v[140:143]
    v_mfma_f32_16x16x32_bf16 v[148:151], a[148:151], v[108:111], v[148:151]
    v_mfma_f32_16x16x32_bf16 v[156:159], a[212:215], v[108:111], v[156:159]
    ds_read_b128 v[104:107], v7 offset:3072
    ds_read_b128 v[108:111], v7 offset:19456
    s_waitcnt lgkmcnt(2)
    v_mfma_f32_16x16x32_bf16 v[128:131], a[24:27], v[96:99], v[128:131]
    v_mfma_f32_16x16x32_bf16 v[136:139], a[88:91], v[96:99], v[136:139]
    s_add_u32 m0, s30, 5376
    s_nop 0
    global_load_lds_dwordx4 v2, s[24:25] offset:768
    v_mfma_f32_16x16x32_bf16 v[144:147], a[152:155], v[96:99], v[144:147]
    v_mfma_f32_16x16x32_bf16 v[152:155], a[216:219], v[96:99], v[152:155]
    v_mfma_f32_16x16x32_bf16 v[132:135], a[24:27], v[100:103], v[132:135]
    v_mfma_f32_16x16x32_bf16 v[140:143], a[88:91], v[100:103], v[140:143]
    v_mfma_f32_16x16x32_bf16 v[148:151], a[152:155], v[100:103], v[148:151]
    v_mfma_f32_16x16x32_bf16 v[156:159], a[216:219], v[100:103], v[156:159]
    ds_read_b128 v[96:99], v6 offset:4096
    ds_read_b128 v[100:103], v6 offset:20480
    s_waitcnt lgkmcnt(2)
    v_mfma_f32_16x16x32_bf16 v[128:131], a[28:31], v[104:107], v[128:131]
    v_mfma_f32_16x16x32_bf16 v[136:139], a[92:95], v[104:107], v[136:139]
    s_add_u32 m0, s30, 6272
    s_nop 0
    global_load_lds_dwordx4 v2, s[24:25] offset:896
    v_mfma_f32_16x16x32_bf16 v[144:147], a[156:159], v[104:107], v[144:147]
    v_mfma_f32_16x16x32_bf16 v[152:155], a[220:223], v[104:107], v[152:155]
    v_mfma_f32_16x16x32_bf16 v[132:135], a[28:31], v[108:111], v[132:135]
    v_mfma_f32_16x16x32_bf16 v[140:143], a[92:95], v[108:111], v[140:143]
    v_mfma_f32_16x16x32_bf16 v[148:151], a[156:159], v[108:111], v[148:151]
    v_mfma_f32_16x16x32_bf16 v[156:159], a[220:223], v[108:111], v[156:159]
    ds_read_b128 v[104:107], v7 offset:4096
    ds_read_b128 v[108:111], v7 offset:20480
    s_waitcnt lgkmcnt(2)
    v_mfma_f32_16x16x32_bf16 v[128:131], a[32:35], v[96:99], v[128:131]
    v_mfma_f32_16x16x32_bf16 v[136:139], a[96:99], v[96:99], v[136:139]
    s_lshl_b32 s21, s6, 14
    s_add_u32 s21, s21, 8192
    s_add_u32 s24, s26, s21
    s_addc_u32 s25, s27, 0
    s_add_u32 s30, s21, 0
    s_add_u32 m0, s30, 0
    s_nop 0
    global_load_lds_dwordx4 v2, s[24:25] offset:0
    v_mfma_f32_16x16x32_bf16 v[144:147], a[160:163], v[96:99], v[144:147]
    v_mfma_f32_16x16x32_bf16 v[152:155], a[224:227], v[96:99], v[152:155]
    v_mfma_f32_16x16x32_bf16 v[132:135], a[32:35], v[100:103], v[132:135]
    v_mfma_f32_16x16x32_bf16 v[140:143], a[96:99], v[100:103], v[140:143]
    v_mfma_f32_16x16x32_bf16 v[148:151], a[160:163], v[100:103], v[148:151]
    v_mfma_f32_16x16x32_bf16 v[156:159], a[224:227], v[100:103], v[156:159]
    ds_read_b128 v[96:99], v6 offset:5120
    ds_read_b128 v[100:103], v6 offset:21504
    s_waitcnt lgkmcnt(2)
    v_mfma_f32_16x16x32_bf16 v[128:131], a[36:39], v[104:107], v[128:131]
    v_mfma_f32_16x16x32_bf16 v[136:139], a[100:103], v[104:107], v[136:139]
    s_add_u32 m0, s30, 896
    s_nop 0
    global_load_lds_dwordx4 v2, s[24:25] offset:128
    v_mfma_f32_16x16x32_bf16 v[144:147], a[164:167], v[104:107], v[144:147]
    v_mfma_f32_16x16x32_bf16 v[152:155], a[228:231], v[104:107], v[152:155]
    v_mfma_f32_16x16x32_bf16 v[132:135], a[36:39], v[108:111], v[132:135]
    v_mfma_f32_16x16x32_bf16 v[140:143], a[100:103], v[108:111], v[140:143]
    v_mfma_f32_16x16x32_bf16 v[148:151], a[164:167], v[108:111], v[148:151]
    v_mfma_f32_16x16x32_bf16 v[156:159], a[228:231], v[108:111], v[156:159]
    ds_read_b128 v[104:107], v7 offset:5120
    ds_read_b128 v[108:111], v7 offset:21504
    s_waitcnt lgkmcnt(2)
    v_mfma_f32_16x16x32_bf16 v[128:131], a[40:43], v[96:99], v[128:131]
    v_mfma_f32_16x16x32_bf16 v[136:139], a[104:107], v[96:99], v[136:139]
    s_add_u32 m0, s30, 1792
    s_nop 0
    global_load_lds_dwordx4 v2, s[24:25] offset:256
    v_mfma_f32_16x16x32_bf16 v[144:147], a[168:171], v[96:99], v[144:147]
    v_mfma_f32_16x16x32_bf16 v[152:155], a[232:235], v[96:99], v[152:155]
    v_mfma_f32_16x16x32_bf16 v[132:135], a[40:43], v[100:103], v[132:135]
    v_mfma_f32_16x16x32_bf16 v[140:143], a[104:107], v[100:103], v[140:143]
    v_mfma_f32_16x16x32_bf16 v[148:151], a[168:171], v[100:103], v[148:151]
    v_mfma_f32_16x16x32_bf16 v[156:159], a[232:235], v[100:103], v[156:159]
    ds_read_b128 v[96:99], v6 offset:6144
    ds_read_b128 v[100:103], v6 offset:22528
    s_waitcnt lgkmcnt(2)
    v_mfma_f32_16x16x32_bf16 v[128:131], a[44:47], v[104:107], v[128:131]
    v_mfma_f32_16x16x32_bf16 v[136:139], a[108:111], v[104:107], v[136:139]
    s_add_u32 m0, s30, 2688
    s_nop 0
    global_load_lds_dwordx4 v2, s[24:25] offset:384
    v_mfma_f32_16x16x32_bf16 v[144:147], a[172:175], v[104:107], v[144:147]
    v_mfma_f32_16x16x32_bf16 v[152:155], a[236:239], v[104:107], v[152:155]
    v_mfma_f32_16x16x32_bf16 v[132:135], a[44:47], v[108:111], v[132:135]
    v_mfma_f32_16x16x32_bf16 v[140:143], a[108:111], v[108:111], v[140:143]
    v_mfma_f32_16x16x32_bf16 v[148:151], a[172:175], v[108:111], v[148:151]
    v_mfma_f32_16x16x32_bf16 v[156:159], a[236:239], v[108:111], v[156:159]
    ds_read_b128 v[104:107], v7 offset:6144
    ds_read_b128 v[108:111], v7 offset:22528
    s_waitcnt lgkmcnt(2)
    v_mfma_f32_16x16x32_bf16 v[128:131], a[48:51], v[96:99], v[128:131]
    v_mfma_f32_16x16x32_bf16 v[136:139], a[112:115], v[96:99], v[136:139]
    s_add_u32 m0, s30, 3584
    s_nop 0
    global_load_lds_dwordx4 v2, s[24:25] offset:512
    v_mfma_f32_16x16x32_bf16 v[144:147], a[176:179], v[96:99], v[144:147]
    v_mfma_f32_16x16x32_bf16 v[152:155], a[240:243], v[96:99], v[152:155]
    v_mfma_f32_16x16x32_bf16 v[132:135], a[48:51], v[100:103], v[132:135]
    v_mfma_f32_16x16x32_bf16 v[140:143], a[112:115], v[100:103], v[140:143]
    v_mfma_f32_16x16x32_bf16 v[148:151], a[176:179], v[100:103], v[148:151]
    v_mfma_f32_16x16x32_bf16 v[156:159], a[240:243], v[100:103], v[156:159]
    ds_read_b128 v[96:99], v6 offset:7168
    ds_read_b128 v[100:103], v6 offset:23552
    s_waitcnt lgkmcnt(2)
    v_mfma_f32_16x16x32_bf16 v[128:131], a[52:55], v[104:107], v[128:131]
    v_mfma_f32_16x16x32_bf16 v[136:139], a[116:119], v[104:107], v[136:139]
    s_add_u32 m0, s30, 4480
    s_nop 0
    global_load_lds_dwordx4 v2, s[24:25] offset:640
    v_mfma_f32_16x16x32_bf16 v[144:147], a[180:183], v[104:107], v[144:147]
    v_mfma_f32_16x16x32_bf16 v[152:155], a[244:247], v[104:107], v[152:155]
    v_mfma_f32_16x16x32_bf16 v[132:135], a[52:55], v[108:111], v[132:135]
    v_mfma_f32_16x16x32_bf16 v[140:143], a[116:119], v[108:111], v[140:143]
    v_mfma_f32_16x16x32_bf16 v[148:151], a[180:183], v[108:111], v[148:151]
    v_mfma_f32_16x16x32_bf16 v[156:159], a[244:247], v[108:111], v[156:159]
    ds_read_b128 v[104:107], v7 offset:7168
    ds_read_b128 v[108:111], v7 offset:23552
    s_waitcnt lgkmcnt(2)
    v_mfma_f32_16x16x32_bf16 v[128:131], a[56:59], v[96:99], v[128:131]
    v_mfma_f32_16x16x32_bf16 v[136:139], a[120:123], v[96:99], v[136:139]
    s_add_u32 m0, s30, 5376
    s_nop 0
    global_load_lds_dwordx4 v2, s[24:25] offset:768
    v_mfma_f32_16x16x32_bf16 v[144:147], a[184:187], v[96:99], v[144:147]
    v_mfma_f32_16x16x32_bf16 v[152:155], a[248:251], v[96:99], v[152:155]
    v_mfma_f32_16x16x32_bf16 v[132:135], a[56:59], v[100:103], v[132:135]
    v_mfma_f32_16x16x32_bf16 v[140:143], a[120:123], v[100:103], v[140:143]
    v_mfma_f32_16x16x32_bf16 v[148:151], a[184:187], v[100:103], v[148:151]
    v_mfma_f32_16x16x32_bf16 v[156:159], a[248:251], v[100:103], v[156:159]
    s_waitcnt lgkmcnt(0)
    v_mfma_f32_16x16x32_bf16 v[128:131], a[60:63], v[104:107], v[128:131]
    v_mfma_f32_16x16x32_bf16 v[136:139], a[124:127], v[104:107], v[136:139]
    s_add_u32 m0, s30, 6272
    s_nop 0
    global_load_lds_dwordx4 v2, s[24:25] offset:896
    v_mfma_f32_16x16x32_bf16 v[144:147], a[188:191], v[104:107], v[144:147]
    v_mfma_f32_16x16x32_bf16 v[152:155], a[252:255], v[104:107], v[152:155]
    v_mfma_f32_16x16x32_bf16 v[132:135], a[60:63], v[108:111], v[132:135]
    v_mfma_f32_16x16x32_bf16 v[140:143], a[124:127], v[108:111], v[140:143]
    v_mfma_f32_16x16x32_bf16 v[148:151], a[188:191], v[108:111], v[148:151]
    v_mfma_f32_16x16x32_bf16 v[156:159], a[252:255], v[108:111], v[156:159]
    s_branch LJ_15
LND_14:
    ds_read_b128 v[96:99], v6 offset:0
    ds_read_b128 v[100:103], v6 offset:16384
    ds_read_b128 v[104:107], v7 offset:0
    ds_read_b128 v[108:111], v7 offset:16384
    s_waitcnt lgkmcnt(2)
    v_mfma_f32_16x16x32_bf16 v[128:131], a[0:3], v[96:99], 0
    v_mfma_f32_16x16x32_bf16 v[136:139], a[64:67], v[96:99], 0
    v_mfma_f32_16x16x32_bf16 v[144:147], a[128:131], v[96:99], 0
    v_mfma_f32_16x16x32_bf16 v[152:155], a[192:195], v[96:99], 0
    v_mfma_f32_16x16x32_bf16 v[132:135], a[0:3], v[100:103], 0
    v_mfma_f32_16x16x32_bf16 v[140:143], a[64:67], v[100:103], 0
    v_mfma_f32_16x16x32_bf16 v[148:151], a[128:131], v[100:103], 0
    v_mfma_f32_16x16x32_bf16 v[156:159], a[192:195], v[100:103], 0
    ds_read_b128 v[96:99], v6 offset:1024
    ds_read_b128 v[100:103], v6 offset:17408
    s_waitcnt lgkmcnt(2)
    v_mfma_f32_16x16x32_bf16 v[128:131], a[4:7], v[104:107], v[128:131]
    v_mfma_f32_16x16x32_bf16 v[136:139], a[68:71], v[104:107], v[136:139]
    v_mfma_f32_16x16x32_bf16 v[144:147], a[132:135], v[104:107], v[144:147]
    v_mfma_f32_16x16x32_bf16 v[152:155], a[196:199], v[104:107], v[152:155]
    v_mfma_f32_16x16x32_bf16 v[132:135], a[4:7], v[108:111], v[132:135]
    v_mfma_f32_16x16x32_bf16 v[140:143], a[68:71], v[108:111], v[140:143]
    v_mfma_f32_16x16x32_bf16 v[148:151], a[132:135], v[108:111], v[148:151]
    v_mfma_f32_16x16x32_bf16 v[156:159], a[196:199], v[108:111], v[156:159]
    ds_read_b128 v[104:107], v7 offset:1024
    ds_read_b128 v[108:111], v7 offset:17408
    s_waitcnt lgkmcnt(2)
    v_mfma_f32_16x16x32_bf16 v[128:131], a[8:11], v[96:99], v[128:131]
    v_mfma_f32_16x16x32_bf16 v[136:139], a[72:75], v[96:99], v[136:139]
    v_mfma_f32_16x16x32_bf16 v[144:147], a[136:139], v[96:99], v[144:147]
    v_mfma_f32_16x16x32_bf16 v[152:155], a[200:203], v[96:99], v[152:155]
    v_mfma_f32_16x16x32_bf16 v[132:135], a[8:11], v[100:103], v[132:135]
    v_mfma_f32_16x16x32_bf16 v[140:143], a[72:75], v[100:103], v[140:143]
    v_mfma_f32_16x16x32_bf16 v[148:151], a[136:139], v[100:103], v[148:151]
    v_mfma_f32_16x16x32_bf16 v[156:159], a[200:203], v[100:103], v[156:159]
    ds_read_b128 v[96:99], v6 offset:2048
    ds_read_b128 v[100:103], v6 offset:18432
    s_waitcnt lgkmcnt(2)
    v_mfma_f32_16x16x32_bf16 v[128:131], a[12:15], v[104:107], v[128:131]
    v_mfma_f32_16x16x32_bf16 v[136:139], a[76:79], v[104:107], v[136:139]
    v_mfma_f32_16x16x32_bf16 v[144:147], a[140:143], v[104:107], v[144:147]
    v_mfma_f32_16x16x32_bf16 v[152:155], a[204:207], v[104:107], v[152:155]
    v_mfma_f32_16x16x32_bf16 v[132:135], a[12:15], v[108:111], v[132:135]
    v_mfma_f32_16x16x32_bf16 v[140:143], a[76:79], v[108:111], v[140:143]
    v_mfma_f32_16x16x32_bf16 v[148:151], a[140:143], v[108:111], v[148:151]
    v_mfma_f32_16x16x32_bf16 v[156:159], a[204:207], v[108:111], v[156:159]
    ds_read_b128 v[104:107], v7 offset:2048
    ds_read_b128 v[108:111], v7 offset:18432
    s_waitcnt lgkmcnt(2)
    v_mfma_f32_16x16x32_bf16 v[128:131], a[16:19], v[96:99], v[128:131]
    v_mfma_f32_16x16x32_bf16 v[136:139], a[80:83], v[96:99], v[136:139]
    v_mfma_f32_16x16x32_bf16 v[144:147], a[144:147], v[96:99], v[144:147]
    v_mfma_f32_16x16x32_bf16 v[152:155], a[208:211], v[96:99], v[152:155]
    v_mfma_f32_16x16x32_bf16 v[132:135], a[16:19], v[100:103], v[132:135]
    v_mfma_f32_16x16x32_bf16 v[140:143], a[80:83], v[100:103], v[140:143]
    v_mfma_f32_16x16x32_bf16 v[148:151], a[144:147], v[100:103], v[148:151]
    v_mfma_f32_16x16x32_bf16 v[156:159], a[208:211], v[100:103], v[156:159]
    ds_read_b128 v[96:99], v6 offset:3072
    ds_read_b128 v[100:103], v6 offset:19456
    s_waitcnt lgkmcnt(2)
    v_mfma_f32_16x16x32_bf16 v[128:131], a[20:23], v[104:107], v[128:131]
    v_mfma_f32_16x16x32_bf16 v[136:139], a[84:87], v[104:107], v[136:139]
    v_mfma_f32_16x16x32_bf16 v[144:147], a[148:151], v[104:107], v[144:147]
    v_mfma_f32_16x16x32_bf16 v[152:155], a[212:215], v[104:107], v[152:155]
    v_mfma_f32_16x16x32_bf16 v[132:135], a[20:23], v[108:111], v[132:135]
    v_mfma_f32_16x16x32_bf16 v[140:143], a[84:87], v[108:111], v[140:143]
    v_mfma_f32_16x16x32_bf16 v[148:151], a[148:151], v[108:111], v[148:151]
    v_mfma_f32_16x16x32_bf16 v[156:159], a[212:215], v[108:111], v[156:159]
    ds_read_b128 v[104:107], v7 offset:3072
    ds_read_b128 v[108:111], v7 offset:19456
    s_waitcnt lgkmcnt(2)
    v_mfma_f32_16x16x32_bf16 v[128:131], a[24:27], v[96:99], v[128:131]
    v_mfma_f32_16x16x32_bf16 v[136:139], a[88:91], v[96:99], v[136:139]
    v_mfma_f32_16x16x32_bf16 v[144:147], a[152:155], v[96:99], v[144:147]
    v_mfma_f32_16x16x32_bf16 v[152:155], a[216:219], v[96:99], v[152:155]
    v_mfma_f32_16x16x32_bf16 v[132:135], a[24:27], v[100:103], v[132:135]
    v_mfma_f32_16x16x32_bf16 v[140:143], a[88:91], v[100:103], v[140:143]
    v_mfma_f32_16x16x32_bf16 v[148:151], a[152:155], v[100:103], v[148:151]
    v_mfma_f32_16x16x32_bf16 v[156:159], a[216:219], v[100:103], v[156:159]
    ds_read_b128 v[96:99], v6 offset:4096
    ds_read_b128 v[100:103], v6 offset:20480
    s_waitcnt lgkmcnt(2)
    v_mfma_f32_16x16x32_bf16 v[128:131], a[28:31], v[104:107], v[128:131]
    v_mfma_f32_16x16x32_bf16 v[136:139], a[92:95], v[104:107], v[136:139]
    v_mfma_f32_16x16x32_bf16 v[144:147], a[156:159], v[104:107], v[144:147]
    v_mfma_f32_16x16x32_bf16 v[152:155], a[220:223], v[104:107], v[152:155]
    v_mfma_f32_16x16x32_bf16 v[132:135], a[28:31], v[108:111], v[132:135]
    v_mfma_f32_16x16x32_bf16 v[140:143], a[92:95], v[108:111], v[140:143]
    v_mfma_f32_16x16x32_bf16 v[148:151], a[156:159], v[108:111], v[148:151]
    v_mfma_f32_16x16x32_bf16 v[156:159], a[220:223], v[108:111], v[156:159]
    ds_read_b128 v[104:107], v7 offset:4096
    ds_read_b128 v[108:111], v7 offset:20480
    s_waitcnt lgkmcnt(2)
    v_mfma_f32_16x16x32_bf16 v[128:131], a[32:35], v[96:99], v[128:131]
    v_mfma_f32_16x16x32_bf16 v[136:139], a[96:99], v[96:99], v[136:139]
    v_mfma_f32_16x16x32_bf16 v[144:147], a[160:163], v[96:99], v[144:147]
    v_mfma_f32_16x16x32_bf16 v[152:155], a[224:227], v[96:99], v[152:155]
    v_mfma_f32_16x16x32_bf16 v[132:135], a[32:35], v[100:103], v[132:135]
    v_mfma_f32_16x16x32_bf16 v[140:143], a[96:99], v[100:103], v[140:143]
    v_mfma_f32_16x16x32_bf16 v[148:151], a[160:163], v[100:103], v[148:151]
    v_mfma_f32_16x16x32_bf16 v[156:159], a[224:227], v[100:103], v[156:159]
    ds_read_b128 v[96:99], v6 offset:5120
    ds_read_b128 v[100:103], v6 offset:21504
    s_waitcnt lgkmcnt(2)
    v_mfma_f32_16x16x32_bf16 v[128:131], a[36:39], v[104:107], v[128:131]
    v_mfma_f32_16x16x32_bf16 v[136:139], a[100:103], v[104:107], v[136:139]
    v_mfma_f32_16x16x32_bf16 v[144:147], a[164:167], v[104:107], v[144:147]
    v_mfma_f32_16x16x32_bf16 v[152:155], a[228:231], v[104:107], v[152:155]
    v_mfma_f32_16x16x32_bf16 v[132:135], a[36:39], v[108:111], v[132:135]
    v_mfma_f32_16x16x32_bf16 v[140:143], a[100:103], v[108:111], v[140:143]
    v_mfma_f32_16x16x32_bf16 v[148:151], a[164:167], v[108:111], v[148:151]
    v_mfma_f32_16x16x32_bf16 v[156:159], a[228:231], v[108:111], v[156:159]
    ds_read_b128 v[104:107], v7 offset:5120
    ds_read_b128 v[108:111], v7 offset:21504
    s_waitcnt lgkmcnt(2)
    v_mfma_f32_16x16x32_bf16 v[128:131], a[40:43], v[96:99], v[128:131]
    v_mfma_f32_16x16x32_bf16 v[136:139], a[104:107], v[96:99], v[136:139]
    v_mfma_f32_16x16x32_bf16 v[144:147], a[168:171], v[96:99], v[144:147]
    v_mfma_f32_16x16x32_bf16 v[152:155], a[232:235], v[96:99], v[152:155]
    v_mfma_f32_16x16x32_bf16 v[132:135], a[40:43], v[100:103], v[132:135]
    v_mfma_f32_16x16x32_bf16 v[140:143], a[104:107], v[100:103], v[140:143]
    v_mfma_f32_16x16x32_bf16 v[148:151], a[168:171], v[100:103], v[148:151]
    v_mfma_f32_16x16x32_bf16 v[156:159], a[232:235], v[100:103], v[156:159]
    ds_read_b128 v[96:99], v6 offset:6144
    ds_read_b128 v[100:103], v6 offset:22528
    s_waitcnt lgkmcnt(2)
    v_mfma_f32_16x16x32_bf16 v[128:131], a[44:47], v[104:107], v[128:131]
    v_mfma_f32_16x16x32_bf16 v[136:139], a[108:111], v[104:107], v[136:139]
    v_mfma_f32_16x16x32_bf16 v[144:147], a[172:175], v[104:107], v[144:147]
    v_mfma_f32_16x16x32_bf16 v[152:155], a[236:239], v[104:107], v[152:155]
    v_mfma_f32_16x16x32_bf16 v[132:135], a[44:47], v[108:111], v[132:135]
    v_mfma_f32_16x16x32_bf16 v[140:143], a[108:111], v[108:111], v[140:143]
    v_mfma_f32_16x16x32_bf16 v[148:151], a[172:175], v[108:111], v[148:151]
    v_mfma_f32_16x16x32_bf16 v[156:159], a[236:239], v[108:111], v[156:159]
    ds_read_b128 v[104:107], v7 offset:6144
    ds_read_b128 v[108:111], v7 offset:22528
    s_waitcnt lgkmcnt(2)
    v_mfma_f32_16x16x32_bf16 v[128:131], a[48:51], v[96:99], v[128:131]
    v_mfma_f32_16x16x32_bf16 v[136:139], a[112:115], v[96:99], v[136:139]
    v_mfma_f32_16x16x32_bf16 v[144:147], a[176:179], v[96:99], v[144:147]
    v_mfma_f32_16x16x32_bf16 v[152:155], a[240:243], v[96:99], v[152:155]
    v_mfma_f32_16x16x32_bf16 v[132:135], a[48:51], v[100:103], v[132:135]
    v_mfma_f32_16x16x32_bf16 v[140:143], a[112:115], v[100:103], v[140:143]
    v_mfma_f32_16x16x32_bf16 v[148:151], a[176:179], v[100:103], v[148:151]
    v_mfma_f32_16x16x32_bf16 v[156:159], a[240:243], v[100:103], v[156:159]
    ds_read_b128 v[96:99], v6 offset:7168
    ds_read_b128 v[100:103], v6 offset:23552
    s_waitcnt lgkmcnt(2)
    v_mfma_f32_16x16x32_bf16 v[128:131], a[52:55], v[104:107], v[128:131]
    v_mfma_f32_16x16x32_bf16 v[136:139], a[116:119], v[104:107], v[136:139]
    v_mfma_f32_16x16x32_bf16 v[144:147], a[180:183], v[104:107], v[144:147]
    v_mfma_f32_16x16x32_bf16 v[152:155], a[244:247], v[104:107], v[152:155]
    v_mfma_f32_16x16x32_bf16 v[132:135], a[52:55], v[108:111], v[132:135]
    v_mfma_f32_16x16x32_bf16 v[140:143], a[116:119], v[108:111], v[140:143]
    v_mfma_f32_16x16x32_bf16 v[148:151], a[180:183], v[108:111], v[148:151]
    v_mfma_f32_16x16x32_bf16 v[156:159], a[244:247], v[108:111], v[156:159]
    ds_read_b128 v[104:107], v7 offset:7168
    ds_read_b128 v[108:111], v7 offset:23552
    s_waitcnt lgkmcnt(2)
    v_mfma_f32_16x16x32_bf16 v[128:131], a[56:59], v[96:99], v[128:131]
    v_mfma_f32_16x16x32_bf16 v[136:139], a[120:123], v[96:99], v[136:139]
    v_mfma_f32_16x16x32_bf16 v[144:147], a[184:187], v[96:99], v[144:147]
    v_mfma_f32_16x16x32_bf16 v[152:155], a[248:251], v[96:99], v[152:155]
    v_mfma_f32_16x16x32_bf16 v[132:135], a[56:59], v[100:103], v[132:135]
    v_mfma_f32_16x16x32_bf16 v[140:143], a[120:123], v[100:103], v[140:143]
    v_mfma_f32_16x16x32_bf16 v[148:151], a[184:187], v[100:103], v[148:151]
    v_mfma_f32_16x16x32_bf16 v[156:159], a[248:251], v[100:103], v[156:159]
    s_waitcnt lgkmcnt(0)
    v_mfma_f32_16x16x32_bf16 v[128:131], a[60:63], v[104:107], v[128:131]
    v_mfma_f32_16x16x32_bf16 v[136:139], a[124:127], v[104:107], v[136:139]
    v_mfma_f32_16x16x32_bf16 v[144:147], a[188:191], v[104:107], v[144:147]
    v_mfma_f32_16x16x32_bf16 v[152:155], a[252:255], v[104:107], v[152:155]
    v_mfma_f32_16x16x32_bf16 v[132:135], a[60:63], v[108:111], v[132:135]
    v_mfma_f32_16x16x32_bf16 v[140:143], a[124:127], v[108:111], v[140:143]
    v_mfma_f32_16x16x32_bf16 v[148:151], a[188:191], v[108:111], v[148:151]
    v_mfma_f32_16x16x32_bf16 v[156:159], a[252:255], v[108:111], v[156:159]
LJ_15:
    s_nop 7
    v_cvt_pk_bf16_f32 v112, v128, v129
    v_cvt_pk_bf16_f32 v113, v130, v131
    v_cvt_pk_bf16_f32 v114, v136, v137
    v_cvt_pk_bf16_f32 v115, v138, v139
    global_store_dwordx4 v16, v[112:115], s[12:13] offset:0 sc1
    v_cvt_pk_bf16_f32 v116, v144, v145
    v_cvt_pk_bf16_f32 v117, v146, v147
    v_cvt_pk_bf16_f32 v118, v152, v153
    v_cvt_pk_bf16_f32 v119, v154, v155
    global_store_dwordx4 v16, v[116:119], s[12:13] offset:1024 sc1
    v_cvt_pk_bf16_f32 v120, v132, v133
    v_cvt_pk_bf16_f32 v121, v134, v135
    v_cvt_pk_bf16_f32 v122, v140, v141
    v_cvt_pk_bf16_f32 v123, v142, v143
    global_store_dwordx4 v17, v[120:123], s[12:13] offset:0 sc1
    v_cvt_pk_bf16_f32 v124, v148, v149
    v_cvt_pk_bf16_f32 v125, v150, v151
    v_cvt_pk_bf16_f32 v126, v156, v157
    v_cvt_pk_bf16_f32 v127, v158, v159
    global_store_dwordx4 v17, v[124:127], s[12:13] offset:1024 sc1
    s_add_u32 s12, s12, 0x80000
    s_addc_u32 s13, s13, 0
    s_add_u32 s20, s20, 1
    s_cmp_le_u32 s20, 3
    s_cbranch_scc0 LEF_16
    s_waitcnt vmcnt(0)
    s_barrier
    s_cmp_eq_u32 s6, 0
    s_cbranch_scc0 LPUB_17
    v_mov_b32 v8, s20
    v_mov_b32 v9, 0
    s_mov_b64 exec, 1
    global_store_dword v9, v8, s[14:15] sc1
    s_mov_b64 exec, -1
LPUB_17:
    s_cmp_eq_u32 s20, 3
    s_cbranch_scc0 LEF_16
LEF_16:
    s_cmp_lt_u32 s20, 32
    s_cbranch_scc1 L_K_loop
L_K_end:
    s_waitcnt vmcnt(0)
    s_barrier
    s_mov_b32 s23, 32
    s_cmp_eq_u32 s6, 0
    s_cbranch_scc0 LPUB_18
    v_mov_b32 v8, s23
    v_mov_b32 v9, 0
    s_mov_b64 exec, 1
    global_store_dword v9, v8, s[14:15] sc1
    s_mov_b64 exec, -1
LPUB_18:
    v_mov_b32 v20, 0
    s_mov_b32 s28, 0
LWA_19:
    global_load_dword v21, v20, s[38:39] sc1
    s_waitcnt vmcnt(0)
    v_readfirstlane_b32 s21, v21
    s_cmp_ge_u32 s21, 256
    s_cbranch_scc1 LWAOK_20
    s_sleep 4
    s_add_u32 s28, s28, 1
    s_cmp_lt_u32 s28, 0x40000
    s_cbranch_scc1 LWA_19
    s_branch L_fail
LWAOK_20:
    s_and_b32 s21, s31, 63
    s_lshr_b32 s5, s21, 2
    s_and_b32 s4, s21, 3
    s_cmp_lt_u32 s5, 8
    s_cselect_b32 s8, s78, s86
    s_cselect_b32 s9, s79, s87
    s_and_b32 s21, s5, 7
    s_lshl_b32 s21, s21, 19
    s_lshl_b32 s22, s4, 8
    s_add_u32 s21, s21, s22
    s_add_u32 s8, s8, s21
    s_addc_u32 s9, s9, 0
    v_lshrrev_b32 v20, 4, v0
    v_and_b32 v23, 15, v0
    v_lshrrev_b32 v21, 2, v23
    v_and_b32 v22, 3, v0
    v_and_b32 v24, 15, v0
    v_lshrrev_b32 v25, 4, v0
    v_lshlrev_b32 v26, 1, v25
    v_xor_b32 v27, v24, v26
    v_xor_b32 v28, 8, v27
    v_lshlrev_b32 v27, 4, v27
    v_lshlrev_b32 v28, 4, v28
    v_lshlrev_b32 v29, 10, v25
    v_add_u32 v27, v27, v29
    v_add_u32 v28, v28, v29
    s_lshl_b32 s21, s6, 17
    s_add_u32 s24, s8, s21
    s_addc_u32 s25, s9, 0
    s_lshl_b32 s30, s6, 15
    s_mov_b32 m0, s30
    s_add_u32 s30, s30, 1024
    global_load_lds_dwordx4 v27, s[24:25]
    s_add_u32 s24, s24, 0x1000
    s_addc_u32 s25, s25, 0
    s_mov_b32 m0, s30
    s_add_u32 s30, s30, 1024
    global_load_lds_dwordx4 v28, s[24:25]
    s_add_u32 s24, s24, 0x1000
    s_addc_u32 s25, s25, 0
    s_mov_b32 m0, s30
    s_add_u32 s30, s30, 1024
    global_load_lds_dwordx4 v27, s[24:25]
    s_add_u32 s24, s24, 0x1000
    s_addc_u32 s25, s25, 0
    s_mov_b32 m0, s30
    s_add_u32 s30, s30, 1024
    global_load_lds_dwordx4 v28, s[24:25]
    s_add_u32 s24, s24, 0x1000
    s_addc_u32 s25, s25, 0
    s_mov_b32 m0, s30
    s_add_u32 s30, s30, 1024
    global_load_lds_dwordx4 v27, s[24:25]
    s_add_u32 s24, s24, 0x1000
    s_addc_u32 s25, s25, 0
    s_mov_b32 m0, s30
    s_add_u32 s30, s30, 1024
    global_load_lds_dwordx4 v28, s[24:25]
    s_add_u32 s24, s24, 0x1000
    s_addc_u32 s25, s25, 0
    s_mov_b32 m0, s30
    s_add_u32 s30, s30, 1024
    global_load_lds_dwordx4 v27, s[24:25]
    s_add_u32 s24, s24, 0x1000
    s_addc_u32 s25, s25, 0
    s_mov_b32 m0, s30
    s_add_u32 s30, s30, 1024
    global_load_lds_dwordx4 v28, s[24:25]
    s_add_u32 s24, s24, 0x1000
    s_addc_u32 s25, s25, 0
    s_mov_b32 m0, s30
    s_add_u32 s30, s30, 1024
    global_load_lds_dwordx4 v27, s[24:25]
    s_add_u32 s24, s24, 0x1000
    s_addc_u32 s25, s25, 0
    s_mov_b32 m0, s30
    s_add_u32 s30, s30, 1024
    global_load_lds_dwordx4 v28, s[24:25]
    s_add_u32 s24, s24, 0x1000
    s_addc_u32 s25, s25, 0
    s_mov_b32 m0, s30
    s_add_u32 s30, s30, 1024
    global_load_lds_dwordx4 v27, s[24:25]
    s_add_u32 s24, s24, 0x1000
    s_addc_u32 s25, s25, 0
    s_mov_b32 m0, s30
    s_add_u32 s30, s30, 1024
    global_load_lds_dwordx4 v28, s[24:25]
    s_add_u32 s24, s24, 0x1000
    s_addc_u32 s25, s25, 0
    s_mov_b32 m0, s30
    s_add_u32 s30, s30, 1024
    global_load_lds_dwordx4 v27, s[24:25]
    s_add_u32 s24, s24, 0x1000
    s_addc_u32 s25, s25, 0
    s_mov_b32 m0, s30
    s_add_u32 s30, s30, 1024
    global_load_lds_dwordx4 v28, s[24:25]
    s_add_u32 s24, s24, 0x1000
    s_addc_u32 s25, s25, 0
    s_mov_b32 m0, s30
    s_add_u32 s30, s30, 1024
    global_load_lds_dwordx4 v27, s[24:25]
    s_add_u32 s24, s24, 0x1000
    s_addc_u32 s25, s25, 0
    s_mov_b32 m0, s30
    s_add_u32 s30, s30, 1024
    global_load_lds_dwordx4 v28, s[24:25]
    s_add_u32 s24, s24, 0x1000
    s_addc_u32 s25, s25, 0
    s_mov_b32 m0, s30
    s_add_u32 s30, s30, 1024
    global_load_lds_dwordx4 v27, s[24:25]
    s_add_u32 s24, s24, 0x1000
    s_addc_u32 s25, s25, 0
    s_mov_b32 m0, s30
    s_add_u32 s30, s30, 1024
    global_load_lds_dwordx4 v28, s[24:25]
    s_add_u32 s24, s24, 0x1000
    s_addc_u32 s25, s25, 0
    s_mov_b32 m0, s30
    s_add_u32 s30, s30, 1024
    global_load_lds_dwordx4 v27, s[24:25]
    s_add_u32 s24, s24, 0x1000
    s_addc_u32 s25, s25, 0
    s_mov_b32 m0, s30
    s_add_u32 s30, s30, 1024
    global_load_lds_dwordx4 v28, s[24:25]
    s_add_u32 s24, s24, 0x1000
    s_addc_u32 s25, s25, 0
    s_mov_b32 m0, s30
    s_add_u32 s30, s30, 1024
    global_load_lds_dwordx4 v27, s[24:25]
    s_add_u32 s24, s24, 0x1000
    s_addc_u32 s25, s25, 0
    s_mov_b32 m0, s30
    s_add_u32 s30, s30, 1024
    global_load_lds_dwordx4 v28, s[24:25]
    s_add_u32 s24, s24, 0x1000
    s_addc_u32 s25, s25, 0
    s_mov_b32 m0, s30
    s_add_u32 s30, s30, 1024
    global_load_lds_dwordx4 v27, s[24:25]
    s_add_u32 s24, s24, 0x1000
    s_addc_u32 s25, s25, 0
    s_mov_b32 m0, s30
    s_add_u32 s30, s30, 1024
    global_load_lds_dwordx4 v28, s[24:25]
    s_add_u32 s24, s24, 0x1000
    s_addc_u32 s25, s25, 0
    s_mov_b32 m0, s30
    s_add_u32 s30, s30, 1024
    global_load_lds_dwordx4 v27, s[24:25]
    s_add_u32 s24, s24, 0x1000
    s_addc_u32 s25, s25, 0
    s_mov_b32 m0, s30
    s_add_u32 s30, s30, 1024
    global_load_lds_dwordx4 v28, s[24:25]
    s_add_u32 s24, s24, 0x1000
    s_addc_u32 s25, s25, 0
    s_mov_b32 m0, s30
    s_add_u32 s30, s30, 1024
    global_load_lds_dwordx4 v27, s[24:25]
    s_add_u32 s24, s24, 0x1000
    s_addc_u32 s25, s25, 0
    s_mov_b32 m0, s30
    s_add_u32 s30, s30, 1024
    global_load_lds_dwordx4 v28, s[24:25]
    s_add_u32 s24, s24, 0x1000
    s_addc_u32 s25, s25, 0
    s_mov_b32 m0, s30
    s_add_u32 s30, s30, 1024
    global_load_lds_dwordx4 v27, s[24:25]
    s_add_u32 s24, s24, 0x1000
    s_addc_u32 s25, s25, 0
    s_mov_b32 m0, s30
    s_add_u32 s30, s30, 1024
    global_load_lds_dwordx4 v28, s[24:25]
    s_add_u32 s24, s24, 0x1000
    s_addc_u32 s25, s25, 0
    s_mov_b32 m0, s30
    s_add_u32 s30, s30, 1024
    global_load_lds_dwordx4 v27, s[24:25]
    s_add_u32 s24, s24, 0x1000
    s_addc_u32 s25, s25, 0
    s_mov_b32 m0, s30
    s_add_u32 s30, s30, 1024
    global_load_lds_dwordx4 v28, s[24:25]
    s_add_u32 s24, s24, 0x1000
    s_addc_u32 s25, s25, 0
    v_lshl_add_u32 v24, v20, 2, v21
    v_and_b32 v25, 7, v24
    v_lshlrev_b32 v24, 8, v24
    v_lshl_add_u32 v24, v22, 3, v24
    s_lshl_b32 s21, s7, 2
    s_add_u32 s22, s21, 0
    v_xor_b32 v26, s22, v25
    v_lshl_add_u32 v8, v26, 5, v24
    v_add_u32 v12, 0x10000, v8
    s_add_u32 s22, s21, 1
    v_xor_b32 v26, s22, v25
    v_lshl_add_u32 v9, v26, 5, v24
    v_add_u32 v13, 0x10000, v9
    s_add_u32 s22, s21, 2
    v_xor_b32 v26, s22, v25
    v_lshl_add_u32 v10, v26, 5, v24
    v_add_u32 v14, 0x10000, v10
    s_add_u32 s22, s21, 3
    v_xor_b32 v26, s22, v25
    v_lshl_add_u32 v11, v26, 5, v24
    v_add_u32 v15, 0x10000, v11
    s_waitcnt vmcnt(0)
    s_barrier
    ds_read_b64_tr_b16 a[0:1], v8 offset:0
    ds_read_b64_tr_b16 a[2:3], v8 offset:4096
    ds_read_b64_tr_b16 a[4:5], v8 offset:8192
    ds_read_b64_tr_b16 a[6:7], v8 offset:12288
    ds_read_b64_tr_b16 a[8:9], v8 offset:16384
    ds_read_b64_tr_b16 a[10:11], v8 offset:20480
    ds_read_b64_tr_b16 a[12:13], v8 offset:24576
    ds_read_b64_tr_b16 a[14:15], v8 offset:28672
    ds_read_b64_tr_b16 a[16:17], v8 offset:32768
    ds_read_b64_tr_b16 a[18:19], v8 offset:36864
    ds_read_b64_tr_b16 a[20:21], v8 offset:40960
    ds_read_b64_tr_b16 a[22:23], v8 offset:45056
    s_waitcnt lgkmcnt(4)
    ds_read_b64_tr_b16 a[24:25], v8 offset:49152
    ds_read_b64_tr_b16 a[26:27], v8 offset:53248
    ds_read_b64_tr_b16 a[28:29], v8 offset:57344
    ds_read_b64_tr_b16 a[30:31], v8 offset:61440
    ds_read_b64_tr_b16 a[32:33], v12 offset:0
    ds_read_b64_tr_b16 a[34:35], v12 offset:4096
    ds_read_b64_tr_b16 a[36:37], v12 offset:8192
    ds_read_b64_tr_b16 a[38:39], v12 offset:12288
    ds_read_b64_tr_b16 a[40:41], v12 offset:16384
    ds_read_b64_tr_b16 a[42:43], v12 offset:20480
    ds_read_b64_tr_b16 a[44:45], v12 offset:24576
    ds_read_b64_tr_b16 a[46:47], v12 offset:28672
    s_waitcnt lgkmcnt(4)
    ds_read_b64_tr_b16 a[48:49], v12 offset:32768
    ds_read_b64_tr_b16 a[50:51], v12 offset:36864
    ds_read_b64_tr_b16 a[52:53], v12 offset:40960
    ds_read_b64_tr_b16 a[54:55], v12 offset:45056
    ds_read_b64_tr_b16 a[56:57], v12 offset:49152
    ds_read_b64_tr_b16 a[58:59], v12 offset:53248
    ds_read_b64_tr_b16 a[60:61], v12 offset:57344
    ds_read_b64_tr_b16 a[62:63], v12 offset:61440
    s_waitcnt lgkmcnt(0)
    ds_read_b64_tr_b16 a[64:65], v9 offset:0
    ds_read_b64_tr_b16 a[66:67], v9 offset:4096
    ds_read_b64_tr_b16 a[68:69], v9 offset:8192
    ds_read_b64_tr_b16 a[70:71], v9 offset:12288
    ds_read_b64_tr_b16 a[72:73], v9 offset:16384
    ds_read_b64_tr_b16 a[74:75], v9 offset:20480
    ds_read_b64_tr_b16 a[76:77], v9 offset:24576
    ds_read_b64_tr_b16 a[78:79], v9 offset:28672
    ds_read_b64_tr_b16 a[80:81], v9 offset:32768
    ds_read_b64_tr_b16 a[82:83], v9 offset:36864
    ds_read_b64_tr_b16 a[84:85], v9 offset:40960
    ds_read_b64_tr_b16 a[86:87], v9 offset:45056
    s_waitcnt lgkmcnt(4)
    ds_read_b64_tr_b16 a[88:89], v9 offset:49152
    ds_read_b64_tr_b16 a[90:91], v9 offset:53248
    ds_read_b64_tr_b16 a[92:93], v9 offset:57344
    ds_read_b64_tr_b16 a[94:95], v9 offset:61440
    ds_read_b64_tr_b16 a[96:97], v13 offset:0
    ds_read_b64_tr_b16 a[98:99], v13 offset:4096
    ds_read_b64_tr_b16 a[100:101], v13 offset:8192
    ds_read_b64_tr_b16 a[102:103], v13 offset:12288
    ds_read_b64_tr_b16 a[104:105], v13 offset:16384
    ds_read_b64_tr_b16 a[106:107], v13 offset:20480
    ds_read_b64_tr_b16 a[108:109], v13 offset:24576
    ds_read_b64_tr_b16 a[110:111], v13 offset:28672
    s_waitcnt lgkmcnt(4)
    ds_read_b64_tr_b16 a[112:113], v13 offset:32768
    ds_read_b64_tr_b16 a[114:115], v13 offset:36864
    ds_read_b64_tr_b16 a[116:117], v13 offset:40960
    ds_read_b64_tr_b16 a[118:119], v13 offset:45056
    ds_read_b64_tr_b16 a[120:121], v13 offset:49152
    ds_read_b64_tr_b16 a[122:123], v13 offset:53248
    ds_read_b64_tr_b16 a[124:125], v13 offset:57344
    ds_read_b64_tr_b16 a[126:127], v13 offset:61440
    s_waitcnt lgkmcnt(0)
    ds_read_b64_tr_b16 a[128:129], v10 offset:0
    ds_read_b64_tr_b16 a[130:131], v10 offset:4096
    ds_read_b64_tr_b16 a[132:133], v10 offset:8192
    ds_read_b64_tr_b16 a[134:135], v10 offset:12288
    ds_read_b64_tr_b16 a[136:137], v10 offset:16384
    ds_read_b64_tr_b16 a[138:139], v10 offset:20480
    ds_read_b64_tr_b16 a[140:141], v10 offset:24576
    ds_read_b64_tr_b16 a[142:143], v10 offset:28672
    ds_read_b64_tr_b16 a[144:145], v10 offset:32768
    ds_read_b64_tr_b16 a[146:147], v10 offset:36864
    ds_read_b64_tr_b16 a[148:149], v10 offset:40960
    ds_read_b64_tr_b16 a[150:151], v10 offset:45056
    s_waitcnt lgkmcnt(4)
    ds_read_b64_tr_b16 a[152:153], v10 offset:49152
    ds_read_b64_tr_b16 a[154:155], v10 offset:53248
    ds_read_b64_tr_b16 a[156:157], v10 offset:57344
    ds_read_b64_tr_b16 a[158:159], v10 offset:61440
    ds_read_b64_tr_b16 a[160:161], v14 offset:0
    ds_read_b64_tr_b16 a[162:163], v14 offset:4096
    ds_read_b64_tr_b16 a[164:165], v14 offset:8192
    ds_read_b64_tr_b16 a[166:167], v14 offset:12288
    ds_read_b64_tr_b16 a[168:169], v14 offset:16384
    ds_read_b64_tr_b16 a[170:171], v14 offset:20480
    ds_read_b64_tr_b16 a[172:173], v14 offset:24576
    ds_read_b64_tr_b16 a[174:175], v14 offset:28672
    s_waitcnt lgkmcnt(4)
    ds_read_b64_tr_b16 a[176:177], v14 offset:32768
    ds_read_b64_tr_b16 a[178:179], v14 offset:36864
    ds_read_b64_tr_b16 a[180:181], v14 offset:40960
    ds_read_b64_tr_b16 a[182:183], v14 offset:45056
    ds_read_b64_tr_b16 a[184:185], v14 offset:49152
    ds_read_b64_tr_b16 a[186:187], v14 offset:53248
    ds_read_b64_tr_b16 a[188:189], v14 offset:57344
    ds_read_b64_tr_b16 a[190:191], v14 offset:61440
    s_waitcnt lgkmcnt(0)
    ds_read_b64_tr_b16 a[192:193], v11 offset:0
    ds_read_b64_tr_b16 a[194:195], v11 offset:4096
    ds_read_b64_tr_b16 a[196:197], v11 offset:8192
    ds_read_b64_tr_b16 a[198:199], v11 offset:12288
    ds_read_b64_tr_b16 a[200:201], v11 offset:16384
    ds_read_b64_tr_b16 a[202:203], v11 offset:20480
    ds_read_b64_tr_b16 a[204:205], v11 offset:24576
    ds_read_b64_tr_b16 a[206:207], v11 offset:28672
    ds_read_b64_tr_b16 a[208:209], v11 offset:32768
    ds_read_b64_tr_b16 a[210:211], v11 offset:36864
    ds_read_b64_tr_b16 a[212:213], v11 offset:40960
    ds_read_b64_tr_b16 a[214:215], v11 offset:45056
    s_waitcnt lgkmcnt(4)
    ds_read_b64_tr_b16 a[216:217], v11 offset:49152
    ds_read_b64_tr_b16 a[218:219], v11 offset:53248
    ds_read_b64_tr_b16 a[220:221], v11 offset:57344
    ds_read_b64_tr_b16 a[222:223], v11 offset:61440
    ds_read_b64_tr_b16 a[224:225], v15 offset:0
    ds_read_b64_tr_b16 a[226:227], v15 offset:4096
    ds_read_b64_tr_b16 a[228:229], v15 offset:8192
    ds_read_b64_tr_b16 a[230:231], v15 offset:12288
    ds_read_b64_tr_b16 a[232:233], v15 offset:16384
    ds_read_b64_tr_b16 a[234:235], v15 offset:20480
    ds_read_b64_tr_b16 a[236:237], v15 offset:24576
    ds_read_b64_tr_b16 a[238:239], v15 offset:28672
    s_waitcnt lgkmcnt(4)
    ds_read_b64_tr_b16 a[240:241], v15 offset:32768
    ds_read_b64_tr_b16 a[242:243], v15 offset:36864
    ds_read_b64_tr_b16 a[244:245], v15 offset:40960
    ds_read_b64_tr_b16 a[246:247], v15 offset:45056
    ds_read_b64_tr_b16 a[248:249], v15 offset:49152
    ds_read_b64_tr_b16 a[250:251], v15 offset:53248
    ds_read_b64_tr_b16 a[252:253], v15 offset:57344
    ds_read_b64_tr_b16 a[254:255], v15 offset:61440
    s_waitcnt lgkmcnt(0)
    s_barrier
    v_lshlrev_b32 v1, 4, v0
    s_lshl_b32 s21, s3, 15
    v_add_u32 v4, s21, v1
    v_mov_b32 v5, v4
    v_add_u32 v6, 0x10000, v4
    v_mov_b32 v7, v6
    s_lshr_b32 s21, s5, 3
    s_lshl_b32 s21, s21, 24
    s_and_b32 s22, s5, 7
    s_lshl_b32 s22, s22, 14
    s_add_u32 s21, s21, s22
    s_add_u32 s21, s21, 0x5400000
    s_add_u32 s26, s18, s21
    s_addc_u32 s27, s19, 0
    s_lshl_b32 s21, s5, 22
    s_add_u32 s21, s21, 0x7400000
    s_add_u32 s12, s18, s21
    s_addc_u32 s13, s19, 0
    s_lshl_b32 s21, s3, 16
    s_lshl_b32 s22, s4, 13
    s_add_u32 s21, s21, s22
    s_lshl_b32 s22, s7, 12
    s_add_u32 s21, s21, s22
    v_add_u32 v16, s21, v1
    v_add_u32 v17, 0x8000, v16
    s_lshl_b32 s21, s5, 2
    s_add_u32 s22, s21, s4
    s_lshl_b32 s22, s22, 7
    s_add_u32 s22, s22, 0x5208000
    s_add_u32 s14, s18, s22
    s_addc_u32 s15, s19, 0
    s_lshl_b32 s21, s21, 7
    s_add_u32 s21, s21, 0x5206000
    s_add_u32 s16, s18, s21
    s_addc_u32 s17, s19, 0
    s_mov_b32 s20, 0
    s_mov_b32 s93, 0
    s_mov_b32 s29, 1
    s_cmp_eq_u32 s6, 0
    s_cbranch_scc0 LRF_21
    v_and_b32 v10, 3, v0
    v_lshlrev_b32 v10, 7, v10
    s_mov_b32 s28, 0
LPM_22:
    global_load_dword v11, v10, s[16:17] sc1
    s_waitcnt vmcnt(0)
    v_readlane_b32 s92, v11, 0
    v_readlane_b32 s21, v11, 1
    s_nop 0
    s_min_u32 s92, s92, s21
    v_readlane_b32 s21, v11, 2
    s_nop 0
    s_min_u32 s92, s92, s21
    v_readlane_b32 s21, v11, 3
    s_nop 0
    s_min_u32 s92, s92, s21
    s_cmp_ge_u32 s92, s29
    s_cbranch_scc1 LPMOK_23
    s_sleep 1
    s_add_u32 s28, s28, 1
    s_cmp_lt_u32 s28, 0x40000
    s_cbranch_scc1 LPM_22
    s_branch L_fail
LPMOK_23:
    v_mov_b32 v8, s92
    v_mov_b32 v9, 163072
    ds_write_b32 v9, v8
    s_waitcnt lgkmcnt(0)
LRF_21:
    s_barrier
    v_mov_b32 v9, 163072
    ds_read_b32 v8, v9
    s_waitcnt lgkmcnt(0)
    s_nop 0
    v_readfirstlane_b32 s92, v8
    s_lshl_b32 s21, s6, 17
    s_add_u32 s24, s26, s21
    s_addc_u32 s25, s27, 0
    s_lshl_b32 s30, s6, 14
    s_add_u32 s30, s30, 0
    s_mov_b32 m0, s30
    s_nop 0
    global_load_lds_dwordx4 v1, s[24:25] offset:0 sc1
    s_mov_b32 m0, s30
    s_nop 0
    global_load_lds_dwordx4 v1, s[24:25] offset:1024 sc1
    s_mov_b32 m0, s30
    s_nop 0
    global_load_lds_dwordx4 v1, s[24:25] offset:2048 sc1
    s_mov_b32 m0, s30
    s_nop 0
    global_load_lds_dwordx4 v1, s[24:25] offset:3072 sc1
    s_add_u32 s24, s24, 4096
    s_addc_u32 s25, s25, 0
    s_add_u32 s30, s30, 4096
    s_mov_b32 m0, s30
    s_nop 0
    global_load_lds_dwordx4 v1, s[24:25] offset:0 sc1
    s_mov_b32 m0, s30
    s_nop 0
    global_load_lds_dwordx4 v1, s[24:25] offset:1024 sc1
    s_mov_b32 m0, s30
    s_nop 0
    global_load_lds_dwordx4 v1, s[24:25] offset:2048 sc1
    s_mov_b32 m0, s30
    s_nop 0
    global_load_lds_dwordx4 v1, s[24:25] offset:3072 sc1
    s_add_u32 s24, s24, 4096
    s_addc_u32 s25, s25, 0
    s_add_u32 s30, s30, 4096
    s_mov_b32 m0, s30
    s_nop 0
    global_load_lds_dwordx4 v1, s[24:25] offset:0 sc1
    s_mov_b32 m0, s30
    s_nop 0
    global_load_lds_dwordx4 v1, s[24:25] offset:1024 sc1
    s_mov_b32 m0, s30
    s_nop 0
    global_load_lds_dwordx4 v1, s[24:25] offset:2048 sc1
    s_mov_b32 m0, s30
    s_nop 0
    global_load_lds_dwordx4 v1, s[24:25] offset:3072 sc1
    s_add_u32 s24, s24, 4096
    s_addc_u32 s25, s25, 0
    s_add_u32 s30, s30, 4096
    s_mov_b32 m0, s30
    s_nop 0
    global_load_lds_dwordx4 v1, s[24:25] offset:0 sc1
    s_mov_b32 m0, s30
    s_nop 0
    global_load_lds_dwordx4 v1, s[24:25] offset:1024 sc1
    s_mov_b32 m0, s30
    s_nop 0
    global_load_lds_dwordx4 v1, s[24:25] offset:2048 sc1
    s_mov_b32 m0, s30
    s_nop 0
    global_load_lds_dwordx4 v1, s[24:25] offset:3072 sc1
    s_waitcnt vmcnt(0)
L_P_loop:
    s_waitcnt vmcnt(8)
    s_barrier
    s_sub_u32 s23, s20, 1
    s_cmp_gt_i32 s23, s93
    s_cbranch_scc0 LNP_24
    s_mov_b32 s93, s23
    s_cmp_eq_u32 s6, 0
    s_cbranch_scc0 LPUB_25
    v_mov_b32 v8, s23
    v_mov_b32 v9, 0
    s_mov_b64 exec, 1
    global_store_dword v9, v8, s[14:15] sc1
    s_mov_b64 exec, -1
LPUB_25:
LNP_24:
    s_add_u32 s26, s26, 0x80000
    s_addc_u32 s27, s27, 0
    s_add_u32 s23, s20, 2
    s_cmp_ge_u32 s92, s23
    s_cbranch_scc0 LPB_26
    ds_read_b128 v[96:99], v4 offset:0
    ds_read_b128 v[100:103], v4 offset:16384
    ds_read_b128 v[104:107], v4 offset:1024
    ds_read_b128 v[108:111], v4 offset:17408
    s_waitcnt lgkmcnt(2)
    v_mfma_f32_16x16x32_bf16 v[128:131], a[0:3], v[96:99], 0
    v_mfma_f32_16x16x32_bf16 v[136:139], a[64:67], v[96:99], 0
    s_lshl_b32 s21, s6, 17
    s_add_u32 s24, s26, s21
    s_addc_u32 s25, s27, 0
    s_lshl_b32 s30, s6, 14
    s_add_u32 s30, s30, 65536
    s_mov_b32 m0, s30
    s_nop 0
    global_load_lds_dwordx4 v1, s[24:25] offset:0 sc1
    v_mfma_f32_16x16x32_bf16 v[144:147], a[128:131], v[96:99], 0
    v_mfma_f32_16x16x32_bf16 v[152:155], a[192:195], v[96:99], 0
    v_mfma_f32_16x16x32_bf16 v[132:135], a[0:3], v[100:103], 0
    v_mfma_f32_16x16x32_bf16 v[140:143], a[64:67], v[100:103], 0
    v_mfma_f32_16x16x32_bf16 v[148:151], a[128:131], v[100:103], 0
    v_mfma_f32_16x16x32_bf16 v[156:159], a[192:195], v[100:103], 0
    ds_read_b128 v[96:99], v4 offset:2048
    ds_read_b128 v[100:103], v4 offset:18432
    s_waitcnt lgkmcnt(2)
    v_mfma_f32_16x16x32_bf16 v[128:131], a[4:7], v[104:107], v[128:131]
    v_mfma_f32_16x16x32_bf16 v[136:139], a[68:71], v[104:107], v[136:139]
    s_mov_b32 m0, s30
    s_nop 0
    global_load_lds_dwordx4 v1, s[24:25] offset:1024 sc1
    v_mfma_f32_16x16x32_bf16 v[144:147], a[132:135], v[104:107], v[144:147]
    v_mfma_f32_16x16x32_bf16 v[152:155], a[196:199], v[104:107], v[152:155]
    v_mfma_f32_16x16x32_bf16 v[132:135], a[4:7], v[108:111], v[132:135]
    v_mfma_f32_16x16x32_bf16 v[140:143], a[68:71], v[108:111], v[140:143]
    v_mfma_f32_16x16x32_bf16 v[148:151], a[132:135], v[108:111], v[148:151]
    v_mfma_f32_16x16x32_bf16 v[156:159], a[196:199], v[108:111], v[156:159]
    ds_read_b128 v[104:107], v4 offset:3072
    ds_read_b128 v[108:111], v4 offset:19456
    s_waitcnt lgkmcnt(2)
    v_mfma_f32_16x16x32_bf16 v[128:131], a[8:11], v[96:99], v[128:131]
    v_mfma_f32_16x16x32_bf16 v[136:139], a[72:75], v[96:99], v[136:139]
    s_mov_b32 m0, s30
    s_nop 0
    global_load_lds_dwordx4 v1, s[24:25] offset:2048 sc1
    v_mfma_f32_16x16x32_bf16 v[144:147], a[136:139], v[96:99], v[144:147]
    v_mfma_f32_16x16x32_bf16 v[152:155], a[200:203], v[96:99], v[152:155]
    v_mfma_f32_16x16x32_bf16 v[132:135], a[8:11], v[100:103], v[132:135]
    v_mfma_f32_16x16x32_bf16 v[140:143], a[72:75], v[100:103], v[140:143]
    v_mfma_f32_16x16x32_bf16 v[148:151], a[136:139], v[100:103], v[148:151]
    v_mfma_f32_16x16x32_bf16 v[156:159], a[200:203], v[100:103], v[156:159]
    ds_read_b128 v[96:99], v4 offset:4096
    ds_read_b128 v[100:103], v4 offset:20480
    s_waitcnt lgkmcnt(2)
    v_mfma_f32_16x16x32_bf16 v[128:131], a[12:15], v[104:107], v[128:131]
    v_mfma_f32_16x16x32_bf16 v[136:139], a[76:79], v[104:107], v[136:139]
    s_mov_b32 m0, s30
    s_nop 0
    global_load_lds_dwordx4 v1, s[24:25] offset:3072 sc1
    v_mfma_f32_16x16x32_bf16 v[144:147], a[140:143], v[104:107], v[144:147]
    v_mfma_f32_16x16x32_bf16 v[152:155], a[204:207], v[104:107], v[152:155]
    v_mfma_f32_16x16x32_bf16 v[132:135], a[12:15], v[108:111], v[132:135]
    v_mfma_f32_16x16x32_bf16 v[140:143], a[76:79], v[108:111], v[140:143]
    v_mfma_f32_16x16x32_bf16 v[148:151], a[140:143], v[108:111], v[148:151]
    v_mfma_f32_16x16x32_bf16 v[156:159], a[204:207], v[108:111], v[156:159]
    ds_read_b128 v[104:107], v4 offset:5120
    ds_read_b128 v[108:111], v4 offset:21504
    s_waitcnt lgkmcnt(2)
    v_mfma_f32_16x16x32_bf16 v[128:131], a[16:19], v[96:99], v[128:131]
    v_mfma_f32_16x16x32_bf16 v[136:139], a[80:83], v[96:99], v[136:139]
    s_add_u32 s24, s24, 4096
    s_addc_u32 s25, s25, 0
    s_add_u32 s30, s30, 4096
    s_mov_b32 m0, s30
    s_nop 0
    global_load_lds_dwordx4 v1, s[24:25] offset:0 sc1
    v_mfma_f32_16x16x32_bf16 v[144:147], a[144:147], v[96:99], v[144:147]
    v_mfma_f32_16x16x32_bf16 v[152:155], a[208:211], v[96:99], v[152:155]
    v_mfma_f32_16x16x32_bf16 v[132:135], a[16:19], v[100:103], v[132:135]
    v_mfma_f32_16x16x32_bf16 v[140:143], a[80:83], v[100:103], v[140:143]
    v_mfma_f32_16x16x32_bf16 v[148:151], a[144:147], v[100:103], v[148:151]
    v_mfma_f32_16x16x32_bf16 v[156:159], a[208:211], v[100:103], v[156:159]
    ds_read_b128 v[96:99], v4 offset:6144
    ds_read_b128 v[100:103], v4 offset:22528
    s_waitcnt lgkmcnt(2)
    v_mfma_f32_16x16x32_bf16 v[128:131], a[20:23], v[104:107], v[128:131]
    v_mfma_f32_16x16x32_bf16 v[136:139], a[84:87], v[104:107], v[136:139]
    s_mov_b32 m0, s30
    s_nop 0
    global_load_lds_dwordx4 v1, s[24:25] offset:1024 sc1
    v_mfma_f32_16x16x32_bf16 v[144:147], a[148:151], v[104:107], v[144:147]
    v_mfma_f32_16x16x32_bf16 v[152:155], a[212:215], v[104:107], v[152:155]
    v_mfma_f32_16x16x32_bf16 v[132:135], a[20:23], v[108:111], v[132:135]
    v_mfma_f32_16x16x32_bf16 v[140:143], a[84:87], v[108:111], v[140:143]
    v_mfma_f32_16x16x32_bf16 v[148:151], a[148:151], v[108:111], v[148:151]
    v_mfma_f32_16x16x32_bf16 v[156:159], a[212:215], v[108:111], v[156:159]
    ds_read_b128 v[104:107], v4 offset:7168
    ds_read_b128 v[108:111], v4 offset:23552
    s_waitcnt lgkmcnt(2)
    v_mfma_f32_16x16x32_bf16 v[128:131], a[24:27], v[96:99], v[128:131]
    v_mfma_f32_16x16x32_bf16 v[136:139], a[88:91], v[96:99], v[136:139]
    s_mov_b32 m0, s30
    s_nop 0
    global_load_lds_dwordx4 v1, s[24:25] offset:2048 sc1
    v_mfma_f32_16x16x32_bf16 v[144:147], a[152:155], v[96:99], v[144:147]
    v_mfma_f32_16x16x32_bf16 v[152:155], a[216:219], v[96:99], v[152:155]
    v_mfma_f32_16x16x32_bf16 v[132:135], a[24:27], v[100:103], v[132:135]
    v_mfma_f32_16x16x32_bf16 v[140:143], a[88:91], v[100:103], v[140:143]
    v_mfma_f32_16x16x32_bf16 v[148:151], a[152:155], v[100:103], v[148:151]
    v_mfma_f32_16x16x32_bf16 v[156:159], a[216:219], v[100:103], v[156:159]
    ds_read_b128 v[96:99], v4 offset:8192
    ds_read_b128 v[100:103], v4 offset:24576
    s_waitcnt lgkmcnt(2)
    v_mfma_f32_16x16x32_bf16 v[128:131], a[28:31], v[104:107], v[128:131]
    v_mfma_f32_16x16x32_bf16 v[136:139], a[92:95], v[104:107], v[136:139]
    s_mov_b32 m0, s30
    s_nop 0
    global_load_lds_dwordx4 v1, s[24:25] offset:3072 sc1
    v_mfma_f32_16x16x32_bf16 v[144:147], a[156:159], v[104:107], v[144:147]
    v_mfma_f32_16x16x32_bf16 v[152:155], a[220:223], v[104:107], v[152:155]
    v_mfma_f32_16x16x32_bf16 v[132:135], a[28:31], v[108:111], v[132:135]
    v_mfma_f32_16x16x32_bf16 v[140:143], a[92:95], v[108:111], v[140:143]
    v_mfma_f32_16x16x32_bf16 v[148:151], a[156:159], v[108:111], v[148:151]
    v_mfma_f32_16x16x32_bf16 v[156:159], a[220:223], v[108:111], v[156:159]
    ds_read_b128 v[104:107], v4 offset:9216
    ds_read_b128 v[108:111], v4 offset:25600
    s_waitcnt lgkmcnt(2)
    v_mfma_f32_16x16x32_bf16 v[128:131], a[32:35], v[96:99], v[128:131]
    v_mfma_f32_16x16x32_bf16 v[136:139], a[96:99], v[96:99], v[136:139]
    s_add_u32 s24, s24, 4096
    s_addc_u32 s25, s25, 0
    s_add_u32 s30, s30, 4096
    s_mov_b32 m0, s30
    s_nop 0
    global_load_lds_dwordx4 v1, s[24:25] offset:0 sc1
    v_mfma_f32_16x16x32_bf16 v[144:147], a[160:163], v[96:99], v[144:147]
    v_mfma_f32_16x16x32_bf16 v[152:155], a[224:227], v[96:99], v[152:155]
    v_mfma_f32_16x16x32_bf16 v[132:135], a[32:35], v[100:103], v[132:135]
    v_mfma_f32_16x16x32_bf16 v[140:143], a[96:99], v[100:103], v[140:143]
    v_mfma_f32_16x16x32_bf16 v[148:151], a[160:163], v[100:103], v[148:151]
    v_mfma_f32_16x16x32_bf16 v[156:159], a[224:227], v[100:103], v[156:159]
    ds_read_b128 v[96:99], v4 offset:10240
    ds_read_b128 v[100:103], v4 offset:26624
    s_waitcnt lgkmcnt(2)
    v_mfma_f32_16x16x32_bf16 v[128:131], a[36:39], v[104:107], v[128:131]
    v_mfma_f32_16x16x32_bf16 v[136:139], a[100:103], v[104:107], v[136:139]
    s_mov_b32 m0, s30
    s_nop 0
    global_load_lds_dwordx4 v1, s[24:25] offset:1024 sc1
    v_mfma_f32_16x16x32_bf16 v[144:147], a[164:167], v[104:107], v[144:147]
    v_mfma_f32_16x16x32_bf16 v[152:155], a[228:231], v[104:107], v[152:155]
    v_mfma_f32_16x16x32_bf16 v[132:135], a[36:39], v[108:111], v[132:135]
    v_mfma_f32_16x16x32_bf16 v[140:143], a[100:103], v[108:111], v[140:143]
    v_mfma_f32_16x16x32_bf16 v[148:151], a[164:167], v[108:111], v[148:151]
    v_mfma_f32_16x16x32_bf16 v[156:159], a[228:231], v[108:111], v[156:159]
    ds_read_b128 v[104:107], v4 offset:11264
    ds_read_b128 v[108:111], v4 offset:27648
    s_waitcnt lgkmcnt(2)
    v_mfma_f32_16x16x32_bf16 v[128:131], a[40:43], v[96:99], v[128:131]
    v_mfma_f32_16x16x32_bf16 v[136:139], a[104:107], v[96:99], v[136:139]
    s_mov_b32 m0, s30
    s_nop 0
    global_load_lds_dwordx4 v1, s[24:25] offset:2048 sc1
    v_mfma_f32_16x16x32_bf16 v[144:147], a[168:171], v[96:99], v[144:147]
    v_mfma_f32_16x16x32_bf16 v[152:155], a[232:235], v[96:99], v[152:155]
    v_mfma_f32_16x16x32_bf16 v[132:135], a[40:43], v[100:103], v[132:135]
    v_mfma_f32_16x16x32_bf16 v[140:143], a[104:107], v[100:103], v[140:143]
    v_mfma_f32_16x16x32_bf16 v[148:151], a[168:171], v[100:103], v[148:151]
    v_mfma_f32_16x16x32_bf16 v[156:159], a[232:235], v[100:103], v[156:159]
    ds_read_b128 v[96:99], v4 offset:12288
    ds_read_b128 v[100:103], v4 offset:28672
    s_waitcnt lgkmcnt(2)
    v_mfma_f32_16x16x32_bf16 v[128:131], a[44:47], v[104:107], v[128:131]
    v_mfma_f32_16x16x32_bf16 v[136:139], a[108:111], v[104:107], v[136:139]
    s_mov_b32 m0, s30
    s_nop 0
    global_load_lds_dwordx4 v1, s[24:25] offset:3072 sc1
    v_mfma_f32_16x16x32_bf16 v[144:147], a[172:175], v[104:107], v[144:147]
    v_mfma_f32_16x16x32_bf16 v[152:155], a[236:239], v[104:107], v[152:155]
    v_mfma_f32_16x16x32_bf16 v[132:135], a[44:47], v[108:111], v[132:135]
    v_mfma_f32_16x16x32_bf16 v[140:143], a[108:111], v[108:111], v[140:143]
    v_mfma_f32_16x16x32_bf16 v[148:151], a[172:175], v[108:111], v[148:151]
    v_mfma_f32_16x16x32_bf16 v[156:159], a[236:239], v[108:111], v[156:159]
    ds_read_b128 v[104:107], v4 offset:13312
    ds_read_b128 v[108:111], v4 offset:29696
    s_waitcnt lgkmcnt(2)
    v_mfma_f32_16x16x32_bf16 v[128:131], a[48:51], v[96:99], v[128:131]
    v_mfma_f32_16x16x32_bf16 v[136:139], a[112:115], v[96:99], v[136:139]
    s_add_u32 s24, s24, 4096
    s_addc_u32 s25, s25, 0
    s_add_u32 s30, s30, 4096
    s_mov_b32 m0, s30
    s_nop 0
    global_load_lds_dwordx4 v1, s[24:25] offset:0 sc1
    v_mfma_f32_16x16x32_bf16 v[144:147], a[176:179], v[96:99], v[144:147]
    v_mfma_f32_16x16x32_bf16 v[152:155], a[240:243], v[96:99], v[152:155]
    v_mfma_f32_16x16x32_bf16 v[132:135], a[48:51], v[100:103], v[132:135]
    v_mfma_f32_16x16x32_bf16 v[140:143], a[112:115], v[100:103], v[140:143]
    v_mfma_f32_16x16x32_bf16 v[148:151], a[176:179], v[100:103], v[148:151]
    v_mfma_f32_16x16x32_bf16 v[156:159], a[240:243], v[100:103], v[156:159]
    ds_read_b128 v[96:99], v4 offset:14336
    ds_read_b128 v[100:103], v4 offset:30720
    s_waitcnt lgkmcnt(2)
    v_mfma_f32_16x16x32_bf16 v[128:131], a[52:55], v[104:107], v[128:131]
    v_mfma_f32_16x16x32_bf16 v[136:139], a[116:119], v[104:107], v[136:139]
    s_mov_b32 m0, s30
    s_nop 0
    global_load_lds_dwordx4 v1, s[24:25] offset:1024 sc1
    v_mfma_f32_16x16x32_bf16 v[144:147], a[180:183], v[104:107], v[144:147]
    v_mfma_f32_16x16x32_bf16 v[152:155], a[244:247], v[104:107], v[152:155]
    v_mfma_f32_16x16x32_bf16 v[132:135], a[52:55], v[108:111], v[132:135]
    v_mfma_f32_16x16x32_bf16 v[140:143], a[116:119], v[108:111], v[140:143]
    v_mfma_f32_16x16x32_bf16 v[148:151], a[180:183], v[108:111], v[148:151]
    v_mfma_f32_16x16x32_bf16 v[156:159], a[244:247], v[108:111], v[156:159]
    ds_read_b128 v[104:107], v4 offset:15360
    ds_read_b128 v[108:111], v4 offset:31744
    s_waitcnt lgkmcnt(2)
    v_mfma_f32_16x16x32_bf16 v[128:131], a[56:59], v[96:99], v[128:131]
    v_mfma_f32_16x16x32_bf16 v[136:139], a[120:123], v[96:99], v[136:139]
    s_mov_b32 m0, s30
    s_nop 0
    global_load_lds_dwordx4 v1, s[24:25] offset:2048 sc1
    v_mfma_f32_16x16x32_bf16 v[144:147], a[184:187], v[96:99], v[144:147]
    v_mfma_f32_16x16x32_bf16 v[152:155], a[248:251], v[96:99], v[152:155]
    v_mfma_f32_16x16x32_bf16 v[132:135], a[56:59], v[100:103], v[132:135]
    v_mfma_f32_16x16x32_bf16 v[140:143], a[120:123], v[100:103], v[140:143]
    v_mfma_f32_16x16x32_bf16 v[148:151], a[184:187], v[100:103], v[148:151]
    v_mfma_f32_16x16x32_bf16 v[156:159], a[248:251], v[100:103], v[156:159]
    s_waitcnt lgkmcnt(0)
    v_mfma_f32_16x16x32_bf16 v[128:131], a[60:63], v[104:107], v[128:131]
    v_mfma_f32_16x16x32_bf16 v[136:139], a[124:127], v[104:107], v[136:139]
    s_mov_b32 m0, s30
    s_nop 0
    global_load_lds_dwordx4 v1, s[24:25] offset:3072 sc1
    v_mfma_f32_16x16x32_bf16 v[144:147], a[188:191], v[104:107], v[144:147]
    v_mfma_f32_16x16x32_bf16 v[152:155], a[252:255], v[104:107], v[152:155]
    v_mfma_f32_16x16x32_bf16 v[132:135], a[60:63], v[108:111], v[132:135]
    v_mfma_f32_16x16x32_bf16 v[140:143], a[124:127], v[108:111], v[140:143]
    v_mfma_f32_16x16x32_bf16 v[148:151], a[188:191], v[108:111], v[148:151]
    v_mfma_f32_16x16x32_bf16 v[156:159], a[252:255], v[108:111], v[156:159]
    s_nop 7
    global_store_dwordx4 v16, v[128:131], s[12:13] offset:0 sc1
    global_store_dwordx4 v16, v[136:139], s[12:13] offset:1024 sc1
    global_store_dwordx4 v16, v[144:147], s[12:13] offset:2048 sc1
    global_store_dwordx4 v16, v[152:155], s[12:13] offset:3072 sc1
    global_store_dwordx4 v17, v[132:135], s[12:13] offset:0 sc1
    global_store_dwordx4 v17, v[140:143], s[12:13] offset:1024 sc1
    global_store_dwordx4 v17, v[148:151], s[12:13] offset:2048 sc1
    global_store_dwordx4 v17, v[156:159], s[12:13] offset:3072 sc1
    s_add_u32 s12, s12, 0x20000
    s_addc_u32 s13, s13, 0
    s_add_u32 s20, s20, 1
    s_branch LJ_27
LPB_26:
    ds_read_b128 v[96:99], v4 offset:0
    ds_read_b128 v[100:103], v4 offset:16384
    ds_read_b128 v[104:107], v4 offset:1024
    ds_read_b128 v[108:111], v4 offset:17408
    s_waitcnt lgkmcnt(2)
    v_mfma_f32_16x16x32_bf16 v[128:131], a[0:3], v[96:99], 0
    v_mfma_f32_16x16x32_bf16 v[136:139], a[64:67], v[96:99], 0
    v_mfma_f32_16x16x32_bf16 v[144:147], a[128:131], v[96:99], 0
    v_mfma_f32_16x16x32_bf16 v[152:155], a[192:195], v[96:99], 0
    v_mfma_f32_16x16x32_bf16 v[132:135], a[0:3], v[100:103], 0
    v_mfma_f32_16x16x32_bf16 v[140:143], a[64:67], v[100:103], 0
    v_mfma_f32_16x16x32_bf16 v[148:151], a[128:131], v[100:103], 0
    v_mfma_f32_16x16x32_bf16 v[156:159], a[192:195], v[100:103], 0
    ds_read_b128 v[96:99], v4 offset:2048
    ds_read_b128 v[100:103], v4 offset:18432
    s_waitcnt lgkmcnt(2)
    v_mfma_f32_16x16x32_bf16 v[128:131], a[4:7], v[104:107], v[128:131]
    v_mfma_f32_16x16x32_bf16 v[136:139], a[68:71], v[104:107], v[136:139]
    v_mfma_f32_16x16x32_bf16 v[144:147], a[132:135], v[104:107], v[144:147]
    v_mfma_f32_16x16x32_bf16 v[152:155], a[196:199], v[104:107], v[152:155]
    v_mfma_f32_16x16x32_bf16 v[132:135], a[4:7], v[108:111], v[132:135]
    v_mfma_f32_16x16x32_bf16 v[140:143], a[68:71], v[108:111], v[140:143]
    v_mfma_f32_16x16x32_bf16 v[148:151], a[132:135], v[108:111], v[148:151]
    v_mfma_f32_16x16x32_bf16 v[156:159], a[196:199], v[108:111], v[156:159]
    ds_read_b128 v[104:107], v4 offset:3072
    ds_read_b128 v[108:111], v4 offset:19456
    s_waitcnt lgkmcnt(2)
    v_mfma_f32_16x16x32_bf16 v[128:131], a[8:11], v[96:99], v[128:131]
    v_mfma_f32_16x16x32_bf16 v[136:139], a[72:75], v[96:99], v[136:139]
    v_mfma_f32_16x16x32_bf16 v[144:147], a[136:139], v[96:99], v[144:147]
    v_mfma_f32_16x16x32_bf16 v[152:155], a[200:203], v[96:99], v[152:155]
    v_mfma_f32_16x16x32_bf16 v[132:135], a[8:11], v[100:103], v[132:135]
    v_mfma_f32_16x16x32_bf16 v[140:143], a[72:75], v[100:103], v[140:143]
    v_mfma_f32_16x16x32_bf16 v[148:151], a[136:139], v[100:103], v[148:151]
    v_mfma_f32_16x16x32_bf16 v[156:159], a[200:203], v[100:103], v[156:159]
    ds_read_b128 v[96:99], v4 offset:4096
    ds_read_b128 v[100:103], v4 offset:20480
    s_waitcnt lgkmcnt(2)
    v_mfma_f32_16x16x32_bf16 v[128:131], a[12:15], v[104:107], v[128:131]
    v_mfma_f32_16x16x32_bf16 v[136:139], a[76:79], v[104:107], v[136:139]
    v_mfma_f32_16x16x32_bf16 v[144:147], a[140:143], v[104:107], v[144:147]
    v_mfma_f32_16x16x32_bf16 v[152:155], a[204:207], v[104:107], v[152:155]
    v_mfma_f32_16x16x32_bf16 v[132:135], a[12:15], v[108:111], v[132:135]
    v_mfma_f32_16x16x32_bf16 v[140:143], a[76:79], v[108:111], v[140:143]
    v_mfma_f32_16x16x32_bf16 v[148:151], a[140:143], v[108:111], v[148:151]
    v_mfma_f32_16x16x32_bf16 v[156:159], a[204:207], v[108:111], v[156:159]
    ds_read_b128 v[104:107], v4 offset:5120
    ds_read_b128 v[108:111], v4 offset:21504
    s_waitcnt lgkmcnt(2)
    v_mfma_f32_16x16x32_bf16 v[128:131], a[16:19], v[96:99], v[128:131]
    v_mfma_f32_16x16x32_bf16 v[136:139], a[80:83], v[96:99], v[136:139]
    v_mfma_f32_16x16x32_bf16 v[144:147], a[144:147], v[96:99], v[144:147]
    v_mfma_f32_16x16x32_bf16 v[152:155], a[208:211], v[96:99], v[152:155]
    v_mfma_f32_16x16x32_bf16 v[132:135], a[16:19], v[100:103], v[132:135]
    v_mfma_f32_16x16x32_bf16 v[140:143], a[80:83], v[100:103], v[140:143]
    v_mfma_f32_16x16x32_bf16 v[148:151], a[144:147], v[100:103], v[148:151]
    v_mfma_f32_16x16x32_bf16 v[156:159], a[208:211], v[100:103], v[156:159]
    ds_read_b128 v[96:99], v4 offset:6144
    ds_read_b128 v[100:103], v4 offset:22528
    s_waitcnt lgkmcnt(2)
    v_mfma_f32_16x16x32_bf16 v[128:131], a[20:23], v[104:107], v[128:131]
    v_mfma_f32_16x16x32_bf16 v[136:139], a[84:87], v[104:107], v[136:139]
    v_mfma_f32_16x16x32_bf16 v[144:147], a[148:151], v[104:107], v[144:147]
    v_mfma_f32_16x16x32_bf16 v[152:155], a[212:215], v[104:107], v[152:155]
    v_mfma_f32_16x16x32_bf16 v[132:135], a[20:23], v[108:111], v[132:135]
    v_mfma_f32_16x16x32_bf16 v[140:143], a[84:87], v[108:111], v[140:143]
    v_mfma_f32_16x16x32_bf16 v[148:151], a[148:151], v[108:111], v[148:151]
    v_mfma_f32_16x16x32_bf16 v[156:159], a[212:215], v[108:111], v[156:159]
    ds_read_b128 v[104:107], v4 offset:7168
    ds_read_b128 v[108:111], v4 offset:23552
    s_waitcnt lgkmcnt(2)
    v_mfma_f32_16x16x32_bf16 v[128:131], a[24:27], v[96:99], v[128:131]
    v_mfma_f32_16x16x32_bf16 v[136:139], a[88:91], v[96:99], v[136:139]
    v_mfma_f32_16x16x32_bf16 v[144:147], a[152:155], v[96:99], v[144:147]
    v_mfma_f32_16x16x32_bf16 v[152:155], a[216:219], v[96:99], v[152:155]
    v_mfma_f32_16x16x32_bf16 v[132:135], a[24:27], v[100:103], v[132:135]
    v_mfma_f32_16x16x32_bf16 v[140:143], a[88:91], v[100:103], v[140:143]
    v_mfma_f32_16x16x32_bf16 v[148:151], a[152:155], v[100:103], v[148:151]
    v_mfma_f32_16x16x32_bf16 v[156:159], a[216:219], v[100:103], v[156:159]
    ds_read_b128 v[96:99], v4 offset:8192
    ds_read_b128 v[100:103], v4 offset:24576
    s_waitcnt lgkmcnt(2)
    v_mfma_f32_16x16x32_bf16 v[128:131], a[28:31], v[104:107], v[128:131]
    v_mfma_f32_16x16x32_bf16 v[136:139], a[92:95], v[104:107], v[136:139]
    v_mfma_f32_16x16x32_bf16 v[144:147], a[156:159], v[104:107], v[144:147]
    v_mfma_f32_16x16x32_bf16 v[152:155], a[220:223], v[104:107], v[152:155]
    v_mfma_f32_16x16x32_bf16 v[132:135], a[28:31], v[108:111], v[132:135]
    v_mfma_f32_16x16x32_bf16 v[140:143], a[92:95], v[108:111], v[140:143]
    v_mfma_f32_16x16x32_bf16 v[148:151], a[156:159], v[108:111], v[148:151]
    v_mfma_f32_16x16x32_bf16 v[156:159], a[220:223], v[108:111], v[156:159]
    ds_read_b128 v[104:107], v4 offset:9216
    ds_read_b128 v[108:111], v4 offset:25600
    s_waitcnt lgkmcnt(2)
    v_mfma_f32_16x16x32_bf16 v[128:131], a[32:35], v[96:99], v[128:131]
    v_mfma_f32_16x16x32_bf16 v[136:139], a[96:99], v[96:99], v[136:139]
    v_mfma_f32_16x16x32_bf16 v[144:147], a[160:163], v[96:99], v[144:147]
    v_mfma_f32_16x16x32_bf16 v[152:155], a[224:227], v[96:99], v[152:155]
    v_mfma_f32_16x16x32_bf16 v[132:135], a[32:35], v[100:103], v[132:135]
    v_mfma_f32_16x16x32_bf16 v[140:143], a[96:99], v[100:103], v[140:143]
    v_mfma_f32_16x16x32_bf16 v[148:151], a[160:163], v[100:103], v[148:151]
    v_mfma_f32_16x16x32_bf16 v[156:159], a[224:227], v[100:103], v[156:159]
    ds_read_b128 v[96:99], v4 offset:10240
    ds_read_b128 v[100:103], v4 offset:26624
    s_waitcnt lgkmcnt(2)
    v_mfma_f32_16x16x32_bf16 v[128:131], a[36:39], v[104:107], v[128:131]
    v_mfma_f32_16x16x32_bf16 v[136:139], a[100:103], v[104:107], v[136:139]
    v_mfma_f32_16x16x32_bf16 v[144:147], a[164:167], v[104:107], v[144:147]
    v_mfma_f32_16x16x32_bf16 v[152:155], a[228:231], v[104:107], v[152:155]
    v_mfma_f32_16x16x32_bf16 v[132:135], a[36:39], v[108:111], v[132:135]
    v_mfma_f32_16x16x32_bf16 v[140:143], a[100:103], v[108:111], v[140:143]
    v_mfma_f32_16x16x32_bf16 v[148:151], a[164:167], v[108:111], v[148:151]
    v_mfma_f32_16x16x32_bf16 v[156:159], a[228:231], v[108:111], v[156:159]
    ds_read_b128 v[104:107], v4 offset:11264
    ds_read_b128 v[108:111], v4 offset:27648
    s_waitcnt lgkmcnt(2)
    v_mfma_f32_16x16x32_bf16 v[128:131], a[40:43], v[96:99], v[128:131]
    v_mfma_f32_16x16x32_bf16 v[136:139], a[104:107], v[96:99], v[136:139]
    v_mfma_f32_16x16x32_bf16 v[144:147], a[168:171], v[96:99], v[144:147]
    v_mfma_f32_16x16x32_bf16 v[152:155], a[232:235], v[96:99], v[152:155]
    v_mfma_f32_16x16x32_bf16 v[132:135], a[40:43], v[100:103], v[132:135]
    v_mfma_f32_16x16x32_bf16 v[140:143], a[104:107], v[100:103], v[140:143]
    v_mfma_f32_16x16x32_bf16 v[148:151], a[168:171], v[100:103], v[148:151]
    v_mfma_f32_16x16x32_bf16 v[156:159], a[232:235], v[100:103], v[156:159]
    ds_read_b128 v[96:99], v4 offset:12288
    ds_read_b128 v[100:103], v4 offset:28672
    s_waitcnt lgkmcnt(2)
    v_mfma_f32_16x16x32_bf16 v[128:131], a[44:47], v[104:107], v[128:131]
    v_mfma_f32_16x16x32_bf16 v[136:139], a[108:111], v[104:107], v[136:139]
    v_mfma_f32_16x16x32_bf16 v[144:147], a[172:175], v[104:107], v[144:147]
    v_mfma_f32_16x16x32_bf16 v[152:155], a[236:239], v[104:107], v[152:155]
    v_mfma_f32_16x16x32_bf16 v[132:135], a[44:47], v[108:111], v[132:135]
    v_mfma_f32_16x16x32_bf16 v[140:143], a[108:111], v[108:111], v[140:143]
    v_mfma_f32_16x16x32_bf16 v[148:151], a[172:175], v[108:111], v[148:151]
    v_mfma_f32_16x16x32_bf16 v[156:159], a[236:239], v[108:111], v[156:159]
    ds_read_b128 v[104:107], v4 offset:13312
    ds_read_b128 v[108:111], v4 offset:29696
    s_waitcnt lgkmcnt(2)
    v_mfma_f32_16x16x32_bf16 v[128:131], a[48:51], v[96:99], v[128:131]
    v_mfma_f32_16x16x32_bf16 v[136:139], a[112:115], v[96:99], v[136:139]
    v_mfma_f32_16x16x32_bf16 v[144:147], a[176:179], v[96:99], v[144:147]
    v_mfma_f32_16x16x32_bf16 v[152:155], a[240:243], v[96:99], v[152:155]
    v_mfma_f32_16x16x32_bf16 v[132:135], a[48:51], v[100:103], v[132:135]
    v_mfma_f32_16x16x32_bf16 v[140:143], a[112:115], v[100:103], v[140:143]
    v_mfma_f32_16x16x32_bf16 v[148:151], a[176:179], v[100:103], v[148:151]
    v_mfma_f32_16x16x32_bf16 v[156:159], a[240:243], v[100:103], v[156:159]
    ds_read_b128 v[96:99], v4 offset:14336
    ds_read_b128 v[100:103], v4 offset:30720
    s_waitcnt lgkmcnt(2)
    v_mfma_f32_16x16x32_bf16 v[128:131], a[52:55], v[104:107], v[128:131]
    v_mfma_f32_16x16x32_bf16 v[136:139], a[116:119], v[104:107], v[136:139]
    v_mfma_f32_16x16x32_bf16 v[144:147], a[180:183], v[104:107], v[144:147]
    v_mfma_f32_16x16x32_bf16 v[152:155], a[244:247], v[104:107], v[152:155]
    v_mfma_f32_16x16x32_bf16 v[132:135], a[52:55], v[108:111], v[132:135]
    v_mfma_f32_16x16x32_bf16 v[140:143], a[116:119], v[108:111], v[140:143]
    v_mfma_f32_16x16x32_bf16 v[148:151], a[180:183], v[108:111], v[148:151]
    v_mfma_f32_16x16x32_bf16 v[156:159], a[244:247], v[108:111], v[156:159]
    ds_read_b128 v[104:107], v4 offset:15360
    ds_read_b128 v[108:111], v4 offset:31744
    s_waitcnt lgkmcnt(2)
    v_mfma_f32_16x16x32_bf16 v[128:131], a[56:59], v[96:99], v[128:131]
    v_mfma_f32_16x16x32_bf16 v[136:139], a[120:123], v[96:99], v[136:139]
    v_mfma_f32_16x16x32_bf16 v[144:147], a[184:187], v[96:99], v[144:147]
    v_mfma_f32_16x16x32_bf16 v[152:155], a[248:251], v[96:99], v[152:155]
    v_mfma_f32_16x16x32_bf16 v[132:135], a[56:59], v[100:103], v[132:135]
    v_mfma_f32_16x16x32_bf16 v[140:143], a[120:123], v[100:103], v[140:143]
    v_mfma_f32_16x16x32_bf16 v[148:151], a[184:187], v[100:103], v[148:151]
    v_mfma_f32_16x16x32_bf16 v[156:159], a[248:251], v[100:103], v[156:159]
    s_waitcnt lgkmcnt(0)
    v_mfma_f32_16x16x32_bf16 v[128:131], a[60:63], v[104:107], v[128:131]
    v_mfma_f32_16x16x32_bf16 v[136:139], a[124:127], v[104:107], v[136:139]
    v_mfma_f32_16x16x32_bf16 v[144:147], a[188:191], v[104:107], v[144:147]
    v_mfma_f32_16x16x32_bf16 v[152:155], a[252:255], v[104:107], v[152:155]
    v_mfma_f32_16x16x32_bf16 v[132:135], a[60:63], v[108:111], v[132:135]
    v_mfma_f32_16x16x32_bf16 v[140:143], a[124:127], v[108:111], v[140:143]
    v_mfma_f32_16x16x32_bf16 v[148:151], a[188:191], v[108:111], v[148:151]
    v_mfma_f32_16x16x32_bf16 v[156:159], a[252:255], v[108:111], v[156:159]
    s_nop 7
    global_store_dwordx4 v16, v[128:131], s[12:13] offset:0 sc1
    global_store_dwordx4 v16, v[136:139], s[12:13] offset:1024 sc1
    global_store_dwordx4 v16, v[144:147], s[12:13] offset:2048 sc1
    global_store_dwordx4 v16, v[152:155], s[12:13] offset:3072 sc1
    global_store_dwordx4 v17, v[132:135], s[12:13] offset:0 sc1
    global_store_dwordx4 v17, v[140:143], s[12:13] offset:1024 sc1
    global_store_dwordx4 v17, v[148:151], s[12:13] offset:2048 sc1
    global_store_dwordx4 v17, v[156:159], s[12:13] offset:3072 sc1
    s_add_u32 s12, s12, 0x20000
    s_addc_u32 s13, s13, 0
    s_add_u32 s20, s20, 1
    s_waitcnt vmcnt(0)
    s_barrier
    s_mov_b32 s93, s20
    s_cmp_eq_u32 s6, 0
    s_cbranch_scc0 LPUB_29
    v_mov_b32 v8, s20
    v_mov_b32 v9, 0
    s_mov_b64 exec, 1
    global_store_dword v9, v8, s[14:15] sc1
    s_mov_b64 exec, -1
LPUB_29:
    s_cmp_lt_u32 s20, 32
    s_cbranch_scc0 L_P_end
    s_add_u32 s29, s20, 1
    s_cmp_eq_u32 s6, 0
    s_cbranch_scc0 LRF_30
    v_and_b32 v10, 3, v0
    v_lshlrev_b32 v10, 7, v10
    s_mov_b32 s28, 0
LPM_31:
    global_load_dword v11, v10, s[16:17] sc1
    s_waitcnt vmcnt(0)
    v_readlane_b32 s92, v11, 0
    v_readlane_b32 s21, v11, 1
    s_nop 0
    s_min_u32 s92, s92, s21
    v_readlane_b32 s21, v11, 2
    s_nop 0
    s_min_u32 s92, s92, s21
    v_readlane_b32 s21, v11, 3
    s_nop 0
    s_min_u32 s92, s92, s21
    s_cmp_ge_u32 s92, s29
    s_cbranch_scc1 LPMOK_32
    s_sleep 1
    s_add_u32 s28, s28, 1
    s_cmp_lt_u32 s28, 0x40000
    s_cbranch_scc1 LPM_31
    s_branch L_fail
LPMOK_32:
    v_mov_b32 v8, s92
    v_mov_b32 v9, 163072
    ds_write_b32 v9, v8
    s_waitcnt lgkmcnt(0)
LRF_30:
    s_barrier
    v_mov_b32 v9, 163072
    ds_read_b32 v8, v9
    s_waitcnt lgkmcnt(0)
    s_nop 0
    v_readfirstlane_b32 s92, v8
    s_lshl_b32 s21, s6, 17
    s_add_u32 s24, s26, s21
    s_addc_u32 s25, s27, 0
    s_lshl_b32 s30, s6, 14
    s_add_u32 s30, s30, 65536
    s_mov_b32 m0, s30
    s_nop 0
    global_load_lds_dwordx4 v1, s[24:25] offset:0 sc1
    s_mov_b32 m0, s30
    s_nop 0
    global_load_lds_dwordx4 v1, s[24:25] offset:1024 sc1
    s_mov_b32 m0, s30
    s_nop 0
    global_load_lds_dwordx4 v1, s[24:25] offset:2048 sc1
    s_mov_b32 m0, s30
    s_nop 0
    global_load_lds_dwordx4 v1, s[24:25] offset:3072 sc1
    s_add_u32 s24, s24, 4096
    s_addc_u32 s25, s25, 0
    s_add_u32 s30, s30, 4096
    s_mov_b32 m0, s30
    s_nop 0
    global_load_lds_dwordx4 v1, s[24:25] offset:0 sc1
    s_mov_b32 m0, s30
    s_nop 0
    global_load_lds_dwordx4 v1, s[24:25] offset:1024 sc1
    s_mov_b32 m0, s30
    s_nop 0
    global_load_lds_dwordx4 v1, s[24:25] offset:2048 sc1
    s_mov_b32 m0, s30
    s_nop 0
    global_load_lds_dwordx4 v1, s[24:25] offset:3072 sc1
    s_add_u32 s24, s24, 4096
    s_addc_u32 s25, s25, 0
    s_add_u32 s30, s30, 4096
    s_mov_b32 m0, s30
    s_nop 0
    global_load_lds_dwordx4 v1, s[24:25] offset:0 sc1
    s_mov_b32 m0, s30
    s_nop 0
    global_load_lds_dwordx4 v1, s[24:25] offset:1024 sc1
    s_mov_b32 m0, s30
    s_nop 0
    global_load_lds_dwordx4 v1, s[24:25] offset:2048 sc1
    s_mov_b32 m0, s30
    s_nop 0
    global_load_lds_dwordx4 v1, s[24:25] offset:3072 sc1
    s_add_u32 s24, s24, 4096
    s_addc_u32 s25, s25, 0
    s_add_u32 s30, s30, 4096
    s_mov_b32 m0, s30
    s_nop 0
    global_load_lds_dwordx4 v1, s[24:25] offset:0 sc1
    s_mov_b32 m0, s30
    s_nop 0
    global_load_lds_dwordx4 v1, s[24:25] offset:1024 sc1
    s_mov_b32 m0, s30
    s_nop 0
    global_load_lds_dwordx4 v1, s[24:25] offset:2048 sc1
    s_mov_b32 m0, s30
    s_nop 0
    global_load_lds_dwordx4 v1, s[24:25] offset:3072 sc1
    s_waitcnt vmcnt(0)
LJ_27:
    s_waitcnt vmcnt(8)
    s_barrier
    s_sub_u32 s23, s20, 1
    s_cmp_gt_i32 s23, s93
    s_cbranch_scc0 LNP_33
    s_mov_b32 s93, s23
    s_cmp_eq_u32 s6, 0
    s_cbranch_scc0 LPUB_34
    v_mov_b32 v8, s23
    v_mov_b32 v9, 0
    s_mov_b64 exec, 1
    global_store_dword v9, v8, s[14:15] sc1
    s_mov_b64 exec, -1
LPUB_34:
LNP_33:
    s_add_u32 s26, s26, 0x80000
    s_addc_u32 s27, s27, 0
    s_add_u32 s23, s20, 2
    s_cmp_ge_u32 s92, s23
    s_cbranch_scc0 LPB_35
    ds_read_b128 v[96:99], v6 offset:0
    ds_read_b128 v[100:103], v6 offset:16384
    ds_read_b128 v[104:107], v6 offset:1024
    ds_read_b128 v[108:111], v6 offset:17408
    s_waitcnt lgkmcnt(2)
    v_mfma_f32_16x16x32_bf16 v[128:131], a[0:3], v[96:99], 0
    v_mfma_f32_16x16x32_bf16 v[136:139], a[64:67], v[96:99], 0
    s_lshl_b32 s21, s6, 17
    s_add_u32 s24, s26, s21
    s_addc_u32 s25, s27, 0
    s_lshl_b32 s30, s6, 14
    s_add_u32 s30, s30, 0
    s_mov_b32 m0, s30
    s_nop 0
    global_load_lds_dwordx4 v1, s[24:25] offset:0 sc1
    v_mfma_f32_16x16x32_bf16 v[144:147], a[128:131], v[96:99], 0
    v_mfma_f32_16x16x32_bf16 v[152:155], a[192:195], v[96:99], 0
    v_mfma_f32_16x16x32_bf16 v[132:135], a[0:3], v[100:103], 0
    v_mfma_f32_16x16x32_bf16 v[140:143], a[64:67], v[100:103], 0
    v_mfma_f32_16x16x32_bf16 v[148:151], a[128:131], v[100:103], 0
    v_mfma_f32_16x16x32_bf16 v[156:159], a[192:195], v[100:103], 0
    ds_read_b128 v[96:99], v6 offset:2048
    ds_read_b128 v[100:103], v6 offset:18432
    s_waitcnt lgkmcnt(2)
    v_mfma_f32_16x16x32_bf16 v[128:131], a[4:7], v[104:107], v[128:131]
    v_mfma_f32_16x16x32_bf16 v[136:139], a[68:71], v[104:107], v[136:139]
    s_mov_b32 m0, s30
    s_nop 0
    global_load_lds_dwordx4 v1, s[24:25] offset:1024 sc1
    v_mfma_f32_16x16x32_bf16 v[144:147], a[132:135], v[104:107], v[144:147]
    v_mfma_f32_16x16x32_bf16 v[152:155], a[196:199], v[104:107], v[152:155]
    v_mfma_f32_16x16x32_bf16 v[132:135], a[4:7], v[108:111], v[132:135]
    v_mfma_f32_16x16x32_bf16 v[140:143], a[68:71], v[108:111], v[140:143]
    v_mfma_f32_16x16x32_bf16 v[148:151], a[132:135], v[108:111], v[148:151]
    v_mfma_f32_16x16x32_bf16 v[156:159], a[196:199], v[108:111], v[156:159]
    ds_read_b128 v[104:107], v6 offset:3072
    ds_read_b128 v[108:111], v6 offset:19456
    s_waitcnt lgkmcnt(2)
    v_mfma_f32_16x16x32_bf16 v[128:131], a[8:11], v[96:99], v[128:131]
    v_mfma_f32_16x16x32_bf16 v[136:139], a[72:75], v[96:99], v[136:139]
    s_mov_b32 m0, s30
    s_nop 0
    global_load_lds_dwordx4 v1, s[24:25] offset:2048 sc1
    v_mfma_f32_16x16x32_bf16 v[144:147], a[136:139], v[96:99], v[144:147]
    v_mfma_f32_16x16x32_bf16 v[152:155], a[200:203], v[96:99], v[152:155]
    v_mfma_f32_16x16x32_bf16 v[132:135], a[8:11], v[100:103], v[132:135]
    v_mfma_f32_16x16x32_bf16 v[140:143], a[72:75], v[100:103], v[140:143]
    v_mfma_f32_16x16x32_bf16 v[148:151], a[136:139], v[100:103], v[148:151]
    v_mfma_f32_16x16x32_bf16 v[156:159], a[200:203], v[100:103], v[156:159]
    ds_read_b128 v[96:99], v6 offset:4096
    ds_read_b128 v[100:103], v6 offset:20480
    s_waitcnt lgkmcnt(2)
    v_mfma_f32_16x16x32_bf16 v[128:131], a[12:15], v[104:107], v[128:131]
    v_mfma_f32_16x16x32_bf16 v[136:139], a[76:79], v[104:107], v[136:139]
    s_mov_b32 m0, s30
    s_nop 0
    global_load_lds_dwordx4 v1, s[24:25] offset:3072 sc1
    v_mfma_f32_16x16x32_bf16 v[144:147], a[140:143], v[104:107], v[144:147]
    v_mfma_f32_16x16x32_bf16 v[152:155], a[204:207], v[104:107], v[152:155]
    v_mfma_f32_16x16x32_bf16 v[132:135], a[12:15], v[108:111], v[132:135]
    v_mfma_f32_16x16x32_bf16 v[140:143], a[76:79], v[108:111], v[140:143]
    v_mfma_f32_16x16x32_bf16 v[148:151], a[140:143], v[108:111], v[148:151]
    v_mfma_f32_16x16x32_bf16 v[156:159], a[204:207], v[108:111], v[156:159]
    ds_read_b128 v[104:107], v6 offset:5120
    ds_read_b128 v[108:111], v6 offset:21504
    s_waitcnt lgkmcnt(2)
    v_mfma_f32_16x16x32_bf16 v[128:131], a[16:19], v[96:99], v[128:131]
    v_mfma_f32_16x16x32_bf16 v[136:139], a[80:83], v[96:99], v[136:139]
    s_add_u32 s24, s24, 4096
    s_addc_u32 s25, s25, 0
    s_add_u32 s30, s30, 4096
    s_mov_b32 m0, s30
    s_nop 0
    global_load_lds_dwordx4 v1, s[24:25] offset:0 sc1
    v_mfma_f32_16x16x32_bf16 v[144:147], a[144:147], v[96:99], v[144:147]
    v_mfma_f32_16x16x32_bf16 v[152:155], a[208:211], v[96:99], v[152:155]
    v_mfma_f32_16x16x32_bf16 v[132:135], a[16:19], v[100:103], v[132:135]
    v_mfma_f32_16x16x32_bf16 v[140:143], a[80:83], v[100:103], v[140:143]
    v_mfma_f32_16x16x32_bf16 v[148:151], a[144:147], v[100:103], v[148:151]
    v_mfma_f32_16x16x32_bf16 v[156:159], a[208:211], v[100:103], v[156:159]
    ds_read_b128 v[96:99], v6 offset:6144
    ds_read_b128 v[100:103], v6 offset:22528
    s_waitcnt lgkmcnt(2)
    v_mfma_f32_16x16x32_bf16 v[128:131], a[20:23], v[104:107], v[128:131]
    v_mfma_f32_16x16x32_bf16 v[136:139], a[84:87], v[104:107], v[136:139]
    s_mov_b32 m0, s30
    s_nop 0
    global_load_lds_dwordx4 v1, s[24:25] offset:1024 sc1
    v_mfma_f32_16x16x32_bf16 v[144:147], a[148:151], v[104:107], v[144:147]
    v_mfma_f32_16x16x32_bf16 v[152:155], a[212:215], v[104:107], v[152:155]
    v_mfma_f32_16x16x32_bf16 v[132:135], a[20:23], v[108:111], v[132:135]
    v_mfma_f32_16x16x32_bf16 v[140:143], a[84:87], v[108:111], v[140:143]
    v_mfma_f32_16x16x32_bf16 v[148:151], a[148:151], v[108:111], v[148:151]
    v_mfma_f32_16x16x32_bf16 v[156:159], a[212:215], v[108:111], v[156:159]
    ds_read_b128 v[104:107], v6 offset:7168
    ds_read_b128 v[108:111], v6 offset:23552
    s_waitcnt lgkmcnt(2)
    v_mfma_f32_16x16x32_bf16 v[128:131], a[24:27], v[96:99], v[128:131]
    v_mfma_f32_16x16x32_bf16 v[136:139], a[88:91], v[96:99], v[136:139]
    s_mov_b32 m0, s30
    s_nop 0
    global_load_lds_dwordx4 v1, s[24:25] offset:2048 sc1
    v_mfma_f32_16x16x32_bf16 v[144:147], a[152:155], v[96:99], v[144:147]
    v_mfma_f32_16x16x32_bf16 v[152:155], a[216:219], v[96:99], v[152:155]
    v_mfma_f32_16x16x32_bf16 v[132:135], a[24:27], v[100:103], v[132:135]
    v_mfma_f32_16x16x32_bf16 v[140:143], a[88:91], v[100:103], v[140:143]
    v_mfma_f32_16x16x32_bf16 v[148:151], a[152:155], v[100:103], v[148:151]
    v_mfma_f32_16x16x32_bf16 v[156:159], a[216:219], v[100:103], v[156:159]
    ds_read_b128 v[96:99], v6 offset:8192
    ds_read_b128 v[100:103], v6 offset:24576
    s_waitcnt lgkmcnt(2)
    v_mfma_f32_16x16x32_bf16 v[128:131], a[28:31], v[104:107], v[128:131]
    v_mfma_f32_16x16x32_bf16 v[136:139], a[92:95], v[104:107], v[136:139]
    s_mov_b32 m0, s30
    s_nop 0
    global_load_lds_dwordx4 v1, s[24:25] offset:3072 sc1
    v_mfma_f32_16x16x32_bf16 v[144:147], a[156:159], v[104:107], v[144:147]
    v_mfma_f32_16x16x32_bf16 v[152:155], a[220:223], v[104:107], v[152:155]
    v_mfma_f32_16x16x32_bf16 v[132:135], a[28:31], v[108:111], v[132:135]
    v_mfma_f32_16x16x32_bf16 v[140:143], a[92:95], v[108:111], v[140:143]
    v_mfma_f32_16x16x32_bf16 v[148:151], a[156:159], v[108:111], v[148:151]
    v_mfma_f32_16x16x32_bf16 v[156:159], a[220:223], v[108:111], v[156:159]
    ds_read_b128 v[104:107], v6 offset:9216
    ds_read_b128 v[108:111], v6 offset:25600
    s_waitcnt lgkmcnt(2)
    v_mfma_f32_16x16x32_bf16 v[128:131], a[32:35], v[96:99], v[128:131]
    v_mfma_f32_16x16x32_bf16 v[136:139], a[96:99], v[96:99], v[136:139]
    s_add_u32 s24, s24, 4096
    s_addc_u32 s25, s25, 0
    s_add_u32 s30, s30, 4096
    s_mov_b32 m0, s30
    s_nop 0
    global_load_lds_dwordx4 v1, s[24:25] offset:0 sc1
    v_mfma_f32_16x16x32_bf16 v[144:147], a[160:163], v[96:99], v[144:147]
    v_mfma_f32_16x16x32_bf16 v[152:155], a[224:227], v[96:99], v[152:155]
    v_mfma_f32_16x16x32_bf16 v[132:135], a[32:35], v[100:103], v[132:135]
    v_mfma_f32_16x16x32_bf16 v[140:143], a[96:99], v[100:103], v[140:143]
    v_mfma_f32_16x16x32_bf16 v[148:151], a[160:163], v[100:103], v[148:151]
    v_mfma_f32_16x16x32_bf16 v[156:159], a[224:227], v[100:103], v[156:159]
    ds_read_b128 v[96:99], v6 offset:10240
    ds_read_b128 v[100:103], v6 offset:26624
    s_waitcnt lgkmcnt(2)
    v_mfma_f32_16x16x32_bf16 v[128:131], a[36:39], v[104:107], v[128:131]
    v_mfma_f32_16x16x32_bf16 v[136:139], a[100:103], v[104:107], v[136:139]
    s_mov_b32 m0, s30
    s_nop 0
    global_load_lds_dwordx4 v1, s[24:25] offset:1024 sc1
    v_mfma_f32_16x16x32_bf16 v[144:147], a[164:167], v[104:107], v[144:147]
    v_mfma_f32_16x16x32_bf16 v[152:155], a[228:231], v[104:107], v[152:155]
    v_mfma_f32_16x16x32_bf16 v[132:135], a[36:39], v[108:111], v[132:135]
    v_mfma_f32_16x16x32_bf16 v[140:143], a[100:103], v[108:111], v[140:143]
    v_mfma_f32_16x16x32_bf16 v[148:151], a[164:167], v[108:111], v[148:151]
    v_mfma_f32_16x16x32_bf16 v[156:159], a[228:231], v[108:111], v[156:159]
    ds_read_b128 v[104:107], v6 offset:11264
    ds_read_b128 v[108:111], v6 offset:27648
    s_waitcnt lgkmcnt(2)
    v_mfma_f32_16x16x32_bf16 v[128:131], a[40:43], v[96:99], v[128:131]
    v_mfma_f32_16x16x32_bf16 v[136:139], a[104:107], v[96:99], v[136:139]
    s_mov_b32 m0, s30
    s_nop 0
    global_load_lds_dwordx4 v1, s[24:25] offset:2048 sc1
    v_mfma_f32_16x16x32_bf16 v[144:147], a[168:171], v[96:99], v[144:147]
    v_mfma_f32_16x16x32_bf16 v[152:155], a[232:235], v[96:99], v[152:155]
    v_mfma_f32_16x16x32_bf16 v[132:135], a[40:43], v[100:103], v[132:135]
    v_mfma_f32_16x16x32_bf16 v[140:143], a[104:107], v[100:103], v[140:143]
    v_mfma_f32_16x16x32_bf16 v[148:151], a[168:171], v[100:103], v[148:151]
    v_mfma_f32_16x16x32_bf16 v[156:159], a[232:235], v[100:103], v[156:159]
    ds_read_b128 v[96:99], v6 offset:12288
    ds_read_b128 v[100:103], v6 offset:28672
    s_waitcnt lgkmcnt(2)
    v_mfma_f32_16x16x32_bf16 v[128:131], a[44:47], v[104:107], v[128:131]
    v_mfma_f32_16x16x32_bf16 v[136:139], a[108:111], v[104:107], v[136:139]
    s_mov_b32 m0, s30
    s_nop 0
    global_load_lds_dwordx4 v1, s[24:25] offset:3072 sc1
    v_mfma_f32_16x16x32_bf16 v[144:147], a[172:175], v[104:107], v[144:147]
    v_mfma_f32_16x16x32_bf16 v[152:155], a[236:239], v[104:107], v[152:155]
    v_mfma_f32_16x16x32_bf16 v[132:135], a[44:47], v[108:111], v[132:135]
    v_mfma_f32_16x16x32_bf16 v[140:143], a[108:111], v[108:111], v[140:143]
    v_mfma_f32_16x16x32_bf16 v[148:151], a[172:175], v[108:111], v[148:151]
    v_mfma_f32_16x16x32_bf16 v[156:159], a[236:239], v[108:111], v[156:159]
    ds_read_b128 v[104:107], v6 offset:13312
    ds_read_b128 v[108:111], v6 offset:29696
    s_waitcnt lgkmcnt(2)
    v_mfma_f32_16x16x32_bf16 v[128:131], a[48:51], v[96:99], v[128:131]
    v_mfma_f32_16x16x32_bf16 v[136:139], a[112:115], v[96:99], v[136:139]
    s_add_u32 s24, s24, 4096
    s_addc_u32 s25, s25, 0
    s_add_u32 s30, s30, 4096
    s_mov_b32 m0, s30
    s_nop 0
    global_load_lds_dwordx4 v1, s[24:25] offset:0 sc1
    v_mfma_f32_16x16x32_bf16 v[144:147], a[176:179], v[96:99], v[144:147]
    v_mfma_f32_16x16x32_bf16 v[152:155], a[240:243], v[96:99], v[152:155]
    v_mfma_f32_16x16x32_bf16 v[132:135], a[48:51], v[100:103], v[132:135]
    v_mfma_f32_16x16x32_bf16 v[140:143], a[112:115], v[100:103], v[140:143]
    v_mfma_f32_16x16x32_bf16 v[148:151], a[176:179], v[100:103], v[148:151]
    v_mfma_f32_16x16x32_bf16 v[156:159], a[240:243], v[100:103], v[156:159]
    ds_read_b128 v[96:99], v6 offset:14336
    ds_read_b128 v[100:103], v6 offset:30720
    s_waitcnt lgkmcnt(2)
    v_mfma_f32_16x16x32_bf16 v[128:131], a[52:55], v[104:107], v[128:131]
    v_mfma_f32_16x16x32_bf16 v[136:139], a[116:119], v[104:107], v[136:139]
    s_mov_b32 m0, s30
    s_nop 0
    global_load_lds_dwordx4 v1, s[24:25] offset:1024 sc1
    v_mfma_f32_16x16x32_bf16 v[144:147], a[180:183], v[104:107], v[144:147]
    v_mfma_f32_16x16x32_bf16 v[152:155], a[244:247], v[104:107], v[152:155]
    v_mfma_f32_16x16x32_bf16 v[132:135], a[52:55], v[108:111], v[132:135]
    v_mfma_f32_16x16x32_bf16 v[140:143], a[116:119], v[108:111], v[140:143]
    v_mfma_f32_16x16x32_bf16 v[148:151], a[180:183], v[108:111], v[148:151]
    v_mfma_f32_16x16x32_bf16 v[156:159], a[244:247], v[108:111], v[156:159]
    ds_read_b128 v[104:107], v6 offset:15360
    ds_read_b128 v[108:111], v6 offset:31744
    s_waitcnt lgkmcnt(2)
    v_mfma_f32_16x16x32_bf16 v[128:131], a[56:59], v[96:99], v[128:131]
    v_mfma_f32_16x16x32_bf16 v[136:139], a[120:123], v[96:99], v[136:139]
    s_mov_b32 m0, s30
    s_nop 0
    global_load_lds_dwordx4 v1, s[24:25] offset:2048 sc1
    v_mfma_f32_16x16x32_bf16 v[144:147], a[184:187], v[96:99], v[144:147]
    v_mfma_f32_16x16x32_bf16 v[152:155], a[248:251], v[96:99], v[152:155]
    v_mfma_f32_16x16x32_bf16 v[132:135], a[56:59], v[100:103], v[132:135]
    v_mfma_f32_16x16x32_bf16 v[140:143], a[120:123], v[100:103], v[140:143]
    v_mfma_f32_16x16x32_bf16 v[148:151], a[184:187], v[100:103], v[148:151]
    v_mfma_f32_16x16x32_bf16 v[156:159], a[248:251], v[100:103], v[156:159]
    s_waitcnt lgkmcnt(0)
    v_mfma_f32_16x16x32_bf16 v[128:131], a[60:63], v[104:107], v[128:131]
    v_mfma_f32_16x16x32_bf16 v[136:139], a[124:127], v[104:107], v[136:139]
    s_mov_b32 m0, s30
    s_nop 0
    global_load_lds_dwordx4 v1, s[24:25] offset:3072 sc1
    v_mfma_f32_16x16x32_bf16 v[144:147], a[188:191], v[104:107], v[144:147]
    v_mfma_f32_16x16x32_bf16 v[152:155], a[252:255], v[104:107], v[152:155]
    v_mfma_f32_16x16x32_bf16 v[132:135], a[60:63], v[108:111], v[132:135]
    v_mfma_f32_16x16x32_bf16 v[140:143], a[124:127], v[108:111], v[140:143]
    v_mfma_f32_16x16x32_bf16 v[148:151], a[188:191], v[108:111], v[148:151]
    v_mfma_f32_16x16x32_bf16 v[156:159], a[252:255], v[108:111], v[156:159]
    s_nop 7
    global_store_dwordx4 v16, v[128:131], s[12:13] offset:0 sc1
    global_store_dwordx4 v16, v[136:139], s[12:13] offset:1024 sc1
    global_store_dwordx4 v16, v[144:147], s[12:13] offset:2048 sc1
    global_store_dwordx4 v16, v[152:155], s[12:13] offset:3072 sc1
    global_store_dwordx4 v17, v[132:135], s[12:13] offset:0 sc1
    global_store_dwordx4 v17, v[140:143], s[12:13] offset:1024 sc1
    global_store_dwordx4 v17, v[148:151], s[12:13] offset:2048 sc1
    global_store_dwordx4 v17, v[156:159], s[12:13] offset:3072 sc1
    s_add_u32 s12, s12, 0x20000
    s_addc_u32 s13, s13, 0
    s_add_u32 s20, s20, 1
    s_branch LJ_36
LPB_35:
    ds_read_b128 v[96:99], v6 offset:0
    ds_read_b128 v[100:103], v6 offset:16384
    ds_read_b128 v[104:107], v6 offset:1024
    ds_read_b128 v[108:111], v6 offset:17408
    s_waitcnt lgkmcnt(2)
    v_mfma_f32_16x16x32_bf16 v[128:131], a[0:3], v[96:99], 0
    v_mfma_f32_16x16x32_bf16 v[136:139], a[64:67], v[96:99], 0
    v_mfma_f32_16x16x32_bf16 v[144:147], a[128:131], v[96:99], 0
    v_mfma_f32_16x16x32_bf16 v[152:155], a[192:195], v[96:99], 0
    v_mfma_f32_16x16x32_bf16 v[132:135], a[0:3], v[100:103], 0
    v_mfma_f32_16x16x32_bf16 v[140:143], a[64:67], v[100:103], 0
    v_mfma_f32_16x16x32_bf16 v[148:151], a[128:131], v[100:103], 0
    v_mfma_f32_16x16x32_bf16 v[156:159], a[192:195], v[100:103], 0
    ds_read_b128 v[96:99], v6 offset:2048
    ds_read_b128 v[100:103], v6 offset:18432
    s_waitcnt lgkmcnt(2)
    v_mfma_f32_16x16x32_bf16 v[128:131], a[4:7], v[104:107], v[128:131]
    v_mfma_f32_16x16x32_bf16 v[136:139], a[68:71], v[104:107], v[136:139]
    v_mfma_f32_16x16x32_bf16 v[144:147], a[132:135], v[104:107], v[144:147]
    v_mfma_f32_16x16x32_bf16 v[152:155], a[196:199], v[104:107], v[152:155]
    v_mfma_f32_16x16x32_bf16 v[132:135], a[4:7], v[108:111], v[132:135]
    v_mfma_f32_16x16x32_bf16 v[140:143], a[68:71], v[108:111], v[140:143]
    v_mfma_f32_16x16x32_bf16 v[148:151], a[132:135], v[108:111], v[148:151]
    v_mfma_f32_16x16x32_bf16 v[156:159], a[196:199], v[108:111], v[156:159]
    ds_read_b128 v[104:107], v6 offset:3072
    ds_read_b128 v[108:111], v6 offset:19456
    s_waitcnt lgkmcnt(2)
    v_mfma_f32_16x16x32_bf16 v[128:131], a[8:11], v[96:99], v[128:131]
    v_mfma_f32_16x16x32_bf16 v[136:139], a[72:75], v[96:99], v[136:139]
    v_mfma_f32_16x16x32_bf16 v[144:147], a[136:139], v[96:99], v[144:147]
    v_mfma_f32_16x16x32_bf16 v[152:155], a[200:203], v[96:99], v[152:155]
    v_mfma_f32_16x16x32_bf16 v[132:135], a[8:11], v[100:103], v[132:135]
    v_mfma_f32_16x16x32_bf16 v[140:143], a[72:75], v[100:103], v[140:143]
    v_mfma_f32_16x16x32_bf16 v[148:151], a[136:139], v[100:103], v[148:151]
    v_mfma_f32_16x16x32_bf16 v[156:159], a[200:203], v[100:103], v[156:159]
    ds_read_b128 v[96:99], v6 offset:4096
    ds_read_b128 v[100:103], v6 offset:20480
    s_waitcnt lgkmcnt(2)
    v_mfma_f32_16x16x32_bf16 v[128:131], a[12:15], v[104:107], v[128:131]
    v_mfma_f32_16x16x32_bf16 v[136:139], a[76:79], v[104:107], v[136:139]
    v_mfma_f32_16x16x32_bf16 v[144:147], a[140:143], v[104:107], v[144:147]
    v_mfma_f32_16x16x32_bf16 v[152:155], a[204:207], v[104:107], v[152:155]
    v_mfma_f32_16x16x32_bf16 v[132:135], a[12:15], v[108:111], v[132:135]
    v_mfma_f32_16x16x32_bf16 v[140:143], a[76:79], v[108:111], v[140:143]
    v_mfma_f32_16x16x32_bf16 v[148:151], a[140:143], v[108:111], v[148:151]
    v_mfma_f32_16x16x32_bf16 v[156:159], a[204:207], v[108:111], v[156:159]
    ds_read_b128 v[104:107], v6 offset:5120
    ds_read_b128 v[108:111], v6 offset:21504
    s_waitcnt lgkmcnt(2)
    v_mfma_f32_16x16x32_bf16 v[128:131], a[16:19], v[96:99], v[128:131]
    v_mfma_f32_16x16x32_bf16 v[136:139], a[80:83], v[96:99], v[136:139]
    v_mfma_f32_16x16x32_bf16 v[144:147], a[144:147], v[96:99], v[144:147]
    v_mfma_f32_16x16x32_bf16 v[152:155], a[208:211], v[96:99], v[152:155]
    v_mfma_f32_16x16x32_bf16 v[132:135], a[16:19], v[100:103], v[132:135]
    v_mfma_f32_16x16x32_bf16 v[140:143], a[80:83], v[100:103], v[140:143]
    v_mfma_f32_16x16x32_bf16 v[148:151], a[144:147], v[100:103], v[148:151]
    v_mfma_f32_16x16x32_bf16 v[156:159], a[208:211], v[100:103], v[156:159]
    ds_read_b128 v[96:99], v6 offset:6144
    ds_read_b128 v[100:103], v6 offset:22528
    s_waitcnt lgkmcnt(2)
    v_mfma_f32_16x16x32_bf16 v[128:131], a[20:23], v[104:107], v[128:131]
    v_mfma_f32_16x16x32_bf16 v[136:139], a[84:87], v[104:107], v[136:139]
    v_mfma_f32_16x16x32_bf16 v[144:147], a[148:151], v[104:107], v[144:147]
    v_mfma_f32_16x16x32_bf16 v[152:155], a[212:215], v[104:107], v[152:155]
    v_mfma_f32_16x16x32_bf16 v[132:135], a[20:23], v[108:111], v[132:135]
    v_mfma_f32_16x16x32_bf16 v[140:143], a[84:87], v[108:111], v[140:143]
    v_mfma_f32_16x16x32_bf16 v[148:151], a[148:151], v[108:111], v[148:151]
    v_mfma_f32_16x16x32_bf16 v[156:159], a[212:215], v[108:111], v[156:159]
    ds_read_b128 v[104:107], v6 offset:7168
    ds_read_b128 v[108:111], v6 offset:23552
    s_waitcnt lgkmcnt(2)
    v_mfma_f32_16x16x32_bf16 v[128:131], a[24:27], v[96:99], v[128:131]
    v_mfma_f32_16x16x32_bf16 v[136:139], a[88:91], v[96:99], v[136:139]
    v_mfma_f32_16x16x32_bf16 v[144:147], a[152:155], v[96:99], v[144:147]
    v_mfma_f32_16x16x32_bf16 v[152:155], a[216:219], v[96:99], v[152:155]
    v_mfma_f32_16x16x32_bf16 v[132:135], a[24:27], v[100:103], v[132:135]
    v_mfma_f32_16x16x32_bf16 v[140:143], a[88:91], v[100:103], v[140:143]
    v_mfma_f32_16x16x32_bf16 v[148:151], a[152:155], v[100:103], v[148:151]
    v_mfma_f32_16x16x32_bf16 v[156:159], a[216:219], v[100:103], v[156:159]
    ds_read_b128 v[96:99], v6 offset:8192
    ds_read_b128 v[100:103], v6 offset:24576
    s_waitcnt lgkmcnt(2)
    v_mfma_f32_16x16x32_bf16 v[128:131], a[28:31], v[104:107], v[128:131]
    v_mfma_f32_16x16x32_bf16 v[136:139], a[92:95], v[104:107], v[136:139]
    v_mfma_f32_16x16x32_bf16 v[144:147], a[156:159], v[104:107], v[144:147]
    v_mfma_f32_16x16x32_bf16 v[152:155], a[220:223], v[104:107], v[152:155]
    v_mfma_f32_16x16x32_bf16 v[132:135], a[28:31], v[108:111], v[132:135]
    v_mfma_f32_16x16x32_bf16 v[140:143], a[92:95], v[108:111], v[140:143]
    v_mfma_f32_16x16x32_bf16 v[148:151], a[156:159], v[108:111], v[148:151]
    v_mfma_f32_16x16x32_bf16 v[156:159], a[220:223], v[108:111], v[156:159]
    ds_read_b128 v[104:107], v6 offset:9216
    ds_read_b128 v[108:111], v6 offset:25600
    s_waitcnt lgkmcnt(2)
    v_mfma_f32_16x16x32_bf16 v[128:131], a[32:35], v[96:99], v[128:131]
    v_mfma_f32_16x16x32_bf16 v[136:139], a[96:99], v[96:99], v[136:139]
    v_mfma_f32_16x16x32_bf16 v[144:147], a[160:163], v[96:99], v[144:147]
    v_mfma_f32_16x16x32_bf16 v[152:155], a[224:227], v[96:99], v[152:155]
    v_mfma_f32_16x16x32_bf16 v[132:135], a[32:35], v[100:103], v[132:135]
    v_mfma_f32_16x16x32_bf16 v[140:143], a[96:99], v[100:103], v[140:143]
    v_mfma_f32_16x16x32_bf16 v[148:151], a[160:163], v[100:103], v[148:151]
    v_mfma_f32_16x16x32_bf16 v[156:159], a[224:227], v[100:103], v[156:159]
    ds_read_b128 v[96:99], v6 offset:10240
    ds_read_b128 v[100:103], v6 offset:26624
    s_waitcnt lgkmcnt(2)
    v_mfma_f32_16x16x32_bf16 v[128:131], a[36:39], v[104:107], v[128:131]
    v_mfma_f32_16x16x32_bf16 v[136:139], a[100:103], v[104:107], v[136:139]
    v_mfma_f32_16x16x32_bf16 v[144:147], a[164:167], v[104:107], v[144:147]
    v_mfma_f32_16x16x32_bf16 v[152:155], a[228:231], v[104:107], v[152:155]
    v_mfma_f32_16x16x32_bf16 v[132:135], a[36:39], v[108:111], v[132:135]
    v_mfma_f32_16x16x32_bf16 v[140:143], a[100:103], v[108:111], v[140:143]
    v_mfma_f32_16x16x32_bf16 v[148:151], a[164:167], v[108:111], v[148:151]
    v_mfma_f32_16x16x32_bf16 v[156:159], a[228:231], v[108:111], v[156:159]
    ds_read_b128 v[104:107], v6 offset:11264
    ds_read_b128 v[108:111], v6 offset:27648
    s_waitcnt lgkmcnt(2)
    v_mfma_f32_16x16x32_bf16 v[128:131], a[40:43], v[96:99], v[128:131]
    v_mfma_f32_16x16x32_bf16 v[136:139], a[104:107], v[96:99], v[136:139]
    v_mfma_f32_16x16x32_bf16 v[144:147], a[168:171], v[96:99], v[144:147]
    v_mfma_f32_16x16x32_bf16 v[152:155], a[232:235], v[96:99], v[152:155]
    v_mfma_f32_16x16x32_bf16 v[132:135], a[40:43], v[100:103], v[132:135]
    v_mfma_f32_16x16x32_bf16 v[140:143], a[104:107], v[100:103], v[140:143]
    v_mfma_f32_16x16x32_bf16 v[148:151], a[168:171], v[100:103], v[148:151]
    v_mfma_f32_16x16x32_bf16 v[156:159], a[232:235], v[100:103], v[156:159]
    ds_read_b128 v[96:99], v6 offset:12288
    ds_read_b128 v[100:103], v6 offset:28672
    s_waitcnt lgkmcnt(2)
    v_mfma_f32_16x16x32_bf16 v[128:131], a[44:47], v[104:107], v[128:131]
    v_mfma_f32_16x16x32_bf16 v[136:139], a[108:111], v[104:107], v[136:139]
    v_mfma_f32_16x16x32_bf16 v[144:147], a[172:175], v[104:107], v[144:147]
    v_mfma_f32_16x16x32_bf16 v[152:155], a[236:239], v[104:107], v[152:155]
    v_mfma_f32_16x16x32_bf16 v[132:135], a[44:47], v[108:111], v[132:135]
    v_mfma_f32_16x16x32_bf16 v[140:143], a[108:111], v[108:111], v[140:143]
    v_mfma_f32_16x16x32_bf16 v[148:151], a[172:175], v[108:111], v[148:151]
    v_mfma_f32_16x16x32_bf16 v[156:159], a[236:239], v[108:111], v[156:159]
    ds_read_b128 v[104:107], v6 offset:13312
    ds_read_b128 v[108:111], v6 offset:29696
    s_waitcnt lgkmcnt(2)
    v_mfma_f32_16x16x32_bf16 v[128:131], a[48:51], v[96:99], v[128:131]
    v_mfma_f32_16x16x32_bf16 v[136:139], a[112:115], v[96:99], v[136:139]
    v_mfma_f32_16x16x32_bf16 v[144:147], a[176:179], v[96:99], v[144:147]
    v_mfma_f32_16x16x32_bf16 v[152:155], a[240:243], v[96:99], v[152:155]
    v_mfma_f32_16x16x32_bf16 v[132:135], a[48:51], v[100:103], v[132:135]
    v_mfma_f32_16x16x32_bf16 v[140:143], a[112:115], v[100:103], v[140:143]
    v_mfma_f32_16x16x32_bf16 v[148:151], a[176:179], v[100:103], v[148:151]
    v_mfma_f32_16x16x32_bf16 v[156:159], a[240:243], v[100:103], v[156:159]
    ds_read_b128 v[96:99], v6 offset:14336
    ds_read_b128 v[100:103], v6 offset:30720
    s_waitcnt lgkmcnt(2)
    v_mfma_f32_16x16x32_bf16 v[128:131], a[52:55], v[104:107], v[128:131]
    v_mfma_f32_16x16x32_bf16 v[136:139], a[116:119], v[104:107], v[136:139]
    v_mfma_f32_16x16x32_bf16 v[144:147], a[180:183], v[104:107], v[144:147]
    v_mfma_f32_16x16x32_bf16 v[152:155], a[244:247], v[104:107], v[152:155]
    v_mfma_f32_16x16x32_bf16 v[132:135], a[52:55], v[108:111], v[132:135]
    v_mfma_f32_16x16x32_bf16 v[140:143], a[116:119], v[108:111], v[140:143]
    v_mfma_f32_16x16x32_bf16 v[148:151], a[180:183], v[108:111], v[148:151]
    v_mfma_f32_16x16x32_bf16 v[156:159], a[244:247], v[108:111], v[156:159]
    ds_read_b128 v[104:107], v6 offset:15360
    ds_read_b128 v[108:111], v6 offset:31744
    s_waitcnt lgkmcnt(2)
    v_mfma_f32_16x16x32_bf16 v[128:131], a[56:59], v[96:99], v[128:131]
    v_mfma_f32_16x16x32_bf16 v[136:139], a[120:123], v[96:99], v[136:139]
    v_mfma_f32_16x16x32_bf16 v[144:147], a[184:187], v[96:99], v[144:147]
    v_mfma_f32_16x16x32_bf16 v[152:155], a[248:251], v[96:99], v[152:155]
    v_mfma_f32_16x16x32_bf16 v[132:135], a[56:59], v[100:103], v[132:135]
    v_mfma_f32_16x16x32_bf16 v[140:143], a[120:123], v[100:103], v[140:143]
    v_mfma_f32_16x16x32_bf16 v[148:151], a[184:187], v[100:103], v[148:151]
    v_mfma_f32_16x16x32_bf16 v[156:159], a[248:251], v[100:103], v[156:159]
    s_waitcnt lgkmcnt(0)
    v_mfma_f32_16x16x32_bf16 v[128:131], a[60:63], v[104:107], v[128:131]
    v_mfma_f32_16x16x32_bf16 v[136:139], a[124:127], v[104:107], v[136:139]
    v_mfma_f32_16x16x32_bf16 v[144:147], a[188:191], v[104:107], v[144:147]
    v_mfma_f32_16x16x32_bf16 v[152:155], a[252:255], v[104:107], v[152:155]
    v_mfma_f32_16x16x32_bf16 v[132:135], a[60:63], v[108:111], v[132:135]
    v_mfma_f32_16x16x32_bf16 v[140:143], a[124:127], v[108:111], v[140:143]
    v_mfma_f32_16x16x32_bf16 v[148:151], a[188:191], v[108:111], v[148:151]
    v_mfma_f32_16x16x32_bf16 v[156:159], a[252:255], v[108:111], v[156:159]
    s_nop 7
    global_store_dwordx4 v16, v[128:131], s[12:13] offset:0 sc1
    global_store_dwordx4 v16, v[136:139], s[12:13] offset:1024 sc1
    global_store_dwordx4 v16, v[144:147], s[12:13] offset:2048 sc1
    global_store_dwordx4 v16, v[152:155], s[12:13] offset:3072 sc1
    global_store_dwordx4 v17, v[132:135], s[12:13] offset:0 sc1
    global_store_dwordx4 v17, v[140:143], s[12:13] offset:1024 sc1
    global_store_dwordx4 v17, v[148:151], s[12:13] offset:2048 sc1
    global_store_dwordx4 v17, v[156:159], s[12:13] offset:3072 sc1
    s_add_u32 s12, s12, 0x20000
    s_addc_u32 s13, s13, 0
    s_add_u32 s20, s20, 1
    s_waitcnt vmcnt(0)
    s_barrier
    s_mov_b32 s93, s20
    s_cmp_eq_u32 s6, 0
    s_cbranch_scc0 LPUB_38
    v_mov_b32 v8, s20
    v_mov_b32 v9, 0
    s_mov_b64 exec, 1
    global_store_dword v9, v8, s[14:15] sc1
    s_mov_b64 exec, -1
LPUB_38:
    s_cmp_lt_u32 s20, 32
    s_cbranch_scc0 L_P_end
    s_add_u32 s29, s20, 1
    s_cmp_eq_u32 s6, 0
    s_cbranch_scc0 LRF_39
    v_and_b32 v10, 3, v0
    v_lshlrev_b32 v10, 7, v10
    s_mov_b32 s28, 0
LPM_40:
    global_load_dword v11, v10, s[16:17] sc1
    s_waitcnt vmcnt(0)
    v_readlane_b32 s92, v11, 0
    v_readlane_b32 s21, v11, 1
    s_nop 0
    s_min_u32 s92, s92, s21
    v_readlane_b32 s21, v11, 2
    s_nop 0
    s_min_u32 s92, s92, s21
    v_readlane_b32 s21, v11, 3
    s_nop 0
    s_min_u32 s92, s92, s21
    s_cmp_ge_u32 s92, s29
    s_cbranch_scc1 LPMOK_41
    s_sleep 1
    s_add_u32 s28, s28, 1
    s_cmp_lt_u32 s28, 0x40000
    s_cbranch_scc1 LPM_40
    s_branch L_fail
LPMOK_41:
    v_mov_b32 v8, s92
    v_mov_b32 v9, 163072
    ds_write_b32 v9, v8
    s_waitcnt lgkmcnt(0)
LRF_39:
    s_barrier
    v_mov_b32 v9, 163072
    ds_read_b32 v8, v9
    s_waitcnt lgkmcnt(0)
    s_nop 0
    v_readfirstlane_b32 s92, v8
    s_lshl_b32 s21, s6, 17
    s_add_u32 s24, s26, s21
    s_addc_u32 s25, s27, 0
    s_lshl_b32 s30, s6, 14
    s_add_u32 s30, s30, 0
    s_mov_b32 m0, s30
    s_nop 0
    global_load_lds_dwordx4 v1, s[24:25] offset:0 sc1
    s_mov_b32 m0, s30
    s_nop 0
    global_load_lds_dwordx4 v1, s[24:25] offset:1024 sc1
    s_mov_b32 m0, s30
    s_nop 0
    global_load_lds_dwordx4 v1, s[24:25] offset:2048 sc1
    s_mov_b32 m0, s30
    s_nop 0
    global_load_lds_dwordx4 v1, s[24:25] offset:3072 sc1
    s_add_u32 s24, s24, 4096
    s_addc_u32 s25, s25, 0
    s_add_u32 s30, s30, 4096
    s_mov_b32 m0, s30
    s_nop 0
    global_load_lds_dwordx4 v1, s[24:25] offset:0 sc1
    s_mov_b32 m0, s30
    s_nop 0
    global_load_lds_dwordx4 v1, s[24:25] offset:1024 sc1
    s_mov_b32 m0, s30
    s_nop 0
    global_load_lds_dwordx4 v1, s[24:25] offset:2048 sc1
    s_mov_b32 m0, s30
    s_nop 0
    global_load_lds_dwordx4 v1, s[24:25] offset:3072 sc1
    s_add_u32 s24, s24, 4096
    s_addc_u32 s25, s25, 0
    s_add_u32 s30, s30, 4096
    s_mov_b32 m0, s30
    s_nop 0
    global_load_lds_dwordx4 v1, s[24:25] offset:0 sc1
    s_mov_b32 m0, s30
    s_nop 0
    global_load_lds_dwordx4 v1, s[24:25] offset:1024 sc1
    s_mov_b32 m0, s30
    s_nop 0
    global_load_lds_dwordx4 v1, s[24:25] offset:2048 sc1
    s_mov_b32 m0, s30
    s_nop 0
    global_load_lds_dwordx4 v1, s[24:25] offset:3072 sc1
    s_add_u32 s24, s24, 4096
    s_addc_u32 s25, s25, 0
    s_add_u32 s30, s30, 4096
    s_mov_b32 m0, s30
    s_nop 0
    global_load_lds_dwordx4 v1, s[24:25] offset:0 sc1
    s_mov_b32 m0, s30
    s_nop 0
    global_load_lds_dwordx4 v1, s[24:25] offset:1024 sc1
    s_mov_b32 m0, s30
    s_nop 0
    global_load_lds_dwordx4 v1, s[24:25] offset:2048 sc1
    s_mov_b32 m0, s30
    s_nop 0
    global_load_lds_dwordx4 v1, s[24:25] offset:3072 sc1
    s_waitcnt vmcnt(0)
LJ_36:
    s_branch L_P_loop
L_P_end:
    s_waitcnt vmcnt(0)
    s_branch L_end
L_roleV:
    s_cmp_eq_u32 s4, 0
    s_cselect_b32 s8, s76, s84
    s_cselect_b32 s9, s77, s85
    s_lshl_b32 s21, s5, 8
    s_add_u32 s8, s8, s21
    s_addc_u32 s9, s9, 0
    v_lshrrev_b32 v20, 4, v0
    v_and_b32 v23, 15, v0
    v_lshrrev_b32 v21, 2, v23
    v_and_b32 v22, 3, v0
    v_and_b32 v24, 15, v0
    v_lshrrev_b32 v25, 4, v0
    v_lshlrev_b32 v26, 1, v25
    v_xor_b32 v27, v24, v26
    v_xor_b32 v28, 8, v27
    v_lshlrev_b32 v27, 4, v27
    v_lshlrev_b32 v28, 4, v28
    v_lshlrev_b32 v29, 13, v25
    v_add_u32 v27, v27, v29
    v_add_u32 v28, v28, v29
    s_lshl_b32 s21, s6, 20
    s_add_u32 s24, s8, s21
    s_addc_u32 s25, s9, 0
    s_lshl_b32 s30, s6, 15
    s_mov_b32 m0, s30
    s_add_u32 s30, s30, 1024
    global_load_lds_dwordx4 v27, s[24:25]
    s_add_u32 s24, s24, 0x8000
    s_addc_u32 s25, s25, 0
    s_mov_b32 m0, s30
    s_add_u32 s30, s30, 1024
    global_load_lds_dwordx4 v27, s[24:25]
    s_add_u32 s24, s24, 0x8000
    s_addc_u32 s25, s25, 0
    s_mov_b32 m0, s30
    s_add_u32 s30, s30, 1024
    global_load_lds_dwordx4 v28, s[24:25]
    s_add_u32 s24, s24, 0x8000
    s_addc_u32 s25, s25, 0
    s_mov_b32 m0, s30
    s_add_u32 s30, s30, 1024
    global_load_lds_dwordx4 v28, s[24:25]
    s_add_u32 s24, s24, 0x8000
    s_addc_u32 s25, s25, 0
    s_mov_b32 m0, s30
    s_add_u32 s30, s30, 1024
    global_load_lds_dwordx4 v27, s[24:25]
    s_add_u32 s24, s24, 0x8000
    s_addc_u32 s25, s25, 0
    s_mov_b32 m0, s30
    s_add_u32 s30, s30, 1024
    global_load_lds_dwordx4 v27, s[24:25]
    s_add_u32 s24, s24, 0x8000
    s_addc_u32 s25, s25, 0
    s_mov_b32 m0, s30
    s_add_u32 s30, s30, 1024
    global_load_lds_dwordx4 v28, s[24:25]
    s_add_u32 s24, s24, 0x8000
    s_addc_u32 s25, s25, 0
    s_mov_b32 m0, s30
    s_add_u32 s30, s30, 1024
    global_load_lds_dwordx4 v28, s[24:25]
    s_add_u32 s24, s24, 0x8000
    s_addc_u32 s25, s25, 0
    s_mov_b32 m0, s30
    s_add_u32 s30, s30, 1024
    global_load_lds_dwordx4 v27, s[24:25]
    s_add_u32 s24, s24, 0x8000
    s_addc_u32 s25, s25, 0
    s_mov_b32 m0, s30
    s_add_u32 s30, s30, 1024
    global_load_lds_dwordx4 v27, s[24:25]
    s_add_u32 s24, s24, 0x8000
    s_addc_u32 s25, s25, 0
    s_mov_b32 m0, s30
    s_add_u32 s30, s30, 1024
    global_load_lds_dwordx4 v28, s[24:25]
    s_add_u32 s24, s24, 0x8000
    s_addc_u32 s25, s25, 0
    s_mov_b32 m0, s30
    s_add_u32 s30, s30, 1024
    global_load_lds_dwordx4 v28, s[24:25]
    s_add_u32 s24, s24, 0x8000
    s_addc_u32 s25, s25, 0
    s_waitcnt vmcnt(8)
    s_mov_b32 m0, s30
    s_add_u32 s30, s30, 1024
    global_load_lds_dwordx4 v27, s[24:25]
    s_add_u32 s24, s24, 0x8000
    s_addc_u32 s25, s25, 0
    s_mov_b32 m0, s30
    s_add_u32 s30, s30, 1024
    global_load_lds_dwordx4 v27, s[24:25]
    s_add_u32 s24, s24, 0x8000
    s_addc_u32 s25, s25, 0
    s_mov_b32 m0, s30
    s_add_u32 s30, s30, 1024
    global_load_lds_dwordx4 v28, s[24:25]
    s_add_u32 s24, s24, 0x8000
    s_addc_u32 s25, s25, 0
    s_mov_b32 m0, s30
    s_add_u32 s30, s30, 1024
    global_load_lds_dwordx4 v28, s[24:25]
    s_add_u32 s24, s24, 0x8000
    s_addc_u32 s25, s25, 0
    s_waitcnt vmcnt(8)
    s_mov_b32 m0, s30
    s_add_u32 s30, s30, 1024
    global_load_lds_dwordx4 v27, s[24:25]
    s_add_u32 s24, s24, 0x8000
    s_addc_u32 s25, s25, 0
    s_mov_b32 m0, s30
    s_add_u32 s30, s30, 1024
    global_load_lds_dwordx4 v27, s[24:25]
    s_add_u32 s24, s24, 0x8000
    s_addc_u32 s25, s25, 0
    s_mov_b32 m0, s30
    s_add_u32 s30, s30, 1024
    global_load_lds_dwordx4 v28, s[24:25]
    s_add_u32 s24, s24, 0x8000
    s_addc_u32 s25, s25, 0
    s_mov_b32 m0, s30
    s_add_u32 s30, s30, 1024
    global_load_lds_dwordx4 v28, s[24:25]
    s_add_u32 s24, s24, 0x8000
    s_addc_u32 s25, s25, 0
    s_waitcnt vmcnt(8)
    s_mov_b32 m0, s30
    s_add_u32 s30, s30, 1024
    global_load_lds_dwordx4 v27, s[24:25]
    s_add_u32 s24, s24, 0x8000
    s_addc_u32 s25, s25, 0
    s_mov_b32 m0, s30
    s_add_u32 s30, s30, 1024
    global_load_lds_dwordx4 v27, s[24:25]
    s_add_u32 s24, s24, 0x8000
    s_addc_u32 s25, s25, 0
    s_mov_b32 m0, s30
    s_add_u32 s30, s30, 1024
    global_load_lds_dwordx4 v28, s[24:25]
    s_add_u32 s24, s24, 0x8000
    s_addc_u32 s25, s25, 0
    s_mov_b32 m0, s30
    s_add_u32 s30, s30, 1024
    global_load_lds_dwordx4 v28, s[24:25]
    s_add_u32 s24, s24, 0x8000
    s_addc_u32 s25, s25, 0
    s_waitcnt vmcnt(8)
    s_mov_b32 m0, s30
    s_add_u32 s30, s30, 1024
    global_load_lds_dwordx4 v27, s[24:25]
    s_add_u32 s24, s24, 0x8000
    s_addc_u32 s25, s25, 0
    s_mov_b32 m0, s30
    s_add_u32 s30, s30, 1024
    global_load_lds_dwordx4 v27, s[24:25]
    s_add_u32 s24, s24, 0x8000
    s_addc_u32 s25, s25, 0
    s_mov_b32 m0, s30
    s_add_u32 s30, s30, 1024
    global_load_lds_dwordx4 v28, s[24:25]
    s_add_u32 s24, s24, 0x8000
    s_addc_u32 s25, s25, 0
    s_mov_b32 m0, s30
    s_add_u32 s30, s30, 1024
    global_load_lds_dwordx4 v28, s[24:25]
    s_add_u32 s24, s24, 0x8000
    s_addc_u32 s25, s25, 0
    s_waitcnt vmcnt(8)
    s_mov_b32 m0, s30
    s_add_u32 s30, s30, 1024
    global_load_lds_dwordx4 v27, s[24:25]
    s_add_u32 s24, s24, 0x8000
    s_addc_u32 s25, s25, 0
    s_mov_b32 m0, s30
    s_add_u32 s30, s30, 1024
    global_load_lds_dwordx4 v27, s[24:25]
    s_add_u32 s24, s24, 0x8000
    s_addc_u32 s25, s25, 0
    s_mov_b32 m0, s30
    s_add_u32 s30, s30, 1024
    global_load_lds_dwordx4 v28, s[24:25]
    s_add_u32 s24, s24, 0x8000
    s_addc_u32 s25, s25, 0
    s_mov_b32 m0, s30
    s_add_u32 s30, s30, 1024
    global_load_lds_dwordx4 v28, s[24:25]
    s_add_u32 s24, s24, 0x8000
    s_addc_u32 s25, s25, 0
    v_lshl_add_u32 v24, v20, 3, v21
    v_and_b32 v25, 1, v20
    v_lshl_add_u32 v25, v25, 2, v21
    v_lshlrev_b32 v24, 8, v24
    v_lshl_add_u32 v24, v22, 3, v24
    s_lshl_b32 s21, s7, 2
    s_add_u32 s22, s21, 0
    v_xor_b32 v26, s22, v25
    v_lshl_add_u32 v8, v26, 5, v24
    v_add_u32 v12, 0x10000, v8
    s_add_u32 s22, s21, 1
    v_xor_b32 v26, s22, v25
    v_lshl_add_u32 v9, v26, 5, v24
    v_add_u32 v13, 0x10000, v9
    s_add_u32 s22, s21, 2
    v_xor_b32 v26, s22, v25
    v_lshl_add_u32 v10, v26, 5, v24
    v_add_u32 v14, 0x10000, v10
    s_add_u32 s22, s21, 3
    v_xor_b32 v26, s22, v25
    v_lshl_add_u32 v11, v26, 5, v24
    v_add_u32 v15, 0x10000, v11
    s_and_b32 s23, s31, 63
    s_lshl_b32 s23, s23, 7
    s_lshr_b32 s22, s31, 6
    s_mov_b32 s21, 0x5202000
    s_cmp_eq_u32 s22, 0
    s_cselect_b32 s21, 0x5200000, s21
    s_cmp_eq_u32 s22, 2
    s_cselect_b32 s21, 0x5206000, s21
    s_add_u32 s21, s21, s23
    s_add_u32 s58, s18, s21
    s_addc_u32 s59, s19, 0
    v_mov_b32 v20, 0
    s_mov_b64 exec, 1
    global_store_dword v20, v20, s[58:59] sc1
    s_mov_b64 exec, -1
    s_add_u32 s21, s23, 0x5208000
    s_cmp_eq_u32 s22, 0
    s_cbranch_scc0 LNK_42
    s_add_u32 s58, s18, s21
    s_addc_u32 s59, s19, 0
    v_mov_b32 v20, 0
    s_mov_b64 exec, 1
    global_store_dword v20, v20, s[58:59] sc1
    s_mov_b64 exec, -1
LNK_42:
    s_waitcnt vmcnt(0)
    s_barrier
    s_cmp_eq_u32 s6, 0
    s_cbranch_scc0 LARR_43
    v_mov_b32 v30, 0
    v_mov_b32 v31, 1
    s_mov_b64 exec, 1
    global_atomic_add v30, v31, s[38:39]
    s_mov_b64 exec, -1
LARR_43:
    ds_read_b64_tr_b16 a[0:1], v8 offset:0
    ds_read_b64_tr_b16 a[2:3], v8 offset:1024
    ds_read_b64_tr_b16 a[4:5], v8 offset:8192
    ds_read_b64_tr_b16 a[6:7], v8 offset:9216
    ds_read_b64_tr_b16 a[8:9], v8 offset:16384
    ds_read_b64_tr_b16 a[10:11], v8 offset:17408
    ds_read_b64_tr_b16 a[12:13], v8 offset:24576
    ds_read_b64_tr_b16 a[14:15], v8 offset:25600
    ds_read_b64_tr_b16 a[16:17], v8 offset:32768
    ds_read_b64_tr_b16 a[18:19], v8 offset:33792
    ds_read_b64_tr_b16 a[20:21], v8 offset:40960
    ds_read_b64_tr_b16 a[22:23], v8 offset:41984
    s_waitcnt lgkmcnt(4)
    ds_read_b64_tr_b16 a[24:25], v8 offset:49152
    ds_read_b64_tr_b16 a[26:27], v8 offset:50176
    ds_read_b64_tr_b16 a[28:29], v8 offset:57344
    ds_read_b64_tr_b16 a[30:31], v8 offset:58368
    ds_read_b64_tr_b16 a[32:33], v12 offset:0
    ds_read_b64_tr_b16 a[34:35], v12 offset:1024
    ds_read_b64_tr_b16 a[36:37], v12 offset:8192
    ds_read_b64_tr_b16 a[38:39], v12 offset:9216
    ds_read_b64_tr_b16 a[40:41], v12 offset:16384
    ds_read_b64_tr_b16 a[42:43], v12 offset:17408
    ds_read_b64_tr_b16 a[44:45], v12 offset:24576
    ds_read_b64_tr_b16 a[46:47], v12 offset:25600
    s_waitcnt lgkmcnt(4)
    ds_read_b64_tr_b16 a[48:49], v12 offset:32768
    ds_read_b64_tr_b16 a[50:51], v12 offset:33792
    ds_read_b64_tr_b16 a[52:53], v12 offset:40960
    ds_read_b64_tr_b16 a[54:55], v12 offset:41984
    ds_read_b64_tr_b16 a[56:57], v12 offset:49152
    ds_read_b64_tr_b16 a[58:59], v12 offset:50176
    ds_read_b64_tr_b16 a[60:61], v12 offset:57344
    ds_read_b64_tr_b16 a[62:63], v12 offset:58368
    s_waitcnt lgkmcnt(0)
    ds_read_b64_tr_b16 a[64:65], v9 offset:0
    ds_read_b64_tr_b16 a[66:67], v9 offset:1024
    ds_read_b64_tr_b16 a[68:69], v9 offset:8192
    ds_read_b64_tr_b16 a[70:71], v9 offset:9216
    ds_read_b64_tr_b16 a[72:73], v9 offset:16384
    ds_read_b64_tr_b16 a[74:75], v9 offset:17408
    ds_read_b64_tr_b16 a[76:77], v9 offset:24576
    ds_read_b64_tr_b16 a[78:79], v9 offset:25600
    ds_read_b64_tr_b16 a[80:81], v9 offset:32768
    ds_read_b64_tr_b16 a[82:83], v9 offset:33792
    ds_read_b64_tr_b16 a[84:85], v9 offset:40960
    ds_read_b64_tr_b16 a[86:87], v9 offset:41984
    s_waitcnt lgkmcnt(4)
    ds_read_b64_tr_b16 a[88:89], v9 offset:49152
    ds_read_b64_tr_b16 a[90:91], v9 offset:50176
    ds_read_b64_tr_b16 a[92:93], v9 offset:57344
    ds_read_b64_tr_b16 a[94:95], v9 offset:58368
    ds_read_b64_tr_b16 a[96:97], v13 offset:0
    ds_read_b64_tr_b16 a[98:99], v13 offset:1024
    ds_read_b64_tr_b16 a[100:101], v13 offset:8192
    ds_read_b64_tr_b16 a[102:103], v13 offset:9216
    ds_read_b64_tr_b16 a[104:105], v13 offset:16384
    ds_read_b64_tr_b16 a[106:107], v13 offset:17408
    ds_read_b64_tr_b16 a[108:109], v13 offset:24576
    ds_read_b64_tr_b16 a[110:111], v13 offset:25600
    s_waitcnt lgkmcnt(4)
    ds_read_b64_tr_b16 a[112:113], v13 offset:32768
    ds_read_b64_tr_b16 a[114:115], v13 offset:33792
    ds_read_b64_tr_b16 a[116:117], v13 offset:40960
    ds_read_b64_tr_b16 a[118:119], v13 offset:41984
    ds_read_b64_tr_b16 a[120:121], v13 offset:49152
    ds_read_b64_tr_b16 a[122:123], v13 offset:50176
    ds_read_b64_tr_b16 a[124:125], v13 offset:57344
    ds_read_b64_tr_b16 a[126:127], v13 offset:58368
    s_waitcnt lgkmcnt(0)
    ds_read_b64_tr_b16 a[128:129], v10 offset:0
    ds_read_b64_tr_b16 a[130:131], v10 offset:1024
    ds_read_b64_tr_b16 a[132:133], v10 offset:8192
    ds_read_b64_tr_b16 a[134:135], v10 offset:9216
    ds_read_b64_tr_b16 a[136:137], v10 offset:16384
    ds_read_b64_tr_b16 a[138:139], v10 offset:17408
    ds_read_b64_tr_b16 a[140:141], v10 offset:24576
    ds_read_b64_tr_b16 a[142:143], v10 offset:25600
    ds_read_b64_tr_b16 a[144:145], v10 offset:32768
    ds_read_b64_tr_b16 a[146:147], v10 offset:33792
    ds_read_b64_tr_b16 a[148:149], v10 offset:40960
    ds_read_b64_tr_b16 a[150:151], v10 offset:41984
    s_waitcnt lgkmcnt(4)
    ds_read_b64_tr_b16 a[152:153], v10 offset:49152
    ds_read_b64_tr_b16 a[154:155], v10 offset:50176
    ds_read_b64_tr_b16 a[156:157], v10 offset:57344
    ds_read_b64_tr_b16 a[158:159], v10 offset:58368
    ds_read_b64_tr_b16 a[160:161], v14 offset:0
    ds_read_b64_tr_b16 a[162:163], v14 offset:1024
    ds_read_b64_tr_b16 a[164:165], v14 offset:8192
    ds_read_b64_tr_b16 a[166:167], v14 offset:9216
    ds_read_b64_tr_b16 a[168:169], v14 offset:16384
    ds_read_b64_tr_b16 a[170:171], v14 offset:17408
    ds_read_b64_tr_b16 a[172:173], v14 offset:24576
    ds_read_b64_tr_b16 a[174:175], v14 offset:25600
    s_waitcnt lgkmcnt(4)
    ds_read_b64_tr_b16 a[176:177], v14 offset:32768
    ds_read_b64_tr_b16 a[178:179], v14 offset:33792
    ds_read_b64_tr_b16 a[180:181], v14 offset:40960
    ds_read_b64_tr_b16 a[182:183], v14 offset:41984
    ds_read_b64_tr_b16 a[184:185], v14 offset:49152
    ds_read_b64_tr_b16 a[186:187], v14 offset:50176
    ds_read_b64_tr_b16 a[188:189], v14 offset:57344
    ds_read_b64_tr_b16 a[190:191], v14 offset:58368
    s_waitcnt lgkmcnt(0)
    ds_read_b64_tr_b16 a[192:193], v11 offset:0
    ds_read_b64_tr_b16 a[194:195], v11 offset:1024
    ds_read_b64_tr_b16 a[196:197], v11 offset:8192
    ds_read_b64_tr_b16 a[198:199], v11 offset:9216
    ds_read_b64_tr_b16 a[200:201], v11 offset:16384
    ds_read_b64_tr_b16 a[202:203], v11 offset:17408
    ds_read_b64_tr_b16 a[204:205], v11 offset:24576
    ds_read_b64_tr_b16 a[206:207], v11 offset:25600
    ds_read_b64_tr_b16 a[208:209], v11 offset:32768
    ds_read_b64_tr_b16 a[210:211], v11 offset:33792
    ds_read_b64_tr_b16 a[212:213], v11 offset:40960
    ds_read_b64_tr_b16 a[214:215], v11 offset:41984
    s_waitcnt lgkmcnt(4)
    ds_read_b64_tr_b16 a[216:217], v11 offset:49152
    ds_read_b64_tr_b16 a[218:219], v11 offset:50176
    ds_read_b64_tr_b16 a[220:221], v11 offset:57344
    ds_read_b64_tr_b16 a[222:223], v11 offset:58368
    ds_read_b64_tr_b16 a[224:225], v15 offset:0
    ds_read_b64_tr_b16 a[226:227], v15 offset:1024
    ds_read_b64_tr_b16 a[228:229], v15 offset:8192
    ds_read_b64_tr_b16 a[230:231], v15 offset:9216
    ds_read_b64_tr_b16 a[232:233], v15 offset:16384
    ds_read_b64_tr_b16 a[234:235], v15 offset:17408
    ds_read_b64_tr_b16 a[236:237], v15 offset:24576
    ds_read_b64_tr_b16 a[238:239], v15 offset:25600
    s_waitcnt lgkmcnt(4)
    ds_read_b64_tr_b16 a[240:241], v15 offset:32768
    ds_read_b64_tr_b16 a[242:243], v15 offset:33792
    ds_read_b64_tr_b16 a[244:245], v15 offset:40960
    ds_read_b64_tr_b16 a[246:247], v15 offset:41984
    ds_read_b64_tr_b16 a[248:249], v15 offset:49152
    ds_read_b64_tr_b16 a[250:251], v15 offset:50176
    ds_read_b64_tr_b16 a[252:253], v15 offset:57344
    ds_read_b64_tr_b16 a[254:255], v15 offset:58368
    s_waitcnt lgkmcnt(0)
    s_barrier
    v_lshlrev_b32 v1, 4, v0
    v_lshrrev_b32 v20, 3, v0
    v_and_b32 v21, 7, v0
    v_and_b32 v22, 6, v20
    v_xor_b32 v21, v21, v22
    v_lshlrev_b32 v21, 4, v21
    v_lshl_add_u32 v2, v20, 10, v21
    v_and_b32 v20, 15, v0
    v_lshrrev_b32 v21, 3, v20
    v_lshlrev_b32 v21, 13, v21
    v_and_b32 v22, 7, v20
    v_and_b32 v23, 6, v22
    v_lshrrev_b32 v24, 4, v0
    v_xor_b32 v23, v24, v23
    v_lshl_add_u32 v23, v22, 3, v23
    v_lshl_add_u32 v21, v23, 4, v21
    s_lshl_b32 s21, s3, 15
    v_add_u32 v4, s21, v21
    v_xor_b32 v5, 64, v4
    v_add_u32 v6, 0x10000, v4
    v_add_u32 v7, 0x10000, v5
    s_mov_b32 s26, s34
    s_mov_b32 s27, s35
    s_lshl_b32 s21, s4, 6
    s_add_u32 s21, s21, s3
    s_lshl_b32 s21, s21, 5
    s_add_u32 s21, s21, s5
    s_lshl_b32 s21, s21, 13
    s_add_u32 s21, s21, 0x2000000
    s_add_u32 s12, s18, s21
    s_addc_u32 s13, s19, 0
    s_lshl_b32 s21, s7, 12
    v_add_u32 v16, s21, v1
    v_add_u32 v17, 0x1000, v16
    s_lshl_b32 s21, s4, 5
    s_add_u32 s21, s21, s5
    s_lshl_b32 s21, s21, 7
    s_add_u32 s21, s21, 0x5202000
    s_add_u32 s14, s18, s21
    s_addc_u32 s15, s19, 0
    s_mov_b32 s20, 0
    s_lshl_b32 s21, s6, 14
    s_add_u32 s21, s21, 0
    s_add_u32 s24, s26, s21
    s_addc_u32 s25, s27, 0
    s_add_u32 s30, s21, 0
    s_add_u32 m0, s30, 0
    s_nop 0
    global_load_lds_dwordx4 v2, s[24:25] offset:0
    s_add_u32 m0, s30, 896
    s_nop 0
    global_load_lds_dwordx4 v2, s[24:25] offset:128
    s_add_u32 m0, s30, 1792
    s_nop 0
    global_load_lds_dwordx4 v2, s[24:25] offset:256
    s_add_u32 m0, s30, 2688
    s_nop 0
    global_load_lds_dwordx4 v2, s[24:25] offset:384
    s_add_u32 m0, s30, 3584
    s_nop 0
    global_load_lds_dwordx4 v2, s[24:25] offset:512
    s_add_u32 m0, s30, 4480
    s_nop 0
    global_load_lds_dwordx4 v2, s[24:25] offset:640
    s_add_u32 m0, s30, 5376
    s_nop 0
    global_load_lds_dwordx4 v2, s[24:25] offset:768
    s_add_u32 m0, s30, 6272
    s_nop 0
    global_load_lds_dwordx4 v2, s[24:25] offset:896
    s_lshl_b32 s21, s6, 14
    s_add_u32 s21, s21, 8192
    s_add_u32 s24, s26, s21
    s_addc_u32 s25, s27, 0
    s_add_u32 s30, s21, 0
    s_add_u32 m0, s30, 0
    s_nop 0
    global_load_lds_dwordx4 v2, s[24:25] offset:0
    s_add_u32 m0, s30, 896
    s_nop 0
    global_load_lds_dwordx4 v2, s[24:25] offset:128
    s_add_u32 m0, s30, 1792
    s_nop 0
    global_load_lds_dwordx4 v2, s[24:25] offset:256
    s_add_u32 m0, s30, 2688
    s_nop 0
    global_load_lds_dwordx4 v2, s[24:25] offset:384
    s_add_u32 m0, s30, 3584
    s_nop 0
    global_load_lds_dwordx4 v2, s[24:25] offset:512
    s_add_u32 m0, s30, 4480
    s_nop 0
    global_load_lds_dwordx4 v2, s[24:25] offset:640
    s_add_u32 m0, s30, 5376
    s_nop 0
    global_load_lds_dwordx4 v2, s[24:25] offset:768
    s_add_u32 m0, s30, 6272
    s_nop 0
    global_load_lds_dwordx4 v2, s[24:25] offset:896
    s_waitcnt vmcnt(0)
L_V_loop:
    s_waitcnt vmcnt(4)
    s_barrier
    s_sub_u32 s23, s20, 1
    s_cmp_ge_i32 s23, 4
    s_cbranch_scc0 LNP_44
    s_cmp_eq_u32 s6, 0
    s_cbranch_scc0 LPUB_45
    v_mov_b32 v8, s23
    v_mov_b32 v9, 0
    s_mov_b64 exec, 1
    global_store_dword v9, v8, s[14:15] sc1
    s_mov_b64 exec, -1
LPUB_45:
LNP_44:
    s_add_u32 s26, s26, 0x10000
    s_addc_u32 s27, s27, 0
    s_add_u32 s23, s20, 1
    s_cmp_lt_u32 s23, 32
    s_cbranch_scc0 LND_46
    ds_read_b128 v[96:99], v4 offset:0
    ds_read_b128 v[100:103], v4 offset:16384
    ds_read_b128 v[104:107], v5 offset:0
    ds_read_b128 v[108:111], v5 offset:16384
    s_waitcnt lgkmcnt(2)
    v_mfma_f32_16x16x32_bf16 v[128:131], v[96:99], a[0:3], 0
    v_mfma_f32_16x16x32_bf16 v[136:139], v[96:99], a[64:67], 0
    s_lshl_b32 s21, s6, 14
    s_add_u32 s21, s21, 0
    s_add_u32 s24, s26, s21
    s_addc_u32 s25, s27, 0
    s_add_u32 s30, s21, 65536
    s_add_u32 m0, s30, 0
    s_nop 0
    global_load_lds_dwordx4 v2, s[24:25] offset:0
    v_mfma_f32_16x16x32_bf16 v[144:147], v[96:99], a[128:131], 0
    v_mfma_f32_16x16x32_bf16 v[152:155], v[96:99], a[192:195], 0
    v_mfma_f32_16x16x32_bf16 v[132:135], v[100:103], a[0:3], 0
    v_mfma_f32_16x16x32_bf16 v[140:143], v[100:103], a[64:67], 0
    v_mfma_f32_16x16x32_bf16 v[148:151], v[100:103], a[128:131], 0
    v_mfma_f32_16x16x32_bf16 v[156:159], v[100:103], a[192:195], 0
    ds_read_b128 v[96:99], v4 offset:1024
    ds_read_b128 v[100:103], v4 offset:17408
    s_waitcnt lgkmcnt(2)
    v_mfma_f32_16x16x32_bf16 v[128:131], v[104:107], a[4:7], v[128:131]
    v_mfma_f32_16x16x32_bf16 v[136:139], v[104:107], a[68:71], v[136:139]
    s_add_u32 m0, s30, 896
    s_nop 0
    global_load_lds_dwordx4 v2, s[24:25] offset:128
    v_mfma_f32_16x16x32_bf16 v[144:147], v[104:107], a[132:135], v[144:147]
    v_mfma_f32_16x16x32_bf16 v[152:155], v[104:107], a[196:199], v[152:155]
    v_mfma_f32_16x16x32_bf16 v[132:135], v[108:111], a[4:7], v[132:135]
    v_mfma_f32_16x16x32_bf16 v[140:143], v[108:111], a[68:71], v[140:143]
    v_mfma_f32_16x16x32_bf16 v[148:151], v[108:111], a[132:135], v[148:151]
    v_mfma_f32_16x16x32_bf16 v[156:159], v[108:111], a[196:199], v[156:159]
    ds_read_b128 v[104:107], v5 offset:1024
    ds_read_b128 v[108:111], v5 offset:17408
    s_waitcnt lgkmcnt(2)
    v_mfma_f32_16x16x32_bf16 v[128:131], v[96:99], a[8:11], v[128:131]
    v_mfma_f32_16x16x32_bf16 v[136:139], v[96:99], a[72:75], v[136:139]
    s_add_u32 m0, s30, 1792
    s_nop 0
    global_load_lds_dwordx4 v2, s[24:25] offset:256
    v_mfma_f32_16x16x32_bf16 v[144:147], v[96:99], a[136:139], v[144:147]
    v_mfma_f32_16x16x32_bf16 v[152:155], v[96:99], a[200:203], v[152:155]
    v_mfma_f32_16x16x32_bf16 v[132:135], v[100:103], a[8:11], v[132:135]
    v_mfma_f32_16x16x32_bf16 v[140:143], v[100:103], a[72:75], v[140:143]
    v_mfma_f32_16x16x32_bf16 v[148:151], v[100:103], a[136:139], v[148:151]
    v_mfma_f32_16x16x32_bf16 v[156:159], v[100:103], a[200:203], v[156:159]
    ds_read_b128 v[96:99], v4 offset:2048
    ds_read_b128 v[100:103], v4 offset:18432
    s_waitcnt lgkmcnt(2)
    v_mfma_f32_16x16x32_bf16 v[128:131], v[104:107], a[12:15], v[128:131]
    v_mfma_f32_16x16x32_bf16 v[136:139], v[104:107], a[76:79], v[136:139]
    s_add_u32 m0, s30, 2688
    s_nop 0
    global_load_lds_dwordx4 v2, s[24:25] offset:384
    v_mfma_f32_16x16x32_bf16 v[144:147], v[104:107], a[140:143], v[144:147]
    v_mfma_f32_16x16x32_bf16 v[152:155], v[104:107], a[204:207], v[152:155]
    v_mfma_f32_16x16x32_bf16 v[132:135], v[108:111], a[12:15], v[132:135]
    v_mfma_f32_16x16x32_bf16 v[140:143], v[108:111], a[76:79], v[140:143]
    v_mfma_f32_16x16x32_bf16 v[148:151], v[108:111], a[140:143], v[148:151]
    v_mfma_f32_16x16x32_bf16 v[156:159], v[108:111], a[204:207], v[156:159]
    ds_read_b128 v[104:107], v5 offset:2048
    ds_read_b128 v[108:111], v5 offset:18432
    s_waitcnt lgkmcnt(2)
    v_mfma_f32_16x16x32_bf16 v[128:131], v[96:99], a[16:19], v[128:131]
    v_mfma_f32_16x16x32_bf16 v[136:139], v[96:99], a[80:83], v[136:139]
    s_add_u32 m0, s30, 3584
    s_nop 0
    global_load_lds_dwordx4 v2, s[24:25] offset:512
    v_mfma_f32_16x16x32_bf16 v[144:147], v[96:99], a[144:147], v[144:147]
    v_mfma_f32_16x16x32_bf16 v[152:155], v[96:99], a[208:211], v[152:155]
    v_mfma_f32_16x16x32_bf16 v[132:135], v[100:103], a[16:19], v[132:135]
    v_mfma_f32_16x16x32_bf16 v[140:143], v[100:103], a[80:83], v[140:143]
    v_mfma_f32_16x16x32_bf16 v[148:151], v[100:103], a[144:147], v[148:151]
    v_mfma_f32_16x16x32_bf16 v[156:159], v[100:103], a[208:211], v[156:159]
    ds_read_b128 v[96:99], v4 offset:3072
    ds_read_b128 v[100:103], v4 offset:19456
    s_waitcnt lgkmcnt(2)
    v_mfma_f32_16x16x32_bf16 v[128:131], v[104:107], a[20:23], v[128:131]
    v_mfma_f32_16x16x32_bf16 v[136:139], v[104:107], a[84:87], v[136:139]
    s_add_u32 m0, s30, 4480
    s_nop 0
    global_load_lds_dwordx4 v2, s[24:25] offset:640
    v_mfma_f32_16x16x32_bf16 v[144:147], v[104:107], a[148:151], v[144:147]
    v_mfma_f32_16x16x32_bf16 v[152:155], v[104:107], a[212:215], v[152:155]
    v_mfma_f32_16x16x32_bf16 v[132:135], v[108:111], a[20:23], v[132:135]
    v_mfma_f32_16x16x32_bf16 v[140:143], v[108:111], a[84:87], v[140:143]
    v_mfma_f32_16x16x32_bf16 v[148:151], v[108:111], a[148:151], v[148:151]
    v_mfma_f32_16x16x32_bf16 v[156:159], v[108:111], a[212:215], v[156:159]
    ds_read_b128 v[104:107], v5 offset:3072
    ds_read_b128 v[108:111], v5 offset:19456
    s_waitcnt lgkmcnt(2)
    v_mfma_f32_16x16x32_bf16 v[128:131], v[96:99], a[24:27], v[128:131]
    v_mfma_f32_16x16x32_bf16 v[136:139], v[96:99], a[88:91], v[136:139]
    s_add_u32 m0, s30, 5376
    s_nop 0
    global_load_lds_dwordx4 v2, s[24:25] offset:768
    v_mfma_f32_16x16x32_bf16 v[144:147], v[96:99], a[152:155], v[144:147]
    v_mfma_f32_16x16x32_bf16 v[152:155], v[96:99], a[216:219], v[152:155]
    v_mfma_f32_16x16x32_bf16 v[132:135], v[100:103], a[24:27], v[132:135]
    v_mfma_f32_16x16x32_bf16 v[140:143], v[100:103], a[88:91], v[140:143]
    v_mfma_f32_16x16x32_bf16 v[148:151], v[100:103], a[152:155], v[148:151]
    v_mfma_f32_16x16x32_bf16 v[156:159], v[100:103], a[216:219], v[156:159]
    ds_read_b128 v[96:99], v4 offset:4096
    ds_read_b128 v[100:103], v4 offset:20480
    s_waitcnt lgkmcnt(2)
    v_mfma_f32_16x16x32_bf16 v[128:131], v[104:107], a[28:31], v[128:131]
    v_mfma_f32_16x16x32_bf16 v[136:139], v[104:107], a[92:95], v[136:139]
    s_add_u32 m0, s30, 6272
    s_nop 0
    global_load_lds_dwordx4 v2, s[24:25] offset:896
    v_mfma_f32_16x16x32_bf16 v[144:147], v[104:107], a[156:159], v[144:147]
    v_mfma_f32_16x16x32_bf16 v[152:155], v[104:107], a[220:223], v[152:155]
    v_mfma_f32_16x16x32_bf16 v[132:135], v[108:111], a[28:31], v[132:135]
    v_mfma_f32_16x16x32_bf16 v[140:143], v[108:111], a[92:95], v[140:143]
    v_mfma_f32_16x16x32_bf16 v[148:151], v[108:111], a[156:159], v[148:151]
    v_mfma_f32_16x16x32_bf16 v[156:159], v[108:111], a[220:223], v[156:159]
    ds_read_b128 v[104:107], v5 offset:4096
    ds_read_b128 v[108:111], v5 offset:20480
    s_waitcnt lgkmcnt(2)
    v_mfma_f32_16x16x32_bf16 v[128:131], v[96:99], a[32:35], v[128:131]
    v_mfma_f32_16x16x32_bf16 v[136:139], v[96:99], a[96:99], v[136:139]
    s_lshl_b32 s21, s6, 14
    s_add_u32 s21, s21, 8192
    s_add_u32 s24, s26, s21
    s_addc_u32 s25, s27, 0
    s_add_u32 s30, s21, 65536
    s_add_u32 m0, s30, 0
    s_nop 0
    global_load_lds_dwordx4 v2, s[24:25] offset:0
    v_mfma_f32_16x16x32_bf16 v[144:147], v[96:99], a[160:163], v[144:147]
    v_mfma_f32_16x16x32_bf16 v[152:155], v[96:99], a[224:227], v[152:155]
    v_mfma_f32_16x16x32_bf16 v[132:135], v[100:103], a[32:35], v[132:135]
    v_mfma_f32_16x16x32_bf16 v[140:143], v[100:103], a[96:99], v[140:143]
    v_mfma_f32_16x16x32_bf16 v[148:151], v[100:103], a[160:163], v[148:151]
    v_mfma_f32_16x16x32_bf16 v[156:159], v[100:103], a[224:227], v[156:159]
    ds_read_b128 v[96:99], v4 offset:5120
    ds_read_b128 v[100:103], v4 offset:21504
    s_waitcnt lgkmcnt(2)
    v_mfma_f32_16x16x32_bf16 v[128:131], v[104:107], a[36:39], v[128:131]
    v_mfma_f32_16x16x32_bf16 v[136:139], v[104:107], a[100:103], v[136:139]
    s_add_u32 m0, s30, 896
    s_nop 0
    global_load_lds_dwordx4 v2, s[24:25] offset:128
    v_mfma_f32_16x16x32_bf16 v[144:147], v[104:107], a[164:167], v[144:147]
    v_mfma_f32_16x16x32_bf16 v[152:155], v[104:107], a[228:231], v[152:155]
    v_mfma_f32_16x16x32_bf16 v[132:135], v[108:111], a[36:39], v[132:135]
    v_mfma_f32_16x16x32_bf16 v[140:143], v[108:111], a[100:103], v[140:143]
    v_mfma_f32_16x16x32_bf16 v[148:151], v[108:111], a[164:167], v[148:151]
    v_mfma_f32_16x16x32_bf16 v[156:159], v[108:111], a[228:231], v[156:159]
    ds_read_b128 v[104:107], v5 offset:5120
    ds_read_b128 v[108:111], v5 offset:21504
    s_waitcnt lgkmcnt(2)
    v_mfma_f32_16x16x32_bf16 v[128:131], v[96:99], a[40:43], v[128:131]
    v_mfma_f32_16x16x32_bf16 v[136:139], v[96:99], a[104:107], v[136:139]
    s_add_u32 m0, s30, 1792
    s_nop 0
    global_load_lds_dwordx4 v2, s[24:25] offset:256
    v_mfma_f32_16x16x32_bf16 v[144:147], v[96:99], a[168:171], v[144:147]
    v_mfma_f32_16x16x32_bf16 v[152:155], v[96:99], a[232:235], v[152:155]
    v_mfma_f32_16x16x32_bf16 v[132:135], v[100:103], a[40:43], v[132:135]
    v_mfma_f32_16x16x32_bf16 v[140:143], v[100:103], a[104:107], v[140:143]
    v_mfma_f32_16x16x32_bf16 v[148:151], v[100:103], a[168:171], v[148:151]
    v_mfma_f32_16x16x32_bf16 v[156:159], v[100:103], a[232:235], v[156:159]
    ds_read_b128 v[96:99], v4 offset:6144
    ds_read_b128 v[100:103], v4 offset:22528
    s_waitcnt lgkmcnt(2)
    v_mfma_f32_16x16x32_bf16 v[128:131], v[104:107], a[44:47], v[128:131]
    v_mfma_f32_16x16x32_bf16 v[136:139], v[104:107], a[108:111], v[136:139]
    s_add_u32 m0, s30, 2688
    s_nop 0
    global_load_lds_dwordx4 v2, s[24:25] offset:384
    v_mfma_f32_16x16x32_bf16 v[144:147], v[104:107], a[172:175], v[144:147]
    v_mfma_f32_16x16x32_bf16 v[152:155], v[104:107], a[236:239], v[152:155]
    v_mfma_f32_16x16x32_bf16 v[132:135], v[108:111], a[44:47], v[132:135]
    v_mfma_f32_16x16x32_bf16 v[140:143], v[108:111], a[108:111], v[140:143]
    v_mfma_f32_16x16x32_bf16 v[148:151], v[108:111], a[172:175], v[148:151]
    v_mfma_f32_16x16x32_bf16 v[156:159], v[108:111], a[236:239], v[156:159]
    ds_read_b128 v[104:107], v5 offset:6144
    ds_read_b128 v[108:111], v5 offset:22528
    s_waitcnt lgkmcnt(2)
    v_mfma_f32_16x16x32_bf16 v[128:131], v[96:99], a[48:51], v[128:131]
    v_mfma_f32_16x16x32_bf16 v[136:139], v[96:99], a[112:115], v[136:139]
    s_add_u32 m0, s30, 3584
    s_nop 0
    global_load_lds_dwordx4 v2, s[24:25] offset:512
    v_mfma_f32_16x16x32_bf16 v[144:147], v[96:99], a[176:179], v[144:147]
    v_mfma_f32_16x16x32_bf16 v[152:155], v[96:99], a[240:243], v[152:155]
    v_mfma_f32_16x16x32_bf16 v[132:135], v[100:103], a[48:51], v[132:135]
    v_mfma_f32_16x16x32_bf16 v[140:143], v[100:103], a[112:115], v[140:143]
    v_mfma_f32_16x16x32_bf16 v[148:151], v[100:103], a[176:179], v[148:151]
    v_mfma_f32_16x16x32_bf16 v[156:159], v[100:103], a[240:243], v[156:159]
    ds_read_b128 v[96:99], v4 offset:7168
    ds_read_b128 v[100:103], v4 offset:23552
    s_waitcnt lgkmcnt(2)
    v_mfma_f32_16x16x32_bf16 v[128:131], v[104:107], a[52:55], v[128:131]
    v_mfma_f32_16x16x32_bf16 v[136:139], v[104:107], a[116:119], v[136:139]
    s_add_u32 m0, s30, 4480
    s_nop 0
    global_load_lds_dwordx4 v2, s[24:25] offset:640
    v_mfma_f32_16x16x32_bf16 v[144:147], v[104:107], a[180:183], v[144:147]
    v_mfma_f32_16x16x32_bf16 v[152:155], v[104:107], a[244:247], v[152:155]
    v_mfma_f32_16x16x32_bf16 v[132:135], v[108:111], a[52:55], v[132:135]
    v_mfma_f32_16x16x32_bf16 v[140:143], v[108:111], a[116:119], v[140:143]
    v_mfma_f32_16x16x32_bf16 v[148:151], v[108:111], a[180:183], v[148:151]
    v_mfma_f32_16x16x32_bf16 v[156:159], v[108:111], a[244:247], v[156:159]
    ds_read_b128 v[104:107], v5 offset:7168
    ds_read_b128 v[108:111], v5 offset:23552
    s_waitcnt lgkmcnt(2)
    v_mfma_f32_16x16x32_bf16 v[128:131], v[96:99], a[56:59], v[128:131]
    v_mfma_f32_16x16x32_bf16 v[136:139], v[96:99], a[120:123], v[136:139]
    s_add_u32 m0, s30, 5376
    s_nop 0
    global_load_lds_dwordx4 v2, s[24:25] offset:768
    v_mfma_f32_16x16x32_bf16 v[144:147], v[96:99], a[184:187], v[144:147]
    v_mfma_f32_16x16x32_bf16 v[152:155], v[96:99], a[248:251], v[152:155]
    v_mfma_f32_16x16x32_bf16 v[132:135], v[100:103], a[56:59], v[132:135]
    v_mfma_f32_16x16x32_bf16 v[140:143], v[100:103], a[120:123], v[140:143]
    v_mfma_f32_16x16x32_bf16 v[148:151], v[100:103], a[184:187], v[148:151]
    v_mfma_f32_16x16x32_bf16 v[156:159], v[100:103], a[248:251], v[156:159]
    s_waitcnt lgkmcnt(0)
    v_mfma_f32_16x16x32_bf16 v[128:131], v[104:107], a[60:63], v[128:131]
    v_mfma_f32_16x16x32_bf16 v[136:139], v[104:107], a[124:127], v[136:139]
    s_add_u32 m0, s30, 6272
    s_nop 0
    global_load_lds_dwordx4 v2, s[24:25] offset:896
    v_mfma_f32_16x16x32_bf16 v[144:147], v[104:107], a[188:191], v[144:147]
    v_mfma_f32_16x16x32_bf16 v[152:155], v[104:107], a[252:255], v[152:155]
    v_mfma_f32_16x16x32_bf16 v[132:135], v[108:111], a[60:63], v[132:135]
    v_mfma_f32_16x16x32_bf16 v[140:143], v[108:111], a[124:127], v[140:143]
    v_mfma_f32_16x16x32_bf16 v[148:151], v[108:111], a[188:191], v[148:151]
    v_mfma_f32_16x16x32_bf16 v[156:159], v[108:111], a[252:255], v[156:159]
    s_branch LJ_47
LND_46:
    ds_read_b128 v[96:99], v4 offset:0
    ds_read_b128 v[100:103], v4 offset:16384
    ds_read_b128 v[104:107], v5 offset:0
    ds_read_b128 v[108:111], v5 offset:16384
    s_waitcnt lgkmcnt(2)
    v_mfma_f32_16x16x32_bf16 v[128:131], v[96:99], a[0:3], 0
    v_mfma_f32_16x16x32_bf16 v[136:139], v[96:99], a[64:67], 0
    v_mfma_f32_16x16x32_bf16 v[144:147], v[96:99], a[128:131], 0
    v_mfma_f32_16x16x32_bf16 v[152:155], v[96:99], a[192:195], 0
    v_mfma_f32_16x16x32_bf16 v[132:135], v[100:103], a[0:3], 0
    v_mfma_f32_16x16x32_bf16 v[140:143], v[100:103], a[64:67], 0
    v_mfma_f32_16x16x32_bf16 v[148:151], v[100:103], a[128:131], 0
    v_mfma_f32_16x16x32_bf16 v[156:159], v[100:103], a[192:195], 0
    ds_read_b128 v[96:99], v4 offset:1024
    ds_read_b128 v[100:103], v4 offset:17408
    s_waitcnt lgkmcnt(2)
    v_mfma_f32_16x16x32_bf16 v[128:131], v[104:107], a[4:7], v[128:131]
    v_mfma_f32_16x16x32_bf16 v[136:139], v[104:107], a[68:71], v[136:139]
    v_mfma_f32_16x16x32_bf16 v[144:147], v[104:107], a[132:135], v[144:147]
    v_mfma_f32_16x16x32_bf16 v[152:155], v[104:107], a[196:199], v[152:155]
    v_mfma_f32_16x16x32_bf16 v[132:135], v[108:111], a[4:7], v[132:135]
    v_mfma_f32_16x16x32_bf16 v[140:143], v[108:111], a[68:71], v[140:143]
    v_mfma_f32_16x16x32_bf16 v[148:151], v[108:111], a[132:135], v[148:151]
    v_mfma_f32_16x16x32_bf16 v[156:159], v[108:111], a[196:199], v[156:159]
    ds_read_b128 v[104:107], v5 offset:1024
    ds_read_b128 v[108:111], v5 offset:17408
    s_waitcnt lgkmcnt(2)
    v_mfma_f32_16x16x32_bf16 v[128:131], v[96:99], a[8:11], v[128:131]
    v_mfma_f32_16x16x32_bf16 v[136:139], v[96:99], a[72:75], v[136:139]
    v_mfma_f32_16x16x32_bf16 v[144:147], v[96:99], a[136:139], v[144:147]
    v_mfma_f32_16x16x32_bf16 v[152:155], v[96:99], a[200:203], v[152:155]
    v_mfma_f32_16x16x32_bf16 v[132:135], v[100:103], a[8:11], v[132:135]
    v_mfma_f32_16x16x32_bf16 v[140:143], v[100:103], a[72:75], v[140:143]
    v_mfma_f32_16x16x32_bf16 v[148:151], v[100:103], a[136:139], v[148:151]
    v_mfma_f32_16x16x32_bf16 v[156:159], v[100:103], a[200:203], v[156:159]
    ds_read_b128 v[96:99], v4 offset:2048
    ds_read_b128 v[100:103], v4 offset:18432
    s_waitcnt lgkmcnt(2)
    v_mfma_f32_16x16x32_bf16 v[128:131], v[104:107], a[12:15], v[128:131]
    v_mfma_f32_16x16x32_bf16 v[136:139], v[104:107], a[76:79], v[136:139]
    v_mfma_f32_16x16x32_bf16 v[144:147], v[104:107], a[140:143], v[144:147]
    v_mfma_f32_16x16x32_bf16 v[152:155], v[104:107], a[204:207], v[152:155]
    v_mfma_f32_16x16x32_bf16 v[132:135], v[108:111], a[12:15], v[132:135]
    v_mfma_f32_16x16x32_bf16 v[140:143], v[108:111], a[76:79], v[140:143]
    v_mfma_f32_16x16x32_bf16 v[148:151], v[108:111], a[140:143], v[148:151]
    v_mfma_f32_16x16x32_bf16 v[156:159], v[108:111], a[204:207], v[156:159]
    ds_read_b128 v[104:107], v5 offset:2048
    ds_read_b128 v[108:111], v5 offset:18432
    s_waitcnt lgkmcnt(2)
    v_mfma_f32_16x16x32_bf16 v[128:131], v[96:99], a[16:19], v[128:131]
    v_mfma_f32_16x16x32_bf16 v[136:139], v[96:99], a[80:83], v[136:139]
    v_mfma_f32_16x16x32_bf16 v[144:147], v[96:99], a[144:147], v[144:147]
    v_mfma_f32_16x16x32_bf16 v[152:155], v[96:99], a[208:211], v[152:155]
    v_mfma_f32_16x16x32_bf16 v[132:135], v[100:103], a[16:19], v[132:135]
    v_mfma_f32_16x16x32_bf16 v[140:143], v[100:103], a[80:83], v[140:143]
    v_mfma_f32_16x16x32_bf16 v[148:151], v[100:103], a[144:147], v[148:151]
    v_mfma_f32_16x16x32_bf16 v[156:159], v[100:103], a[208:211], v[156:159]
    ds_read_b128 v[96:99], v4 offset:3072
    ds_read_b128 v[100:103], v4 offset:19456
    s_waitcnt lgkmcnt(2)
    v_mfma_f32_16x16x32_bf16 v[128:131], v[104:107], a[20:23], v[128:131]
    v_mfma_f32_16x16x32_bf16 v[136:139], v[104:107], a[84:87], v[136:139]
    v_mfma_f32_16x16x32_bf16 v[144:147], v[104:107], a[148:151], v[144:147]
    v_mfma_f32_16x16x32_bf16 v[152:155], v[104:107], a[212:215], v[152:155]
    v_mfma_f32_16x16x32_bf16 v[132:135], v[108:111], a[20:23], v[132:135]
    v_mfma_f32_16x16x32_bf16 v[140:143], v[108:111], a[84:87], v[140:143]
    v_mfma_f32_16x16x32_bf16 v[148:151], v[108:111], a[148:151], v[148:151]
    v_mfma_f32_16x16x32_bf16 v[156:159], v[108:111], a[212:215], v[156:159]
    ds_read_b128 v[104:107], v5 offset:3072
    ds_read_b128 v[108:111], v5 offset:19456
    s_waitcnt lgkmcnt(2)
    v_mfma_f32_16x16x32_bf16 v[128:131], v[96:99], a[24:27], v[128:131]
    v_mfma_f32_16x16x32_bf16 v[136:139], v[96:99], a[88:91], v[136:139]
    v_mfma_f32_16x16x32_bf16 v[144:147], v[96:99], a[152:155], v[144:147]
    v_mfma_f32_16x16x32_bf16 v[152:155], v[96:99], a[216:219], v[152:155]
    v_mfma_f32_16x16x32_bf16 v[132:135], v[100:103], a[24:27], v[132:135]
    v_mfma_f32_16x16x32_bf16 v[140:143], v[100:103], a[88:91], v[140:143]
    v_mfma_f32_16x16x32_bf16 v[148:151], v[100:103], a[152:155], v[148:151]
    v_mfma_f32_16x16x32_bf16 v[156:159], v[100:103], a[216:219], v[156:159]
    ds_read_b128 v[96:99], v4 offset:4096
    ds_read_b128 v[100:103], v4 offset:20480
    s_waitcnt lgkmcnt(2)
    v_mfma_f32_16x16x32_bf16 v[128:131], v[104:107], a[28:31], v[128:131]
    v_mfma_f32_16x16x32_bf16 v[136:139], v[104:107], a[92:95], v[136:139]
    v_mfma_f32_16x16x32_bf16 v[144:147], v[104:107], a[156:159], v[144:147]
    v_mfma_f32_16x16x32_bf16 v[152:155], v[104:107], a[220:223], v[152:155]
    v_mfma_f32_16x16x32_bf16 v[132:135], v[108:111], a[28:31], v[132:135]
    v_mfma_f32_16x16x32_bf16 v[140:143], v[108:111], a[92:95], v[140:143]
    v_mfma_f32_16x16x32_bf16 v[148:151], v[108:111], a[156:159], v[148:151]
    v_mfma_f32_16x16x32_bf16 v[156:159], v[108:111], a[220:223], v[156:159]
    ds_read_b128 v[104:107], v5 offset:4096
    ds_read_b128 v[108:111], v5 offset:20480
    s_waitcnt lgkmcnt(2)
    v_mfma_f32_16x16x32_bf16 v[128:131], v[96:99], a[32:35], v[128:131]
    v_mfma_f32_16x16x32_bf16 v[136:139], v[96:99], a[96:99], v[136:139]
    v_mfma_f32_16x16x32_bf16 v[144:147], v[96:99], a[160:163], v[144:147]
    v_mfma_f32_16x16x32_bf16 v[152:155], v[96:99], a[224:227], v[152:155]
    v_mfma_f32_16x16x32_bf16 v[132:135], v[100:103], a[32:35], v[132:135]
    v_mfma_f32_16x16x32_bf16 v[140:143], v[100:103], a[96:99], v[140:143]
    v_mfma_f32_16x16x32_bf16 v[148:151], v[100:103], a[160:163], v[148:151]
    v_mfma_f32_16x16x32_bf16 v[156:159], v[100:103], a[224:227], v[156:159]
    ds_read_b128 v[96:99], v4 offset:5120
    ds_read_b128 v[100:103], v4 offset:21504
    s_waitcnt lgkmcnt(2)
    v_mfma_f32_16x16x32_bf16 v[128:131], v[104:107], a[36:39], v[128:131]
    v_mfma_f32_16x16x32_bf16 v[136:139], v[104:107], a[100:103], v[136:139]
    v_mfma_f32_16x16x32_bf16 v[144:147], v[104:107], a[164:167], v[144:147]
    v_mfma_f32_16x16x32_bf16 v[152:155], v[104:107], a[228:231], v[152:155]
    v_mfma_f32_16x16x32_bf16 v[132:135], v[108:111], a[36:39], v[132:135]
    v_mfma_f32_16x16x32_bf16 v[140:143], v[108:111], a[100:103], v[140:143]
    v_mfma_f32_16x16x32_bf16 v[148:151], v[108:111], a[164:167], v[148:151]
    v_mfma_f32_16x16x32_bf16 v[156:159], v[108:111], a[228:231], v[156:159]
    ds_read_b128 v[104:107], v5 offset:5120
    ds_read_b128 v[108:111], v5 offset:21504
    s_waitcnt lgkmcnt(2)
    v_mfma_f32_16x16x32_bf16 v[128:131], v[96:99], a[40:43], v[128:131]
    v_mfma_f32_16x16x32_bf16 v[136:139], v[96:99], a[104:107], v[136:139]
    v_mfma_f32_16x16x32_bf16 v[144:147], v[96:99], a[168:171], v[144:147]
    v_mfma_f32_16x16x32_bf16 v[152:155], v[96:99], a[232:235], v[152:155]
    v_mfma_f32_16x16x32_bf16 v[132:135], v[100:103], a[40:43], v[132:135]
    v_mfma_f32_16x16x32_bf16 v[140:143], v[100:103], a[104:107], v[140:143]
    v_mfma_f32_16x16x32_bf16 v[148:151], v[100:103], a[168:171], v[148:151]
    v_mfma_f32_16x16x32_bf16 v[156:159], v[100:103], a[232:235], v[156:159]
    ds_read_b128 v[96:99], v4 offset:6144
    ds_read_b128 v[100:103], v4 offset:22528
    s_waitcnt lgkmcnt(2)
    v_mfma_f32_16x16x32_bf16 v[128:131], v[104:107], a[44:47], v[128:131]
    v_mfma_f32_16x16x32_bf16 v[136:139], v[104:107], a[108:111], v[136:139]
    v_mfma_f32_16x16x32_bf16 v[144:147], v[104:107], a[172:175], v[144:147]
    v_mfma_f32_16x16x32_bf16 v[152:155], v[104:107], a[236:239], v[152:155]
    v_mfma_f32_16x16x32_bf16 v[132:135], v[108:111], a[44:47], v[132:135]
    v_mfma_f32_16x16x32_bf16 v[140:143], v[108:111], a[108:111], v[140:143]
    v_mfma_f32_16x16x32_bf16 v[148:151], v[108:111], a[172:175], v[148:151]
    v_mfma_f32_16x16x32_bf16 v[156:159], v[108:111], a[236:239], v[156:159]
    ds_read_b128 v[104:107], v5 offset:6144
    ds_read_b128 v[108:111], v5 offset:22528
    s_waitcnt lgkmcnt(2)
    v_mfma_f32_16x16x32_bf16 v[128:131], v[96:99], a[48:51], v[128:131]
    v_mfma_f32_16x16x32_bf16 v[136:139], v[96:99], a[112:115], v[136:139]
    v_mfma_f32_16x16x32_bf16 v[144:147], v[96:99], a[176:179], v[144:147]
    v_mfma_f32_16x16x32_bf16 v[152:155], v[96:99], a[240:243], v[152:155]
    v_mfma_f32_16x16x32_bf16 v[132:135], v[100:103], a[48:51], v[132:135]
    v_mfma_f32_16x16x32_bf16 v[140:143], v[100:103], a[112:115], v[140:143]
    v_mfma_f32_16x16x32_bf16 v[148:151], v[100:103], a[176:179], v[148:151]
    v_mfma_f32_16x16x32_bf16 v[156:159], v[100:103], a[240:243], v[156:159]
    ds_read_b128 v[96:99], v4 offset:7168
    ds_read_b128 v[100:103], v4 offset:23552
    s_waitcnt lgkmcnt(2)
    v_mfma_f32_16x16x32_bf16 v[128:131], v[104:107], a[52:55], v[128:131]
    v_mfma_f32_16x16x32_bf16 v[136:139], v[104:107], a[116:119], v[136:139]
    v_mfma_f32_16x16x32_bf16 v[144:147], v[104:107], a[180:183], v[144:147]
    v_mfma_f32_16x16x32_bf16 v[152:155], v[104:107], a[244:247], v[152:155]
    v_mfma_f32_16x16x32_bf16 v[132:135], v[108:111], a[52:55], v[132:135]
    v_mfma_f32_16x16x32_bf16 v[140:143], v[108:111], a[116:119], v[140:143]
    v_mfma_f32_16x16x32_bf16 v[148:151], v[108:111], a[180:183], v[148:151]
    v_mfma_f32_16x16x32_bf16 v[156:159], v[108:111], a[244:247], v[156:159]
    ds_read_b128 v[104:107], v5 offset:7168
    ds_read_b128 v[108:111], v5 offset:23552
    s_waitcnt lgkmcnt(2)
    v_mfma_f32_16x16x32_bf16 v[128:131], v[96:99], a[56:59], v[128:131]
    v_mfma_f32_16x16x32_bf16 v[136:139], v[96:99], a[120:123], v[136:139]
    v_mfma_f32_16x16x32_bf16 v[144:147], v[96:99], a[184:187], v[144:147]
    v_mfma_f32_16x16x32_bf16 v[152:155], v[96:99], a[248:251], v[152:155]
    v_mfma_f32_16x16x32_bf16 v[132:135], v[100:103], a[56:59], v[132:135]
    v_mfma_f32_16x16x32_bf16 v[140:143], v[100:103], a[120:123], v[140:143]
    v_mfma_f32_16x16x32_bf16 v[148:151], v[100:103], a[184:187], v[148:151]
    v_mfma_f32_16x16x32_bf16 v[156:159], v[100:103], a[248:251], v[156:159]
    s_waitcnt lgkmcnt(0)
    v_mfma_f32_16x16x32_bf16 v[128:131], v[104:107], a[60:63], v[128:131]
    v_mfma_f32_16x16x32_bf16 v[136:139], v[104:107], a[124:127], v[136:139]
    v_mfma_f32_16x16x32_bf16 v[144:147], v[104:107], a[188:191], v[144:147]
    v_mfma_f32_16x16x32_bf16 v[152:155], v[104:107], a[252:255], v[152:155]
    v_mfma_f32_16x16x32_bf16 v[132:135], v[108:111], a[60:63], v[132:135]
    v_mfma_f32_16x16x32_bf16 v[140:143], v[108:111], a[124:127], v[140:143]
    v_mfma_f32_16x16x32_bf16 v[148:151], v[108:111], a[188:191], v[148:151]
    v_mfma_f32_16x16x32_bf16 v[156:159], v[108:111], a[252:255], v[156:159]
LJ_47:
    s_nop 7
    v_cvt_pk_bf16_f32 v112, v128, v129
    v_cvt_pk_bf16_f32 v113, v130, v131
    v_cvt_pk_bf16_f32 v114, v132, v133
    v_cvt_pk_bf16_f32 v115, v134, v135
    global_store_dwordx4 v16, v[112:115], s[12:13] offset:0 sc1
    v_cvt_pk_bf16_f32 v116, v136, v137
    v_cvt_pk_bf16_f32 v117, v138, v139
    v_cvt_pk_bf16_f32 v118, v140, v141
    v_cvt_pk_bf16_f32 v119, v142, v143
    global_store_dwordx4 v16, v[116:119], s[12:13] offset:1024 sc1
    v_cvt_pk_bf16_f32 v120, v144, v145
    v_cvt_pk_bf16_f32 v121, v146, v147
    v_cvt_pk_bf16_f32 v122, v148, v149
    v_cvt_pk_bf16_f32 v123, v150, v151
    global_store_dwordx4 v16, v[120:123], s[12:13] offset:2048 sc1
    v_cvt_pk_bf16_f32 v124, v152, v153
    v_cvt_pk_bf16_f32 v125, v154, v155
    v_cvt_pk_bf16_f32 v126, v156, v157
    v_cvt_pk_bf16_f32 v127, v158, v159
    global_store_dwordx4 v16, v[124:127], s[12:13] offset:3072 sc1
    s_add_u32 s12, s12, 0x80000
    s_addc_u32 s13, s13, 0
    s_add_u32 s20, s20, 1
    s_cmp_le_u32 s20, 3
    s_cbranch_scc0 LEF_48
    s_waitcnt vmcnt(0)
    s_barrier
    s_cmp_eq_u32 s6, 0
    s_cbranch_scc0 LPUB_49
    v_mov_b32 v8, s20
    v_mov_b32 v9, 0
    s_mov_b64 exec, 1
    global_store_dword v9, v8, s[14:15] sc1
    s_mov_b64 exec, -1
LPUB_49:
    s_cmp_eq_u32 s20, 3
    s_cbranch_scc0 LEF_48
LEF_48:
    s_waitcnt vmcnt(4)
    s_barrier
    s_sub_u32 s23, s20, 1
    s_cmp_ge_i32 s23, 4
    s_cbranch_scc0 LNP_50
    s_cmp_eq_u32 s6, 0
    s_cbranch_scc0 LPUB_51
    v_mov_b32 v8, s23
    v_mov_b32 v9, 0
    s_mov_b64 exec, 1
    global_store_dword v9, v8, s[14:15] sc1
    s_mov_b64 exec, -1
LPUB_51:
LNP_50:
    s_add_u32 s26, s26, 0x10000
    s_addc_u32 s27, s27, 0
    s_add_u32 s23, s20, 1
    s_cmp_lt_u32 s23, 32
    s_cbranch_scc0 LND_52
    ds_read_b128 v[96:99], v6 offset:0
    ds_read_b128 v[100:103], v6 offset:16384
    ds_read_b128 v[104:107], v7 offset:0
    ds_read_b128 v[108:111], v7 offset:16384
    s_waitcnt lgkmcnt(2)
    v_mfma_f32_16x16x32_bf16 v[128:131], v[96:99], a[0:3], 0
    v_mfma_f32_16x16x32_bf16 v[136:139], v[96:99], a[64:67], 0
    s_lshl_b32 s21, s6, 14
    s_add_u32 s21, s21, 0
    s_add_u32 s24, s26, s21
    s_addc_u32 s25, s27, 0
    s_add_u32 s30, s21, 0
    s_add_u32 m0, s30, 0
    s_nop 0
    global_load_lds_dwordx4 v2, s[24:25] offset:0
    v_mfma_f32_16x16x32_bf16 v[144:147], v[96:99], a[128:131], 0
    v_mfma_f32_16x16x32_bf16 v[152:155], v[96:99], a[192:195], 0
    v_mfma_f32_16x16x32_bf16 v[132:135], v[100:103], a[0:3], 0
    v_mfma_f32_16x16x32_bf16 v[140:143], v[100:103], a[64:67], 0
    v_mfma_f32_16x16x32_bf16 v[148:151], v[100:103], a[128:131], 0
    v_mfma_f32_16x16x32_bf16 v[156:159], v[100:103], a[192:195], 0
    ds_read_b128 v[96:99], v6 offset:1024
    ds_read_b128 v[100:103], v6 offset:17408
    s_waitcnt lgkmcnt(2)
    v_mfma_f32_16x16x32_bf16 v[128:131], v[104:107], a[4:7], v[128:131]
    v_mfma_f32_16x16x32_bf16 v[136:139], v[104:107], a[68:71], v[136:139]
    s_add_u32 m0, s30, 896
    s_nop 0
    global_load_lds_dwordx4 v2, s[24:25] offset:128
    v_mfma_f32_16x16x32_bf16 v[144:147], v[104:107], a[132:135], v[144:147]
    v_mfma_f32_16x16x32_bf16 v[152:155], v[104:107], a[196:199], v[152:155]
    v_mfma_f32_16x16x32_bf16 v[132:135], v[108:111], a[4:7], v[132:135]
    v_mfma_f32_16x16x32_bf16 v[140:143], v[108:111], a[68:71], v[140:143]
    v_mfma_f32_16x16x32_bf16 v[148:151], v[108:111], a[132:135], v[148:151]
    v_mfma_f32_16x16x32_bf16 v[156:159], v[108:111], a[196:199], v[156:159]
    ds_read_b128 v[104:107], v7 offset:1024
    ds_read_b128 v[108:111], v7 offset:17408
    s_waitcnt lgkmcnt(2)
    v_mfma_f32_16x16x32_bf16 v[128:131], v[96:99], a[8:11], v[128:131]
    v_mfma_f32_16x16x32_bf16 v[136:139], v[96:99], a[72:75], v[136:139]
    s_add_u32 m0, s30, 1792
    s_nop 0
    global_load_lds_dwordx4 v2, s[24:25] offset:256
    v_mfma_f32_16x16x32_bf16 v[144:147], v[96:99], a[136:139], v[144:147]
    v_mfma_f32_16x16x32_bf16 v[152:155], v[96:99], a[200:203], v[152:155]
    v_mfma_f32_16x16x32_bf16 v[132:135], v[100:103], a[8:11], v[132:135]
    v_mfma_f32_16x16x32_bf16 v[140:143], v[100:103], a[72:75], v[140:143]
    v_mfma_f32_16x16x32_bf16 v[148:151], v[100:103], a[136:139], v[148:151]
    v_mfma_f32_16x16x32_bf16 v[156:159], v[100:103], a[200:203], v[156:159]
    ds_read_b128 v[96:99], v6 offset:2048
    ds_read_b128 v[100:103], v6 offset:18432
    s_waitcnt lgkmcnt(2)
    v_mfma_f32_16x16x32_bf16 v[128:131], v[104:107], a[12:15], v[128:131]
    v_mfma_f32_16x16x32_bf16 v[136:139], v[104:107], a[76:79], v[136:139]
    s_add_u32 m0, s30, 2688
    s_nop 0
    global_load_lds_dwordx4 v2, s[24:25] offset:384
    v_mfma_f32_16x16x32_bf16 v[144:147], v[104:107], a[140:143], v[144:147]
    v_mfma_f32_16x16x32_bf16 v[152:155], v[104:107], a[204:207], v[152:155]
    v_mfma_f32_16x16x32_bf16 v[132:135], v[108:111], a[12:15], v[132:135]
    v_mfma_f32_16x16x32_bf16 v[140:143], v[108:111], a[76:79], v[140:143]
    v_mfma_f32_16x16x32_bf16 v[148:151], v[108:111], a[140:143], v[148:151]
    v_mfma_f32_16x16x32_bf16 v[156:159], v[108:111], a[204:207], v[156:159]
    ds_read_b128 v[104:107], v7 offset:2048
    ds_read_b128 v[108:111], v7 offset:18432
    s_waitcnt lgkmcnt(2)
    v_mfma_f32_16x16x32_bf16 v[128:131], v[96:99], a[16:19], v[128:131]
    v_mfma_f32_16x16x32_bf16 v[136:139], v[96:99], a[80:83], v[136:139]
    s_add_u32 m0, s30, 3584
    s_nop 0
    global_load_lds_dwordx4 v2, s[24:25] offset:512
    v_mfma_f32_16x16x32_bf16 v[144:147], v[96:99], a[144:147], v[144:147]
    v_mfma_f32_16x16x32_bf16 v[152:155], v[96:99], a[208:211], v[152:155]
    v_mfma_f32_16x16x32_bf16 v[132:135], v[100:103], a[16:19], v[132:135]
    v_mfma_f32_16x16x32_bf16 v[140:143], v[100:103], a[80:83], v[140:143]
    v_mfma_f32_16x16x32_bf16 v[148:151], v[100:103], a[144:147], v[148:151]
    v_mfma_f32_16x16x32_bf16 v[156:159], v[100:103], a[208:211], v[156:159]
    ds_read_b128 v[96:99], v6 offset:3072
    ds_read_b128 v[100:103], v6 offset:19456
    s_waitcnt lgkmcnt(2)
    v_mfma_f32_16x16x32_bf16 v[128:131], v[104:107], a[20:23], v[128:131]
    v_mfma_f32_16x16x32_bf16 v[136:139], v[104:107], a[84:87], v[136:139]
    s_add_u32 m0, s30, 4480
    s_nop 0
    global_load_lds_dwordx4 v2, s[24:25] offset:640
    v_mfma_f32_16x16x32_bf16 v[144:147], v[104:107], a[148:151], v[144:147]
    v_mfma_f32_16x16x32_bf16 v[152:155], v[104:107], a[212:215], v[152:155]
    v_mfma_f32_16x16x32_bf16 v[132:135], v[108:111], a[20:23], v[132:135]
    v_mfma_f32_16x16x32_bf16 v[140:143], v[108:111], a[84:87], v[140:143]
    v_mfma_f32_16x16x32_bf16 v[148:151], v[108:111], a[148:151], v[148:151]
    v_mfma_f32_16x16x32_bf16 v[156:159], v[108:111], a[212:215], v[156:159]
    ds_read_b128 v[104:107], v7 offset:3072
    ds_read_b128 v[108:111], v7 offset:19456
    s_waitcnt lgkmcnt(2)
    v_mfma_f32_16x16x32_bf16 v[128:131], v[96:99], a[24:27], v[128:131]
    v_mfma_f32_16x16x32_bf16 v[136:139], v[96:99], a[88:91], v[136:139]
    s_add_u32 m0, s30, 5376
    s_nop 0
    global_load_lds_dwordx4 v2, s[24:25] offset:768
    v_mfma_f32_16x16x32_bf16 v[144:147], v[96:99], a[152:155], v[144:147]
    v_mfma_f32_16x16x32_bf16 v[152:155], v[96:99], a[216:219], v[152:155]
    v_mfma_f32_16x16x32_bf16 v[132:135], v[100:103], a[24:27], v[132:135]
    v_mfma_f32_16x16x32_bf16 v[140:143], v[100:103], a[88:91], v[140:143]
    v_mfma_f32_16x16x32_bf16 v[148:151], v[100:103], a[152:155], v[148:151]
    v_mfma_f32_16x16x32_bf16 v[156:159], v[100:103], a[216:219], v[156:159]
    ds_read_b128 v[96:99], v6 offset:4096
    ds_read_b128 v[100:103], v6 offset:20480
    s_waitcnt lgkmcnt(2)
    v_mfma_f32_16x16x32_bf16 v[128:131], v[104:107], a[28:31], v[128:131]
    v_mfma_f32_16x16x32_bf16 v[136:139], v[104:107], a[92:95], v[136:139]
    s_add_u32 m0, s30, 6272
    s_nop 0
    global_load_lds_dwordx4 v2, s[24:25] offset:896
    v_mfma_f32_16x16x32_bf16 v[144:147], v[104:107], a[156:159], v[144:147]
    v_mfma_f32_16x16x32_bf16 v[152:155], v[104:107], a[220:223], v[152:155]
    v_mfma_f32_16x16x32_bf16 v[132:135], v[108:111], a[28:31], v[132:135]
    v_mfma_f32_16x16x32_bf16 v[140:143], v[108:111], a[92:95], v[140:143]
    v_mfma_f32_16x16x32_bf16 v[148:151], v[108:111], a[156:159], v[148:151]
    v_mfma_f32_16x16x32_bf16 v[156:159], v[108:111], a[220:223], v[156:159]
    ds_read_b128 v[104:107], v7 offset:4096
    ds_read_b128 v[108:111], v7 offset:20480
    s_waitcnt lgkmcnt(2)
    v_mfma_f32_16x16x32_bf16 v[128:131], v[96:99], a[32:35], v[128:131]
    v_mfma_f32_16x16x32_bf16 v[136:139], v[96:99], a[96:99], v[136:139]
    s_lshl_b32 s21, s6, 14
    s_add_u32 s21, s21, 8192
    s_add_u32 s24, s26, s21
    s_addc_u32 s25, s27, 0
    s_add_u32 s30, s21, 0
    s_add_u32 m0, s30, 0
    s_nop 0
    global_load_lds_dwordx4 v2, s[24:25] offset:0
    v_mfma_f32_16x16x32_bf16 v[144:147], v[96:99], a[160:163], v[144:147]
    v_mfma_f32_16x16x32_bf16 v[152:155], v[96:99], a[224:227], v[152:155]
    v_mfma_f32_16x16x32_bf16 v[132:135], v[100:103], a[32:35], v[132:135]
    v_mfma_f32_16x16x32_bf16 v[140:143], v[100:103], a[96:99], v[140:143]
    v_mfma_f32_16x16x32_bf16 v[148:151], v[100:103], a[160:163], v[148:151]
    v_mfma_f32_16x16x32_bf16 v[156:159], v[100:103], a[224:227], v[156:159]
    ds_read_b128 v[96:99], v6 offset:5120
    ds_read_b128 v[100:103], v6 offset:21504
    s_waitcnt lgkmcnt(2)
    v_mfma_f32_16x16x32_bf16 v[128:131], v[104:107], a[36:39], v[128:131]
    v_mfma_f32_16x16x32_bf16 v[136:139], v[104:107], a[100:103], v[136:139]
    s_add_u32 m0, s30, 896
    s_nop 0
    global_load_lds_dwordx4 v2, s[24:25] offset:128
    v_mfma_f32_16x16x32_bf16 v[144:147], v[104:107], a[164:167], v[144:147]
    v_mfma_f32_16x16x32_bf16 v[152:155], v[104:107], a[228:231], v[152:155]
    v_mfma_f32_16x16x32_bf16 v[132:135], v[108:111], a[36:39], v[132:135]
    v_mfma_f32_16x16x32_bf16 v[140:143], v[108:111], a[100:103], v[140:143]
    v_mfma_f32_16x16x32_bf16 v[148:151], v[108:111], a[164:167], v[148:151]
    v_mfma_f32_16x16x32_bf16 v[156:159], v[108:111], a[228:231], v[156:159]
    ds_read_b128 v[104:107], v7 offset:5120
    ds_read_b128 v[108:111], v7 offset:21504
    s_waitcnt lgkmcnt(2)
    v_mfma_f32_16x16x32_bf16 v[128:131], v[96:99], a[40:43], v[128:131]
    v_mfma_f32_16x16x32_bf16 v[136:139], v[96:99], a[104:107], v[136:139]
    s_add_u32 m0, s30, 1792
    s_nop 0
    global_load_lds_dwordx4 v2, s[24:25] offset:256
    v_mfma_f32_16x16x32_bf16 v[144:147], v[96:99], a[168:171], v[144:147]
    v_mfma_f32_16x16x32_bf16 v[152:155], v[96:99], a[232:235], v[152:155]
    v_mfma_f32_16x16x32_bf16 v[132:135], v[100:103], a[40:43], v[132:135]
    v_mfma_f32_16x16x32_bf16 v[140:143], v[100:103], a[104:107], v[140:143]
    v_mfma_f32_16x16x32_bf16 v[148:151], v[100:103], a[168:171], v[148:151]
    v_mfma_f32_16x16x32_bf16 v[156:159], v[100:103], a[232:235], v[156:159]
    ds_read_b128 v[96:99], v6 offset:6144
    ds_read_b128 v[100:103], v6 offset:22528
    s_waitcnt lgkmcnt(2)
    v_mfma_f32_16x16x32_bf16 v[128:131], v[104:107], a[44:47], v[128:131]
    v_mfma_f32_16x16x32_bf16 v[136:139], v[104:107], a[108:111], v[136:139]
    s_add_u32 m0, s30, 2688
    s_nop 0
    global_load_lds_dwordx4 v2, s[24:25] offset:384
    v_mfma_f32_16x16x32_bf16 v[144:147], v[104:107], a[172:175], v[144:147]
    v_mfma_f32_16x16x32_bf16 v[152:155], v[104:107], a[236:239], v[152:155]
    v_mfma_f32_16x16x32_bf16 v[132:135], v[108:111], a[44:47], v[132:135]
    v_mfma_f32_16x16x32_bf16 v[140:143], v[108:111], a[108:111], v[140:143]
    v_mfma_f32_16x16x32_bf16 v[148:151], v[108:111], a[172:175], v[148:151]
    v_mfma_f32_16x16x32_bf16 v[156:159], v[108:111], a[236:239], v[156:159]
    ds_read_b128 v[104:107], v7 offset:6144
    ds_read_b128 v[108:111], v7 offset:22528
    s_waitcnt lgkmcnt(2)
    v_mfma_f32_16x16x32_bf16 v[128:131], v[96:99], a[48:51], v[128:131]
    v_mfma_f32_16x16x32_bf16 v[136:139], v[96:99], a[112:115], v[136:139]
    s_add_u32 m0, s30, 3584
    s_nop 0
    global_load_lds_dwordx4 v2, s[24:25] offset:512
    v_mfma_f32_16x16x32_bf16 v[144:147], v[96:99], a[176:179], v[144:147]
    v_mfma_f32_16x16x32_bf16 v[152:155], v[96:99], a[240:243], v[152:155]
    v_mfma_f32_16x16x32_bf16 v[132:135], v[100:103], a[48:51], v[132:135]
    v_mfma_f32_16x16x32_bf16 v[140:143], v[100:103], a[112:115], v[140:143]
    v_mfma_f32_16x16x32_bf16 v[148:151], v[100:103], a[176:179], v[148:151]
    v_mfma_f32_16x16x32_bf16 v[156:159], v[100:103], a[240:243], v[156:159]
    ds_read_b128 v[96:99], v6 offset:7168
    ds_read_b128 v[100:103], v6 offset:23552
    s_waitcnt lgkmcnt(2)
    v_mfma_f32_16x16x32_bf16 v[128:131], v[104:107], a[52:55], v[128:131]
    v_mfma_f32_16x16x32_bf16 v[136:139], v[104:107], a[116:119], v[136:139]
    s_add_u32 m0, s30, 4480
    s_nop 0
    global_load_lds_dwordx4 v2, s[24:25] offset:640
    v_mfma_f32_16x16x32_bf16 v[144:147], v[104:107], a[180:183], v[144:147]
    v_mfma_f32_16x16x32_bf16 v[152:155], v[104:107], a[244:247], v[152:155]
    v_mfma_f32_16x16x32_bf16 v[132:135], v[108:111], a[52:55], v[132:135]
    v_mfma_f32_16x16x32_bf16 v[140:143], v[108:111], a[116:119], v[140:143]
    v_mfma_f32_16x16x32_bf16 v[148:151], v[108:111], a[180:183], v[148:151]
    v_mfma_f32_16x16x32_bf16 v[156:159], v[108:111], a[244:247], v[156:159]
    ds_read_b128 v[104:107], v7 offset:7168
    ds_read_b128 v[108:111], v7 offset:23552
    s_waitcnt lgkmcnt(2)
    v_mfma_f32_16x16x32_bf16 v[128:131], v[96:99], a[56:59], v[128:131]
    v_mfma_f32_16x16x32_bf16 v[136:139], v[96:99], a[120:123], v[136:139]
    s_add_u32 m0, s30, 5376
    s_nop 0
    global_load_lds_dwordx4 v2, s[24:25] offset:768
    v_mfma_f32_16x16x32_bf16 v[144:147], v[96:99], a[184:187], v[144:147]
    v_mfma_f32_16x16x32_bf16 v[152:155], v[96:99], a[248:251], v[152:155]
    v_mfma_f32_16x16x32_bf16 v[132:135], v[100:103], a[56:59], v[132:135]
    v_mfma_f32_16x16x32_bf16 v[140:143], v[100:103], a[120:123], v[140:143]
    v_mfma_f32_16x16x32_bf16 v[148:151], v[100:103], a[184:187], v[148:151]
    v_mfma_f32_16x16x32_bf16 v[156:159], v[100:103], a[248:251], v[156:159]
    s_waitcnt lgkmcnt(0)
    v_mfma_f32_16x16x32_bf16 v[128:131], v[104:107], a[60:63], v[128:131]
    v_mfma_f32_16x16x32_bf16 v[136:139], v[104:107], a[124:127], v[136:139]
    s_add_u32 m0, s30, 6272
    s_nop 0
    global_load_lds_dwordx4 v2, s[24:25] offset:896
    v_mfma_f32_16x16x32_bf16 v[144:147], v[104:107], a[188:191], v[144:147]
    v_mfma_f32_16x16x32_bf16 v[152:155], v[104:107], a[252:255], v[152:155]
    v_mfma_f32_16x16x32_bf16 v[132:135], v[108:111], a[60:63], v[132:135]
    v_mfma_f32_16x16x32_bf16 v[140:143], v[108:111], a[124:127], v[140:143]
    v_mfma_f32_16x16x32_bf16 v[148:151], v[108:111], a[188:191], v[148:151]
    v_mfma_f32_16x16x32_bf16 v[156:159], v[108:111], a[252:255], v[156:159]
    s_branch LJ_53
LND_52:
    ds_read_b128 v[96:99], v6 offset:0
    ds_read_b128 v[100:103], v6 offset:16384
    ds_read_b128 v[104:107], v7 offset:0
    ds_read_b128 v[108:111], v7 offset:16384
    s_waitcnt lgkmcnt(2)
    v_mfma_f32_16x16x32_bf16 v[128:131], v[96:99], a[0:3], 0
    v_mfma_f32_16x16x32_bf16 v[136:139], v[96:99], a[64:67], 0
    v_mfma_f32_16x16x32_bf16 v[144:147], v[96:99], a[128:131], 0
    v_mfma_f32_16x16x32_bf16 v[152:155], v[96:99], a[192:195], 0
    v_mfma_f32_16x16x32_bf16 v[132:135], v[100:103], a[0:3], 0
    v_mfma_f32_16x16x32_bf16 v[140:143], v[100:103], a[64:67], 0
    v_mfma_f32_16x16x32_bf16 v[148:151], v[100:103], a[128:131], 0
    v_mfma_f32_16x16x32_bf16 v[156:159], v[100:103], a[192:195], 0
    ds_read_b128 v[96:99], v6 offset:1024
    ds_read_b128 v[100:103], v6 offset:17408
    s_waitcnt lgkmcnt(2)
    v_mfma_f32_16x16x32_bf16 v[128:131], v[104:107], a[4:7], v[128:131]
    v_mfma_f32_16x16x32_bf16 v[136:139], v[104:107], a[68:71], v[136:139]
    v_mfma_f32_16x16x32_bf16 v[144:147], v[104:107], a[132:135], v[144:147]
    v_mfma_f32_16x16x32_bf16 v[152:155], v[104:107], a[196:199], v[152:155]
    v_mfma_f32_16x16x32_bf16 v[132:135], v[108:111], a[4:7], v[132:135]
    v_mfma_f32_16x16x32_bf16 v[140:143], v[108:111], a[68:71], v[140:143]
    v_mfma_f32_16x16x32_bf16 v[148:151], v[108:111], a[132:135], v[148:151]
    v_mfma_f32_16x16x32_bf16 v[156:159], v[108:111], a[196:199], v[156:159]
    ds_read_b128 v[104:107], v7 offset:1024
    ds_read_b128 v[108:111], v7 offset:17408
    s_waitcnt lgkmcnt(2)
    v_mfma_f32_16x16x32_bf16 v[128:131], v[96:99], a[8:11], v[128:131]
    v_mfma_f32_16x16x32_bf16 v[136:139], v[96:99], a[72:75], v[136:139]
    v_mfma_f32_16x16x32_bf16 v[144:147], v[96:99], a[136:139], v[144:147]
    v_mfma_f32_16x16x32_bf16 v[152:155], v[96:99], a[200:203], v[152:155]
    v_mfma_f32_16x16x32_bf16 v[132:135], v[100:103], a[8:11], v[132:135]
    v_mfma_f32_16x16x32_bf16 v[140:143], v[100:103], a[72:75], v[140:143]
    v_mfma_f32_16x16x32_bf16 v[148:151], v[100:103], a[136:139], v[148:151]
    v_mfma_f32_16x16x32_bf16 v[156:159], v[100:103], a[200:203], v[156:159]
    ds_read_b128 v[96:99], v6 offset:2048
    ds_read_b128 v[100:103], v6 offset:18432
    s_waitcnt lgkmcnt(2)
    v_mfma_f32_16x16x32_bf16 v[128:131], v[104:107], a[12:15], v[128:131]
    v_mfma_f32_16x16x32_bf16 v[136:139], v[104:107], a[76:79], v[136:139]
    v_mfma_f32_16x16x32_bf16 v[144:147], v[104:107], a[140:143], v[144:147]
    v_mfma_f32_16x16x32_bf16 v[152:155], v[104:107], a[204:207], v[152:155]
    v_mfma_f32_16x16x32_bf16 v[132:135], v[108:111], a[12:15], v[132:135]
    v_mfma_f32_16x16x32_bf16 v[140:143], v[108:111], a[76:79], v[140:143]
    v_mfma_f32_16x16x32_bf16 v[148:151], v[108:111], a[140:143], v[148:151]
    v_mfma_f32_16x16x32_bf16 v[156:159], v[108:111], a[204:207], v[156:159]
    ds_read_b128 v[104:107], v7 offset:2048
    ds_read_b128 v[108:111], v7 offset:18432
    s_waitcnt lgkmcnt(2)
    v_mfma_f32_16x16x32_bf16 v[128:131], v[96:99], a[16:19], v[128:131]
    v_mfma_f32_16x16x32_bf16 v[136:139], v[96:99], a[80:83], v[136:139]
    v_mfma_f32_16x16x32_bf16 v[144:147], v[96:99], a[144:147], v[144:147]
    v_mfma_f32_16x16x32_bf16 v[152:155], v[96:99], a[208:211], v[152:155]
    v_mfma_f32_16x16x32_bf16 v[132:135], v[100:103], a[16:19], v[132:135]
    v_mfma_f32_16x16x32_bf16 v[140:143], v[100:103], a[80:83], v[140:143]
    v_mfma_f32_16x16x32_bf16 v[148:151], v[100:103], a[144:147], v[148:151]
    v_mfma_f32_16x16x32_bf16 v[156:159], v[100:103], a[208:211], v[156:159]
    ds_read_b128 v[96:99], v6 offset:3072
    ds_read_b128 v[100:103], v6 offset:19456
    s_waitcnt lgkmcnt(2)
    v_mfma_f32_16x16x32_bf16 v[128:131], v[104:107], a[20:23], v[128:131]
    v_mfma_f32_16x16x32_bf16 v[136:139], v[104:107], a[84:87], v[136:139]
    v_mfma_f32_16x16x32_bf16 v[144:147], v[104:107], a[148:151], v[144:147]
    v_mfma_f32_16x16x32_bf16 v[152:155], v[104:107], a[212:215], v[152:155]
    v_mfma_f32_16x16x32_bf16 v[132:135], v[108:111], a[20:23], v[132:135]
    v_mfma_f32_16x16x32_bf16 v[140:143], v[108:111], a[84:87], v[140:143]
    v_mfma_f32_16x16x32_bf16 v[148:151], v[108:111], a[148:151], v[148:151]
    v_mfma_f32_16x16x32_bf16 v[156:159], v[108:111], a[212:215], v[156:159]
    ds_read_b128 v[104:107], v7 offset:3072
    ds_read_b128 v[108:111], v7 offset:19456
    s_waitcnt lgkmcnt(2)
    v_mfma_f32_16x16x32_bf16 v[128:131], v[96:99], a[24:27], v[128:131]
    v_mfma_f32_16x16x32_bf16 v[136:139], v[96:99], a[88:91], v[136:139]
    v_mfma_f32_16x16x32_bf16 v[144:147], v[96:99], a[152:155], v[144:147]
    v_mfma_f32_16x16x32_bf16 v[152:155], v[96:99], a[216:219], v[152:155]
    v_mfma_f32_16x16x32_bf16 v[132:135], v[100:103], a[24:27], v[132:135]
    v_mfma_f32_16x16x32_bf16 v[140:143], v[100:103], a[88:91], v[140:143]
    v_mfma_f32_16x16x32_bf16 v[148:151], v[100:103], a[152:155], v[148:151]
    v_mfma_f32_16x16x32_bf16 v[156:159], v[100:103], a[216:219], v[156:159]
    ds_read_b128 v[96:99], v6 offset:4096
    ds_read_b128 v[100:103], v6 offset:20480
    s_waitcnt lgkmcnt(2)
    v_mfma_f32_16x16x32_bf16 v[128:131], v[104:107], a[28:31], v[128:131]
    v_mfma_f32_16x16x32_bf16 v[136:139], v[104:107], a[92:95], v[136:139]
    v_mfma_f32_16x16x32_bf16 v[144:147], v[104:107], a[156:159], v[144:147]
    v_mfma_f32_16x16x32_bf16 v[152:155], v[104:107], a[220:223], v[152:155]
    v_mfma_f32_16x16x32_bf16 v[132:135], v[108:111], a[28:31], v[132:135]
    v_mfma_f32_16x16x32_bf16 v[140:143], v[108:111], a[92:95], v[140:143]
    v_mfma_f32_16x16x32_bf16 v[148:151], v[108:111], a[156:159], v[148:151]
    v_mfma_f32_16x16x32_bf16 v[156:159], v[108:111], a[220:223], v[156:159]
    ds_read_b128 v[104:107], v7 offset:4096
    ds_read_b128 v[108:111], v7 offset:20480
    s_waitcnt lgkmcnt(2)
    v_mfma_f32_16x16x32_bf16 v[128:131], v[96:99], a[32:35], v[128:131]
    v_mfma_f32_16x16x32_bf16 v[136:139], v[96:99], a[96:99], v[136:139]
    v_mfma_f32_16x16x32_bf16 v[144:147], v[96:99], a[160:163], v[144:147]
    v_mfma_f32_16x16x32_bf16 v[152:155], v[96:99], a[224:227], v[152:155]
    v_mfma_f32_16x16x32_bf16 v[132:135], v[100:103], a[32:35], v[132:135]
    v_mfma_f32_16x16x32_bf16 v[140:143], v[100:103], a[96:99], v[140:143]
    v_mfma_f32_16x16x32_bf16 v[148:151], v[100:103], a[160:163], v[148:151]
    v_mfma_f32_16x16x32_bf16 v[156:159], v[100:103], a[224:227], v[156:159]
    ds_read_b128 v[96:99], v6 offset:5120
    ds_read_b128 v[100:103], v6 offset:21504
    s_waitcnt lgkmcnt(2)
    v_mfma_f32_16x16x32_bf16 v[128:131], v[104:107], a[36:39], v[128:131]
    v_mfma_f32_16x16x32_bf16 v[136:139], v[104:107], a[100:103], v[136:139]
    v_mfma_f32_16x16x32_bf16 v[144:147], v[104:107], a[164:167], v[144:147]
    v_mfma_f32_16x16x32_bf16 v[152:155], v[104:107], a[228:231], v[152:155]
    v_mfma_f32_16x16x32_bf16 v[132:135], v[108:111], a[36:39], v[132:135]
    v_mfma_f32_16x16x32_bf16 v[140:143], v[108:111], a[100:103], v[140:143]
    v_mfma_f32_16x16x32_bf16 v[148:151], v[108:111], a[164:167], v[148:151]
    v_mfma_f32_16x16x32_bf16 v[156:159], v[108:111], a[228:231], v[156:159]
    ds_read_b128 v[104:107], v7 offset:5120
    ds_read_b128 v[108:111], v7 offset:21504
    s_waitcnt lgkmcnt(2)
    v_mfma_f32_16x16x32_bf16 v[128:131], v[96:99], a[40:43], v[128:131]
    v_mfma_f32_16x16x32_bf16 v[136:139], v[96:99], a[104:107], v[136:139]
    v_mfma_f32_16x16x32_bf16 v[144:147], v[96:99], a[168:171], v[144:147]
    v_mfma_f32_16x16x32_bf16 v[152:155], v[96:99], a[232:235], v[152:155]
    v_mfma_f32_16x16x32_bf16 v[132:135], v[100:103], a[40:43], v[132:135]
    v_mfma_f32_16x16x32_bf16 v[140:143], v[100:103], a[104:107], v[140:143]
    v_mfma_f32_16x16x32_bf16 v[148:151], v[100:103], a[168:171], v[148:151]
    v_mfma_f32_16x16x32_bf16 v[156:159], v[100:103], a[232:235], v[156:159]
    ds_read_b128 v[96:99], v6 offset:6144
    ds_read_b128 v[100:103], v6 offset:22528
    s_waitcnt lgkmcnt(2)
    v_mfma_f32_16x16x32_bf16 v[128:131], v[104:107], a[44:47], v[128:131]
    v_mfma_f32_16x16x32_bf16 v[136:139], v[104:107], a[108:111], v[136:139]
    v_mfma_f32_16x16x32_bf16 v[144:147], v[104:107], a[172:175], v[144:147]
    v_mfma_f32_16x16x32_bf16 v[152:155], v[104:107], a[236:239], v[152:155]
    v_mfma_f32_16x16x32_bf16 v[132:135], v[108:111], a[44:47], v[132:135]
    v_mfma_f32_16x16x32_bf16 v[140:143], v[108:111], a[108:111], v[140:143]
    v_mfma_f32_16x16x32_bf16 v[148:151], v[108:111], a[172:175], v[148:151]
    v_mfma_f32_16x16x32_bf16 v[156:159], v[108:111], a[236:239], v[156:159]
    ds_read_b128 v[104:107], v7 offset:6144
    ds_read_b128 v[108:111], v7 offset:22528
    s_waitcnt lgkmcnt(2)
    v_mfma_f32_16x16x32_bf16 v[128:131], v[96:99], a[48:51], v[128:131]
    v_mfma_f32_16x16x32_bf16 v[136:139], v[96:99], a[112:115], v[136:139]
    v_mfma_f32_16x16x32_bf16 v[144:147], v[96:99], a[176:179], v[144:147]
    v_mfma_f32_16x16x32_bf16 v[152:155], v[96:99], a[240:243], v[152:155]
    v_mfma_f32_16x16x32_bf16 v[132:135], v[100:103], a[48:51], v[132:135]
    v_mfma_f32_16x16x32_bf16 v[140:143], v[100:103], a[112:115], v[140:143]
    v_mfma_f32_16x16x32_bf16 v[148:151], v[100:103], a[176:179], v[148:151]
    v_mfma_f32_16x16x32_bf16 v[156:159], v[100:103], a[240:243], v[156:159]
    ds_read_b128 v[96:99], v6 offset:7168
    ds_read_b128 v[100:103], v6 offset:23552
    s_waitcnt lgkmcnt(2)
    v_mfma_f32_16x16x32_bf16 v[128:131], v[104:107], a[52:55], v[128:131]
    v_mfma_f32_16x16x32_bf16 v[136:139], v[104:107], a[116:119], v[136:139]
    v_mfma_f32_16x16x32_bf16 v[144:147], v[104:107], a[180:183], v[144:147]
    v_mfma_f32_16x16x32_bf16 v[152:155], v[104:107], a[244:247], v[152:155]
    v_mfma_f32_16x16x32_bf16 v[132:135], v[108:111], a[52:55], v[132:135]
    v_mfma_f32_16x16x32_bf16 v[140:143], v[108:111], a[116:119], v[140:143]
    v_mfma_f32_16x16x32_bf16 v[148:151], v[108:111], a[180:183], v[148:151]
    v_mfma_f32_16x16x32_bf16 v[156:159], v[108:111], a[244:247], v[156:159]
    ds_read_b128 v[104:107], v7 offset:7168
    ds_read_b128 v[108:111], v7 offset:23552
    s_waitcnt lgkmcnt(2)
    v_mfma_f32_16x16x32_bf16 v[128:131], v[96:99], a[56:59], v[128:131]
    v_mfma_f32_16x16x32_bf16 v[136:139], v[96:99], a[120:123], v[136:139]
    v_mfma_f32_16x16x32_bf16 v[144:147], v[96:99], a[184:187], v[144:147]
    v_mfma_f32_16x16x32_bf16 v[152:155], v[96:99], a[248:251], v[152:155]
    v_mfma_f32_16x16x32_bf16 v[132:135], v[100:103], a[56:59], v[132:135]
    v_mfma_f32_16x16x32_bf16 v[140:143], v[100:103], a[120:123], v[140:143]
    v_mfma_f32_16x16x32_bf16 v[148:151], v[100:103], a[184:187], v[148:151]
    v_mfma_f32_16x16x32_bf16 v[156:159], v[100:103], a[248:251], v[156:159]
    s_waitcnt lgkmcnt(0)
    v_mfma_f32_16x16x32_bf16 v[128:131], v[104:107], a[60:63], v[128:131]
    v_mfma_f32_16x16x32_bf16 v[136:139], v[104:107], a[124:127], v[136:139]
    v_mfma_f32_16x16x32_bf16 v[144:147], v[104:107], a[188:191], v[144:147]
    v_mfma_f32_16x16x32_bf16 v[152:155], v[104:107], a[252:255], v[152:155]
    v_mfma_f32_16x16x32_bf16 v[132:135], v[108:111], a[60:63], v[132:135]
    v_mfma_f32_16x16x32_bf16 v[140:143], v[108:111], a[124:127], v[140:143]
    v_mfma_f32_16x16x32_bf16 v[148:151], v[108:111], a[188:191], v[148:151]
    v_mfma_f32_16x16x32_bf16 v[156:159], v[108:111], a[252:255], v[156:159]
LJ_53:
    s_nop 7
    v_cvt_pk_bf16_f32 v112, v128, v129
    v_cvt_pk_bf16_f32 v113, v130, v131
    v_cvt_pk_bf16_f32 v114, v132, v133
    v_cvt_pk_bf16_f32 v115, v134, v135
    global_store_dwordx4 v16, v[112:115], s[12:13] offset:0 sc1
    v_cvt_pk_bf16_f32 v116, v136, v137
    v_cvt_pk_bf16_f32 v117, v138, v139
    v_cvt_pk_bf16_f32 v118, v140, v141
    v_cvt_pk_bf16_f32 v119, v142, v143
    global_store_dwordx4 v16, v[116:119], s[12:13] offset:1024 sc1
    v_cvt_pk_bf16_f32 v120, v144, v145
    v_cvt_pk_bf16_f32 v121, v146, v147
    v_cvt_pk_bf16_f32 v122, v148, v149
    v_cvt_pk_bf16_f32 v123, v150, v151
    global_store_dwordx4 v16, v[120:123], s[12:13] offset:2048 sc1
    v_cvt_pk_bf16_f32 v124, v152, v153
    v_cvt_pk_bf16_f32 v125, v154, v155
    v_cvt_pk_bf16_f32 v126, v156, v157
    v_cvt_pk_bf16_f32 v127, v158, v159
    global_store_dwordx4 v16, v[124:127], s[12:13] offset:3072 sc1
    s_add_u32 s12, s12, 0x80000
    s_addc_u32 s13, s13, 0
    s_add_u32 s20, s20, 1
    s_cmp_le_u32 s20, 3
    s_cbranch_scc0 LEF_54
    s_waitcnt vmcnt(0)
    s_barrier
    s_cmp_eq_u32 s6, 0
    s_cbranch_scc0 LPUB_55
    v_mov_b32 v8, s20
    v_mov_b32 v9, 0
    s_mov_b64 exec, 1
    global_store_dword v9, v8, s[14:15] sc1
    s_mov_b64 exec, -1
LPUB_55:
    s_cmp_eq_u32 s20, 3
    s_cbranch_scc0 LEF_54
LEF_54:
    s_cmp_lt_u32 s20, 32
    s_cbranch_scc1 L_V_loop
L_V_end:
    s_waitcnt vmcnt(0)
    s_barrier
    s_mov_b32 s23, 32
    s_cmp_eq_u32 s6, 0
    s_cbranch_scc0 LPUB_56
    v_mov_b32 v8, s23
    v_mov_b32 v9, 0
    s_mov_b64 exec, 1
    global_store_dword v9, v8, s[14:15] sc1
    s_mov_b64 exec, -1
LPUB_56:
    v_mov_b32 v20, 0
    s_mov_b32 s28, 0
LWA_57:
    global_load_dword v21, v20, s[38:39] sc1
    s_waitcnt vmcnt(0)
    v_readfirstlane_b32 s21, v21
    s_cmp_ge_u32 s21, 256
    s_cbranch_scc1 LWAOK_58
    s_sleep 4
    s_add_u32 s28, s28, 1
    s_cmp_lt_u32 s28, 0x40000
    s_cbranch_scc1 LWA_57
    s_branch L_fail
LWAOK_58:
    s_and_b32 s5, s31, 63
    s_and_b32 s21, s5, 31
    s_lshl_b32 s21, s21, 2
    s_add_u32 s21, s21, s6
    s_lshr_b32 s3, s21, 5
    s_and_b32 s7, s21, 31
    s_lshr_b32 s20, s5, 5
    s_lshr_b32 s21, s7, 3
    s_lshl_b32 s21, s21, 7
    s_add_u32 s21, s21, 0x5208000
    s_add_u32 s16, s18, s21
    s_addc_u32 s17, s19, 0
    v_lshlrev_b32 v1, 4, v0
LFIN_59:
    s_add_u32 s29, s20, 1
    v_lshlrev_b32 v10, 9, v0
    s_mov_b32 s28, 0
LWF_60:
    s_mov_b64 exec, 0xffff
    global_load_dword v11, v10, s[16:17] sc1
    s_waitcnt vmcnt(0)
    v_cmp_gt_u32 vcc, s29, v11
    s_mov_b64 exec, -1
    s_and_b32 s21, vcc_lo, 0xffff
    s_cmp_eq_u32 s21, 0
    s_cbranch_scc1 LWFOK_61
    s_sleep 1
    s_add_u32 s28, s28, 1
    s_cmp_lt_u32 s28, 0x40000
    s_cbranch_scc1 LWF_60
    s_branch L_fail
LWFOK_61:
    s_lshl_b32 s21, s20, 2
    s_add_u32 s21, s21, s3
    s_lshl_b32 s22, s21, 5
    s_add_u32 s22, s22, s7
    s_lshl_b32 s22, s22, 10
    s_add_u32 s22, s22, 0x7400000
    s_add_u32 s24, s18, s22
    s_addc_u32 s25, s19, 0
    global_load_dwordx4 v[32:35], v1, s[24:25] sc1
    s_add_u32 s24, s24, 0x400000
    s_addc_u32 s25, s25, 0
    global_load_dwordx4 v[36:39], v1, s[24:25] sc1
    s_add_u32 s24, s24, 0x400000
    s_addc_u32 s25, s25, 0
    global_load_dwordx4 v[40:43], v1, s[24:25] sc1
    s_add_u32 s24, s24, 0x400000
    s_addc_u32 s25, s25, 0
    global_load_dwordx4 v[44:47], v1, s[24:25] sc1
    s_add_u32 s24, s24, 0x400000
    s_addc_u32 s25, s25, 0
    global_load_dwordx4 v[48:51], v1, s[24:25] sc1
    s_add_u32 s24, s24, 0x400000
    s_addc_u32 s25, s25, 0
    global_load_dwordx4 v[52:55], v1, s[24:25] sc1
    s_add_u32 s24, s24, 0x400000
    s_addc_u32 s25, s25, 0
    global_load_dwordx4 v[56:59], v1, s[24:25] sc1
    s_add_u32 s24, s24, 0x400000
    s_addc_u32 s25, s25, 0
    global_load_dwordx4 v[60:63], v1, s[24:25] sc1
    s_add_u32 s24, s24, 0x400000
    s_addc_u32 s25, s25, 0
    global_load_dwordx4 v[64:67], v1, s[24:25] sc1
    s_add_u32 s24, s24, 0x400000
    s_addc_u32 s25, s25, 0
    global_load_dwordx4 v[68:71], v1, s[24:25] sc1
    s_add_u32 s24, s24, 0x400000
    s_addc_u32 s25, s25, 0
    global_load_dwordx4 v[72:75], v1, s[24:25] sc1
    s_add_u32 s24, s24, 0x400000
    s_addc_u32 s25, s25, 0
    global_load_dwordx4 v[76:79], v1, s[24:25] sc1
    s_add_u32 s24, s24, 0x400000
    s_addc_u32 s25, s25, 0
    global_load_dwordx4 v[80:83], v1, s[24:25] sc1
    s_add_u32 s24, s24, 0x400000
    s_addc_u32 s25, s25, 0
    global_load_dwordx4 v[84:87], v1, s[24:25] sc1
    s_add_u32 s24, s24, 0x400000
    s_addc_u32 s25, s25, 0
    global_load_dwordx4 v[88:91], v1, s[24:25] sc1
    s_add_u32 s24, s24, 0x400000
    s_addc_u32 s25, s25, 0
    global_load_dwordx4 v[92:95], v1, s[24:25] sc1
    s_lshl_b32 s22, s21, 6
    s_add_u32 s22, s22, 0x5220000
    s_add_u32 s24, s18, s22
    s_addc_u32 s25, s19, 0
    v_and_b32 v20, 15, v0
    v_lshlrev_b32 v21, 2, v20
    global_load_dword v22, v21, s[24:25] sc1
    s_lshl_b32 s22, s21, 14
    s_lshl_b32 s23, s7, 5
    s_add_u32 s22, s22, s23
    v_lshlrev_b32 v23, 10, v20
    v_lshrrev_b32 v24, 4, v0
    v_lshl_add_u32 v23, v24, 3, v23
    v_add_u32 v23, s22, v23
    s_waitcnt vmcnt(0)
    v_add_f32 v32, v32, v36
    v_add_f32 v33, v33, v37
    v_add_f32 v34, v34, v38
    v_add_f32 v35, v35, v39
    v_add_f32 v32, v32, v40
    v_add_f32 v33, v33, v41
    v_add_f32 v34, v34, v42
    v_add_f32 v35, v35, v43
    v_add_f32 v32, v32, v44
    v_add_f32 v33, v33, v45
    v_add_f32 v34, v34, v46
    v_add_f32 v35, v35, v47
    v_add_f32 v32, v32, v48
    v_add_f32 v33, v33, v49
    v_add_f32 v34, v34, v50
    v_add_f32 v35, v35, v51
    v_add_f32 v32, v32, v52
    v_add_f32 v33, v33, v53
    v_add_f32 v34, v34, v54
    v_add_f32 v35, v35, v55
    v_add_f32 v32, v32, v56
    v_add_f32 v33, v33, v57
    v_add_f32 v34, v34, v58
    v_add_f32 v35, v35, v59
    v_add_f32 v32, v32, v60
    v_add_f32 v33, v33, v61
    v_add_f32 v34, v34, v62
    v_add_f32 v35, v35, v63
    v_add_f32 v64, v64, v68
    v_add_f32 v65, v65, v69
    v_add_f32 v66, v66, v70
    v_add_f32 v67, v67, v71
    v_add_f32 v64, v64, v72
    v_add_f32 v65, v65, v73
    v_add_f32 v66, v66, v74
    v_add_f32 v67, v67, v75
    v_add_f32 v64, v64, v76
    v_add_f32 v65, v65, v77
    v_add_f32 v66, v66, v78
    v_add_f32 v67, v67, v79
    v_add_f32 v64, v64, v80
    v_add_f32 v65, v65, v81
    v_add_f32 v66, v66, v82
    v_add_f32 v67, v67, v83
    v_add_f32 v64, v64, v84
    v_add_f32 v65, v65, v85
    v_add_f32 v66, v66, v86
    v_add_f32 v67, v67, v87
    v_add_f32 v64, v64, v88
    v_add_f32 v65, v65, v89
    v_add_f32 v66, v66, v90
    v_add_f32 v67, v67, v91
    v_add_f32 v64, v64, v92
    v_add_f32 v65, v65, v93
    v_add_f32 v66, v66, v94
    v_add_f32 v67, v67, v95
    v_sub_f32 v25, 1.0, v22
    v_cvt_pk_bf16_f32 v25, v25, v25
    v_lshlrev_b32 v25, 16, v25
    v_cvt_pk_bf16_f32 v26, v32, v33
    v_lshlrev_b32 v32, 16, v26
    v_and_b32 v33, 0xffff0000, v26
    v_cvt_pk_bf16_f32 v26, v34, v35
    v_lshlrev_b32 v34, 16, v26
    v_and_b32 v35, 0xffff0000, v26
    v_cvt_pk_bf16_f32 v26, v64, v65
    v_lshlrev_b32 v64, 16, v26
    v_and_b32 v65, 0xffff0000, v26
    v_cvt_pk_bf16_f32 v26, v66, v67
    v_lshlrev_b32 v66, 16, v26
    v_and_b32 v67, 0xffff0000, v26
    v_mul_f32 v32, v22, v32
    v_mul_f32 v64, v25, v64
    v_mul_f32 v33, v22, v33
    v_mul_f32 v65, v25, v65
    v_mul_f32 v34, v22, v34
    v_mul_f32 v66, v25, v66
    v_mul_f32 v35, v22, v35
    v_mul_f32 v67, v25, v67
    v_cvt_pk_bf16_f32 v26, v32, v33
    v_lshlrev_b32 v32, 16, v26
    v_and_b32 v33, 0xffff0000, v26
    v_cvt_pk_bf16_f32 v26, v34, v35
    v_lshlrev_b32 v34, 16, v26
    v_and_b32 v35, 0xffff0000, v26
    v_cvt_pk_bf16_f32 v26, v64, v65
    v_lshlrev_b32 v64, 16, v26
    v_and_b32 v65, 0xffff0000, v26
    v_cvt_pk_bf16_f32 v26, v66, v67
    v_lshlrev_b32 v66, 16, v26
    v_and_b32 v67, 0xffff0000, v26
    v_add_f32 v32, v32, v64
    v_add_f32 v33, v33, v65
    v_add_f32 v34, v34, v66
    v_add_f32 v35, v35, v67
    v_cvt_pk_bf16_f32 v28, v32, v33
    v_cvt_pk_bf16_f32 v29, v34, v35
    global_store_dwordx2 v23, v[28:29], s[36:37]
    s_add_u32 s20, s20, 2
    s_cmp_lt_u32 s20, 32
    s_cbranch_scc1 LFIN_59
    s_waitcnt vmcnt(0)
    s_branch L_end
L_roleQ:
    s_cmp_eq_u32 s4, 0
    s_cselect_b32 s8, s72, s80
    s_cselect_b32 s9, s73, s81
    s_lshl_b32 s21, s5, 8
    s_add_u32 s8, s8, s21
    s_addc_u32 s9, s9, 0
    s_and_b32 s23, s31, 63
    s_lshl_b32 s23, s23, 7
    s_lshr_b32 s22, s31, 6
    s_mov_b32 s21, 0x5202000
    s_cmp_eq_u32 s22, 0
    s_cselect_b32 s21, 0x5200000, s21
    s_cmp_eq_u32 s22, 2
    s_cselect_b32 s21, 0x5206000, s21
    s_add_u32 s21, s21, s23
    s_add_u32 s58, s18, s21
    s_addc_u32 s59, s19, 0
    v_mov_b32 v20, 0
    s_mov_b64 exec, 1
    global_store_dword v20, v20, s[58:59] sc1
    s_mov_b64 exec, -1
    s_add_u32 s21, s23, 0x5208000
    s_cmp_eq_u32 s22, 0
    s_cbranch_scc0 LNK_62
    s_add_u32 s58, s18, s21
    s_addc_u32 s59, s19, 0
    v_mov_b32 v20, 0
    s_mov_b64 exec, 1
    global_store_dword v20, v20, s[58:59] sc1
    s_mov_b64 exec, -1
LNK_62:
    s_waitcnt vmcnt(0)
    s_barrier
    s_cmp_eq_u32 s6, 0
    s_cbranch_scc0 LARR_63
    v_mov_b32 v30, 0
    v_mov_b32 v31, 1
    s_mov_b64 exec, 1
    global_atomic_add v30, v31, s[38:39]
    s_mov_b64 exec, -1
LARR_63:
    s_lshl_b32 s23, s4, 5
    s_add_u32 s23, s23, s5
    s_lshl_b32 s21, s23, 7
    s_add_u32 s21, s21, 0x5206000
    s_add_u32 s14, s18, s21
    s_addc_u32 s15, s19, 0
    s_lshl_b32 s21, s23, 7
    s_add_u32 s21, s21, 0x5200000
    s_add_u32 s66, s18, s21
    s_addc_u32 s67, s19, 0
    s_lshl_b32 s21, s23, 7
    s_add_u32 s21, s21, 0x5202000
    s_add_u32 s68, s18, s21
    s_addc_u32 s69, s19, 0
    s_lshl_b32 s21, s23, 7
    s_add_u32 s21, s21, 0x5204000
    s_add_u32 s70, s18, s21
    s_addc_u32 s71, s19, 0
    v_lshrrev_b32 v20, 4, v0
    v_and_b32 v23, 15, v0
    v_lshrrev_b32 v21, 2, v23
    v_and_b32 v22, 3, v0
    v_and_b32 v24, 15, v0
    v_lshrrev_b32 v25, 4, v0
    v_lshlrev_b32 v26, 1, v25
    v_xor_b32 v27, v24, v26
    v_xor_b32 v28, 8, v27
    v_lshlrev_b32 v27, 4, v27
    v_lshlrev_b32 v28, 4, v28
    v_lshlrev_b32 v29, 13, v25
    v_add_u32 v27, v27, v29
    v_add_u32 v28, v28, v29
    s_lshl_b32 s21, s6, 20
    s_add_u32 s24, s8, s21
    s_addc_u32 s25, s9, 0
    s_lshl_b32 s30, s6, 15
    s_mov_b32 m0, s30
    s_add_u32 s30, s30, 1024
    global_load_lds_dwordx4 v27, s[24:25]
    s_add_u32 s24, s24, 0x8000
    s_addc_u32 s25, s25, 0
    s_mov_b32 m0, s30
    s_add_u32 s30, s30, 1024
    global_load_lds_dwordx4 v27, s[24:25]
    s_add_u32 s24, s24, 0x8000
    s_addc_u32 s25, s25, 0
    s_mov_b32 m0, s30
    s_add_u32 s30, s30, 1024
    global_load_lds_dwordx4 v28, s[24:25]
    s_add_u32 s24, s24, 0x8000
    s_addc_u32 s25, s25, 0
    s_mov_b32 m0, s30
    s_add_u32 s30, s30, 1024
    global_load_lds_dwordx4 v28, s[24:25]
    s_add_u32 s24, s24, 0x8000
    s_addc_u32 s25, s25, 0
    s_mov_b32 m0, s30
    s_add_u32 s30, s30, 1024
    global_load_lds_dwordx4 v27, s[24:25]
    s_add_u32 s24, s24, 0x8000
    s_addc_u32 s25, s25, 0
    s_mov_b32 m0, s30
    s_add_u32 s30, s30, 1024
    global_load_lds_dwordx4 v27, s[24:25]
    s_add_u32 s24, s24, 0x8000
    s_addc_u32 s25, s25, 0
    s_mov_b32 m0, s30
    s_add_u32 s30, s30, 1024
    global_load_lds_dwordx4 v28, s[24:25]
    s_add_u32 s24, s24, 0x8000
    s_addc_u32 s25, s25, 0
    s_mov_b32 m0, s30
    s_add_u32 s30, s30, 1024
    global_load_lds_dwordx4 v28, s[24:25]
    s_add_u32 s24, s24, 0x8000
    s_addc_u32 s25, s25, 0
    s_mov_b32 m0, s30
    s_add_u32 s30, s30, 1024
    global_load_lds_dwordx4 v27, s[24:25]
    s_add_u32 s24, s24, 0x8000
    s_addc_u32 s25, s25, 0
    s_mov_b32 m0, s30
    s_add_u32 s30, s30, 1024
    global_load_lds_dwordx4 v27, s[24:25]
    s_add_u32 s24, s24, 0x8000
    s_addc_u32 s25, s25, 0
    s_mov_b32 m0, s30
    s_add_u32 s30, s30, 1024
    global_load_lds_dwordx4 v28, s[24:25]
    s_add_u32 s24, s24, 0x8000
    s_addc_u32 s25, s25, 0
    s_mov_b32 m0, s30
    s_add_u32 s30, s30, 1024
    global_load_lds_dwordx4 v28, s[24:25]
    s_add_u32 s24, s24, 0x8000
    s_addc_u32 s25, s25, 0
    s_waitcnt vmcnt(8)
    s_mov_b32 m0, s30
    s_add_u32 s30, s30, 1024
    global_load_lds_dwordx4 v27, s[24:25]
    s_add_u32 s24, s24, 0x8000
    s_addc_u32 s25, s25, 0
    s_mov_b32 m0, s30
    s_add_u32 s30, s30, 1024
    global_load_lds_dwordx4 v27, s[24:25]
    s_add_u32 s24, s24, 0x8000
    s_addc_u32 s25, s25, 0
    s_mov_b32 m0, s30
    s_add_u32 s30, s30, 1024
    global_load_lds_dwordx4 v28, s[24:25]
    s_add_u32 s24, s24, 0x8000
    s_addc_u32 s25, s25, 0
    s_mov_b32 m0, s30
    s_add_u32 s30, s30, 1024
    global_load_lds_dwordx4 v28, s[24:25]
    s_add_u32 s24, s24, 0x8000
    s_addc_u32 s25, s25, 0
    s_waitcnt vmcnt(8)
    s_mov_b32 m0, s30
    s_add_u32 s30, s30, 1024
    global_load_lds_dwordx4 v27, s[24:25]
    s_add_u32 s24, s24, 0x8000
    s_addc_u32 s25, s25, 0
    s_mov_b32 m0, s30
    s_add_u32 s30, s30, 1024
    global_load_lds_dwordx4 v27, s[24:25]
    s_add_u32 s24, s24, 0x8000
    s_addc_u32 s25, s25, 0
    s_mov_b32 m0, s30
    s_add_u32 s30, s30, 1024
    global_load_lds_dwordx4 v28, s[24:25]
    s_add_u32 s24, s24, 0x8000
    s_addc_u32 s25, s25, 0
    s_mov_b32 m0, s30
    s_add_u32 s30, s30, 1024
    global_load_lds_dwordx4 v28, s[24:25]
    s_add_u32 s24, s24, 0x8000
    s_addc_u32 s25, s25, 0
    s_waitcnt vmcnt(8)
    s_mov_b32 m0, s30
    s_add_u32 s30, s30, 1024
    global_load_lds_dwordx4 v27, s[24:25]
    s_add_u32 s24, s24, 0x8000
    s_addc_u32 s25, s25, 0
    s_mov_b32 m0, s30
    s_add_u32 s30, s30, 1024
    global_load_lds_dwordx4 v27, s[24:25]
    s_add_u32 s24, s24, 0x8000
    s_addc_u32 s25, s25, 0
    s_mov_b32 m0, s30
    s_add_u32 s30, s30, 1024
    global_load_lds_dwordx4 v28, s[24:25]
    s_add_u32 s24, s24, 0x8000
    s_addc_u32 s25, s25, 0
    s_mov_b32 m0, s30
    s_add_u32 s30, s30, 1024
    global_load_lds_dwordx4 v28, s[24:25]
    s_add_u32 s24, s24, 0x8000
    s_addc_u32 s25, s25, 0
    s_waitcnt vmcnt(8)
    s_mov_b32 m0, s30
    s_add_u32 s30, s30, 1024
    global_load_lds_dwordx4 v27, s[24:25]
    s_add_u32 s24, s24, 0x8000
    s_addc_u32 s25, s25, 0
    s_mov_b32 m0, s30
    s_add_u32 s30, s30, 1024
    global_load_lds_dwordx4 v27, s[24:25]
    s_add_u32 s24, s24, 0x8000
    s_addc_u32 s25, s25, 0
    s_mov_b32 m0, s30
    s_add_u32 s30, s30, 1024
    global_load_lds_dwordx4 v28, s[24:25]
    s_add_u32 s24, s24, 0x8000
    s_addc_u32 s25, s25, 0
    s_mov_b32 m0, s30
    s_add_u32 s30, s30, 1024
    global_load_lds_dwordx4 v28, s[24:25]
    s_add_u32 s24, s24, 0x8000
    s_addc_u32 s25, s25, 0
    s_waitcnt vmcnt(8)
    s_mov_b32 m0, s30
    s_add_u32 s30, s30, 1024
    global_load_lds_dwordx4 v27, s[24:25]
    s_add_u32 s24, s24, 0x8000
    s_addc_u32 s25, s25, 0
    s_mov_b32 m0, s30
    s_add_u32 s30, s30, 1024
    global_load_lds_dwordx4 v27, s[24:25]
    s_add_u32 s24, s24, 0x8000
    s_addc_u32 s25, s25, 0
    s_mov_b32 m0, s30
    s_add_u32 s30, s30, 1024
    global_load_lds_dwordx4 v28, s[24:25]
    s_add_u32 s24, s24, 0x8000
    s_addc_u32 s25, s25, 0
    s_mov_b32 m0, s30
    s_add_u32 s30, s30, 1024
    global_load_lds_dwordx4 v28, s[24:25]
    s_add_u32 s24, s24, 0x8000
    s_addc_u32 s25, s25, 0
    v_lshl_add_u32 v24, v20, 3, v21
    v_and_b32 v25, 1, v20
    v_lshl_add_u32 v25, v25, 2, v21
    v_lshlrev_b32 v24, 8, v24
    v_lshl_add_u32 v24, v22, 3, v24
    s_lshl_b32 s21, s7, 2
    s_add_u32 s22, s21, 0
    v_xor_b32 v26, s22, v25
    v_lshl_add_u32 v8, v26, 5, v24
    v_add_u32 v12, 0x10000, v8
    s_add_u32 s22, s21, 1
    v_xor_b32 v26, s22, v25
    v_lshl_add_u32 v9, v26, 5, v24
    v_add_u32 v13, 0x10000, v9
    s_add_u32 s22, s21, 2
    v_xor_b32 v26, s22, v25
    v_lshl_add_u32 v10, v26, 5, v24
    v_add_u32 v14, 0x10000, v10
    s_add_u32 s22, s21, 3
    v_xor_b32 v26, s22, v25
    v_lshl_add_u32 v11, v26, 5, v24
    v_add_u32 v15, 0x10000, v11
    s_waitcnt vmcnt(0)
    s_barrier
    ds_read_b64_tr_b16 a[0:1], v8 offset:0
    ds_read_b64_tr_b16 a[2:3], v8 offset:1024
    ds_read_b64_tr_b16 a[4:5], v8 offset:8192
    ds_read_b64_tr_b16 a[6:7], v8 offset:9216
    ds_read_b64_tr_b16 a[8:9], v8 offset:16384
    ds_read_b64_tr_b16 a[10:11], v8 offset:17408
    ds_read_b64_tr_b16 a[12:13], v8 offset:24576
    ds_read_b64_tr_b16 a[14:15], v8 offset:25600
    ds_read_b64_tr_b16 a[16:17], v8 offset:32768
    ds_read_b64_tr_b16 a[18:19], v8 offset:33792
    ds_read_b64_tr_b16 a[20:21], v8 offset:40960
    ds_read_b64_tr_b16 a[22:23], v8 offset:41984
    s_waitcnt lgkmcnt(4)
    ds_read_b64_tr_b16 a[24:25], v8 offset:49152
    ds_read_b64_tr_b16 a[26:27], v8 offset:50176
    ds_read_b64_tr_b16 a[28:29], v8 offset:57344
    ds_read_b64_tr_b16 a[30:31], v8 offset:58368
    ds_read_b64_tr_b16 a[32:33], v12 offset:0
    ds_read_b64_tr_b16 a[34:35], v12 offset:1024
    ds_read_b64_tr_b16 a[36:37], v12 offset:8192
    ds_read_b64_tr_b16 a[38:39], v12 offset:9216
    ds_read_b64_tr_b16 a[40:41], v12 offset:16384
    ds_read_b64_tr_b16 a[42:43], v12 offset:17408
    ds_read_b64_tr_b16 a[44:45], v12 offset:24576
    ds_read_b64_tr_b16 a[46:47], v12 offset:25600
    s_waitcnt lgkmcnt(4)
    ds_read_b64_tr_b16 a[48:49], v12 offset:32768
    ds_read_b64_tr_b16 a[50:51], v12 offset:33792
    ds_read_b64_tr_b16 a[52:53], v12 offset:40960
    ds_read_b64_tr_b16 a[54:55], v12 offset:41984
    ds_read_b64_tr_b16 a[56:57], v12 offset:49152
    ds_read_b64_tr_b16 a[58:59], v12 offset:50176
    ds_read_b64_tr_b16 a[60:61], v12 offset:57344
    ds_read_b64_tr_b16 a[62:63], v12 offset:58368
    s_waitcnt lgkmcnt(0)
    ds_read_b64_tr_b16 a[64:65], v9 offset:0
    ds_read_b64_tr_b16 a[66:67], v9 offset:1024
    ds_read_b64_tr_b16 a[68:69], v9 offset:8192
    ds_read_b64_tr_b16 a[70:71], v9 offset:9216
    ds_read_b64_tr_b16 a[72:73], v9 offset:16384
    ds_read_b64_tr_b16 a[74:75], v9 offset:17408
    ds_read_b64_tr_b16 a[76:77], v9 offset:24576
    ds_read_b64_tr_b16 a[78:79], v9 offset:25600
    ds_read_b64_tr_b16 a[80:81], v9 offset:32768
    ds_read_b64_tr_b16 a[82:83], v9 offset:33792
    ds_read_b64_tr_b16 a[84:85], v9 offset:40960
    ds_read_b64_tr_b16 a[86:87], v9 offset:41984
    s_waitcnt lgkmcnt(4)
    ds_read_b64_tr_b16 a[88:89], v9 offset:49152
    ds_read_b64_tr_b16 a[90:91], v9 offset:50176
    ds_read_b64_tr_b16 a[92:93], v9 offset:57344
    ds_read_b64_tr_b16 a[94:95], v9 offset:58368
    ds_read_b64_tr_b16 a[96:97], v13 offset:0
    ds_read_b64_tr_b16 a[98:99], v13 offset:1024
    ds_read_b64_tr_b16 a[100:101], v13 offset:8192
    ds_read_b64_tr_b16 a[102:103], v13 offset:9216
    ds_read_b64_tr_b16 a[104:105], v13 offset:16384
    ds_read_b64_tr_b16 a[106:107], v13 offset:17408
    ds_read_b64_tr_b16 a[108:109], v13 offset:24576
    ds_read_b64_tr_b16 a[110:111], v13 offset:25600
    s_waitcnt lgkmcnt(4)
    ds_read_b64_tr_b16 a[112:113], v13 offset:32768
    ds_read_b64_tr_b16 a[114:115], v13 offset:33792
    ds_read_b64_tr_b16 a[116:117], v13 offset:40960
    ds_read_b64_tr_b16 a[118:119], v13 offset:41984
    ds_read_b64_tr_b16 a[120:121], v13 offset:49152
    ds_read_b64_tr_b16 a[122:123], v13 offset:50176
    ds_read_b64_tr_b16 a[124:125], v13 offset:57344
    ds_read_b64_tr_b16 a[126:127], v13 offset:58368
    s_waitcnt lgkmcnt(0)
    ds_read_b64_tr_b16 a[128:129], v10 offset:0
    ds_read_b64_tr_b16 a[130:131], v10 offset:1024
    ds_read_b64_tr_b16 a[132:133], v10 offset:8192
    ds_read_b64_tr_b16 a[134:135], v10 offset:9216
    ds_read_b64_tr_b16 a[136:137], v10 offset:16384
    ds_read_b64_tr_b16 a[138:139], v10 offset:17408
    ds_read_b64_tr_b16 a[140:141], v10 offset:24576
    ds_read_b64_tr_b16 a[142:143], v10 offset:25600
    ds_read_b64_tr_b16 a[144:145], v10 offset:32768
    ds_read_b64_tr_b16 a[146:147], v10 offset:33792
    ds_read_b64_tr_b16 a[148:149], v10 offset:40960
    ds_read_b64_tr_b16 a[150:151], v10 offset:41984
    s_waitcnt lgkmcnt(4)
    ds_read_b64_tr_b16 a[152:153], v10 offset:49152
    ds_read_b64_tr_b16 a[154:155], v10 offset:50176
    ds_read_b64_tr_b16 a[156:157], v10 offset:57344
    ds_read_b64_tr_b16 a[158:159], v10 offset:58368
    ds_read_b64_tr_b16 a[160:161], v14 offset:0
    ds_read_b64_tr_b16 a[162:163], v14 offset:1024
    ds_read_b64_tr_b16 a[164:165], v14 offset:8192
    ds_read_b64_tr_b16 a[166:167], v14 offset:9216
    ds_read_b64_tr_b16 a[168:169], v14 offset:16384
    ds_read_b64_tr_b16 a[170:171], v14 offset:17408
    ds_read_b64_tr_b16 a[172:173], v14 offset:24576
    ds_read_b64_tr_b16 a[174:175], v14 offset:25600
    s_waitcnt lgkmcnt(4)
    ds_read_b64_tr_b16 a[176:177], v14 offset:32768
    ds_read_b64_tr_b16 a[178:179], v14 offset:33792
    ds_read_b64_tr_b16 a[180:181], v14 offset:40960
    ds_read_b64_tr_b16 a[182:183], v14 offset:41984
    ds_read_b64_tr_b16 a[184:185], v14 offset:49152
    ds_read_b64_tr_b16 a[186:187], v14 offset:50176
    ds_read_b64_tr_b16 a[188:189], v14 offset:57344
    ds_read_b64_tr_b16 a[190:191], v14 offset:58368
    s_waitcnt lgkmcnt(0)
    ds_read_b64_tr_b16 a[192:193], v11 offset:0
    ds_read_b64_tr_b16 a[194:195], v11 offset:1024
    ds_read_b64_tr_b16 a[196:197], v11 offset:8192
    ds_read_b64_tr_b16 a[198:199], v11 offset:9216
    ds_read_b64_tr_b16 a[200:201], v11 offset:16384
    ds_read_b64_tr_b16 a[202:203], v11 offset:17408
    ds_read_b64_tr_b16 a[204:205], v11 offset:24576
    ds_read_b64_tr_b16 a[206:207], v11 offset:25600
    ds_read_b64_tr_b16 a[208:209], v11 offset:32768
    ds_read_b64_tr_b16 a[210:211], v11 offset:33792
    ds_read_b64_tr_b16 a[212:213], v11 offset:40960
    ds_read_b64_tr_b16 a[214:215], v11 offset:41984
    s_waitcnt lgkmcnt(4)
    ds_read_b64_tr_b16 a[216:217], v11 offset:49152
    ds_read_b64_tr_b16 a[218:219], v11 offset:50176
    ds_read_b64_tr_b16 a[220:221], v11 offset:57344
    ds_read_b64_tr_b16 a[222:223], v11 offset:58368
    ds_read_b64_tr_b16 a[224:225], v15 offset:0
    ds_read_b64_tr_b16 a[226:227], v15 offset:1024
    ds_read_b64_tr_b16 a[228:229], v15 offset:8192
    ds_read_b64_tr_b16 a[230:231], v15 offset:9216
    ds_read_b64_tr_b16 a[232:233], v15 offset:16384
    ds_read_b64_tr_b16 a[234:235], v15 offset:17408
    ds_read_b64_tr_b16 a[236:237], v15 offset:24576
    ds_read_b64_tr_b16 a[238:239], v15 offset:25600
    s_waitcnt lgkmcnt(4)
    ds_read_b64_tr_b16 a[240:241], v15 offset:32768
    ds_read_b64_tr_b16 a[242:243], v15 offset:33792
    ds_read_b64_tr_b16 a[244:245], v15 offset:40960
    ds_read_b64_tr_b16 a[246:247], v15 offset:41984
    ds_read_b64_tr_b16 a[248:249], v15 offset:49152
    ds_read_b64_tr_b16 a[250:251], v15 offset:50176
    ds_read_b64_tr_b16 a[252:253], v15 offset:57344
    ds_read_b64_tr_b16 a[254:255], v15 offset:58368
    s_waitcnt lgkmcnt(0)
    s_barrier
    s_lshl_b32 s21, s5, 17
    s_lshl_b32 s22, s6, 15
    s_add_u32 s21, s21, s22
    s_cmp_eq_u32 s4, 0
    s_cselect_b32 s24, s78, s86
    s_cselect_b32 s25, s79, s87
    s_add_u32 s24, s24, s21
    s_addc_u32 s25, s25, 0
    v_lshlrev_b32 v20, 7, v0
    global_load_dword v240, v20, s[24:25]
    s_add_u32 s24, s24, 0x2000
    s_addc_u32 s25, s25, 0
    global_load_dword v241, v20, s[24:25]
    s_add_u32 s24, s24, 0x2000
    s_addc_u32 s25, s25, 0
    global_load_dword v242, v20, s[24:25]
    s_add_u32 s24, s24, 0x2000
    s_addc_u32 s25, s25, 0
    global_load_dword v243, v20, s[24:25]
    s_add_u32 s24, s24, 0x2000
    s_addc_u32 s25, s25, 0
    s_lshl_b32 s21, s4, 5
    s_add_u32 s21, s21, s5
    s_lshl_b32 s21, s21, 2
    s_add_u32 s21, s21, s6
    s_lshl_b32 s22, s21, 13
    s_add_u32 s24, s34, s22
    s_addc_u32 s25, s35, 0
    v_lshlrev_b32 v20, 4, v0
    global_load_dwordx4 v[32:35], v20, s[32:33]
    global_load_dwordx4 v[36:39], v20, s[24:25] offset:0
    global_load_dwordx4 v[40:43], v20, s[24:25] offset:1024
    global_load_dwordx4 v[44:47], v20, s[24:25] offset:2048
    global_load_dwordx4 v[48:51], v20, s[24:25] offset:3072
    s_add_u32 s24, s24, 4096
    s_addc_u32 s25, s25, 0
    global_load_dwordx4 v[52:55], v20, s[24:25] offset:0
    global_load_dwordx4 v[56:59], v20, s[24:25] offset:1024
    global_load_dwordx4 v[60:63], v20, s[24:25] offset:2048
    global_load_dwordx4 v[64:67], v20, s[24:25] offset:3072
    s_waitcnt vmcnt(0)
    v_mov_b32 v94, 0
    v_lshlrev_b32 v72, 16, v32
    v_and_b32 v73, 0xffff0000, v32
    v_lshlrev_b32 v74, 16, v33
    v_and_b32 v75, 0xffff0000, v33
    v_lshlrev_b32 v76, 16, v34
    v_and_b32 v77, 0xffff0000, v34
    v_lshlrev_b32 v78, 16, v35
    v_and_b32 v79, 0xffff0000, v35
    v_lshlrev_b32 v90, 16, v36
    v_and_b32 v91, 0xffff0000, v36
    v_mul_f32 v90, v90, v72
    v_mul_f32 v91, v91, v73
    v_cvt_pk_bf16_f32 v92, v90, v91
    v_lshlrev_b32 v90, 16, v92
    v_and_b32 v91, 0xffff0000, v92
    v_add_f32 v80, v90, v91
    v_lshlrev_b32 v90, 16, v37
    v_and_b32 v91, 0xffff0000, v37
    v_mul_f32 v90, v90, v74
    v_mul_f32 v91, v91, v75
    v_cvt_pk_bf16_f32 v92, v90, v91
    v_lshlrev_b32 v90, 16, v92
    v_and_b32 v91, 0xffff0000, v92
    v_add_f32 v80, v80, v90
    v_add_f32 v80, v80, v91
    v_lshlrev_b32 v90, 16, v38
    v_and_b32 v91, 0xffff0000, v38
    v_mul_f32 v90, v90, v76
    v_mul_f32 v91, v91, v77
    v_cvt_pk_bf16_f32 v92, v90, v91
    v_lshlrev_b32 v90, 16, v92
    v_and_b32 v91, 0xffff0000, v92
    v_add_f32 v80, v80, v90
    v_add_f32 v80, v80, v91
    v_lshlrev_b32 v90, 16, v39
    v_and_b32 v91, 0xffff0000, v39
    v_mul_f32 v90, v90, v78
    v_mul_f32 v91, v91, v79
    v_cvt_pk_bf16_f32 v92, v90, v91
    v_lshlrev_b32 v90, 16, v92
    v_and_b32 v91, 0xffff0000, v92
    v_add_f32 v80, v80, v90
    v_add_f32 v80, v80, v91
    s_nop 1
    v_add_f32_dpp v80, v80, v80 row_shr:1 row_mask:0xf bank_mask:0xf bound_ctrl:0
    s_nop 1
    v_add_f32_dpp v80, v80, v80 row_shr:2 row_mask:0xf bank_mask:0xf bound_ctrl:0
    s_nop 1
    v_add_f32_dpp v80, v80, v80 row_shr:4 row_mask:0xf bank_mask:0xf bound_ctrl:0
    s_nop 1
    v_add_f32_dpp v80, v80, v80 row_shr:8 row_mask:0xf bank_mask:0xf bound_ctrl:0
    s_nop 0
    v_readlane_b32 s40, v80, 15
    v_readlane_b32 s41, v80, 31
    v_readlane_b32 s42, v80, 47
    v_readlane_b32 s43, v80, 63
    v_mov_b32 v93, s40
    v_add_f32 v93, s41, v93
    v_add_f32 v93, s42, v93
    v_add_f32 v93, s43, v93
    v_cvt_pk_bf16_f32 v93, v93, v93
    v_lshlrev_b32 v93, 16, v93
    v_mul_f32 v93, 0xbfb8aa3b, v93
    v_exp_f32 v93, v93
    s_nop 0
    v_add_f32 v93, 1.0, v93
    v_rcp_f32 v93, v93
    s_nop 0
    v_cvt_pk_bf16_f32 v93, v93, v93
    v_lshlrev_b32 v93, 16, v93
    v_cmp_eq_u32 vcc, 0, v0
    s_nop 1
    v_cndmask_b32 v94, v94, v93, vcc
    v_lshlrev_b32 v90, 16, v40
    v_and_b32 v91, 0xffff0000, v40
    v_mul_f32 v90, v90, v72
    v_mul_f32 v91, v91, v73
    v_cvt_pk_bf16_f32 v92, v90, v91
    v_lshlrev_b32 v90, 16, v92
    v_and_b32 v91, 0xffff0000, v92
    v_add_f32 v81, v90, v91
    v_lshlrev_b32 v90, 16, v41
    v_and_b32 v91, 0xffff0000, v41
    v_mul_f32 v90, v90, v74
    v_mul_f32 v91, v91, v75
    v_cvt_pk_bf16_f32 v92, v90, v91
    v_lshlrev_b32 v90, 16, v92
    v_and_b32 v91, 0xffff0000, v92
    v_add_f32 v81, v81, v90
    v_add_f32 v81, v81, v91
    v_lshlrev_b32 v90, 16, v42
    v_and_b32 v91, 0xffff0000, v42
    v_mul_f32 v90, v90, v76
    v_mul_f32 v91, v91, v77
    v_cvt_pk_bf16_f32 v92, v90, v91
    v_lshlrev_b32 v90, 16, v92
    v_and_b32 v91, 0xffff0000, v92
    v_add_f32 v81, v81, v90
    v_add_f32 v81, v81, v91
    v_lshlrev_b32 v90, 16, v43
    v_and_b32 v91, 0xffff0000, v43
    v_mul_f32 v90, v90, v78
    v_mul_f32 v91, v91, v79
    v_cvt_pk_bf16_f32 v92, v90, v91
    v_lshlrev_b32 v90, 16, v92
    v_and_b32 v91, 0xffff0000, v92
    v_add_f32 v81, v81, v90
    v_add_f32 v81, v81, v91
    s_nop 1
    v_add_f32_dpp v81, v81, v81 row_shr:1 row_mask:0xf bank_mask:0xf bound_ctrl:0
    s_nop 1
    v_add_f32_dpp v81, v81, v81 row_shr:2 row_mask:0xf bank_mask:0xf bound_ctrl:0
    s_nop 1
    v_add_f32_dpp v81, v81, v81 row_shr:4 row_mask:0xf bank_mask:0xf bound_ctrl:0
    s_nop 1
    v_add_f32_dpp v81, v81, v81 row_shr:8 row_mask:0xf bank_mask:0xf bound_ctrl:0
    s_nop 0
    v_readlane_b32 s40, v81, 15
    v_readlane_b32 s41, v81, 31
    v_readlane_b32 s42, v81, 47
    v_readlane_b32 s43, v81, 63
    v_mov_b32 v93, s40
    v_add_f32 v93, s41, v93
    v_add_f32 v93, s42, v93
    v_add_f32 v93, s43, v93
    v_cvt_pk_bf16_f32 v93, v93, v93
    v_lshlrev_b32 v93, 16, v93
    v_mul_f32 v93, 0xbfb8aa3b, v93
    v_exp_f32 v93, v93
    s_nop 0
    v_add_f32 v93, 1.0, v93
    v_rcp_f32 v93, v93
    s_nop 0
    v_cvt_pk_bf16_f32 v93, v93, v93
    v_lshlrev_b32 v93, 16, v93
    v_cmp_eq_u32 vcc, 1, v0
    s_nop 1
    v_cndmask_b32 v94, v94, v93, vcc
    v_lshlrev_b32 v90, 16, v44
    v_and_b32 v91, 0xffff0000, v44
    v_mul_f32 v90, v90, v72
    v_mul_f32 v91, v91, v73
    v_cvt_pk_bf16_f32 v92, v90, v91
    v_lshlrev_b32 v90, 16, v92
    v_and_b32 v91, 0xffff0000, v92
    v_add_f32 v82, v90, v91
    v_lshlrev_b32 v90, 16, v45
    v_and_b32 v91, 0xffff0000, v45
    v_mul_f32 v90, v90, v74
    v_mul_f32 v91, v91, v75
    v_cvt_pk_bf16_f32 v92, v90, v91
    v_lshlrev_b32 v90, 16, v92
    v_and_b32 v91, 0xffff0000, v92
    v_add_f32 v82, v82, v90
    v_add_f32 v82, v82, v91
    v_lshlrev_b32 v90, 16, v46
    v_and_b32 v91, 0xffff0000, v46
    v_mul_f32 v90, v90, v76
    v_mul_f32 v91, v91, v77
    v_cvt_pk_bf16_f32 v92, v90, v91
    v_lshlrev_b32 v90, 16, v92
    v_and_b32 v91, 0xffff0000, v92
    v_add_f32 v82, v82, v90
    v_add_f32 v82, v82, v91
    v_lshlrev_b32 v90, 16, v47
    v_and_b32 v91, 0xffff0000, v47
    v_mul_f32 v90, v90, v78
    v_mul_f32 v91, v91, v79
    v_cvt_pk_bf16_f32 v92, v90, v91
    v_lshlrev_b32 v90, 16, v92
    v_and_b32 v91, 0xffff0000, v92
    v_add_f32 v82, v82, v90
    v_add_f32 v82, v82, v91
    s_nop 1
    v_add_f32_dpp v82, v82, v82 row_shr:1 row_mask:0xf bank_mask:0xf bound_ctrl:0
    s_nop 1
    v_add_f32_dpp v82, v82, v82 row_shr:2 row_mask:0xf bank_mask:0xf bound_ctrl:0
    s_nop 1
    v_add_f32_dpp v82, v82, v82 row_shr:4 row_mask:0xf bank_mask:0xf bound_ctrl:0
    s_nop 1
    v_add_f32_dpp v82, v82, v82 row_shr:8 row_mask:0xf bank_mask:0xf bound_ctrl:0
    s_nop 0
    v_readlane_b32 s40, v82, 15
    v_readlane_b32 s41, v82, 31
    v_readlane_b32 s42, v82, 47
    v_readlane_b32 s43, v82, 63
    v_mov_b32 v93, s40
    v_add_f32 v93, s41, v93
    v_add_f32 v93, s42, v93
    v_add_f32 v93, s43, v93
    v_cvt_pk_bf16_f32 v93, v93, v93
    v_lshlrev_b32 v93, 16, v93
    v_mul_f32 v93, 0xbfb8aa3b, v93
    v_exp_f32 v93, v93
    s_nop 0
    v_add_f32 v93, 1.0, v93
    v_rcp_f32 v93, v93
    s_nop 0
    v_cvt_pk_bf16_f32 v93, v93, v93
    v_lshlrev_b32 v93, 16, v93
    v_cmp_eq_u32 vcc, 2, v0
    s_nop 1
    v_cndmask_b32 v94, v94, v93, vcc
    v_lshlrev_b32 v90, 16, v48
    v_and_b32 v91, 0xffff0000, v48
    v_mul_f32 v90, v90, v72
    v_mul_f32 v91, v91, v73
    v_cvt_pk_bf16_f32 v92, v90, v91
    v_lshlrev_b32 v90, 16, v92
    v_and_b32 v91, 0xffff0000, v92
    v_add_f32 v83, v90, v91
    v_lshlrev_b32 v90, 16, v49
    v_and_b32 v91, 0xffff0000, v49
    v_mul_f32 v90, v90, v74
    v_mul_f32 v91, v91, v75
    v_cvt_pk_bf16_f32 v92, v90, v91
    v_lshlrev_b32 v90, 16, v92
    v_and_b32 v91, 0xffff0000, v92
    v_add_f32 v83, v83, v90
    v_add_f32 v83, v83, v91
    v_lshlrev_b32 v90, 16, v50
    v_and_b32 v91, 0xffff0000, v50
    v_mul_f32 v90, v90, v76
    v_mul_f32 v91, v91, v77
    v_cvt_pk_bf16_f32 v92, v90, v91
    v_lshlrev_b32 v90, 16, v92
    v_and_b32 v91, 0xffff0000, v92
    v_add_f32 v83, v83, v90
    v_add_f32 v83, v83, v91
    v_lshlrev_b32 v90, 16, v51
    v_and_b32 v91, 0xffff0000, v51
    v_mul_f32 v90, v90, v78
    v_mul_f32 v91, v91, v79
    v_cvt_pk_bf16_f32 v92, v90, v91
    v_lshlrev_b32 v90, 16, v92
    v_and_b32 v91, 0xffff0000, v92
    v_add_f32 v83, v83, v90
    v_add_f32 v83, v83, v91
    s_nop 1
    v_add_f32_dpp v83, v83, v83 row_shr:1 row_mask:0xf bank_mask:0xf bound_ctrl:0
    s_nop 1
    v_add_f32_dpp v83, v83, v83 row_shr:2 row_mask:0xf bank_mask:0xf bound_ctrl:0
    s_nop 1
    v_add_f32_dpp v83, v83, v83 row_shr:4 row_mask:0xf bank_mask:0xf bound_ctrl:0
    s_nop 1
    v_add_f32_dpp v83, v83, v83 row_shr:8 row_mask:0xf bank_mask:0xf bound_ctrl:0
    s_nop 0
    v_readlane_b32 s40, v83, 15
    v_readlane_b32 s41, v83, 31
    v_readlane_b32 s42, v83, 47
    v_readlane_b32 s43, v83, 63
    v_mov_b32 v93, s40
    v_add_f32 v93, s41, v93
    v_add_f32 v93, s42, v93
    v_add_f32 v93, s43, v93
    v_cvt_pk_bf16_f32 v93, v93, v93
    v_lshlrev_b32 v93, 16, v93
    v_mul_f32 v93, 0xbfb8aa3b, v93
    v_exp_f32 v93, v93
    s_nop 0
    v_add_f32 v93, 1.0, v93
    v_rcp_f32 v93, v93
    s_nop 0
    v_cvt_pk_bf16_f32 v93, v93, v93
    v_lshlrev_b32 v93, 16, v93
    v_cmp_eq_u32 vcc, 3, v0
    s_nop 1
    v_cndmask_b32 v94, v94, v93, vcc
    v_lshlrev_b32 v90, 16, v52
    v_and_b32 v91, 0xffff0000, v52
    v_mul_f32 v90, v90, v72
    v_mul_f32 v91, v91, v73
    v_cvt_pk_bf16_f32 v92, v90, v91
    v_lshlrev_b32 v90, 16, v92
    v_and_b32 v91, 0xffff0000, v92
    v_add_f32 v84, v90, v91
    v_lshlrev_b32 v90, 16, v53
    v_and_b32 v91, 0xffff0000, v53
    v_mul_f32 v90, v90, v74
    v_mul_f32 v91, v91, v75
    v_cvt_pk_bf16_f32 v92, v90, v91
    v_lshlrev_b32 v90, 16, v92
    v_and_b32 v91, 0xffff0000, v92
    v_add_f32 v84, v84, v90
    v_add_f32 v84, v84, v91
    v_lshlrev_b32 v90, 16, v54
    v_and_b32 v91, 0xffff0000, v54
    v_mul_f32 v90, v90, v76
    v_mul_f32 v91, v91, v77
    v_cvt_pk_bf16_f32 v92, v90, v91
    v_lshlrev_b32 v90, 16, v92
    v_and_b32 v91, 0xffff0000, v92
    v_add_f32 v84, v84, v90
    v_add_f32 v84, v84, v91
    v_lshlrev_b32 v90, 16, v55
    v_and_b32 v91, 0xffff0000, v55
    v_mul_f32 v90, v90, v78
    v_mul_f32 v91, v91, v79
    v_cvt_pk_bf16_f32 v92, v90, v91
    v_lshlrev_b32 v90, 16, v92
    v_and_b32 v91, 0xffff0000, v92
    v_add_f32 v84, v84, v90
    v_add_f32 v84, v84, v91
    s_nop 1
    v_add_f32_dpp v84, v84, v84 row_shr:1 row_mask:0xf bank_mask:0xf bound_ctrl:0
    s_nop 1
    v_add_f32_dpp v84, v84, v84 row_shr:2 row_mask:0xf bank_mask:0xf bound_ctrl:0
    s_nop 1
    v_add_f32_dpp v84, v84, v84 row_shr:4 row_mask:0xf bank_mask:0xf bound_ctrl:0
    s_nop 1
    v_add_f32_dpp v84, v84, v84 row_shr:8 row_mask:0xf bank_mask:0xf bound_ctrl:0
    s_nop 0
    v_readlane_b32 s40, v84, 15
    v_readlane_b32 s41, v84, 31
    v_readlane_b32 s42, v84, 47
    v_readlane_b32 s43, v84, 63
    v_mov_b32 v93, s40
    v_add_f32 v93, s41, v93
    v_add_f32 v93, s42, v93
    v_add_f32 v93, s43, v93
    v_cvt_pk_bf16_f32 v93, v93, v93
    v_lshlrev_b32 v93, 16, v93
    v_mul_f32 v93, 0xbfb8aa3b, v93
    v_exp_f32 v93, v93
    s_nop 0
    v_add_f32 v93, 1.0, v93
    v_rcp_f32 v93, v93
    s_nop 0
    v_cvt_pk_bf16_f32 v93, v93, v93
    v_lshlrev_b32 v93, 16, v93
    v_cmp_eq_u32 vcc, 4, v0
    s_nop 1
    v_cndmask_b32 v94, v94, v93, vcc
    v_lshlrev_b32 v90, 16, v56
    v_and_b32 v91, 0xffff0000, v56
    v_mul_f32 v90, v90, v72
    v_mul_f32 v91, v91, v73
    v_cvt_pk_bf16_f32 v92, v90, v91
    v_lshlrev_b32 v90, 16, v92
    v_and_b32 v91, 0xffff0000, v92
    v_add_f32 v85, v90, v91
    v_lshlrev_b32 v90, 16, v57
    v_and_b32 v91, 0xffff0000, v57
    v_mul_f32 v90, v90, v74
    v_mul_f32 v91, v91, v75
    v_cvt_pk_bf16_f32 v92, v90, v91
    v_lshlrev_b32 v90, 16, v92
    v_and_b32 v91, 0xffff0000, v92
    v_add_f32 v85, v85, v90
    v_add_f32 v85, v85, v91
    v_lshlrev_b32 v90, 16, v58
    v_and_b32 v91, 0xffff0000, v58
    v_mul_f32 v90, v90, v76
    v_mul_f32 v91, v91, v77
    v_cvt_pk_bf16_f32 v92, v90, v91
    v_lshlrev_b32 v90, 16, v92
    v_and_b32 v91, 0xffff0000, v92
    v_add_f32 v85, v85, v90
    v_add_f32 v85, v85, v91
    v_lshlrev_b32 v90, 16, v59
    v_and_b32 v91, 0xffff0000, v59
    v_mul_f32 v90, v90, v78
    v_mul_f32 v91, v91, v79
    v_cvt_pk_bf16_f32 v92, v90, v91
    v_lshlrev_b32 v90, 16, v92
    v_and_b32 v91, 0xffff0000, v92
    v_add_f32 v85, v85, v90
    v_add_f32 v85, v85, v91
    s_nop 1
    v_add_f32_dpp v85, v85, v85 row_shr:1 row_mask:0xf bank_mask:0xf bound_ctrl:0
    s_nop 1
    v_add_f32_dpp v85, v85, v85 row_shr:2 row_mask:0xf bank_mask:0xf bound_ctrl:0
    s_nop 1
    v_add_f32_dpp v85, v85, v85 row_shr:4 row_mask:0xf bank_mask:0xf bound_ctrl:0
    s_nop 1
    v_add_f32_dpp v85, v85, v85 row_shr:8 row_mask:0xf bank_mask:0xf bound_ctrl:0
    s_nop 0
    v_readlane_b32 s40, v85, 15
    v_readlane_b32 s41, v85, 31
    v_readlane_b32 s42, v85, 47
    v_readlane_b32 s43, v85, 63
    v_mov_b32 v93, s40
    v_add_f32 v93, s41, v93
    v_add_f32 v93, s42, v93
    v_add_f32 v93, s43, v93
    v_cvt_pk_bf16_f32 v93, v93, v93
    v_lshlrev_b32 v93, 16, v93
    v_mul_f32 v93, 0xbfb8aa3b, v93
    v_exp_f32 v93, v93
    s_nop 0
    v_add_f32 v93, 1.0, v93
    v_rcp_f32 v93, v93
    s_nop 0
    v_cvt_pk_bf16_f32 v93, v93, v93
    v_lshlrev_b32 v93, 16, v93
    v_cmp_eq_u32 vcc, 5, v0
    s_nop 1
    v_cndmask_b32 v94, v94, v93, vcc
    v_lshlrev_b32 v90, 16, v60
    v_and_b32 v91, 0xffff0000, v60
    v_mul_f32 v90, v90, v72
    v_mul_f32 v91, v91, v73
    v_cvt_pk_bf16_f32 v92, v90, v91
    v_lshlrev_b32 v90, 16, v92
    v_and_b32 v91, 0xffff0000, v92
    v_add_f32 v86, v90, v91
    v_lshlrev_b32 v90, 16, v61
    v_and_b32 v91, 0xffff0000, v61
    v_mul_f32 v90, v90, v74
    v_mul_f32 v91, v91, v75
    v_cvt_pk_bf16_f32 v92, v90, v91
    v_lshlrev_b32 v90, 16, v92
    v_and_b32 v91, 0xffff0000, v92
    v_add_f32 v86, v86, v90
    v_add_f32 v86, v86, v91
    v_lshlrev_b32 v90, 16, v62
    v_and_b32 v91, 0xffff0000, v62
    v_mul_f32 v90, v90, v76
    v_mul_f32 v91, v91, v77
    v_cvt_pk_bf16_f32 v92, v90, v91
    v_lshlrev_b32 v90, 16, v92
    v_and_b32 v91, 0xffff0000, v92
    v_add_f32 v86, v86, v90
    v_add_f32 v86, v86, v91
    v_lshlrev_b32 v90, 16, v63
    v_and_b32 v91, 0xffff0000, v63
    v_mul_f32 v90, v90, v78
    v_mul_f32 v91, v91, v79
    v_cvt_pk_bf16_f32 v92, v90, v91
    v_lshlrev_b32 v90, 16, v92
    v_and_b32 v91, 0xffff0000, v92
    v_add_f32 v86, v86, v90
    v_add_f32 v86, v86, v91
    s_nop 1
    v_add_f32_dpp v86, v86, v86 row_shr:1 row_mask:0xf bank_mask:0xf bound_ctrl:0
    s_nop 1
    v_add_f32_dpp v86, v86, v86 row_shr:2 row_mask:0xf bank_mask:0xf bound_ctrl:0
    s_nop 1
    v_add_f32_dpp v86, v86, v86 row_shr:4 row_mask:0xf bank_mask:0xf bound_ctrl:0
    s_nop 1
    v_add_f32_dpp v86, v86, v86 row_shr:8 row_mask:0xf bank_mask:0xf bound_ctrl:0
    s_nop 0
    v_readlane_b32 s40, v86, 15
    v_readlane_b32 s41, v86, 31
    v_readlane_b32 s42, v86, 47
    v_readlane_b32 s43, v86, 63
    v_mov_b32 v93, s40
    v_add_f32 v93, s41, v93
    v_add_f32 v93, s42, v93
    v_add_f32 v93, s43, v93
    v_cvt_pk_bf16_f32 v93, v93, v93
    v_lshlrev_b32 v93, 16, v93
    v_mul_f32 v93, 0xbfb8aa3b, v93
    v_exp_f32 v93, v93
    s_nop 0
    v_add_f32 v93, 1.0, v93
    v_rcp_f32 v93, v93
    s_nop 0
    v_cvt_pk_bf16_f32 v93, v93, v93
    v_lshlrev_b32 v93, 16, v93
    v_cmp_eq_u32 vcc, 6, v0
    s_nop 1
    v_cndmask_b32 v94, v94, v93, vcc
    v_lshlrev_b32 v90, 16, v64
    v_and_b32 v91, 0xffff0000, v64
    v_mul_f32 v90, v90, v72
    v_mul_f32 v91, v91, v73
    v_cvt_pk_bf16_f32 v92, v90, v91
    v_lshlrev_b32 v90, 16, v92
    v_and_b32 v91, 0xffff0000, v92
    v_add_f32 v87, v90, v91
    v_lshlrev_b32 v90, 16, v65
    v_and_b32 v91, 0xffff0000, v65
    v_mul_f32 v90, v90, v74
    v_mul_f32 v91, v91, v75
    v_cvt_pk_bf16_f32 v92, v90, v91
    v_lshlrev_b32 v90, 16, v92
    v_and_b32 v91, 0xffff0000, v92
    v_add_f32 v87, v87, v90
    v_add_f32 v87, v87, v91
    v_lshlrev_b32 v90, 16, v66
    v_and_b32 v91, 0xffff0000, v66
    v_mul_f32 v90, v90, v76
    v_mul_f32 v91, v91, v77
    v_cvt_pk_bf16_f32 v92, v90, v91
    v_lshlrev_b32 v90, 16, v92
    v_and_b32 v91, 0xffff0000, v92
    v_add_f32 v87, v87, v90
    v_add_f32 v87, v87, v91
    v_lshlrev_b32 v90, 16, v67
    v_and_b32 v91, 0xffff0000, v67
    v_mul_f32 v90, v90, v78
    v_mul_f32 v91, v91, v79
    v_cvt_pk_bf16_f32 v92, v90, v91
    v_lshlrev_b32 v90, 16, v92
    v_and_b32 v91, 0xffff0000, v92
    v_add_f32 v87, v87, v90
    v_add_f32 v87, v87, v91
    s_nop 1
    v_add_f32_dpp v87, v87, v87 row_shr:1 row_mask:0xf bank_mask:0xf bound_ctrl:0
    s_nop 1
    v_add_f32_dpp v87, v87, v87 row_shr:2 row_mask:0xf bank_mask:0xf bound_ctrl:0
    s_nop 1
    v_add_f32_dpp v87, v87, v87 row_shr:4 row_mask:0xf bank_mask:0xf bound_ctrl:0
    s_nop 1
    v_add_f32_dpp v87, v87, v87 row_shr:8 row_mask:0xf bank_mask:0xf bound_ctrl:0
    s_nop 0
    v_readlane_b32 s40, v87, 15
    v_readlane_b32 s41, v87, 31
    v_readlane_b32 s42, v87, 47
    v_readlane_b32 s43, v87, 63
    v_mov_b32 v93, s40
    v_add_f32 v93, s41, v93
    v_add_f32 v93, s42, v93
    v_add_f32 v93, s43, v93
    v_cvt_pk_bf16_f32 v93, v93, v93
    v_lshlrev_b32 v93, 16, v93
    v_mul_f32 v93, 0xbfb8aa3b, v93
    v_exp_f32 v93, v93
    s_nop 0
    v_add_f32 v93, 1.0, v93
    v_rcp_f32 v93, v93
    s_nop 0
    v_cvt_pk_bf16_f32 v93, v93, v93
    v_lshlrev_b32 v93, 16, v93
    v_cmp_eq_u32 vcc, 7, v0
    s_nop 1
    v_cndmask_b32 v94, v94, v93, vcc
    s_lshl_b32 s22, s21, 5
    s_add_u32 s22, s22, 0x5220000
    s_add_u32 s24, s18, s22
    s_addc_u32 s25, s19, 0
    v_lshlrev_b32 v20, 2, v0
    s_mov_b64 exec, 0xff
    global_store_dword v20, v94, s[24:25] sc1
    s_mov_b64 exec, -1
    v_mov_b32 v20, 0
    s_mov_b32 s28, 0
LWA_64:
    global_load_dword v21, v20, s[38:39] sc1
    s_waitcnt vmcnt(0)
    v_readfirstlane_b32 s21, v21
    s_cmp_ge_u32 s21, 256
    s_cbranch_scc1 LWAOK_65
    s_sleep 4
    s_add_u32 s28, s28, 1
    s_cmp_lt_u32 s28, 0x40000
    s_cbranch_scc1 LWA_64
    s_branch L_fail
LWAOK_65:
    v_lshlrev_b32 v1, 4, v0
    v_lshrrev_b32 v20, 3, v0
    v_and_b32 v21, 7, v0
    v_and_b32 v22, 6, v20
    v_xor_b32 v21, v21, v22
    v_lshlrev_b32 v21, 4, v21
    v_lshl_add_u32 v2, v20, 10, v21
    v_and_b32 v20, 15, v0
    v_lshrrev_b32 v21, 3, v20
    v_lshlrev_b32 v21, 13, v21
    v_and_b32 v22, 7, v20
    v_and_b32 v23, 6, v22
    v_lshrrev_b32 v24, 4, v0
    v_xor_b32 v23, v24, v23
    v_lshl_add_u32 v23, v22, 3, v23
    v_lshl_add_u32 v21, v23, 4, v21
    s_lshl_b32 s21, s3, 15
    v_add_u32 v4, s21, v21
    v_xor_b32 v5, 64, v4
    v_add_u32 v6, 0x10000, v4
    v_add_u32 v7, 0x10000, v5
    s_mov_b32 s26, s34
    s_mov_b32 s27, s35
    s_lshl_b32 s21, s4, 6
    s_add_u32 s21, s21, s3
    s_lshl_b32 s21, s21, 5
    s_add_u32 s21, s21, s5
    s_lshl_b32 s22, s21, 13
    s_add_u32 s58, s18, s22
    s_addc_u32 s59, s19, 0
    s_add_u32 s22, s22, 0x2000000
    s_add_u32 s60, s18, s22
    s_addc_u32 s61, s19, 0
    s_lshl_b32 s22, s21, 12
    s_add_u32 s22, s22, 0x4200000
    s_add_u32 s62, s18, s22
    s_addc_u32 s63, s19, 0
    s_lshl_b32 s21, s4, 24
    s_lshl_b32 s22, s6, 17
    s_add_u32 s21, s21, s22
    s_lshl_b32 s22, s5, 12
    s_add_u32 s21, s21, s22
    s_add_u32 s21, s21, 0x5400000
    s_add_u32 s64, s18, s21
    s_addc_u32 s65, s19, 0
    s_lshl_b32 s21, s3, 13
    s_lshl_b32 s22, s7, 11
    s_add_u32 s21, s21, s22
    s_add_u32 s21, s21, 131072
    v_add_u32 v16, s21, v1
    s_lshl_b32 s21, s6, 12
    s_add_u32 s21, s21, 131072
    v_add_u32 v17, s21, v1
    v_and_b32 v20, 15, v0
    v_lshrrev_b32 v21, 4, v0
    v_lshlrev_b32 v22, 5, v20
    v_lshl_add_u32 v22, v21, 3, v22
    s_lshl_b32 s21, s3, 12
    s_lshl_b32 s22, s7, 11
    s_add_u32 s22, s22, s21
    s_add_u32 s22, s22, 147456
    v_add_u32 v18, s22, v22
    v_lshrrev_b32 v22, 2, v20
    v_lshl_add_u32 v22, v21, 2, v22
    v_lshlrev_b32 v22, 5, v22
    v_and_b32 v23, 3, v20
    v_lshl_add_u32 v22, v23, 3, v22
    s_add_u32 s21, s21, 147456
    v_add_u32 v19, s21, v22
    v_lshl_add_u32 v22, v21, 2, 0
    v_cmp_le_u32 s[40:41], v22, v20
    v_lshl_add_u32 v22, v21, 2, 1
    v_cmp_le_u32 s[42:43], v22, v20
    v_lshl_add_u32 v22, v21, 2, 2
    v_cmp_le_u32 s[44:45], v22, v20
    v_lshl_add_u32 v22, v21, 2, 3
    v_cmp_le_u32 s[46:47], v22, v20
    s_nop 4
    s_cmp_eq_u32 s7, 0
    s_cselect_b64 s[48:49], 0, s[40:41]
    s_cselect_b64 s[40:41], s[40:41], -1
    s_cselect_b64 s[50:51], 0, s[42:43]
    s_cselect_b64 s[42:43], s[42:43], -1
    s_cselect_b64 s[52:53], 0, s[44:45]
    s_cselect_b64 s[44:45], s[44:45], -1
    s_cselect_b64 s[54:55], 0, s[46:47]
    s_cselect_b64 s[46:47], s[46:47], -1
    s_mov_b32 s56, 0x3e0293ee
    v_mov_b32 v24, 0
    v_mov_b32 v25, 0
    v_mov_b32 v26, 0
    v_mov_b32 v27, 0
    s_lshl_b32 s21, s6, 11
    s_add_u32 s21, s21, 147456
    v_add_u32 v22, s21, v1
    ds_write_b128 v22, v[24:27]
    ds_write_b128 v22, v[24:27] offset:1024
    v_and_b32 v29, 3, v0
    v_lshlrev_b32 v29, 13, v29
    v_mov_b32 v249, 0
    v_mov_b32 v241, 0
    v_mov_b32 v247, 0xff800000
    s_mov_b32 s20, 0
    s_lshl_b32 s21, s6, 14
    s_add_u32 s21, s21, 0
    s_add_u32 s24, s26, s21
    s_addc_u32 s25, s27, 0
    s_add_u32 s30, s21, 0
    s_add_u32 m0, s30, 0
    s_nop 0
    global_load_lds_dwordx4 v2, s[24:25] offset:0
    s_add_u32 m0, s30, 896
    s_nop 0
    global_load_lds_dwordx4 v2, s[24:25] offset:128
    s_add_u32 m0, s30, 1792
    s_nop 0
    global_load_lds_dwordx4 v2, s[24:25] offset:256
    s_add_u32 m0, s30, 2688
    s_nop 0
    global_load_lds_dwordx4 v2, s[24:25] offset:384
    s_add_u32 m0, s30, 3584
    s_nop 0
    global_load_lds_dwordx4 v2, s[24:25] offset:512
    s_add_u32 m0, s30, 4480
    s_nop 0
    global_load_lds_dwordx4 v2, s[24:25] offset:640
    s_add_u32 m0, s30, 5376
    s_nop 0
    global_load_lds_dwordx4 v2, s[24:25] offset:768
    s_add_u32 m0, s30, 6272
    s_nop 0
    global_load_lds_dwordx4 v2, s[24:25] offset:896
    s_lshl_b32 s21, s6, 14
    s_add_u32 s21, s21, 8192
    s_add_u32 s24, s26, s21
    s_addc_u32 s25, s27, 0
    s_add_u32 s30, s21, 0
    s_add_u32 m0, s30, 0
    s_nop 0
    global_load_lds_dwordx4 v2, s[24:25] offset:0
    s_add_u32 m0, s30, 896
    s_nop 0
    global_load_lds_dwordx4 v2, s[24:25] offset:128
    s_add_u32 m0, s30, 1792
    s_nop 0
    global_load_lds_dwordx4 v2, s[24:25] offset:256
    s_add_u32 m0, s30, 2688
    s_nop 0
    global_load_lds_dwordx4 v2, s[24:25] offset:384
    s_add_u32 m0, s30, 3584
    s_nop 0
    global_load_lds_dwordx4 v2, s[24:25] offset:512
    s_add_u32 m0, s30, 4480
    s_nop 0
    global_load_lds_dwordx4 v2, s[24:25] offset:640
    s_add_u32 m0, s30, 5376
    s_nop 0
    global_load_lds_dwordx4 v2, s[24:25] offset:768
    s_add_u32 m0, s30, 6272
    s_nop 0
    global_load_lds_dwordx4 v2, s[24:25] offset:896
L_Q_loop:
    s_waitcnt vmcnt(0) lgkmcnt(0)
    s_barrier
    s_cmp_ge_u32 s20, 1
    s_cbranch_scc0 LNP_66
    s_cmp_eq_u32 s6, 0
    s_cbranch_scc0 LPUB_67
    v_mov_b32 v8, s20
    v_mov_b32 v9, 0
    s_mov_b64 exec, 1
    global_store_dword v9, v8, s[14:15] sc1
    s_mov_b64 exec, -1
LPUB_67:
LNP_66:
    s_add_u32 s26, s26, 0x10000
    s_addc_u32 s27, s27, 0
    global_load_dword v28, v29, s[66:67] sc1
    s_add_u32 s23, s20, 1
    s_cmp_lt_u32 s23, 32
    s_cbranch_scc0 LND_68
    ds_read_b128 v[96:99], v4 offset:0
    ds_read_b128 v[100:103], v4 offset:16384
    ds_read_b128 v[104:107], v5 offset:0
    ds_read_b128 v[108:111], v5 offset:16384
    s_waitcnt lgkmcnt(2)
    v_mfma_f32_16x16x32_bf16 v[128:131], a[0:3], v[96:99], 0
    v_mfma_f32_16x16x32_bf16 v[136:139], a[64:67], v[96:99], 0
    s_lshl_b32 s21, s6, 14
    s_add_u32 s21, s21, 0
    s_add_u32 s24, s26, s21
    s_addc_u32 s25, s27, 0
    s_add_u32 s30, s21, 65536
    s_add_u32 m0, s30, 0
    s_nop 0
    global_load_lds_dwordx4 v2, s[24:25] offset:0
    v_mfma_f32_16x16x32_bf16 v[144:147], a[128:131], v[96:99], 0
    v_mfma_f32_16x16x32_bf16 v[152:155], a[192:195], v[96:99], 0
    v_mfma_f32_16x16x32_bf16 v[132:135], a[0:3], v[100:103], 0
    v_mfma_f32_16x16x32_bf16 v[140:143], a[64:67], v[100:103], 0
    v_mfma_f32_16x16x32_bf16 v[148:151], a[128:131], v[100:103], 0
    v_mfma_f32_16x16x32_bf16 v[156:159], a[192:195], v[100:103], 0
    ds_read_b128 v[96:99], v4 offset:1024
    ds_read_b128 v[100:103], v4 offset:17408
    s_waitcnt lgkmcnt(2)
    v_mfma_f32_16x16x32_bf16 v[128:131], a[4:7], v[104:107], v[128:131]
    v_mfma_f32_16x16x32_bf16 v[136:139], a[68:71], v[104:107], v[136:139]
    s_add_u32 m0, s30, 896
    s_nop 0
    global_load_lds_dwordx4 v2, s[24:25] offset:128
    v_mfma_f32_16x16x32_bf16 v[144:147], a[132:135], v[104:107], v[144:147]
    v_mfma_f32_16x16x32_bf16 v[152:155], a[196:199], v[104:107], v[152:155]
    v_mfma_f32_16x16x32_bf16 v[132:135], a[4:7], v[108:111], v[132:135]
    v_mfma_f32_16x16x32_bf16 v[140:143], a[68:71], v[108:111], v[140:143]
    v_mfma_f32_16x16x32_bf16 v[148:151], a[132:135], v[108:111], v[148:151]
    v_mfma_f32_16x16x32_bf16 v[156:159], a[196:199], v[108:111], v[156:159]
    ds_read_b128 v[104:107], v5 offset:1024
    ds_read_b128 v[108:111], v5 offset:17408
    s_waitcnt lgkmcnt(2)
    v_mfma_f32_16x16x32_bf16 v[128:131], a[8:11], v[96:99], v[128:131]
    v_mfma_f32_16x16x32_bf16 v[136:139], a[72:75], v[96:99], v[136:139]
    s_add_u32 m0, s30, 1792
    s_nop 0
    global_load_lds_dwordx4 v2, s[24:25] offset:256
    v_mfma_f32_16x16x32_bf16 v[144:147], a[136:139], v[96:99], v[144:147]
    v_mfma_f32_16x16x32_bf16 v[152:155], a[200:203], v[96:99], v[152:155]
    v_mfma_f32_16x16x32_bf16 v[132:135], a[8:11], v[100:103], v[132:135]
    v_mfma_f32_16x16x32_bf16 v[140:143], a[72:75], v[100:103], v[140:143]
    v_mfma_f32_16x16x32_bf16 v[148:151], a[136:139], v[100:103], v[148:151]
    v_mfma_f32_16x16x32_bf16 v[156:159], a[200:203], v[100:103], v[156:159]
    ds_read_b128 v[96:99], v4 offset:2048
    ds_read_b128 v[100:103], v4 offset:18432
    s_waitcnt lgkmcnt(2)
    v_mfma_f32_16x16x32_bf16 v[128:131], a[12:15], v[104:107], v[128:131]
    v_mfma_f32_16x16x32_bf16 v[136:139], a[76:79], v[104:107], v[136:139]
    s_add_u32 m0, s30, 2688
    s_nop 0
    global_load_lds_dwordx4 v2, s[24:25] offset:384
    v_mfma_f32_16x16x32_bf16 v[144:147], a[140:143], v[104:107], v[144:147]
    v_mfma_f32_16x16x32_bf16 v[152:155], a[204:207], v[104:107], v[152:155]
    v_mfma_f32_16x16x32_bf16 v[132:135], a[12:15], v[108:111], v[132:135]
    v_mfma_f32_16x16x32_bf16 v[140:143], a[76:79], v[108:111], v[140:143]
    v_mfma_f32_16x16x32_bf16 v[148:151], a[140:143], v[108:111], v[148:151]
    v_mfma_f32_16x16x32_bf16 v[156:159], a[204:207], v[108:111], v[156:159]
    ds_read_b128 v[104:107], v5 offset:2048
    ds_read_b128 v[108:111], v5 offset:18432
    s_waitcnt lgkmcnt(2)
    v_mfma_f32_16x16x32_bf16 v[128:131], a[16:19], v[96:99], v[128:131]
    v_mfma_f32_16x16x32_bf16 v[136:139], a[80:83], v[96:99], v[136:139]
    s_add_u32 m0, s30, 3584
    s_nop 0
    global_load_lds_dwordx4 v2, s[24:25] offset:512
    v_mfma_f32_16x16x32_bf16 v[144:147], a[144:147], v[96:99], v[144:147]
    v_mfma_f32_16x16x32_bf16 v[152:155], a[208:211], v[96:99], v[152:155]
    v_mfma_f32_16x16x32_bf16 v[132:135], a[16:19], v[100:103], v[132:135]
    v_mfma_f32_16x16x32_bf16 v[140:143], a[80:83], v[100:103], v[140:143]
    v_mfma_f32_16x16x32_bf16 v[148:151], a[144:147], v[100:103], v[148:151]
    v_mfma_f32_16x16x32_bf16 v[156:159], a[208:211], v[100:103], v[156:159]
    ds_read_b128 v[96:99], v4 offset:3072
    ds_read_b128 v[100:103], v4 offset:19456
    s_waitcnt lgkmcnt(2)
    v_mfma_f32_16x16x32_bf16 v[128:131], a[20:23], v[104:107], v[128:131]
    v_mfma_f32_16x16x32_bf16 v[136:139], a[84:87], v[104:107], v[136:139]
    s_add_u32 m0, s30, 4480
    s_nop 0
    global_load_lds_dwordx4 v2, s[24:25] offset:640
    v_mfma_f32_16x16x32_bf16 v[144:147], a[148:151], v[104:107], v[144:147]
    v_mfma_f32_16x16x32_bf16 v[152:155], a[212:215], v[104:107], v[152:155]
    v_mfma_f32_16x16x32_bf16 v[132:135], a[20:23], v[108:111], v[132:135]
    v_mfma_f32_16x16x32_bf16 v[140:143], a[84:87], v[108:111], v[140:143]
    v_mfma_f32_16x16x32_bf16 v[148:151], a[148:151], v[108:111], v[148:151]
    v_mfma_f32_16x16x32_bf16 v[156:159], a[212:215], v[108:111], v[156:159]
    ds_read_b128 v[104:107], v5 offset:3072
    ds_read_b128 v[108:111], v5 offset:19456
    s_waitcnt lgkmcnt(2)
    v_mfma_f32_16x16x32_bf16 v[128:131], a[24:27], v[96:99], v[128:131]
    v_mfma_f32_16x16x32_bf16 v[136:139], a[88:91], v[96:99], v[136:139]
    s_add_u32 m0, s30, 5376
    s_nop 0
    global_load_lds_dwordx4 v2, s[24:25] offset:768
    v_mfma_f32_16x16x32_bf16 v[144:147], a[152:155], v[96:99], v[144:147]
    v_mfma_f32_16x16x32_bf16 v[152:155], a[216:219], v[96:99], v[152:155]
    v_mfma_f32_16x16x32_bf16 v[132:135], a[24:27], v[100:103], v[132:135]
    v_mfma_f32_16x16x32_bf16 v[140:143], a[88:91], v[100:103], v[140:143]
    v_mfma_f32_16x16x32_bf16 v[148:151], a[152:155], v[100:103], v[148:151]
    v_mfma_f32_16x16x32_bf16 v[156:159], a[216:219], v[100:103], v[156:159]
    ds_read_b128 v[96:99], v4 offset:4096
    ds_read_b128 v[100:103], v4 offset:20480
    s_waitcnt lgkmcnt(2)
    v_mfma_f32_16x16x32_bf16 v[128:131], a[28:31], v[104:107], v[128:131]
    v_mfma_f32_16x16x32_bf16 v[136:139], a[92:95], v[104:107], v[136:139]
    s_add_u32 m0, s30, 6272
    s_nop 0
    global_load_lds_dwordx4 v2, s[24:25] offset:896
    v_mfma_f32_16x16x32_bf16 v[144:147], a[156:159], v[104:107], v[144:147]
    v_mfma_f32_16x16x32_bf16 v[152:155], a[220:223], v[104:107], v[152:155]
    v_mfma_f32_16x16x32_bf16 v[132:135], a[28:31], v[108:111], v[132:135]
    v_mfma_f32_16x16x32_bf16 v[140:143], a[92:95], v[108:111], v[140:143]
    v_mfma_f32_16x16x32_bf16 v[148:151], a[156:159], v[108:111], v[148:151]
    v_mfma_f32_16x16x32_bf16 v[156:159], a[220:223], v[108:111], v[156:159]
    ds_read_b128 v[104:107], v5 offset:4096
    ds_read_b128 v[108:111], v5 offset:20480
    s_waitcnt lgkmcnt(2)
    v_mfma_f32_16x16x32_bf16 v[128:131], a[32:35], v[96:99], v[128:131]
    v_mfma_f32_16x16x32_bf16 v[136:139], a[96:99], v[96:99], v[136:139]
    s_lshl_b32 s21, s6, 14
    s_add_u32 s21, s21, 8192
    s_add_u32 s24, s26, s21
    s_addc_u32 s25, s27, 0
    s_add_u32 s30, s21, 65536
    s_add_u32 m0, s30, 0
    s_nop 0
    global_load_lds_dwordx4 v2, s[24:25] offset:0
    v_mfma_f32_16x16x32_bf16 v[144:147], a[160:163], v[96:99], v[144:147]
    v_mfma_f32_16x16x32_bf16 v[152:155], a[224:227], v[96:99], v[152:155]
    v_mfma_f32_16x16x32_bf16 v[132:135], a[32:35], v[100:103], v[132:135]
    v_mfma_f32_16x16x32_bf16 v[140:143], a[96:99], v[100:103], v[140:143]
    v_mfma_f32_16x16x32_bf16 v[148:151], a[160:163], v[100:103], v[148:151]
    v_mfma_f32_16x16x32_bf16 v[156:159], a[224:227], v[100:103], v[156:159]
    ds_read_b128 v[96:99], v4 offset:5120
    ds_read_b128 v[100:103], v4 offset:21504
    s_waitcnt lgkmcnt(2)
    v_mfma_f32_16x16x32_bf16 v[128:131], a[36:39], v[104:107], v[128:131]
    v_mfma_f32_16x16x32_bf16 v[136:139], a[100:103], v[104:107], v[136:139]
    s_add_u32 m0, s30, 896
    s_nop 0
    global_load_lds_dwordx4 v2, s[24:25] offset:128
    v_mfma_f32_16x16x32_bf16 v[144:147], a[164:167], v[104:107], v[144:147]
    v_mfma_f32_16x16x32_bf16 v[152:155], a[228:231], v[104:107], v[152:155]
    v_mfma_f32_16x16x32_bf16 v[132:135], a[36:39], v[108:111], v[132:135]
    v_mfma_f32_16x16x32_bf16 v[140:143], a[100:103], v[108:111], v[140:143]
    v_mfma_f32_16x16x32_bf16 v[148:151], a[164:167], v[108:111], v[148:151]
    v_mfma_f32_16x16x32_bf16 v[156:159], a[228:231], v[108:111], v[156:159]
    ds_read_b128 v[104:107], v5 offset:5120
    ds_read_b128 v[108:111], v5 offset:21504
    s_waitcnt lgkmcnt(2)
    v_mfma_f32_16x16x32_bf16 v[128:131], a[40:43], v[96:99], v[128:131]
    v_mfma_f32_16x16x32_bf16 v[136:139], a[104:107], v[96:99], v[136:139]
    s_add_u32 m0, s30, 1792
    s_nop 0
    global_load_lds_dwordx4 v2, s[24:25] offset:256
    v_mfma_f32_16x16x32_bf16 v[144:147], a[168:171], v[96:99], v[144:147]
    v_mfma_f32_16x16x32_bf16 v[152:155], a[232:235], v[96:99], v[152:155]
    v_mfma_f32_16x16x32_bf16 v[132:135], a[40:43], v[100:103], v[132:135]
    v_mfma_f32_16x16x32_bf16 v[140:143], a[104:107], v[100:103], v[140:143]
    v_mfma_f32_16x16x32_bf16 v[148:151], a[168:171], v[100:103], v[148:151]
    v_mfma_f32_16x16x32_bf16 v[156:159], a[232:235], v[100:103], v[156:159]
    ds_read_b128 v[96:99], v4 offset:6144
    ds_read_b128 v[100:103], v4 offset:22528
    s_waitcnt lgkmcnt(2)
    v_mfma_f32_16x16x32_bf16 v[128:131], a[44:47], v[104:107], v[128:131]
    v_mfma_f32_16x16x32_bf16 v[136:139], a[108:111], v[104:107], v[136:139]
    s_add_u32 m0, s30, 2688
    s_nop 0
    global_load_lds_dwordx4 v2, s[24:25] offset:384
    v_mfma_f32_16x16x32_bf16 v[144:147], a[172:175], v[104:107], v[144:147]
    v_mfma_f32_16x16x32_bf16 v[152:155], a[236:239], v[104:107], v[152:155]
    v_mfma_f32_16x16x32_bf16 v[132:135], a[44:47], v[108:111], v[132:135]
    v_mfma_f32_16x16x32_bf16 v[140:143], a[108:111], v[108:111], v[140:143]
    v_mfma_f32_16x16x32_bf16 v[148:151], a[172:175], v[108:111], v[148:151]
    v_mfma_f32_16x16x32_bf16 v[156:159], a[236:239], v[108:111], v[156:159]
    ds_read_b128 v[104:107], v5 offset:6144
    ds_read_b128 v[108:111], v5 offset:22528
    s_waitcnt lgkmcnt(2)
    v_mfma_f32_16x16x32_bf16 v[128:131], a[48:51], v[96:99], v[128:131]
    v_mfma_f32_16x16x32_bf16 v[136:139], a[112:115], v[96:99], v[136:139]
    s_add_u32 m0, s30, 3584
    s_nop 0
    global_load_lds_dwordx4 v2, s[24:25] offset:512
    v_mfma_f32_16x16x32_bf16 v[144:147], a[176:179], v[96:99], v[144:147]
    v_mfma_f32_16x16x32_bf16 v[152:155], a[240:243], v[96:99], v[152:155]
    v_mfma_f32_16x16x32_bf16 v[132:135], a[48:51], v[100:103], v[132:135]
    v_mfma_f32_16x16x32_bf16 v[140:143], a[112:115], v[100:103], v[140:143]
    v_mfma_f32_16x16x32_bf16 v[148:151], a[176:179], v[100:103], v[148:151]
    v_mfma_f32_16x16x32_bf16 v[156:159], a[240:243], v[100:103], v[156:159]
    ds_read_b128 v[96:99], v4 offset:7168
    ds_read_b128 v[100:103], v4 offset:23552
    s_waitcnt lgkmcnt(2)
    v_mfma_f32_16x16x32_bf16 v[128:131], a[52:55], v[104:107], v[128:131]
    v_mfma_f32_16x16x32_bf16 v[136:139], a[116:119], v[104:107], v[136:139]
    s_add_u32 m0, s30, 4480
    s_nop 0
    global_load_lds_dwordx4 v2, s[24:25] offset:640
    v_mfma_f32_16x16x32_bf16 v[144:147], a[180:183], v[104:107], v[144:147]
    v_mfma_f32_16x16x32_bf16 v[152:155], a[244:247], v[104:107], v[152:155]
    v_mfma_f32_16x16x32_bf16 v[132:135], a[52:55], v[108:111], v[132:135]
    v_mfma_f32_16x16x32_bf16 v[140:143], a[116:119], v[108:111], v[140:143]
    v_mfma_f32_16x16x32_bf16 v[148:151], a[180:183], v[108:111], v[148:151]
    v_mfma_f32_16x16x32_bf16 v[156:159], a[244:247], v[108:111], v[156:159]
    ds_read_b128 v[104:107], v5 offset:7168
    ds_read_b128 v[108:111], v5 offset:23552
    s_waitcnt lgkmcnt(2)
    v_mfma_f32_16x16x32_bf16 v[128:131], a[56:59], v[96:99], v[128:131]
    v_mfma_f32_16x16x32_bf16 v[136:139], a[120:123], v[96:99], v[136:139]
    s_add_u32 m0, s30, 5376
    s_nop 0
    global_load_lds_dwordx4 v2, s[24:25] offset:768
    v_mfma_f32_16x16x32_bf16 v[144:147], a[184:187], v[96:99], v[144:147]
    v_mfma_f32_16x16x32_bf16 v[152:155], a[248:251], v[96:99], v[152:155]
    v_mfma_f32_16x16x32_bf16 v[132:135], a[56:59], v[100:103], v[132:135]
    v_mfma_f32_16x16x32_bf16 v[140:143], a[120:123], v[100:103], v[140:143]
    v_mfma_f32_16x16x32_bf16 v[148:151], a[184:187], v[100:103], v[148:151]
    v_mfma_f32_16x16x32_bf16 v[156:159], a[248:251], v[100:103], v[156:159]
    s_waitcnt lgkmcnt(0)
    v_mfma_f32_16x16x32_bf16 v[128:131], a[60:63], v[104:107], v[128:131]
    v_mfma_f32_16x16x32_bf16 v[136:139], a[124:127], v[104:107], v[136:139]
    s_add_u32 m0, s30, 6272
    s_nop 0
    global_load_lds_dwordx4 v2, s[24:25] offset:896
    v_mfma_f32_16x16x32_bf16 v[144:147], a[188:191], v[104:107], v[144:147]
    v_mfma_f32_16x16x32_bf16 v[152:155], a[252:255], v[104:107], v[152:155]
    v_mfma_f32_16x16x32_bf16 v[132:135], a[60:63], v[108:111], v[132:135]
    v_mfma_f32_16x16x32_bf16 v[140:143], a[124:127], v[108:111], v[140:143]
    v_mfma_f32_16x16x32_bf16 v[148:151], a[188:191], v[108:111], v[148:151]
    v_mfma_f32_16x16x32_bf16 v[156:159], a[252:255], v[108:111], v[156:159]
    s_waitcnt vmcnt(16)
    s_branch LJ_69
LND_68:
    ds_read_b128 v[96:99], v4 offset:0
    ds_read_b128 v[100:103], v4 offset:16384
    ds_read_b128 v[104:107], v5 offset:0
    ds_read_b128 v[108:111], v5 offset:16384
    s_waitcnt lgkmcnt(2)
    v_mfma_f32_16x16x32_bf16 v[128:131], a[0:3], v[96:99], 0
    v_mfma_f32_16x16x32_bf16 v[136:139], a[64:67], v[96:99], 0
    v_mfma_f32_16x16x32_bf16 v[144:147], a[128:131], v[96:99], 0
    v_mfma_f32_16x16x32_bf16 v[152:155], a[192:195], v[96:99], 0
    v_mfma_f32_16x16x32_bf16 v[132:135], a[0:3], v[100:103], 0
    v_mfma_f32_16x16x32_bf16 v[140:143], a[64:67], v[100:103], 0
    v_mfma_f32_16x16x32_bf16 v[148:151], a[128:131], v[100:103], 0
    v_mfma_f32_16x16x32_bf16 v[156:159], a[192:195], v[100:103], 0
    ds_read_b128 v[96:99], v4 offset:1024
    ds_read_b128 v[100:103], v4 offset:17408
    s_waitcnt lgkmcnt(2)
    v_mfma_f32_16x16x32_bf16 v[128:131], a[4:7], v[104:107], v[128:131]
    v_mfma_f32_16x16x32_bf16 v[136:139], a[68:71], v[104:107], v[136:139]
    v_mfma_f32_16x16x32_bf16 v[144:147], a[132:135], v[104:107], v[144:147]
    v_mfma_f32_16x16x32_bf16 v[152:155], a[196:199], v[104:107], v[152:155]
    v_mfma_f32_16x16x32_bf16 v[132:135], a[4:7], v[108:111], v[132:135]
    v_mfma_f32_16x16x32_bf16 v[140:143], a[68:71], v[108:111], v[140:143]
    v_mfma_f32_16x16x32_bf16 v[148:151], a[132:135], v[108:111], v[148:151]
    v_mfma_f32_16x16x32_bf16 v[156:159], a[196:199], v[108:111], v[156:159]
    ds_read_b128 v[104:107], v5 offset:1024
    ds_read_b128 v[108:111], v5 offset:17408
    s_waitcnt lgkmcnt(2)
    v_mfma_f32_16x16x32_bf16 v[128:131], a[8:11], v[96:99], v[128:131]
    v_mfma_f32_16x16x32_bf16 v[136:139], a[72:75], v[96:99], v[136:139]
    v_mfma_f32_16x16x32_bf16 v[144:147], a[136:139], v[96:99], v[144:147]
    v_mfma_f32_16x16x32_bf16 v[152:155], a[200:203], v[96:99], v[152:155]
    v_mfma_f32_16x16x32_bf16 v[132:135], a[8:11], v[100:103], v[132:135]
    v_mfma_f32_16x16x32_bf16 v[140:143], a[72:75], v[100:103], v[140:143]
    v_mfma_f32_16x16x32_bf16 v[148:151], a[136:139], v[100:103], v[148:151]
    v_mfma_f32_16x16x32_bf16 v[156:159], a[200:203], v[100:103], v[156:159]
    ds_read_b128 v[96:99], v4 offset:2048
    ds_read_b128 v[100:103], v4 offset:18432
    s_waitcnt lgkmcnt(2)
    v_mfma_f32_16x16x32_bf16 v[128:131], a[12:15], v[104:107], v[128:131]
    v_mfma_f32_16x16x32_bf16 v[136:139], a[76:79], v[104:107], v[136:139]
    v_mfma_f32_16x16x32_bf16 v[144:147], a[140:143], v[104:107], v[144:147]
    v_mfma_f32_16x16x32_bf16 v[152:155], a[204:207], v[104:107], v[152:155]
    v_mfma_f32_16x16x32_bf16 v[132:135], a[12:15], v[108:111], v[132:135]
    v_mfma_f32_16x16x32_bf16 v[140:143], a[76:79], v[108:111], v[140:143]
    v_mfma_f32_16x16x32_bf16 v[148:151], a[140:143], v[108:111], v[148:151]
    v_mfma_f32_16x16x32_bf16 v[156:159], a[204:207], v[108:111], v[156:159]
    ds_read_b128 v[104:107], v5 offset:2048
    ds_read_b128 v[108:111], v5 offset:18432
    s_waitcnt lgkmcnt(2)
    v_mfma_f32_16x16x32_bf16 v[128:131], a[16:19], v[96:99], v[128:131]
    v_mfma_f32_16x16x32_bf16 v[136:139], a[80:83], v[96:99], v[136:139]
    v_mfma_f32_16x16x32_bf16 v[144:147], a[144:147], v[96:99], v[144:147]
    v_mfma_f32_16x16x32_bf16 v[152:155], a[208:211], v[96:99], v[152:155]
    v_mfma_f32_16x16x32_bf16 v[132:135], a[16:19], v[100:103], v[132:135]
    v_mfma_f32_16x16x32_bf16 v[140:143], a[80:83], v[100:103], v[140:143]
    v_mfma_f32_16x16x32_bf16 v[148:151], a[144:147], v[100:103], v[148:151]
    v_mfma_f32_16x16x32_bf16 v[156:159], a[208:211], v[100:103], v[156:159]
    ds_read_b128 v[96:99], v4 offset:3072
    ds_read_b128 v[100:103], v4 offset:19456
    s_waitcnt lgkmcnt(2)
    v_mfma_f32_16x16x32_bf16 v[128:131], a[20:23], v[104:107], v[128:131]
    v_mfma_f32_16x16x32_bf16 v[136:139], a[84:87], v[104:107], v[136:139]
    v_mfma_f32_16x16x32_bf16 v[144:147], a[148:151], v[104:107], v[144:147]
    v_mfma_f32_16x16x32_bf16 v[152:155], a[212:215], v[104:107], v[152:155]
    v_mfma_f32_16x16x32_bf16 v[132:135], a[20:23], v[108:111], v[132:135]
    v_mfma_f32_16x16x32_bf16 v[140:143], a[84:87], v[108:111], v[140:143]
    v_mfma_f32_16x16x32_bf16 v[148:151], a[148:151], v[108:111], v[148:151]
    v_mfma_f32_16x16x32_bf16 v[156:159], a[212:215], v[108:111], v[156:159]
    ds_read_b128 v[104:107], v5 offset:3072
    ds_read_b128 v[108:111], v5 offset:19456
    s_waitcnt lgkmcnt(2)
    v_mfma_f32_16x16x32_bf16 v[128:131], a[24:27], v[96:99], v[128:131]
    v_mfma_f32_16x16x32_bf16 v[136:139], a[88:91], v[96:99], v[136:139]
    v_mfma_f32_16x16x32_bf16 v[144:147], a[152:155], v[96:99], v[144:147]
    v_mfma_f32_16x16x32_bf16 v[152:155], a[216:219], v[96:99], v[152:155]
    v_mfma_f32_16x16x32_bf16 v[132:135], a[24:27], v[100:103], v[132:135]
    v_mfma_f32_16x16x32_bf16 v[140:143], a[88:91], v[100:103], v[140:143]
    v_mfma_f32_16x16x32_bf16 v[148:151], a[152:155], v[100:103], v[148:151]
    v_mfma_f32_16x16x32_bf16 v[156:159], a[216:219], v[100:103], v[156:159]
    ds_read_b128 v[96:99], v4 offset:4096
    ds_read_b128 v[100:103], v4 offset:20480
    s_waitcnt lgkmcnt(2)
    v_mfma_f32_16x16x32_bf16 v[128:131], a[28:31], v[104:107], v[128:131]
    v_mfma_f32_16x16x32_bf16 v[136:139], a[92:95], v[104:107], v[136:139]
    v_mfma_f32_16x16x32_bf16 v[144:147], a[156:159], v[104:107], v[144:147]
    v_mfma_f32_16x16x32_bf16 v[152:155], a[220:223], v[104:107], v[152:155]
    v_mfma_f32_16x16x32_bf16 v[132:135], a[28:31], v[108:111], v[132:135]
    v_mfma_f32_16x16x32_bf16 v[140:143], a[92:95], v[108:111], v[140:143]
    v_mfma_f32_16x16x32_bf16 v[148:151], a[156:159], v[108:111], v[148:151]
    v_mfma_f32_16x16x32_bf16 v[156:159], a[220:223], v[108:111], v[156:159]
    ds_read_b128 v[104:107], v5 offset:4096
    ds_read_b128 v[108:111], v5 offset:20480
    s_waitcnt lgkmcnt(2)
    v_mfma_f32_16x16x32_bf16 v[128:131], a[32:35], v[96:99], v[128:131]
    v_mfma_f32_16x16x32_bf16 v[136:139], a[96:99], v[96:99], v[136:139]
    v_mfma_f32_16x16x32_bf16 v[144:147], a[160:163], v[96:99], v[144:147]
    v_mfma_f32_16x16x32_bf16 v[152:155], a[224:227], v[96:99], v[152:155]
    v_mfma_f32_16x16x32_bf16 v[132:135], a[32:35], v[100:103], v[132:135]
    v_mfma_f32_16x16x32_bf16 v[140:143], a[96:99], v[100:103], v[140:143]
    v_mfma_f32_16x16x32_bf16 v[148:151], a[160:163], v[100:103], v[148:151]
    v_mfma_f32_16x16x32_bf16 v[156:159], a[224:227], v[100:103], v[156:159]
    ds_read_b128 v[96:99], v4 offset:5120
    ds_read_b128 v[100:103], v4 offset:21504
    s_waitcnt lgkmcnt(2)
    v_mfma_f32_16x16x32_bf16 v[128:131], a[36:39], v[104:107], v[128:131]
    v_mfma_f32_16x16x32_bf16 v[136:139], a[100:103], v[104:107], v[136:139]
    v_mfma_f32_16x16x32_bf16 v[144:147], a[164:167], v[104:107], v[144:147]
    v_mfma_f32_16x16x32_bf16 v[152:155], a[228:231], v[104:107], v[152:155]
    v_mfma_f32_16x16x32_bf16 v[132:135], a[36:39], v[108:111], v[132:135]
    v_mfma_f32_16x16x32_bf16 v[140:143], a[100:103], v[108:111], v[140:143]
    v_mfma_f32_16x16x32_bf16 v[148:151], a[164:167], v[108:111], v[148:151]
    v_mfma_f32_16x16x32_bf16 v[156:159], a[228:231], v[108:111], v[156:159]
    ds_read_b128 v[104:107], v5 offset:5120
    ds_read_b128 v[108:111], v5 offset:21504
    s_waitcnt lgkmcnt(2)
    v_mfma_f32_16x16x32_bf16 v[128:131], a[40:43], v[96:99], v[128:131]
    v_mfma_f32_16x16x32_bf16 v[136:139], a[104:107], v[96:99], v[136:139]
    v_mfma_f32_16x16x32_bf16 v[144:147], a[168:171], v[96:99], v[144:147]
    v_mfma_f32_16x16x32_bf16 v[152:155], a[232:235], v[96:99], v[152:155]
    v_mfma_f32_16x16x32_bf16 v[132:135], a[40:43], v[100:103], v[132:135]
    v_mfma_f32_16x16x32_bf16 v[140:143], a[104:107], v[100:103], v[140:143]
    v_mfma_f32_16x16x32_bf16 v[148:151], a[168:171], v[100:103], v[148:151]
    v_mfma_f32_16x16x32_bf16 v[156:159], a[232:235], v[100:103], v[156:159]
    ds_read_b128 v[96:99], v4 offset:6144
    ds_read_b128 v[100:103], v4 offset:22528
    s_waitcnt lgkmcnt(2)
    v_mfma_f32_16x16x32_bf16 v[128:131], a[44:47], v[104:107], v[128:131]
    v_mfma_f32_16x16x32_bf16 v[136:139], a[108:111], v[104:107], v[136:139]
    v_mfma_f32_16x16x32_bf16 v[144:147], a[172:175], v[104:107], v[144:147]
    v_mfma_f32_16x16x32_bf16 v[152:155], a[236:239], v[104:107], v[152:155]
    v_mfma_f32_16x16x32_bf16 v[132:135], a[44:47], v[108:111], v[132:135]
    v_mfma_f32_16x16x32_bf16 v[140:143], a[108:111], v[108:111], v[140:143]
    v_mfma_f32_16x16x32_bf16 v[148:151], a[172:175], v[108:111], v[148:151]
    v_mfma_f32_16x16x32_bf16 v[156:159], a[236:239], v[108:111], v[156:159]
    ds_read_b128 v[104:107], v5 offset:6144
    ds_read_b128 v[108:111], v5 offset:22528
    s_waitcnt lgkmcnt(2)
    v_mfma_f32_16x16x32_bf16 v[128:131], a[48:51], v[96:99], v[128:131]
    v_mfma_f32_16x16x32_bf16 v[136:139], a[112:115], v[96:99], v[136:139]
    v_mfma_f32_16x16x32_bf16 v[144:147], a[176:179], v[96:99], v[144:147]
    v_mfma_f32_16x16x32_bf16 v[152:155], a[240:243], v[96:99], v[152:155]
    v_mfma_f32_16x16x32_bf16 v[132:135], a[48:51], v[100:103], v[132:135]
    v_mfma_f32_16x16x32_bf16 v[140:143], a[112:115], v[100:103], v[140:143]
    v_mfma_f32_16x16x32_bf16 v[148:151], a[176:179], v[100:103], v[148:151]
    v_mfma_f32_16x16x32_bf16 v[156:159], a[240:243], v[100:103], v[156:159]
    ds_read_b128 v[96:99], v4 offset:7168
    ds_read_b128 v[100:103], v4 offset:23552
    s_waitcnt lgkmcnt(2)
    v_mfma_f32_16x16x32_bf16 v[128:131], a[52:55], v[104:107], v[128:131]
    v_mfma_f32_16x16x32_bf16 v[136:139], a[116:119], v[104:107], v[136:139]
    v_mfma_f32_16x16x32_bf16 v[144:147], a[180:183], v[104:107], v[144:147]
    v_mfma_f32_16x16x32_bf16 v[152:155], a[244:247], v[104:107], v[152:155]
    v_mfma_f32_16x16x32_bf16 v[132:135], a[52:55], v[108:111], v[132:135]
    v_mfma_f32_16x16x32_bf16 v[140:143], a[116:119], v[108:111], v[140:143]
    v_mfma_f32_16x16x32_bf16 v[148:151], a[180:183], v[108:111], v[148:151]
    v_mfma_f32_16x16x32_bf16 v[156:159], a[244:247], v[108:111], v[156:159]
    ds_read_b128 v[104:107], v5 offset:7168
    ds_read_b128 v[108:111], v5 offset:23552
    s_waitcnt lgkmcnt(2)
    v_mfma_f32_16x16x32_bf16 v[128:131], a[56:59], v[96:99], v[128:131]
    v_mfma_f32_16x16x32_bf16 v[136:139], a[120:123], v[96:99], v[136:139]
    v_mfma_f32_16x16x32_bf16 v[144:147], a[184:187], v[96:99], v[144:147]
    v_mfma_f32_16x16x32_bf16 v[152:155], a[248:251], v[96:99], v[152:155]
    v_mfma_f32_16x16x32_bf16 v[132:135], a[56:59], v[100:103], v[132:135]
    v_mfma_f32_16x16x32_bf16 v[140:143], a[120:123], v[100:103], v[140:143]
    v_mfma_f32_16x16x32_bf16 v[148:151], a[184:187], v[100:103], v[148:151]
    v_mfma_f32_16x16x32_bf16 v[156:159], a[248:251], v[100:103], v[156:159]
    s_waitcnt lgkmcnt(0)
    v_mfma_f32_16x16x32_bf16 v[128:131], a[60:63], v[104:107], v[128:131]
    v_mfma_f32_16x16x32_bf16 v[136:139], a[124:127], v[104:107], v[136:139]
    v_mfma_f32_16x16x32_bf16 v[144:147], a[188:191], v[104:107], v[144:147]
    v_mfma_f32_16x16x32_bf16 v[152:155], a[252:255], v[104:107], v[152:155]
    v_mfma_f32_16x16x32_bf16 v[132:135], a[60:63], v[108:111], v[132:135]
    v_mfma_f32_16x16x32_bf16 v[140:143], a[124:127], v[108:111], v[140:143]
    v_mfma_f32_16x16x32_bf16 v[148:151], a[188:191], v[108:111], v[148:151]
    v_mfma_f32_16x16x32_bf16 v[156:159], a[252:255], v[108:111], v[156:159]
    s_waitcnt vmcnt(0)
LJ_69:
    v_readlane_b32 s92, v28, 0
    v_readlane_b32 s93, v28, 1
    v_readlane_b32 s94, v28, 2
    s_nop 4
    v_cvt_pk_bf16_f32 v112, v128, v129
    v_cvt_pk_bf16_f32 v113, v130, v131
    v_cvt_pk_bf16_f32 v114, v136, v137
    v_cvt_pk_bf16_f32 v115, v138, v139
    ds_write_b128 v16, v[112:115] offset:0
    v_cvt_pk_bf16_f32 v116, v144, v145
    v_cvt_pk_bf16_f32 v117, v146, v147
    v_cvt_pk_bf16_f32 v118, v152, v153
    v_cvt_pk_bf16_f32 v119, v154, v155
    ds_write_b128 v16, v[116:119] offset:1024
    v_cvt_pk_bf16_f32 v120, v132, v133
    v_cvt_pk_bf16_f32 v121, v134, v135
    v_cvt_pk_bf16_f32 v122, v140, v141
    v_cvt_pk_bf16_f32 v123, v142, v143
    ds_write_b128 v16, v[120:123] offset:4096
    v_cvt_pk_bf16_f32 v124, v148, v149
    v_cvt_pk_bf16_f32 v125, v150, v151
    v_cvt_pk_bf16_f32 v126, v156, v157
    v_cvt_pk_bf16_f32 v127, v158, v159
    ds_write_b128 v16, v[124:127] offset:5120
    s_add_u32 s29, s20, 1
    s_min_u32 s92, s92, s93
    s_cmp_ge_u32 s92, s29
    s_cbranch_scc1 LKVOK_70
    v_mov_b32 v10, 0
    s_mov_b32 s28, 0
LWF_71:
    global_load_dword v11, v10, s[66:67] sc1
    s_waitcnt vmcnt(0)
    v_cmp_gt_u32 vcc, s29, v11
    s_and_b32 s21, vcc_lo, 1
    s_cmp_eq_u32 s21, 0
    s_cbranch_scc1 LWFOK_72
    s_sleep 4
    s_add_u32 s28, s28, 1
    s_cmp_lt_u32 s28, 0x40000
    s_cbranch_scc1 LWF_71
    s_branch L_fail
LWFOK_72:
    v_mov_b32 v10, 0
    s_mov_b32 s28, 0
LWF_73:
    global_load_dword v11, v10, s[68:69] sc1
    s_waitcnt vmcnt(0)
    v_cmp_gt_u32 vcc, s29, v11
    s_and_b32 s21, vcc_lo, 1
    s_cmp_eq_u32 s21, 0
    s_cbranch_scc1 LWFOK_74
    s_sleep 4
    s_add_u32 s28, s28, 1
    s_cmp_lt_u32 s28, 0x40000
    s_cbranch_scc1 LWF_73
    s_branch L_fail
LWFOK_74:
LKVOK_70:
    s_add_u32 s24, s58, 4096
    s_addc_u32 s25, s59, 0
    global_load_dwordx4 v[48:51], v1, s[58:59] offset:0 sc1
    global_load_dwordx4 v[52:55], v1, s[58:59] offset:1024 sc1
    global_load_dwordx4 v[56:59], v1, s[58:59] offset:2048 sc1
    global_load_dwordx4 v[60:63], v1, s[58:59] offset:3072 sc1
    global_load_dwordx4 v[64:67], v1, s[24:25] offset:0 sc1
    global_load_dwordx4 v[68:71], v1, s[24:25] offset:1024 sc1
    global_load_dwordx4 v[72:75], v1, s[24:25] offset:2048 sc1
    global_load_dwordx4 v[76:79], v1, s[24:25] offset:3072 sc1
    s_add_u32 s24, s60, 4096
    s_addc_u32 s25, s61, 0
    global_load_dwordx4 v[160:163], v1, s[60:61] offset:0 sc1
    global_load_dwordx4 v[164:167], v1, s[60:61] offset:1024 sc1
    global_load_dwordx4 v[168:171], v1, s[60:61] offset:2048 sc1
    global_load_dwordx4 v[172:175], v1, s[60:61] offset:3072 sc1
    global_load_dwordx4 v[176:179], v1, s[24:25] offset:0 sc1
    global_load_dwordx4 v[180:183], v1, s[24:25] offset:1024 sc1
    global_load_dwordx4 v[184:187], v1, s[24:25] offset:2048 sc1
    global_load_dwordx4 v[188:191], v1, s[24:25] offset:3072 sc1
    s_add_u32 s58, s58, 0x80000
    s_addc_u32 s59, s59, 0
    s_add_u32 s60, s60, 0x80000
    s_addc_u32 s61, s61, 0
    s_waitcnt lgkmcnt(0)
    s_barrier
    ds_read_b128 v[32:35], v17 offset:0
    ds_read_b128 v[36:39], v17 offset:1024
    ds_read_b128 v[40:43], v17 offset:2048
    ds_read_b128 v[44:47], v17 offset:3072
    s_lshl_b32 s29, s20, 1
    s_add_u32 s29, s29, 2
    s_cmp_ge_u32 s94, s29
    s_cbranch_scc1 LCOK_75
    v_mov_b32 v10, 0
    s_mov_b32 s28, 0
LWF_76:
    global_load_dword v11, v10, s[70:71] sc1
    s_waitcnt vmcnt(0)
    v_cmp_gt_u32 vcc, s29, v11
    s_and_b32 s21, vcc_lo, 1
    s_cmp_eq_u32 s21, 0
    s_cbranch_scc1 LWFOK_77
    s_sleep 1
    s_add_u32 s28, s28, 1
    s_cmp_lt_u32 s28, 0x40000
    s_cbranch_scc1 LWF_76
    s_branch L_fail
LWFOK_77:
LCOK_75:
    global_load_dwordx4 v[192:195], v1, s[62:63] offset:0 sc1
    global_load_dwordx4 v[196:199], v1, s[62:63] offset:1024 sc1
    global_load_dwordx4 v[200:203], v1, s[62:63] offset:2048 sc1
    global_load_dwordx4 v[204:207], v1, s[62:63] offset:3072 sc1
    s_add_u32 s62, s62, 0x40000
    s_addc_u32 s63, s63, 0
    s_waitcnt vmcnt(12) lgkmcnt(0)
    v_mfma_f32_16x16x32_bf16 v[224:227], v[48:51], v[32:35], 0
    v_mfma_f32_16x16x32_bf16 v[224:227], v[52:55], v[36:39], v[224:227]
    v_mfma_f32_16x16x32_bf16 v[224:227], v[56:59], v[40:43], v[224:227]
    v_mfma_f32_16x16x32_bf16 v[224:227], v[60:63], v[44:47], v[224:227]
    v_mfma_f32_16x16x32_bf16 v[228:231], v[64:67], v[32:35], 0
    v_mfma_f32_16x16x32_bf16 v[228:231], v[68:71], v[36:39], v[228:231]
    v_mfma_f32_16x16x32_bf16 v[228:231], v[72:75], v[40:43], v[228:231]
    v_mfma_f32_16x16x32_bf16 v[228:231], v[76:79], v[44:47], v[228:231]
    s_waitcnt vmcnt(0)
    s_cmp_eq_u32 s7, 0
    s_cbranch_scc0 LTA_78
    ds_write_b32 v18, v192 offset:0
    ds_write_b32 v18, v193 offset:512
    ds_write_b32 v18, v196 offset:1024
    ds_write_b32 v18, v197 offset:1536
    s_branch LTB_79
LTA_78:
    ds_write_b32 v18, v200 offset:0
    ds_write_b32 v18, v201 offset:512
    ds_write_b32 v18, v204 offset:1024
    ds_write_b32 v18, v205 offset:1536
LTB_79:
    s_waitcnt lgkmcnt(0)
    s_barrier
    ds_read_b64_tr_b16 v[208:209], v19 offset:0
    ds_read_b64_tr_b16 v[210:211], v19 offset:512
    ds_read_b64_tr_b16 v[212:213], v19 offset:1024
    ds_read_b64_tr_b16 v[214:215], v19 offset:1536
    ds_read_b64_tr_b16 v[216:217], v19 offset:2048
    ds_read_b64_tr_b16 v[218:219], v19 offset:2560
    ds_read_b64_tr_b16 v[220:221], v19 offset:3072
    ds_read_b64_tr_b16 v[222:223], v19 offset:3584
    s_waitcnt lgkmcnt(0)
    v_mfma_f32_16x16x32_bf16 v[232:235], v[208:211], v[32:35], 0
    v_mfma_f32_16x16x32_bf16 v[232:235], v[212:215], v[36:39], v[232:235]
    v_mfma_f32_16x16x32_bf16 v[232:235], v[216:219], v[40:43], v[232:235]
    v_mfma_f32_16x16x32_bf16 v[232:235], v[220:223], v[44:47], v[232:235]
    v_cndmask_b32 v224, v247, v224, s[40:41]
    v_cndmask_b32 v225, v247, v225, s[42:43]
    v_cndmask_b32 v226, v247, v226, s[44:45]
    v_cndmask_b32 v227, v247, v227, s[46:47]
    v_cndmask_b32 v228, v247, v228, s[48:49]
    v_cndmask_b32 v229, v247, v229, s[50:51]
    v_cndmask_b32 v230, v247, v230, s[52:53]
    v_cndmask_b32 v231, v247, v231, s[54:55]
    v_max3_f32 v242, v224, v225, v226
    v_max3_f32 v243, v227, v228, v229
    v_max3_f32 v242, v242, v230, v231
    v_max3_f32 v243, v243, v232, v233
    v_max_f32 v242, v242, v243
    v_mov_b32 v243, v242
    s_nop 1
    v_permlane16_swap_b32 v242, v243
    v_max_f32 v242, v242, v243
    v_mov_b32 v243, v242
    s_nop 1
    v_permlane32_swap_b32 v242, v243
    v_max_f32 v242, v242, v243
    v_mul_f32 v242, s56, v242
    v_fma_f32 v224, v224, s56, -v242
    v_fma_f32 v225, v225, s56, -v242
    v_fma_f32 v226, v226, s56, -v242
    v_fma_f32 v227, v227, s56, -v242
    v_fma_f32 v228, v228, s56, -v242
    v_fma_f32 v229, v229, s56, -v242
    v_fma_f32 v230, v230, s56, -v242
    v_fma_f32 v231, v231, s56, -v242
    v_fma_f32 v232, v232, s56, -v242
    v_fma_f32 v233, v233, s56, -v242
    v_exp_f32 v224, v224
    v_exp_f32 v225, v225
    v_exp_f32 v226, v226
    v_exp_f32 v227, v227
    v_exp_f32 v228, v228
    v_exp_f32 v229, v229
    v_exp_f32 v230, v230
    v_exp_f32 v231, v231
    v_exp_f32 v232, v232
    v_exp_f32 v233, v233
    v_cvt_pk_bf16_f32 v236, v224, v225
    v_cvt_pk_bf16_f32 v237, v226, v227
    v_cvt_pk_bf16_f32 v238, v228, v229
    v_cvt_pk_bf16_f32 v239, v230, v231
    v_cvt_pk_bf16_f32 v240, v232, v233
    v_add_f32 v244, v224, v225
    v_add_f32 v244, v244, v226
    v_add_f32 v244, v244, v227
    v_add_f32 v244, v244, v228
    v_add_f32 v244, v244, v229
    v_add_f32 v244, v244, v230
    v_add_f32 v244, v244, v231
    v_add_f32 v244, v244, v232
    v_add_f32 v244, v244, v233
    v_mov_b32 v245, v244
    s_nop 1
    v_permlane16_swap_b32 v244, v245
    v_add_f32 v244, v244, v245
    v_mov_b32 v245, v244
    s_nop 1
    v_permlane32_swap_b32 v244, v245
    v_add_f32 v244, v244, v245
    v_rcp_f32 v244, v244
    v_mfma_f32_16x16x32_bf16 v[128:131], v[160:163], v[236:239], 0
    v_mfma_f32_16x16x32_bf16 v[132:135], v[164:167], v[236:239], 0
    v_mfma_f32_16x16x32_bf16 v[136:139], v[168:171], v[236:239], 0
    v_mfma_f32_16x16x32_bf16 v[140:143], v[172:175], v[236:239], 0
    v_mfma_f32_16x16x32_bf16 v[144:147], v[176:179], v[236:239], 0
    v_mfma_f32_16x16x32_bf16 v[148:151], v[180:183], v[236:239], 0
    v_mfma_f32_16x16x32_bf16 v[152:155], v[184:187], v[236:239], 0
    v_mfma_f32_16x16x32_bf16 v[156:159], v[188:191], v[236:239], 0
    v_mov_b32 v248, v194
    s_nop 1
    v_mfma_f32_16x16x16_bf16 v[128:131], v[248:249], v[240:241], v[128:131]
    v_mov_b32 v248, v195
    s_nop 1
    v_mfma_f32_16x16x16_bf16 v[132:135], v[248:249], v[240:241], v[132:135]
    v_mov_b32 v248, v198
    s_nop 1
    v_mfma_f32_16x16x16_bf16 v[136:139], v[248:249], v[240:241], v[136:139]
    v_mov_b32 v248, v199
    s_nop 1
    v_mfma_f32_16x16x16_bf16 v[140:143], v[248:249], v[240:241], v[140:143]
    v_mov_b32 v248, v202
    s_nop 1
    v_mfma_f32_16x16x16_bf16 v[144:147], v[248:249], v[240:241], v[144:147]
    v_mov_b32 v248, v203
    s_nop 1
    v_mfma_f32_16x16x16_bf16 v[148:151], v[248:249], v[240:241], v[148:151]
    v_mov_b32 v248, v206
    s_nop 1
    v_mfma_f32_16x16x16_bf16 v[152:155], v[248:249], v[240:241], v[152:155]
    v_mov_b32 v248, v207
    s_nop 1
    v_mfma_f32_16x16x16_bf16 v[156:159], v[248:249], v[240:241], v[156:159]
    v_mul_f32 v128, v128, v244
    v_mul_f32 v129, v129, v244
    v_mul_f32 v130, v130, v244
    v_mul_f32 v131, v131, v244
    v_mul_f32 v132, v132, v244
    v_mul_f32 v133, v133, v244
    v_mul_f32 v134, v134, v244
    v_mul_f32 v135, v135, v244
    v_mul_f32 v136, v136, v244
    v_mul_f32 v137, v137, v244
    v_mul_f32 v138, v138, v244
    v_mul_f32 v139, v139, v244
    v_mul_f32 v140, v140, v244
    v_mul_f32 v141, v141, v244
    v_mul_f32 v142, v142, v244
    v_mul_f32 v143, v143, v244
    v_mul_f32 v144, v144, v244
    v_mul_f32 v145, v145, v244
    v_mul_f32 v146, v146, v244
    v_mul_f32 v147, v147, v244
    v_mul_f32 v148, v148, v244
    v_mul_f32 v149, v149, v244
    v_mul_f32 v150, v150, v244
    v_mul_f32 v151, v151, v244
    v_mul_f32 v152, v152, v244
    v_mul_f32 v153, v153, v244
    v_mul_f32 v154, v154, v244
    v_mul_f32 v155, v155, v244
    v_mul_f32 v156, v156, v244
    v_mul_f32 v157, v157, v244
    v_mul_f32 v158, v158, v244
    v_mul_f32 v159, v159, v244
    v_cvt_pk_bf16_f32 v112, v128, v129
    v_cvt_pk_bf16_f32 v113, v130, v131
    v_cvt_pk_bf16_f32 v114, v132, v133
    v_cvt_pk_bf16_f32 v115, v134, v135
    global_store_dwordx4 v1, v[112:115], s[64:65] offset:0 sc1
    v_cvt_pk_bf16_f32 v116, v136, v137
    v_cvt_pk_bf16_f32 v117, v138, v139
    v_cvt_pk_bf16_f32 v118, v140, v141
    v_cvt_pk_bf16_f32 v119, v142, v143
    global_store_dwordx4 v1, v[116:119], s[64:65] offset:1024 sc1
    v_cvt_pk_bf16_f32 v120, v144, v145
    v_cvt_pk_bf16_f32 v121, v146, v147
    v_cvt_pk_bf16_f32 v122, v148, v149
    v_cvt_pk_bf16_f32 v123, v150, v151
    global_store_dwordx4 v1, v[120:123], s[64:65] offset:2048 sc1
    v_cvt_pk_bf16_f32 v124, v152, v153
    v_cvt_pk_bf16_f32 v125, v154, v155
    v_cvt_pk_bf16_f32 v126, v156, v157
    v_cvt_pk_bf16_f32 v127, v158, v159
    global_store_dwordx4 v1, v[124:127], s[64:65] offset:3072 sc1
    s_add_u32 s64, s64, 0x80000
    s_addc_u32 s65, s65, 0
    s_add_u32 s20, s20, 1
    s_waitcnt vmcnt(0) lgkmcnt(0)
    s_barrier
    s_cmp_ge_u32 s20, 1
    s_cbranch_scc0 LNP_80
    s_cmp_eq_u32 s6, 0
    s_cbranch_scc0 LPUB_81
    v_mov_b32 v8, s20
    v_mov_b32 v9, 0
    s_mov_b64 exec, 1
    global_store_dword v9, v8, s[14:15] sc1
    s_mov_b64 exec, -1
LPUB_81:
LNP_80:
    s_add_u32 s26, s26, 0x10000
    s_addc_u32 s27, s27, 0
    global_load_dword v28, v29, s[66:67] sc1
    s_add_u32 s23, s20, 1
    s_cmp_lt_u32 s23, 32
    s_cbranch_scc0 LND_82
    ds_read_b128 v[96:99], v6 offset:0
    ds_read_b128 v[100:103], v6 offset:16384
    ds_read_b128 v[104:107], v7 offset:0
    ds_read_b128 v[108:111], v7 offset:16384
    s_waitcnt lgkmcnt(2)
    v_mfma_f32_16x16x32_bf16 v[128:131], a[0:3], v[96:99], 0
    v_mfma_f32_16x16x32_bf16 v[136:139], a[64:67], v[96:99], 0
    s_lshl_b32 s21, s6, 14
    s_add_u32 s21, s21, 0
    s_add_u32 s24, s26, s21
    s_addc_u32 s25, s27, 0
    s_add_u32 s30, s21, 0
    s_add_u32 m0, s30, 0
    s_nop 0
    global_load_lds_dwordx4 v2, s[24:25] offset:0
    v_mfma_f32_16x16x32_bf16 v[144:147], a[128:131], v[96:99], 0
    v_mfma_f32_16x16x32_bf16 v[152:155], a[192:195], v[96:99], 0
    v_mfma_f32_16x16x32_bf16 v[132:135], a[0:3], v[100:103], 0
    v_mfma_f32_16x16x32_bf16 v[140:143], a[64:67], v[100:103], 0
    v_mfma_f32_16x16x32_bf16 v[148:151], a[128:131], v[100:103], 0
    v_mfma_f32_16x16x32_bf16 v[156:159], a[192:195], v[100:103], 0
    ds_read_b128 v[96:99], v6 offset:1024
    ds_read_b128 v[100:103], v6 offset:17408
    s_waitcnt lgkmcnt(2)
    v_mfma_f32_16x16x32_bf16 v[128:131], a[4:7], v[104:107], v[128:131]
    v_mfma_f32_16x16x32_bf16 v[136:139], a[68:71], v[104:107], v[136:139]
    s_add_u32 m0, s30, 896
    s_nop 0
    global_load_lds_dwordx4 v2, s[24:25] offset:128
    v_mfma_f32_16x16x32_bf16 v[144:147], a[132:135], v[104:107], v[144:147]
    v_mfma_f32_16x16x32_bf16 v[152:155], a[196:199], v[104:107], v[152:155]
    v_mfma_f32_16x16x32_bf16 v[132:135], a[4:7], v[108:111], v[132:135]
    v_mfma_f32_16x16x32_bf16 v[140:143], a[68:71], v[108:111], v[140:143]
    v_mfma_f32_16x16x32_bf16 v[148:151], a[132:135], v[108:111], v[148:151]
    v_mfma_f32_16x16x32_bf16 v[156:159], a[196:199], v[108:111], v[156:159]
    ds_read_b128 v[104:107], v7 offset:1024
    ds_read_b128 v[108:111], v7 offset:17408
    s_waitcnt lgkmcnt(2)
    v_mfma_f32_16x16x32_bf16 v[128:131], a[8:11], v[96:99], v[128:131]
    v_mfma_f32_16x16x32_bf16 v[136:139], a[72:75], v[96:99], v[136:139]
    s_add_u32 m0, s30, 1792
    s_nop 0
    global_load_lds_dwordx4 v2, s[24:25] offset:256
    v_mfma_f32_16x16x32_bf16 v[144:147], a[136:139], v[96:99], v[144:147]
    v_mfma_f32_16x16x32_bf16 v[152:155], a[200:203], v[96:99], v[152:155]
    v_mfma_f32_16x16x32_bf16 v[132:135], a[8:11], v[100:103], v[132:135]
    v_mfma_f32_16x16x32_bf16 v[140:143], a[72:75], v[100:103], v[140:143]
    v_mfma_f32_16x16x32_bf16 v[148:151], a[136:139], v[100:103], v[148:151]
    v_mfma_f32_16x16x32_bf16 v[156:159], a[200:203], v[100:103], v[156:159]
    ds_read_b128 v[96:99], v6 offset:2048
    ds_read_b128 v[100:103], v6 offset:18432
    s_waitcnt lgkmcnt(2)
    v_mfma_f32_16x16x32_bf16 v[128:131], a[12:15], v[104:107], v[128:131]
    v_mfma_f32_16x16x32_bf16 v[136:139], a[76:79], v[104:107], v[136:139]
    s_add_u32 m0, s30, 2688
    s_nop 0
    global_load_lds_dwordx4 v2, s[24:25] offset:384
    v_mfma_f32_16x16x32_bf16 v[144:147], a[140:143], v[104:107], v[144:147]
    v_mfma_f32_16x16x32_bf16 v[152:155], a[204:207], v[104:107], v[152:155]
    v_mfma_f32_16x16x32_bf16 v[132:135], a[12:15], v[108:111], v[132:135]
    v_mfma_f32_16x16x32_bf16 v[140:143], a[76:79], v[108:111], v[140:143]
    v_mfma_f32_16x16x32_bf16 v[148:151], a[140:143], v[108:111], v[148:151]
    v_mfma_f32_16x16x32_bf16 v[156:159], a[204:207], v[108:111], v[156:159]
    ds_read_b128 v[104:107], v7 offset:2048
    ds_read_b128 v[108:111], v7 offset:18432
    s_waitcnt lgkmcnt(2)
    v_mfma_f32_16x16x32_bf16 v[128:131], a[16:19], v[96:99], v[128:131]
    v_mfma_f32_16x16x32_bf16 v[136:139], a[80:83], v[96:99], v[136:139]
    s_add_u32 m0, s30, 3584
    s_nop 0
    global_load_lds_dwordx4 v2, s[24:25] offset:512
    v_mfma_f32_16x16x32_bf16 v[144:147], a[144:147], v[96:99], v[144:147]
    v_mfma_f32_16x16x32_bf16 v[152:155], a[208:211], v[96:99], v[152:155]
    v_mfma_f32_16x16x32_bf16 v[132:135], a[16:19], v[100:103], v[132:135]
    v_mfma_f32_16x16x32_bf16 v[140:143], a[80:83], v[100:103], v[140:143]
    v_mfma_f32_16x16x32_bf16 v[148:151], a[144:147], v[100:103], v[148:151]
    v_mfma_f32_16x16x32_bf16 v[156:159], a[208:211], v[100:103], v[156:159]
    ds_read_b128 v[96:99], v6 offset:3072
    ds_read_b128 v[100:103], v6 offset:19456
    s_waitcnt lgkmcnt(2)
    v_mfma_f32_16x16x32_bf16 v[128:131], a[20:23], v[104:107], v[128:131]
    v_mfma_f32_16x16x32_bf16 v[136:139], a[84:87], v[104:107], v[136:139]
    s_add_u32 m0, s30, 4480
    s_nop 0
    global_load_lds_dwordx4 v2, s[24:25] offset:640
    v_mfma_f32_16x16x32_bf16 v[144:147], a[148:151], v[104:107], v[144:147]
    v_mfma_f32_16x16x32_bf16 v[152:155], a[212:215], v[104:107], v[152:155]
    v_mfma_f32_16x16x32_bf16 v[132:135], a[20:23], v[108:111], v[132:135]
    v_mfma_f32_16x16x32_bf16 v[140:143], a[84:87], v[108:111], v[140:143]
    v_mfma_f32_16x16x32_bf16 v[148:151], a[148:151], v[108:111], v[148:151]
    v_mfma_f32_16x16x32_bf16 v[156:159], a[212:215], v[108:111], v[156:159]
    ds_read_b128 v[104:107], v7 offset:3072
    ds_read_b128 v[108:111], v7 offset:19456
    s_waitcnt lgkmcnt(2)
    v_mfma_f32_16x16x32_bf16 v[128:131], a[24:27], v[96:99], v[128:131]
    v_mfma_f32_16x16x32_bf16 v[136:139], a[88:91], v[96:99], v[136:139]
    s_add_u32 m0, s30, 5376
    s_nop 0
    global_load_lds_dwordx4 v2, s[24:25] offset:768
    v_mfma_f32_16x16x32_bf16 v[144:147], a[152:155], v[96:99], v[144:147]
    v_mfma_f32_16x16x32_bf16 v[152:155], a[216:219], v[96:99], v[152:155]
    v_mfma_f32_16x16x32_bf16 v[132:135], a[24:27], v[100:103], v[132:135]
    v_mfma_f32_16x16x32_bf16 v[140:143], a[88:91], v[100:103], v[140:143]
    v_mfma_f32_16x16x32_bf16 v[148:151], a[152:155], v[100:103], v[148:151]
    v_mfma_f32_16x16x32_bf16 v[156:159], a[216:219], v[100:103], v[156:159]
    ds_read_b128 v[96:99], v6 offset:4096
    ds_read_b128 v[100:103], v6 offset:20480
    s_waitcnt lgkmcnt(2)
    v_mfma_f32_16x16x32_bf16 v[128:131], a[28:31], v[104:107], v[128:131]
    v_mfma_f32_16x16x32_bf16 v[136:139], a[92:95], v[104:107], v[136:139]
    s_add_u32 m0, s30, 6272
    s_nop 0
    global_load_lds_dwordx4 v2, s[24:25] offset:896
    v_mfma_f32_16x16x32_bf16 v[144:147], a[156:159], v[104:107], v[144:147]
    v_mfma_f32_16x16x32_bf16 v[152:155], a[220:223], v[104:107], v[152:155]
    v_mfma_f32_16x16x32_bf16 v[132:135], a[28:31], v[108:111], v[132:135]
    v_mfma_f32_16x16x32_bf16 v[140:143], a[92:95], v[108:111], v[140:143]
    v_mfma_f32_16x16x32_bf16 v[148:151], a[156:159], v[108:111], v[148:151]
    v_mfma_f32_16x16x32_bf16 v[156:159], a[220:223], v[108:111], v[156:159]
    ds_read_b128 v[104:107], v7 offset:4096
    ds_read_b128 v[108:111], v7 offset:20480
    s_waitcnt lgkmcnt(2)
    v_mfma_f32_16x16x32_bf16 v[128:131], a[32:35], v[96:99], v[128:131]
    v_mfma_f32_16x16x32_bf16 v[136:139], a[96:99], v[96:99], v[136:139]
    s_lshl_b32 s21, s6, 14
    s_add_u32 s21, s21, 8192
    s_add_u32 s24, s26, s21
    s_addc_u32 s25, s27, 0
    s_add_u32 s30, s21, 0
    s_add_u32 m0, s30, 0
    s_nop 0
    global_load_lds_dwordx4 v2, s[24:25] offset:0
    v_mfma_f32_16x16x32_bf16 v[144:147], a[160:163], v[96:99], v[144:147]
    v_mfma_f32_16x16x32_bf16 v[152:155], a[224:227], v[96:99], v[152:155]
    v_mfma_f32_16x16x32_bf16 v[132:135], a[32:35], v[100:103], v[132:135]
    v_mfma_f32_16x16x32_bf16 v[140:143], a[96:99], v[100:103], v[140:143]
    v_mfma_f32_16x16x32_bf16 v[148:151], a[160:163], v[100:103], v[148:151]
    v_mfma_f32_16x16x32_bf16 v[156:159], a[224:227], v[100:103], v[156:159]
    ds_read_b128 v[96:99], v6 offset:5120
    ds_read_b128 v[100:103], v6 offset:21504
    s_waitcnt lgkmcnt(2)
    v_mfma_f32_16x16x32_bf16 v[128:131], a[36:39], v[104:107], v[128:131]
    v_mfma_f32_16x16x32_bf16 v[136:139], a[100:103], v[104:107], v[136:139]
    s_add_u32 m0, s30, 896
    s_nop 0
    global_load_lds_dwordx4 v2, s[24:25] offset:128
    v_mfma_f32_16x16x32_bf16 v[144:147], a[164:167], v[104:107], v[144:147]
    v_mfma_f32_16x16x32_bf16 v[152:155], a[228:231], v[104:107], v[152:155]
    v_mfma_f32_16x16x32_bf16 v[132:135], a[36:39], v[108:111], v[132:135]
    v_mfma_f32_16x16x32_bf16 v[140:143], a[100:103], v[108:111], v[140:143]
    v_mfma_f32_16x16x32_bf16 v[148:151], a[164:167], v[108:111], v[148:151]
    v_mfma_f32_16x16x32_bf16 v[156:159], a[228:231], v[108:111], v[156:159]
    ds_read_b128 v[104:107], v7 offset:5120
    ds_read_b128 v[108:111], v7 offset:21504
    s_waitcnt lgkmcnt(2)
    v_mfma_f32_16x16x32_bf16 v[128:131], a[40:43], v[96:99], v[128:131]
    v_mfma_f32_16x16x32_bf16 v[136:139], a[104:107], v[96:99], v[136:139]
    s_add_u32 m0, s30, 1792
    s_nop 0
    global_load_lds_dwordx4 v2, s[24:25] offset:256
    v_mfma_f32_16x16x32_bf16 v[144:147], a[168:171], v[96:99], v[144:147]
    v_mfma_f32_16x16x32_bf16 v[152:155], a[232:235], v[96:99], v[152:155]
    v_mfma_f32_16x16x32_bf16 v[132:135], a[40:43], v[100:103], v[132:135]
    v_mfma_f32_16x16x32_bf16 v[140:143], a[104:107], v[100:103], v[140:143]
    v_mfma_f32_16x16x32_bf16 v[148:151], a[168:171], v[100:103], v[148:151]
    v_mfma_f32_16x16x32_bf16 v[156:159], a[232:235], v[100:103], v[156:159]
    ds_read_b128 v[96:99], v6 offset:6144
    ds_read_b128 v[100:103], v6 offset:22528
    s_waitcnt lgkmcnt(2)
    v_mfma_f32_16x16x32_bf16 v[128:131], a[44:47], v[104:107], v[128:131]
    v_mfma_f32_16x16x32_bf16 v[136:139], a[108:111], v[104:107], v[136:139]
    s_add_u32 m0, s30, 2688
    s_nop 0
    global_load_lds_dwordx4 v2, s[24:25] offset:384
    v_mfma_f32_16x16x32_bf16 v[144:147], a[172:175], v[104:107], v[144:147]
    v_mfma_f32_16x16x32_bf16 v[152:155], a[236:239], v[104:107], v[152:155]
    v_mfma_f32_16x16x32_bf16 v[132:135], a[44:47], v[108:111], v[132:135]
    v_mfma_f32_16x16x32_bf16 v[140:143], a[108:111], v[108:111], v[140:143]
    v_mfma_f32_16x16x32_bf16 v[148:151], a[172:175], v[108:111], v[148:151]
    v_mfma_f32_16x16x32_bf16 v[156:159], a[236:239], v[108:111], v[156:159]
    ds_read_b128 v[104:107], v7 offset:6144
    ds_read_b128 v[108:111], v7 offset:22528
    s_waitcnt lgkmcnt(2)
    v_mfma_f32_16x16x32_bf16 v[128:131], a[48:51], v[96:99], v[128:131]
    v_mfma_f32_16x16x32_bf16 v[136:139], a[112:115], v[96:99], v[136:139]
    s_add_u32 m0, s30, 3584
    s_nop 0
    global_load_lds_dwordx4 v2, s[24:25] offset:512
    v_mfma_f32_16x16x32_bf16 v[144:147], a[176:179], v[96:99], v[144:147]
    v_mfma_f32_16x16x32_bf16 v[152:155], a[240:243], v[96:99], v[152:155]
    v_mfma_f32_16x16x32_bf16 v[132:135], a[48:51], v[100:103], v[132:135]
    v_mfma_f32_16x16x32_bf16 v[140:143], a[112:115], v[100:103], v[140:143]
    v_mfma_f32_16x16x32_bf16 v[148:151], a[176:179], v[100:103], v[148:151]
    v_mfma_f32_16x16x32_bf16 v[156:159], a[240:243], v[100:103], v[156:159]
    ds_read_b128 v[96:99], v6 offset:7168
    ds_read_b128 v[100:103], v6 offset:23552
    s_waitcnt lgkmcnt(2)
    v_mfma_f32_16x16x32_bf16 v[128:131], a[52:55], v[104:107], v[128:131]
    v_mfma_f32_16x16x32_bf16 v[136:139], a[116:119], v[104:107], v[136:139]
    s_add_u32 m0, s30, 4480
    s_nop 0
    global_load_lds_dwordx4 v2, s[24:25] offset:640
    v_mfma_f32_16x16x32_bf16 v[144:147], a[180:183], v[104:107], v[144:147]
    v_mfma_f32_16x16x32_bf16 v[152:155], a[244:247], v[104:107], v[152:155]
    v_mfma_f32_16x16x32_bf16 v[132:135], a[52:55], v[108:111], v[132:135]
    v_mfma_f32_16x16x32_bf16 v[140:143], a[116:119], v[108:111], v[140:143]
    v_mfma_f32_16x16x32_bf16 v[148:151], a[180:183], v[108:111], v[148:151]
    v_mfma_f32_16x16x32_bf16 v[156:159], a[244:247], v[108:111], v[156:159]
    ds_read_b128 v[104:107], v7 offset:7168
    ds_read_b128 v[108:111], v7 offset:23552
    s_waitcnt lgkmcnt(2)
    v_mfma_f32_16x16x32_bf16 v[128:131], a[56:59], v[96:99], v[128:131]
    v_mfma_f32_16x16x32_bf16 v[136:139], a[120:123], v[96:99], v[136:139]
    s_add_u32 m0, s30, 5376
    s_nop 0
    global_load_lds_dwordx4 v2, s[24:25] offset:768
    v_mfma_f32_16x16x32_bf16 v[144:147], a[184:187], v[96:99], v[144:147]
    v_mfma_f32_16x16x32_bf16 v[152:155], a[248:251], v[96:99], v[152:155]
    v_mfma_f32_16x16x32_bf16 v[132:135], a[56:59], v[100:103], v[132:135]
    v_mfma_f32_16x16x32_bf16 v[140:143], a[120:123], v[100:103], v[140:143]
    v_mfma_f32_16x16x32_bf16 v[148:151], a[184:187], v[100:103], v[148:151]
    v_mfma_f32_16x16x32_bf16 v[156:159], a[248:251], v[100:103], v[156:159]
    s_waitcnt lgkmcnt(0)
    v_mfma_f32_16x16x32_bf16 v[128:131], a[60:63], v[104:107], v[128:131]
    v_mfma_f32_16x16x32_bf16 v[136:139], a[124:127], v[104:107], v[136:139]
    s_add_u32 m0, s30, 6272
    s_nop 0
    global_load_lds_dwordx4 v2, s[24:25] offset:896
    v_mfma_f32_16x16x32_bf16 v[144:147], a[188:191], v[104:107], v[144:147]
    v_mfma_f32_16x16x32_bf16 v[152:155], a[252:255], v[104:107], v[152:155]
    v_mfma_f32_16x16x32_bf16 v[132:135], a[60:63], v[108:111], v[132:135]
    v_mfma_f32_16x16x32_bf16 v[140:143], a[124:127], v[108:111], v[140:143]
    v_mfma_f32_16x16x32_bf16 v[148:151], a[188:191], v[108:111], v[148:151]
    v_mfma_f32_16x16x32_bf16 v[156:159], a[252:255], v[108:111], v[156:159]
    s_waitcnt vmcnt(16)
    s_branch LJ_83
LND_82:
    ds_read_b128 v[96:99], v6 offset:0
    ds_read_b128 v[100:103], v6 offset:16384
    ds_read_b128 v[104:107], v7 offset:0
    ds_read_b128 v[108:111], v7 offset:16384
    s_waitcnt lgkmcnt(2)
    v_mfma_f32_16x16x32_bf16 v[128:131], a[0:3], v[96:99], 0
    v_mfma_f32_16x16x32_bf16 v[136:139], a[64:67], v[96:99], 0
    v_mfma_f32_16x16x32_bf16 v[144:147], a[128:131], v[96:99], 0
    v_mfma_f32_16x16x32_bf16 v[152:155], a[192:195], v[96:99], 0
    v_mfma_f32_16x16x32_bf16 v[132:135], a[0:3], v[100:103], 0
    v_mfma_f32_16x16x32_bf16 v[140:143], a[64:67], v[100:103], 0
    v_mfma_f32_16x16x32_bf16 v[148:151], a[128:131], v[100:103], 0
    v_mfma_f32_16x16x32_bf16 v[156:159], a[192:195], v[100:103], 0
    ds_read_b128 v[96:99], v6 offset:1024
    ds_read_b128 v[100:103], v6 offset:17408
    s_waitcnt lgkmcnt(2)
    v_mfma_f32_16x16x32_bf16 v[128:131], a[4:7], v[104:107], v[128:131]
    v_mfma_f32_16x16x32_bf16 v[136:139], a[68:71], v[104:107], v[136:139]
    v_mfma_f32_16x16x32_bf16 v[144:147], a[132:135], v[104:107], v[144:147]
    v_mfma_f32_16x16x32_bf16 v[152:155], a[196:199], v[104:107], v[152:155]
    v_mfma_f32_16x16x32_bf16 v[132:135], a[4:7], v[108:111], v[132:135]
    v_mfma_f32_16x16x32_bf16 v[140:143], a[68:71], v[108:111], v[140:143]
    v_mfma_f32_16x16x32_bf16 v[148:151], a[132:135], v[108:111], v[148:151]
    v_mfma_f32_16x16x32_bf16 v[156:159], a[196:199], v[108:111], v[156:159]
    ds_read_b128 v[104:107], v7 offset:1024
    ds_read_b128 v[108:111], v7 offset:17408
    s_waitcnt lgkmcnt(2)
    v_mfma_f32_16x16x32_bf16 v[128:131], a[8:11], v[96:99], v[128:131]
    v_mfma_f32_16x16x32_bf16 v[136:139], a[72:75], v[96:99], v[136:139]
    v_mfma_f32_16x16x32_bf16 v[144:147], a[136:139], v[96:99], v[144:147]
    v_mfma_f32_16x16x32_bf16 v[152:155], a[200:203], v[96:99], v[152:155]
    v_mfma_f32_16x16x32_bf16 v[132:135], a[8:11], v[100:103], v[132:135]
    v_mfma_f32_16x16x32_bf16 v[140:143], a[72:75], v[100:103], v[140:143]
    v_mfma_f32_16x16x32_bf16 v[148:151], a[136:139], v[100:103], v[148:151]
    v_mfma_f32_16x16x32_bf16 v[156:159], a[200:203], v[100:103], v[156:159]
    ds_read_b128 v[96:99], v6 offset:2048
    ds_read_b128 v[100:103], v6 offset:18432
    s_waitcnt lgkmcnt(2)
    v_mfma_f32_16x16x32_bf16 v[128:131], a[12:15], v[104:107], v[128:131]
    v_mfma_f32_16x16x32_bf16 v[136:139], a[76:79], v[104:107], v[136:139]
    v_mfma_f32_16x16x32_bf16 v[144:147], a[140:143], v[104:107], v[144:147]
    v_mfma_f32_16x16x32_bf16 v[152:155], a[204:207], v[104:107], v[152:155]
    v_mfma_f32_16x16x32_bf16 v[132:135], a[12:15], v[108:111], v[132:135]
    v_mfma_f32_16x16x32_bf16 v[140:143], a[76:79], v[108:111], v[140:143]
    v_mfma_f32_16x16x32_bf16 v[148:151], a[140:143], v[108:111], v[148:151]
    v_mfma_f32_16x16x32_bf16 v[156:159], a[204:207], v[108:111], v[156:159]
    ds_read_b128 v[104:107], v7 offset:2048
    ds_read_b128 v[108:111], v7 offset:18432
    s_waitcnt lgkmcnt(2)
    v_mfma_f32_16x16x32_bf16 v[128:131], a[16:19], v[96:99], v[128:131]
    v_mfma_f32_16x16x32_bf16 v[136:139], a[80:83], v[96:99], v[136:139]
    v_mfma_f32_16x16x32_bf16 v[144:147], a[144:147], v[96:99], v[144:147]
    v_mfma_f32_16x16x32_bf16 v[152:155], a[208:211], v[96:99], v[152:155]
    v_mfma_f32_16x16x32_bf16 v[132:135], a[16:19], v[100:103], v[132:135]
    v_mfma_f32_16x16x32_bf16 v[140:143], a[80:83], v[100:103], v[140:143]
    v_mfma_f32_16x16x32_bf16 v[148:151], a[144:147], v[100:103], v[148:151]
    v_mfma_f32_16x16x32_bf16 v[156:159], a[208:211], v[100:103], v[156:159]
    ds_read_b128 v[96:99], v6 offset:3072
    ds_read_b128 v[100:103], v6 offset:19456
    s_waitcnt lgkmcnt(2)
    v_mfma_f32_16x16x32_bf16 v[128:131], a[20:23], v[104:107], v[128:131]
    v_mfma_f32_16x16x32_bf16 v[136:139], a[84:87], v[104:107], v[136:139]
    v_mfma_f32_16x16x32_bf16 v[144:147], a[148:151], v[104:107], v[144:147]
    v_mfma_f32_16x16x32_bf16 v[152:155], a[212:215], v[104:107], v[152:155]
    v_mfma_f32_16x16x32_bf16 v[132:135], a[20:23], v[108:111], v[132:135]
    v_mfma_f32_16x16x32_bf16 v[140:143], a[84:87], v[108:111], v[140:143]
    v_mfma_f32_16x16x32_bf16 v[148:151], a[148:151], v[108:111], v[148:151]
    v_mfma_f32_16x16x32_bf16 v[156:159], a[212:215], v[108:111], v[156:159]
    ds_read_b128 v[104:107], v7 offset:3072
    ds_read_b128 v[108:111], v7 offset:19456
    s_waitcnt lgkmcnt(2)
    v_mfma_f32_16x16x32_bf16 v[128:131], a[24:27], v[96:99], v[128:131]
    v_mfma_f32_16x16x32_bf16 v[136:139], a[88:91], v[96:99], v[136:139]
    v_mfma_f32_16x16x32_bf16 v[144:147], a[152:155], v[96:99], v[144:147]
    v_mfma_f32_16x16x32_bf16 v[152:155], a[216:219], v[96:99], v[152:155]
    v_mfma_f32_16x16x32_bf16 v[132:135], a[24:27], v[100:103], v[132:135]
    v_mfma_f32_16x16x32_bf16 v[140:143], a[88:91], v[100:103], v[140:143]
    v_mfma_f32_16x16x32_bf16 v[148:151], a[152:155], v[100:103], v[148:151]
    v_mfma_f32_16x16x32_bf16 v[156:159], a[216:219], v[100:103], v[156:159]
    ds_read_b128 v[96:99], v6 offset:4096
    ds_read_b128 v[100:103], v6 offset:20480
    s_waitcnt lgkmcnt(2)
    v_mfma_f32_16x16x32_bf16 v[128:131], a[28:31], v[104:107], v[128:131]
    v_mfma_f32_16x16x32_bf16 v[136:139], a[92:95], v[104:107], v[136:139]
    v_mfma_f32_16x16x32_bf16 v[144:147], a[156:159], v[104:107], v[144:147]
    v_mfma_f32_16x16x32_bf16 v[152:155], a[220:223], v[104:107], v[152:155]
    v_mfma_f32_16x16x32_bf16 v[132:135], a[28:31], v[108:111], v[132:135]
    v_mfma_f32_16x16x32_bf16 v[140:143], a[92:95], v[108:111], v[140:143]
    v_mfma_f32_16x16x32_bf16 v[148:151], a[156:159], v[108:111], v[148:151]
    v_mfma_f32_16x16x32_bf16 v[156:159], a[220:223], v[108:111], v[156:159]
    ds_read_b128 v[104:107], v7 offset:4096
    ds_read_b128 v[108:111], v7 offset:20480
    s_waitcnt lgkmcnt(2)
    v_mfma_f32_16x16x32_bf16 v[128:131], a[32:35], v[96:99], v[128:131]
    v_mfma_f32_16x16x32_bf16 v[136:139], a[96:99], v[96:99], v[136:139]
    v_mfma_f32_16x16x32_bf16 v[144:147], a[160:163], v[96:99], v[144:147]
    v_mfma_f32_16x16x32_bf16 v[152:155], a[224:227], v[96:99], v[152:155]
    v_mfma_f32_16x16x32_bf16 v[132:135], a[32:35], v[100:103], v[132:135]
    v_mfma_f32_16x16x32_bf16 v[140:143], a[96:99], v[100:103], v[140:143]
    v_mfma_f32_16x16x32_bf16 v[148:151], a[160:163], v[100:103], v[148:151]
    v_mfma_f32_16x16x32_bf16 v[156:159], a[224:227], v[100:103], v[156:159]
    ds_read_b128 v[96:99], v6 offset:5120
    ds_read_b128 v[100:103], v6 offset:21504
    s_waitcnt lgkmcnt(2)
    v_mfma_f32_16x16x32_bf16 v[128:131], a[36:39], v[104:107], v[128:131]
    v_mfma_f32_16x16x32_bf16 v[136:139], a[100:103], v[104:107], v[136:139]
    v_mfma_f32_16x16x32_bf16 v[144:147], a[164:167], v[104:107], v[144:147]
    v_mfma_f32_16x16x32_bf16 v[152:155], a[228:231], v[104:107], v[152:155]
    v_mfma_f32_16x16x32_bf16 v[132:135], a[36:39], v[108:111], v[132:135]
    v_mfma_f32_16x16x32_bf16 v[140:143], a[100:103], v[108:111], v[140:143]
    v_mfma_f32_16x16x32_bf16 v[148:151], a[164:167], v[108:111], v[148:151]
    v_mfma_f32_16x16x32_bf16 v[156:159], a[228:231], v[108:111], v[156:159]
    ds_read_b128 v[104:107], v7 offset:5120
    ds_read_b128 v[108:111], v7 offset:21504
    s_waitcnt lgkmcnt(2)
    v_mfma_f32_16x16x32_bf16 v[128:131], a[40:43], v[96:99], v[128:131]
    v_mfma_f32_16x16x32_bf16 v[136:139], a[104:107], v[96:99], v[136:139]
    v_mfma_f32_16x16x32_bf16 v[144:147], a[168:171], v[96:99], v[144:147]
    v_mfma_f32_16x16x32_bf16 v[152:155], a[232:235], v[96:99], v[152:155]
    v_mfma_f32_16x16x32_bf16 v[132:135], a[40:43], v[100:103], v[132:135]
    v_mfma_f32_16x16x32_bf16 v[140:143], a[104:107], v[100:103], v[140:143]
    v_mfma_f32_16x16x32_bf16 v[148:151], a[168:171], v[100:103], v[148:151]
    v_mfma_f32_16x16x32_bf16 v[156:159], a[232:235], v[100:103], v[156:159]
    ds_read_b128 v[96:99], v6 offset:6144
    ds_read_b128 v[100:103], v6 offset:22528
    s_waitcnt lgkmcnt(2)
    v_mfma_f32_16x16x32_bf16 v[128:131], a[44:47], v[104:107], v[128:131]
    v_mfma_f32_16x16x32_bf16 v[136:139], a[108:111], v[104:107], v[136:139]
    v_mfma_f32_16x16x32_bf16 v[144:147], a[172:175], v[104:107], v[144:147]
    v_mfma_f32_16x16x32_bf16 v[152:155], a[236:239], v[104:107], v[152:155]
    v_mfma_f32_16x16x32_bf16 v[132:135], a[44:47], v[108:111], v[132:135]
    v_mfma_f32_16x16x32_bf16 v[140:143], a[108:111], v[108:111], v[140:143]
    v_mfma_f32_16x16x32_bf16 v[148:151], a[172:175], v[108:111], v[148:151]
    v_mfma_f32_16x16x32_bf16 v[156:159], a[236:239], v[108:111], v[156:159]
    ds_read_b128 v[104:107], v7 offset:6144
    ds_read_b128 v[108:111], v7 offset:22528
    s_waitcnt lgkmcnt(2)
    v_mfma_f32_16x16x32_bf16 v[128:131], a[48:51], v[96:99], v[128:131]
    v_mfma_f32_16x16x32_bf16 v[136:139], a[112:115], v[96:99], v[136:139]
    v_mfma_f32_16x16x32_bf16 v[144:147], a[176:179], v[96:99], v[144:147]
    v_mfma_f32_16x16x32_bf16 v[152:155], a[240:243], v[96:99], v[152:155]
    v_mfma_f32_16x16x32_bf16 v[132:135], a[48:51], v[100:103], v[132:135]
    v_mfma_f32_16x16x32_bf16 v[140:143], a[112:115], v[100:103], v[140:143]
    v_mfma_f32_16x16x32_bf16 v[148:151], a[176:179], v[100:103], v[148:151]
    v_mfma_f32_16x16x32_bf16 v[156:159], a[240:243], v[100:103], v[156:159]
    ds_read_b128 v[96:99], v6 offset:7168
    ds_read_b128 v[100:103], v6 offset:23552
    s_waitcnt lgkmcnt(2)
    v_mfma_f32_16x16x32_bf16 v[128:131], a[52:55], v[104:107], v[128:131]
    v_mfma_f32_16x16x32_bf16 v[136:139], a[116:119], v[104:107], v[136:139]
    v_mfma_f32_16x16x32_bf16 v[144:147], a[180:183], v[104:107], v[144:147]
    v_mfma_f32_16x16x32_bf16 v[152:155], a[244:247], v[104:107], v[152:155]
    v_mfma_f32_16x16x32_bf16 v[132:135], a[52:55], v[108:111], v[132:135]
    v_mfma_f32_16x16x32_bf16 v[140:143], a[116:119], v[108:111], v[140:143]
    v_mfma_f32_16x16x32_bf16 v[148:151], a[180:183], v[108:111], v[148:151]
    v_mfma_f32_16x16x32_bf16 v[156:159], a[244:247], v[108:111], v[156:159]
    ds_read_b128 v[104:107], v7 offset:7168
    ds_read_b128 v[108:111], v7 offset:23552
    s_waitcnt lgkmcnt(2)
    v_mfma_f32_16x16x32_bf16 v[128:131], a[56:59], v[96:99], v[128:131]
    v_mfma_f32_16x16x32_bf16 v[136:139], a[120:123], v[96:99], v[136:139]
    v_mfma_f32_16x16x32_bf16 v[144:147], a[184:187], v[96:99], v[144:147]
    v_mfma_f32_16x16x32_bf16 v[152:155], a[248:251], v[96:99], v[152:155]
    v_mfma_f32_16x16x32_bf16 v[132:135], a[56:59], v[100:103], v[132:135]
    v_mfma_f32_16x16x32_bf16 v[140:143], a[120:123], v[100:103], v[140:143]
    v_mfma_f32_16x16x32_bf16 v[148:151], a[184:187], v[100:103], v[148:151]
    v_mfma_f32_16x16x32_bf16 v[156:159], a[248:251], v[100:103], v[156:159]
    s_waitcnt lgkmcnt(0)
    v_mfma_f32_16x16x32_bf16 v[128:131], a[60:63], v[104:107], v[128:131]
    v_mfma_f32_16x16x32_bf16 v[136:139], a[124:127], v[104:107], v[136:139]
    v_mfma_f32_16x16x32_bf16 v[144:147], a[188:191], v[104:107], v[144:147]
    v_mfma_f32_16x16x32_bf16 v[152:155], a[252:255], v[104:107], v[152:155]
    v_mfma_f32_16x16x32_bf16 v[132:135], a[60:63], v[108:111], v[132:135]
    v_mfma_f32_16x16x32_bf16 v[140:143], a[124:127], v[108:111], v[140:143]
    v_mfma_f32_16x16x32_bf16 v[148:151], a[188:191], v[108:111], v[148:151]
    v_mfma_f32_16x16x32_bf16 v[156:159], a[252:255], v[108:111], v[156:159]
    s_waitcnt vmcnt(0)
LJ_83:
    v_readlane_b32 s92, v28, 0
    v_readlane_b32 s93, v28, 1
    v_readlane_b32 s94, v28, 2
    s_nop 4
    v_cvt_pk_bf16_f32 v112, v128, v129
    v_cvt_pk_bf16_f32 v113, v130, v131
    v_cvt_pk_bf16_f32 v114, v136, v137
    v_cvt_pk_bf16_f32 v115, v138, v139
    ds_write_b128 v16, v[112:115] offset:0
    v_cvt_pk_bf16_f32 v116, v144, v145
    v_cvt_pk_bf16_f32 v117, v146, v147
    v_cvt_pk_bf16_f32 v118, v152, v153
    v_cvt_pk_bf16_f32 v119, v154, v155
    ds_write_b128 v16, v[116:119] offset:1024
    v_cvt_pk_bf16_f32 v120, v132, v133
    v_cvt_pk_bf16_f32 v121, v134, v135
    v_cvt_pk_bf16_f32 v122, v140, v141
    v_cvt_pk_bf16_f32 v123, v142, v143
    ds_write_b128 v16, v[120:123] offset:4096
    v_cvt_pk_bf16_f32 v124, v148, v149
    v_cvt_pk_bf16_f32 v125, v150, v151
    v_cvt_pk_bf16_f32 v126, v156, v157
    v_cvt_pk_bf16_f32 v127, v158, v159
    ds_write_b128 v16, v[124:127] offset:5120
    s_add_u32 s29, s20, 1
    s_min_u32 s92, s92, s93
    s_cmp_ge_u32 s92, s29
    s_cbranch_scc1 LKVOK_84
    v_mov_b32 v10, 0
    s_mov_b32 s28, 0
LWF_85:
    global_load_dword v11, v10, s[66:67] sc1
    s_waitcnt vmcnt(0)
    v_cmp_gt_u32 vcc, s29, v11
    s_and_b32 s21, vcc_lo, 1
    s_cmp_eq_u32 s21, 0
    s_cbranch_scc1 LWFOK_86
    s_sleep 4
    s_add_u32 s28, s28, 1
    s_cmp_lt_u32 s28, 0x40000
    s_cbranch_scc1 LWF_85
    s_branch L_fail
LWFOK_86:
    v_mov_b32 v10, 0
    s_mov_b32 s28, 0
LWF_87:
    global_load_dword v11, v10, s[68:69] sc1
    s_waitcnt vmcnt(0)
    v_cmp_gt_u32 vcc, s29, v11
    s_and_b32 s21, vcc_lo, 1
    s_cmp_eq_u32 s21, 0
    s_cbranch_scc1 LWFOK_88
    s_sleep 4
    s_add_u32 s28, s28, 1
    s_cmp_lt_u32 s28, 0x40000
    s_cbranch_scc1 LWF_87
    s_branch L_fail
LWFOK_88:
LKVOK_84:
    s_add_u32 s24, s58, 4096
    s_addc_u32 s25, s59, 0
    global_load_dwordx4 v[48:51], v1, s[58:59] offset:0 sc1
    global_load_dwordx4 v[52:55], v1, s[58:59] offset:1024 sc1
    global_load_dwordx4 v[56:59], v1, s[58:59] offset:2048 sc1
    global_load_dwordx4 v[60:63], v1, s[58:59] offset:3072 sc1
    global_load_dwordx4 v[64:67], v1, s[24:25] offset:0 sc1
    global_load_dwordx4 v[68:71], v1, s[24:25] offset:1024 sc1
    global_load_dwordx4 v[72:75], v1, s[24:25] offset:2048 sc1
    global_load_dwordx4 v[76:79], v1, s[24:25] offset:3072 sc1
    s_add_u32 s24, s60, 4096
    s_addc_u32 s25, s61, 0
    global_load_dwordx4 v[160:163], v1, s[60:61] offset:0 sc1
    global_load_dwordx4 v[164:167], v1, s[60:61] offset:1024 sc1
    global_load_dwordx4 v[168:171], v1, s[60:61] offset:2048 sc1
    global_load_dwordx4 v[172:175], v1, s[60:61] offset:3072 sc1
    global_load_dwordx4 v[176:179], v1, s[24:25] offset:0 sc1
    global_load_dwordx4 v[180:183], v1, s[24:25] offset:1024 sc1
    global_load_dwordx4 v[184:187], v1, s[24:25] offset:2048 sc1
    global_load_dwordx4 v[188:191], v1, s[24:25] offset:3072 sc1
    s_add_u32 s58, s58, 0x80000
    s_addc_u32 s59, s59, 0
    s_add_u32 s60, s60, 0x80000
    s_addc_u32 s61, s61, 0
    s_waitcnt lgkmcnt(0)
    s_barrier
    ds_read_b128 v[32:35], v17 offset:0
    ds_read_b128 v[36:39], v17 offset:1024
    ds_read_b128 v[40:43], v17 offset:2048
    ds_read_b128 v[44:47], v17 offset:3072
    s_lshl_b32 s29, s20, 1
    s_add_u32 s29, s29, 2
    s_cmp_ge_u32 s94, s29
    s_cbranch_scc1 LCOK_89
    v_mov_b32 v10, 0
    s_mov_b32 s28, 0
LWF_90:
    global_load_dword v11, v10, s[70:71] sc1
    s_waitcnt vmcnt(0)
    v_cmp_gt_u32 vcc, s29, v11
    s_and_b32 s21, vcc_lo, 1
    s_cmp_eq_u32 s21, 0
    s_cbranch_scc1 LWFOK_91
    s_sleep 1
    s_add_u32 s28, s28, 1
    s_cmp_lt_u32 s28, 0x40000
    s_cbranch_scc1 LWF_90
    s_branch L_fail
LWFOK_91:
LCOK_89:
    global_load_dwordx4 v[192:195], v1, s[62:63] offset:0 sc1
    global_load_dwordx4 v[196:199], v1, s[62:63] offset:1024 sc1
    global_load_dwordx4 v[200:203], v1, s[62:63] offset:2048 sc1
    global_load_dwordx4 v[204:207], v1, s[62:63] offset:3072 sc1
    s_add_u32 s62, s62, 0x40000
    s_addc_u32 s63, s63, 0
    s_waitcnt vmcnt(12) lgkmcnt(0)
    v_mfma_f32_16x16x32_bf16 v[224:227], v[48:51], v[32:35], 0
    v_mfma_f32_16x16x32_bf16 v[224:227], v[52:55], v[36:39], v[224:227]
    v_mfma_f32_16x16x32_bf16 v[224:227], v[56:59], v[40:43], v[224:227]
    v_mfma_f32_16x16x32_bf16 v[224:227], v[60:63], v[44:47], v[224:227]
    v_mfma_f32_16x16x32_bf16 v[228:231], v[64:67], v[32:35], 0
    v_mfma_f32_16x16x32_bf16 v[228:231], v[68:71], v[36:39], v[228:231]
    v_mfma_f32_16x16x32_bf16 v[228:231], v[72:75], v[40:43], v[228:231]
    v_mfma_f32_16x16x32_bf16 v[228:231], v[76:79], v[44:47], v[228:231]
    s_waitcnt vmcnt(0)
    s_cmp_eq_u32 s7, 0
    s_cbranch_scc0 LTA_92
    ds_write_b32 v18, v192 offset:0
    ds_write_b32 v18, v193 offset:512
    ds_write_b32 v18, v196 offset:1024
    ds_write_b32 v18, v197 offset:1536
    s_branch LTB_93
LTA_92:
    ds_write_b32 v18, v200 offset:0
    ds_write_b32 v18, v201 offset:512
    ds_write_b32 v18, v204 offset:1024
    ds_write_b32 v18, v205 offset:1536
LTB_93:
    s_waitcnt lgkmcnt(0)
    s_barrier
    ds_read_b64_tr_b16 v[208:209], v19 offset:0
    ds_read_b64_tr_b16 v[210:211], v19 offset:512
    ds_read_b64_tr_b16 v[212:213], v19 offset:1024
    ds_read_b64_tr_b16 v[214:215], v19 offset:1536
    ds_read_b64_tr_b16 v[216:217], v19 offset:2048
    ds_read_b64_tr_b16 v[218:219], v19 offset:2560
    ds_read_b64_tr_b16 v[220:221], v19 offset:3072
    ds_read_b64_tr_b16 v[222:223], v19 offset:3584
    s_waitcnt lgkmcnt(0)
    v_mfma_f32_16x16x32_bf16 v[232:235], v[208:211], v[32:35], 0
    v_mfma_f32_16x16x32_bf16 v[232:235], v[212:215], v[36:39], v[232:235]
    v_mfma_f32_16x16x32_bf16 v[232:235], v[216:219], v[40:43], v[232:235]
    v_mfma_f32_16x16x32_bf16 v[232:235], v[220:223], v[44:47], v[232:235]
    v_cndmask_b32 v224, v247, v224, s[40:41]
    v_cndmask_b32 v225, v247, v225, s[42:43]
    v_cndmask_b32 v226, v247, v226, s[44:45]
    v_cndmask_b32 v227, v247, v227, s[46:47]
    v_cndmask_b32 v228, v247, v228, s[48:49]
    v_cndmask_b32 v229, v247, v229, s[50:51]
    v_cndmask_b32 v230, v247, v230, s[52:53]
    v_cndmask_b32 v231, v247, v231, s[54:55]
    v_max3_f32 v242, v224, v225, v226
    v_max3_f32 v243, v227, v228, v229
    v_max3_f32 v242, v242, v230, v231
    v_max3_f32 v243, v243, v232, v233
    v_max_f32 v242, v242, v243
    v_mov_b32 v243, v242
    s_nop 1
    v_permlane16_swap_b32 v242, v243
    v_max_f32 v242, v242, v243
    v_mov_b32 v243, v242
    s_nop 1
    v_permlane32_swap_b32 v242, v243
    v_max_f32 v242, v242, v243
    v_mul_f32 v242, s56, v242
    v_fma_f32 v224, v224, s56, -v242
    v_fma_f32 v225, v225, s56, -v242
    v_fma_f32 v226, v226, s56, -v242
    v_fma_f32 v227, v227, s56, -v242
    v_fma_f32 v228, v228, s56, -v242
    v_fma_f32 v229, v229, s56, -v242
    v_fma_f32 v230, v230, s56, -v242
    v_fma_f32 v231, v231, s56, -v242
    v_fma_f32 v232, v232, s56, -v242
    v_fma_f32 v233, v233, s56, -v242
    v_exp_f32 v224, v224
    v_exp_f32 v225, v225
    v_exp_f32 v226, v226
    v_exp_f32 v227, v227
    v_exp_f32 v228, v228
    v_exp_f32 v229, v229
    v_exp_f32 v230, v230
    v_exp_f32 v231, v231
    v_exp_f32 v232, v232
    v_exp_f32 v233, v233
    v_cvt_pk_bf16_f32 v236, v224, v225
    v_cvt_pk_bf16_f32 v237, v226, v227
    v_cvt_pk_bf16_f32 v238, v228, v229
    v_cvt_pk_bf16_f32 v239, v230, v231
    v_cvt_pk_bf16_f32 v240, v232, v233
    v_add_f32 v244, v224, v225
    v_add_f32 v244, v244, v226
    v_add_f32 v244, v244, v227
    v_add_f32 v244, v244, v228
    v_add_f32 v244, v244, v229
    v_add_f32 v244, v244, v230
    v_add_f32 v244, v244, v231
    v_add_f32 v244, v244, v232
    v_add_f32 v244, v244, v233
    v_mov_b32 v245, v244
    s_nop 1
    v_permlane16_swap_b32 v244, v245
    v_add_f32 v244, v244, v245
    v_mov_b32 v245, v244
    s_nop 1
    v_permlane32_swap_b32 v244, v245
    v_add_f32 v244, v244, v245
    v_rcp_f32 v244, v244
    v_mfma_f32_16x16x32_bf16 v[128:131], v[160:163], v[236:239], 0
    v_mfma_f32_16x16x32_bf16 v[132:135], v[164:167], v[236:239], 0
    v_mfma_f32_16x16x32_bf16 v[136:139], v[168:171], v[236:239], 0
    v_mfma_f32_16x16x32_bf16 v[140:143], v[172:175], v[236:239], 0
    v_mfma_f32_16x16x32_bf16 v[144:147], v[176:179], v[236:239], 0
    v_mfma_f32_16x16x32_bf16 v[148:151], v[180:183], v[236:239], 0
    v_mfma_f32_16x16x32_bf16 v[152:155], v[184:187], v[236:239], 0
    v_mfma_f32_16x16x32_bf16 v[156:159], v[188:191], v[236:239], 0
    v_mov_b32 v248, v194
    s_nop 1
    v_mfma_f32_16x16x16_bf16 v[128:131], v[248:249], v[240:241], v[128:131]
    v_mov_b32 v248, v195
    s_nop 1
    v_mfma_f32_16x16x16_bf16 v[132:135], v[248:249], v[240:241], v[132:135]
    v_mov_b32 v248, v198
    s_nop 1
    v_mfma_f32_16x16x16_bf16 v[136:139], v[248:249], v[240:241], v[136:139]
    v_mov_b32 v248, v199
    s_nop 1
    v_mfma_f32_16x16x16_bf16 v[140:143], v[248:249], v[240:241], v[140:143]
    v_mov_b32 v248, v202
    s_nop 1
    v_mfma_f32_16x16x16_bf16 v[144:147], v[248:249], v[240:241], v[144:147]
    v_mov_b32 v248, v203
    s_nop 1
    v_mfma_f32_16x16x16_bf16 v[148:151], v[248:249], v[240:241], v[148:151]
    v_mov_b32 v248, v206
    s_nop 1
    v_mfma_f32_16x16x16_bf16 v[152:155], v[248:249], v[240:241], v[152:155]
    v_mov_b32 v248, v207
    s_nop 1
    v_mfma_f32_16x16x16_bf16 v[156:159], v[248:249], v[240:241], v[156:159]
    v_mul_f32 v128, v128, v244
    v_mul_f32 v129, v129, v244
    v_mul_f32 v130, v130, v244
    v_mul_f32 v131, v131, v244
    v_mul_f32 v132, v132, v244
    v_mul_f32 v133, v133, v244
    v_mul_f32 v134, v134, v244
    v_mul_f32 v135, v135, v244
    v_mul_f32 v136, v136, v244
    v_mul_f32 v137, v137, v244
    v_mul_f32 v138, v138, v244
    v_mul_f32 v139, v139, v244
    v_mul_f32 v140, v140, v244
    v_mul_f32 v141, v141, v244
    v_mul_f32 v142, v142, v244
    v_mul_f32 v143, v143, v244
    v_mul_f32 v144, v144, v244
    v_mul_f32 v145, v145, v244
    v_mul_f32 v146, v146, v244
    v_mul_f32 v147, v147, v244
    v_mul_f32 v148, v148, v244
    v_mul_f32 v149, v149, v244
    v_mul_f32 v150, v150, v244
    v_mul_f32 v151, v151, v244
    v_mul_f32 v152, v152, v244
    v_mul_f32 v153, v153, v244
    v_mul_f32 v154, v154, v244
    v_mul_f32 v155, v155, v244
    v_mul_f32 v156, v156, v244
    v_mul_f32 v157, v157, v244
    v_mul_f32 v158, v158, v244
    v_mul_f32 v159, v159, v244
    v_cvt_pk_bf16_f32 v112, v128, v129
    v_cvt_pk_bf16_f32 v113, v130, v131
    v_cvt_pk_bf16_f32 v114, v132, v133
    v_cvt_pk_bf16_f32 v115, v134, v135
    global_store_dwordx4 v1, v[112:115], s[64:65] offset:0 sc1
    v_cvt_pk_bf16_f32 v116, v136, v137
    v_cvt_pk_bf16_f32 v117, v138, v139
    v_cvt_pk_bf16_f32 v118, v140, v141
    v_cvt_pk_bf16_f32 v119, v142, v143
    global_store_dwordx4 v1, v[116:119], s[64:65] offset:1024 sc1
    v_cvt_pk_bf16_f32 v120, v144, v145
    v_cvt_pk_bf16_f32 v121, v146, v147
    v_cvt_pk_bf16_f32 v122, v148, v149
    v_cvt_pk_bf16_f32 v123, v150, v151
    global_store_dwordx4 v1, v[120:123], s[64:65] offset:2048 sc1
    v_cvt_pk_bf16_f32 v124, v152, v153
    v_cvt_pk_bf16_f32 v125, v154, v155
    v_cvt_pk_bf16_f32 v126, v156, v157
    v_cvt_pk_bf16_f32 v127, v158, v159
    global_store_dwordx4 v1, v[124:127], s[64:65] offset:3072 sc1
    s_add_u32 s64, s64, 0x80000
    s_addc_u32 s65, s65, 0
    s_add_u32 s20, s20, 1
    s_cmp_lt_u32 s20, 32
    s_cbranch_scc1 L_Q_loop
    s_waitcnt vmcnt(0)
    s_barrier
    s_mov_b32 s23, 32
    s_cmp_eq_u32 s6, 0
    s_cbranch_scc0 LPUB_94
    v_mov_b32 v8, s23
    v_mov_b32 v9, 0
    s_mov_b64 exec, 1
    global_store_dword v9, v8, s[14:15] sc1
    s_mov_b64 exec, -1
LPUB_94:
    s_branch L_end
L_fail:
    s_nop 0
L_end:
    s_endpgm
L_code_end:
.section .rodata,"a"
.p2align 6
.amdhsa_kernel gated_mix__memory_aug_recurrent_mem_tr__memory_aug_recurrent_mem_tr__prompt_kernel
  .amdhsa_next_free_vgpr 512
  .amdhsa_next_free_sgpr 102
  .amdhsa_accum_offset 256
  .amdhsa_group_segment_fixed_size 0
  .amdhsa_kernarg_size 144
  .amdhsa_user_sgpr_count 2
  .amdhsa_user_sgpr_kernarg_segment_ptr 1
  .amdhsa_system_sgpr_workgroup_id_x 1
.end_amdhsa_kernel
```
